```python
import torch

def _softmax(x, axis=-1):
    return torch.softmax(x, dim=axis)

def _gelu(x):
    return torch.nn.functional.gelu(x, approximate='tanh')

def _silu(x):
    return torch.nn.functional.silu(x)

def _sigmoid(x):
    return torch.sigmoid(x)

def _layernorm(x, axis=-1, eps=1e-05):
    m = x.mean(dim=axis, keepdim=True)
    v = x.var(dim=axis, keepdim=True, unbiased=False)
    return (x - m) / torch.sqrt(v + eps)

def _scatter_add(tgt, idx, src, axis=0):
    return tgt.clone().index_add_(axis, idx, src)

def _segment_sum(src, seg, n):
    out = torch.zeros((n,) + src.shape[1:], dtype=src.dtype)
    return out.index_add_(0, seg, src)

def _pad(x, pw):
    flat = tuple((v for pair in reversed(pw) for v in pair))
    return torch.nn.functional.pad(x, flat)
kernel_name = 'interleave_layers__memory_aug_recurrent_mem_tr__sliding_local_dilated__prompt'

def setup_inputs():

    _w = lambda a: (lambda t: t.to(torch.bfloat16) if t.is_floating_point() else t)(torch.as_tensor(a))

    def _A_setup():
        B, S, Dm = (1, 2048, 512)
        H, Dh = (32, 128)
        M, seg = (8, 32)
        seg = min(seg, S)
        S = S // seg * seg
        return {'x': _w((lambda *s: torch.randn(*s, dtype=torch.bfloat16) * 0.05)(B, S, Dm)), 'mem0': _w((lambda *s: torch.randn(*s, dtype=torch.bfloat16) * 0.8)(B, M, Dm)), 'Wq': _w((lambda *s: torch.randn(*s, dtype=torch.bfloat16) * 0.8)(Dm, H, Dh) * Dm ** (-0.5)), 'Wk': _w((lambda *s: torch.randn(*s, dtype=torch.bfloat16) * 0.8)(Dm, H, Dh) * Dm ** (-0.5)), 'Wv': _w((lambda *s: torch.randn(*s, dtype=torch.bfloat16) * 0.8)(Dm, H, Dh) * Dm ** (-0.5)), 'Wo': _w((lambda *s: torch.randn(*s, dtype=torch.bfloat16) * 0.8)(H, Dh, Dm) * (H * Dh) ** (-0.5)), 'seg_len': seg}
    _A_in = _A_setup()

    def _B_setup():
        B, S, D = (1, 2048, 512)
        return {'x': _w((lambda *s: torch.randn(*s, dtype=torch.bfloat16) * 0.05)(B, S, D)), 'wqkv': _w((lambda *s: torch.randn(*s, dtype=torch.bfloat16) * 0.05)(D, 3 * D)), 'wo': _w((lambda *s: torch.randn(*s, dtype=torch.bfloat16) * 0.05)(D, D))}
    _B_in = _B_setup()
    return {'A_x': _A_in['x'], 'A_mem0': _A_in['mem0'], 'A_Wq': _A_in['Wq'], 'A_Wk': _A_in['Wk'], 'A_Wv': _A_in['Wv'], 'A_Wo': _A_in['Wo'], 'A_seg_len': _A_in['seg_len'], 'B_x': _B_in['x'], 'B_wqkv': _B_in['wqkv'], 'B_wo': _B_in['wo']}

def reference(A_x, A_mem0, A_Wq, A_Wk, A_Wv, A_Wo, A_seg_len, B_x, B_wqkv, B_wo):

    def _A_ref(x, mem0, Wq, Wk, Wv, Wo, seg_len):
        B, S, Dm = x.shape
        H, Dh = (Wq.shape[1], Wq.shape[2])
        M = mem0.shape[1]
        scale = Dh ** (-0.5)
        n_seg = S // seg_len
        L = M + seg_len
        idx = torch.arange(L)
        mask = (idx[:, None] < M) | (idx[:, None] >= idx[None, :])
        mem = mem0
        outs = []
        for s in range(n_seg):
            xs = x[:, s * seg_len:(s + 1) * seg_len, :].clone()
            h = torch.concatenate([mem, xs], axis=1)
            q = torch.einsum('btd,dhe->bhte', h, Wq)
            k = torch.einsum('btd,dhe->bhte', h, Wk)
            v = torch.einsum('btd,dhe->bhte', h, Wv)
            scores = torch.einsum('bhqe,bhke->bhqk', q, k) * scale
            scores = torch.where(mask[None, None], scores, -1000000000.0)
            p = _softmax(scores, axis=-1)
            o = torch.einsum('bhqk,bhke->bhqe', p, v)
            o = torch.einsum('bhte,hed->btd', o, Wo)
            mem = o[:, :M, :].clone()
            outs.append(o[:, M:, :])
        return torch.concatenate(outs, axis=1)

    def _B_ref(x, wqkv, wo):
        B, S, D = x.shape
        H = 32
        Dh = D // H
        W, dil = (8, 2)
        qkv = (lambda x, *d: x.permute(*d))((x @ wqkv).reshape(B, S, 3, H, Dh), 2, 0, 3, 1, 4)
        q, k, v = (qkv[0], qkv[1], qkv[2])
        scale = Dh ** (-0.5)
        pos = torch.arange(S)
        off = torch.arange(W) * dil
        idx = pos[:, None] - off[None, :]
        mask = idx >= 0
        idx_c = torch.where(mask, idx, 0).reshape(-1)
        kg = k[:, :, idx_c, :].reshape(B, H, S, W, Dh)
        vg = v[:, :, idx_c, :].reshape(B, H, S, W, Dh)
        logits = torch.einsum('bhsd,bhswd->bhsw', q, kg) * scale
        logits = torch.where(mask[None, None, :, :], logits, -1000000000.0)
        attn = _softmax(logits, axis=-1)
        o = torch.einsum('bhsw,bhswd->bhsd', attn, vg)
        return (lambda x, *d: x.permute(*d))(o, 0, 2, 1, 3).reshape(B, S, D) @ wo
    x = A_x
    x = x + _A_ref(_layernorm(x, axis=-1), A_mem0, A_Wq, A_Wk, A_Wv, A_Wo, A_seg_len)
    x = x + _B_ref(_layernorm(x, axis=-1), B_wqkv, B_wo)
    x = x + _A_ref(_layernorm(x, axis=-1), A_mem0, A_Wq, A_Wk, A_Wv, A_Wo, A_seg_len)
    x = x + _B_ref(_layernorm(x, axis=-1), B_wqkv, B_wo)
    return x
```

```asm
; @launch grid=(256,1,1) block=(256,1,1) lds=163840
.amdgcn_target "amdgcn-amd-amdhsa--gfx950"
.text
.globl interleave_layers__memory_aug_recurrent_mem_tr__sliding_local_dilated__prompt_kernel
.p2align 8
.type interleave_layers__memory_aug_recurrent_mem_tr__sliding_local_dilated__prompt_kernel,@function
interleave_layers__memory_aug_recurrent_mem_tr__sliding_local_dilated__prompt_kernel:
ENTRY:
s_cmp_ge_u32 s2, 256
s_cbranch_scc1 DONE
s_load_dwordx4 s[8:11], s[0:1], 88
s_getreg_b32 s91, hwreg(HW_REG_XCC_ID, 0, 4)
v_lshrrev_b32 v1, 6, v0
s_nop 0
v_readfirstlane_b32 s19, v1
v_and_b32 v0, 63, v0
s_and_b32 s91, s91, 7
s_waitcnt lgkmcnt(0)
s_mov_b32 s12, s10
s_mov_b32 s13, s11
s_mov_b32 s14, 268435456
s_mov_b32 s15, 0x20000
v_mov_b64 v[126:127], 0
s_cmp_lg_u32 s19, 0
s_cbranch_scc1 NORANK
s_and_b32 s21, s91, 3
s_lshl_b32 s21, s21, 6
s_lshr_b32 s22, s91, 2
s_lshl_b32 s22, s22, 3
s_add_u32 s21, s21, s22
s_lshr_b32 s22, s2, 3
s_lshl_b32 s22, 1, s22
v_mov_b32 v2, s21
v_mov_b32 v4, s22
v_mov_b32 v5, 0x100
s_mov_b64 exec, 1
global_atomic_add_x2 v[126:127], v2, v[4:5], s[8:9] sc0
s_mov_b64 exec, -1
NORANK:
s_lshr_b32 s22, s2, 3
s_lshl_b32 s21, s91, 5
s_add_u32 s21, s21, s22
s_lshr_b32 s22, s21, 5
s_lshl_b32 s22, s22, 2
s_lshr_b32 s22, 0x76541302, s22
s_and_b32 s22, s22, 7
s_lshl_b32 s22, s22, 5
s_and_b32 s90, s21, 31
s_or_b32 s90, s90, s22
s_mov_b32 s92, 0
s_branch DISPATCH
REROLE:
s_waitcnt vmcnt(0) lgkmcnt(0)
s_barrier
s_lshr_b32 s21, s89, 8
v_mov_b32 v60, 32512
s_cmp_lg_u32 s19, 0
s_cbranch_scc1 BC_1
v_mov_b32 v61, s21
ds_write_b32 v60, v61
s_waitcnt lgkmcnt(0)
BC_1:
s_barrier
ds_read_b32 v61, v60
s_waitcnt lgkmcnt(0)
v_readfirstlane_b32 s21, v61
s_barrier
s_add_u32 s65, s65, s21
s_lshr_b32 s22, s65, 5
s_lshl_b32 s22, s22, 2
s_lshr_b32 s22, 0x76541302, s22
s_and_b32 s22, s22, 7
s_lshl_b32 s22, s22, 5
s_and_b32 s90, s65, 31
s_or_b32 s90, s90, s22
s_mov_b32 s18, s66
s_mov_b32 s92, 1
v_mbcnt_lo_u32_b32 v0, -1, 0
v_mbcnt_hi_u32_b32 v0, -1, v0
DISPATCH:
s_mov_b32 s21, s90
s_cmp_ge_u32 s21, 160
s_cbranch_scc1 ROLE_P
s_cmp_ge_u32 s21, 64
s_cbranch_scc1 ROLE_WB
s_and_b32 s16, s21, 31
s_lshr_b32 s17, s21, 5
v_and_b32 v1, 15, v0
v_lshrrev_b32 v2, 4, v0
v_lshrrev_b32 v6, 1, v2
v_and_b32_e64 v7, 1, v2
v_lshlrev_b32_e64 v8, 17, v6
v_lshl_add_u32 v8, v7, 15, v8
v_lshl_add_u32 v3, v1, 3, v8
v_and_b32_e64 v9, 14, v1
v_lshl_add_u32 v4, v9, 2, v8
v_and_b32_e64 v9, 1, v1
v_lshl_add_u32 v4, v9, 18, v4
v_lshlrev_b32 v8, 15, v7
v_lshl_add_u32 v8, v6, 13, v8
v_lshl_add_u32 v5, v1, 3, v8
s_lshl_b32 s3, s19, 15
s_add_u32 s3, s3, 32768
v_lshl_add_u32 v6, v0, 4, s3
s_load_dwordx4 s[40:43], s[0:1], 16
s_load_dwordx4 s[44:47], s[0:1], 32
s_waitcnt lgkmcnt(0)
s_cmp_lt_u32 s19, 2
s_cselect_b32 s4, s40, s42
s_cselect_b32 s5, s41, s43
s_mov_b32 s6, 0x400000
s_mov_b32 s7, 0x20000
s_mov_b32 s8, s44
s_mov_b32 s9, s45
s_mov_b32 s10, 0x400000
s_mov_b32 s11, 0x20000
s_mov_b32 s48, s46
s_mov_b32 s49, s47
s_mov_b32 s50, 0x400000
s_mov_b32 s51, 0x20000
s_lshl_b32 s20, s16, 8
s_and_b32 s21, s19, 1
s_lshl_b32 s21, s21, 7
s_add_u32 s21, s21, s20
s_lshl_b32 s22, s19, 6
s_add_u32 s22, s22, s20
s_lshl_b32 s23, s16, 17
s_lshl_b32 s24, s19, 8
s_add_u32 s23, s23, s24
s_and_b32 s24, s19, 0
s_lshl_b32 s24, s24, 7
s_add_u32 s23, s23, s24
s_xor_b32 s29, s23, 128
s_mov_b32 s26, 0x05040100
s_mov_b32 s27, 0x07060302
s_mov_b32 s30, 0x55555555
s_mov_b32 s31, 0x55555555
s_lshl_b32 s28, s19, 1
s_add_u32 s28, s28, 0
s_and_b32 s28, s28, 7
s_lshl_b32 s28, s28, 19
s_add_u32 s28, s28, s21
s_add_u32 s25, s28, 0
buffer_load_dwordx2 v[16:17], v3, s[4:7], s25 offen
s_add_u32 s25, s28, 8192
buffer_load_dwordx2 v[18:19], v3, s[4:7], s25 offen
s_add_u32 s25, s28, 65536
buffer_load_dwordx2 v[20:21], v3, s[4:7], s25 offen
s_add_u32 s25, s28, 73728
buffer_load_dwordx2 v[22:23], v3, s[4:7], s25 offen
s_add_u32 s25, s28, 16384
buffer_load_dwordx2 v[24:25], v3, s[4:7], s25 offen
s_add_u32 s25, s28, 24576
buffer_load_dwordx2 v[26:27], v3, s[4:7], s25 offen
s_add_u32 s25, s28, 81920
buffer_load_dwordx2 v[28:29], v3, s[4:7], s25 offen
s_add_u32 s25, s28, 90112
buffer_load_dwordx2 v[30:31], v3, s[4:7], s25 offen
s_add_u32 s25, s28, 262144
buffer_load_dwordx2 v[32:33], v3, s[4:7], s25 offen
s_add_u32 s25, s28, 270336
buffer_load_dwordx2 v[34:35], v3, s[4:7], s25 offen
s_add_u32 s25, s28, 327680
buffer_load_dwordx2 v[36:37], v3, s[4:7], s25 offen
s_add_u32 s25, s28, 335872
buffer_load_dwordx2 v[38:39], v3, s[4:7], s25 offen
s_add_u32 s25, s28, 278528
buffer_load_dwordx2 v[40:41], v3, s[4:7], s25 offen
s_add_u32 s25, s28, 286720
buffer_load_dwordx2 v[42:43], v3, s[4:7], s25 offen
s_add_u32 s25, s28, 344064
buffer_load_dwordx2 v[44:45], v3, s[4:7], s25 offen
s_add_u32 s25, s28, 352256
buffer_load_dwordx2 v[46:47], v3, s[4:7], s25 offen
s_lshl_b32 s28, s19, 1
s_add_u32 s28, s28, 1
s_and_b32 s28, s28, 7
s_lshl_b32 s28, s28, 19
s_add_u32 s28, s28, s21
s_add_u32 s25, s28, 0
buffer_load_dwordx2 v[48:49], v3, s[4:7], s25 offen
s_add_u32 s25, s28, 8192
buffer_load_dwordx2 v[50:51], v3, s[4:7], s25 offen
s_add_u32 s25, s28, 65536
buffer_load_dwordx2 v[52:53], v3, s[4:7], s25 offen
s_add_u32 s25, s28, 73728
buffer_load_dwordx2 v[54:55], v3, s[4:7], s25 offen
s_add_u32 s25, s28, 16384
buffer_load_dwordx2 v[56:57], v3, s[4:7], s25 offen
s_add_u32 s25, s28, 24576
buffer_load_dwordx2 v[58:59], v3, s[4:7], s25 offen
s_add_u32 s25, s28, 81920
buffer_load_dwordx2 v[60:61], v3, s[4:7], s25 offen
s_add_u32 s25, s28, 90112
buffer_load_dwordx2 v[62:63], v3, s[4:7], s25 offen
s_add_u32 s25, s28, 262144
buffer_load_dwordx2 v[64:65], v3, s[4:7], s25 offen
s_add_u32 s25, s28, 270336
buffer_load_dwordx2 v[66:67], v3, s[4:7], s25 offen
s_add_u32 s25, s28, 327680
buffer_load_dwordx2 v[68:69], v3, s[4:7], s25 offen
s_add_u32 s25, s28, 335872
buffer_load_dwordx2 v[70:71], v3, s[4:7], s25 offen
s_add_u32 s25, s28, 278528
buffer_load_dwordx2 v[72:73], v3, s[4:7], s25 offen
s_add_u32 s25, s28, 286720
buffer_load_dwordx2 v[74:75], v3, s[4:7], s25 offen
s_add_u32 s25, s28, 344064
buffer_load_dwordx2 v[76:77], v3, s[4:7], s25 offen
s_add_u32 s25, s28, 352256
buffer_load_dwordx2 v[78:79], v3, s[4:7], s25 offen
s_cmp_eq_u32 s92, 1
s_cbranch_scc1 SR_2
s_waitcnt vmcnt(32)
v_readfirstlane_b32 s89, v127
SR_2:
s_lshl_b32 s28, s19, 1
s_add_u32 s28, s28, 2
s_and_b32 s28, s28, 7
s_lshl_b32 s28, s28, 19
s_add_u32 s28, s28, s21
s_add_u32 s25, s28, 0
buffer_load_dwordx2 v[80:81], v3, s[4:7], s25 offen
s_add_u32 s25, s28, 8192
buffer_load_dwordx2 v[82:83], v3, s[4:7], s25 offen
s_add_u32 s25, s28, 65536
buffer_load_dwordx2 v[84:85], v3, s[4:7], s25 offen
s_add_u32 s25, s28, 73728
buffer_load_dwordx2 v[86:87], v3, s[4:7], s25 offen
s_add_u32 s25, s28, 16384
buffer_load_dwordx2 v[88:89], v3, s[4:7], s25 offen
s_add_u32 s25, s28, 24576
buffer_load_dwordx2 v[90:91], v3, s[4:7], s25 offen
s_add_u32 s25, s28, 81920
buffer_load_dwordx2 v[92:93], v3, s[4:7], s25 offen
s_add_u32 s25, s28, 90112
buffer_load_dwordx2 v[94:95], v3, s[4:7], s25 offen
s_add_u32 s25, s28, 262144
buffer_load_dwordx2 v[96:97], v3, s[4:7], s25 offen
s_add_u32 s25, s28, 270336
buffer_load_dwordx2 v[98:99], v3, s[4:7], s25 offen
s_add_u32 s25, s28, 327680
buffer_load_dwordx2 v[100:101], v3, s[4:7], s25 offen
s_add_u32 s25, s28, 335872
buffer_load_dwordx2 v[102:103], v3, s[4:7], s25 offen
s_add_u32 s25, s28, 278528
buffer_load_dwordx2 v[104:105], v3, s[4:7], s25 offen
s_add_u32 s25, s28, 286720
buffer_load_dwordx2 v[106:107], v3, s[4:7], s25 offen
s_add_u32 s25, s28, 344064
buffer_load_dwordx2 v[108:109], v3, s[4:7], s25 offen
s_add_u32 s25, s28, 352256
buffer_load_dwordx2 v[110:111], v3, s[4:7], s25 offen
s_waitcnt vmcnt(46)
v_perm_b32 v8, v18, v16, s26
s_waitcnt vmcnt(44)
v_perm_b32 v9, v22, v20, s26
s_waitcnt vmcnt(42)
v_perm_b32 v10, v26, v24, s26
s_waitcnt vmcnt(40)
v_perm_b32 v11, v30, v28, s26
s_waitcnt vmcnt(38)
v_perm_b32 v12, v34, v32, s26
s_waitcnt vmcnt(36)
v_perm_b32 v13, v38, v36, s26
s_waitcnt vmcnt(34)
v_perm_b32 v14, v42, v40, s26
s_waitcnt vmcnt(32)
v_perm_b32 v15, v46, v44, s26
ds_write_b128 v6, v[8:11] offset:0
ds_write_b128 v6, v[12:15] offset:1024
v_perm_b32 v8, v18, v16, s27
v_perm_b32 v9, v22, v20, s27
v_perm_b32 v10, v26, v24, s27
v_perm_b32 v11, v30, v28, s27
v_perm_b32 v12, v34, v32, s27
v_perm_b32 v13, v38, v36, s27
v_perm_b32 v14, v42, v40, s27
v_perm_b32 v15, v46, v44, s27
ds_write_b128 v6, v[8:11] offset:2048
ds_write_b128 v6, v[12:15] offset:3072
v_perm_b32 v8, v19, v17, s26
v_perm_b32 v9, v23, v21, s26
v_perm_b32 v10, v27, v25, s26
v_perm_b32 v11, v31, v29, s26
v_perm_b32 v12, v35, v33, s26
v_perm_b32 v13, v39, v37, s26
v_perm_b32 v14, v43, v41, s26
v_perm_b32 v15, v47, v45, s26
ds_write_b128 v6, v[8:11] offset:4096
ds_write_b128 v6, v[12:15] offset:5120
v_perm_b32 v8, v19, v17, s27
v_perm_b32 v9, v23, v21, s27
v_perm_b32 v10, v27, v25, s27
v_perm_b32 v11, v31, v29, s27
v_perm_b32 v12, v35, v33, s27
v_perm_b32 v13, v39, v37, s27
v_perm_b32 v14, v43, v41, s27
v_perm_b32 v15, v47, v45, s27
ds_write_b128 v6, v[8:11] offset:6144
ds_write_b128 v6, v[12:15] offset:7168
s_lshl_b32 s28, s19, 1
s_add_u32 s28, s28, 3
s_and_b32 s28, s28, 7
s_lshl_b32 s28, s28, 19
s_add_u32 s28, s28, s21
s_add_u32 s25, s28, 0
buffer_load_dwordx2 v[16:17], v3, s[4:7], s25 offen
s_add_u32 s25, s28, 8192
buffer_load_dwordx2 v[18:19], v3, s[4:7], s25 offen
s_add_u32 s25, s28, 65536
buffer_load_dwordx2 v[20:21], v3, s[4:7], s25 offen
s_add_u32 s25, s28, 73728
buffer_load_dwordx2 v[22:23], v3, s[4:7], s25 offen
s_add_u32 s25, s28, 16384
buffer_load_dwordx2 v[24:25], v3, s[4:7], s25 offen
s_add_u32 s25, s28, 24576
buffer_load_dwordx2 v[26:27], v3, s[4:7], s25 offen
s_add_u32 s25, s28, 81920
buffer_load_dwordx2 v[28:29], v3, s[4:7], s25 offen
s_add_u32 s25, s28, 90112
buffer_load_dwordx2 v[30:31], v3, s[4:7], s25 offen
s_add_u32 s25, s28, 262144
buffer_load_dwordx2 v[32:33], v3, s[4:7], s25 offen
s_add_u32 s25, s28, 270336
buffer_load_dwordx2 v[34:35], v3, s[4:7], s25 offen
s_add_u32 s25, s28, 327680
buffer_load_dwordx2 v[36:37], v3, s[4:7], s25 offen
s_add_u32 s25, s28, 335872
buffer_load_dwordx2 v[38:39], v3, s[4:7], s25 offen
s_add_u32 s25, s28, 278528
buffer_load_dwordx2 v[40:41], v3, s[4:7], s25 offen
s_add_u32 s25, s28, 286720
buffer_load_dwordx2 v[42:43], v3, s[4:7], s25 offen
s_add_u32 s25, s28, 344064
buffer_load_dwordx2 v[44:45], v3, s[4:7], s25 offen
s_add_u32 s25, s28, 352256
buffer_load_dwordx2 v[46:47], v3, s[4:7], s25 offen
s_waitcnt vmcnt(46)
v_perm_b32 v8, v50, v48, s26
s_waitcnt vmcnt(44)
v_perm_b32 v9, v54, v52, s26
s_waitcnt vmcnt(42)
v_perm_b32 v10, v58, v56, s26
s_waitcnt vmcnt(40)
v_perm_b32 v11, v62, v60, s26
s_waitcnt vmcnt(38)
v_perm_b32 v12, v66, v64, s26
s_waitcnt vmcnt(36)
v_perm_b32 v13, v70, v68, s26
s_waitcnt vmcnt(34)
v_perm_b32 v14, v74, v72, s26
s_waitcnt vmcnt(32)
v_perm_b32 v15, v78, v76, s26
ds_write_b128 v6, v[8:11] offset:8192
ds_write_b128 v6, v[12:15] offset:9216
v_perm_b32 v8, v50, v48, s27
v_perm_b32 v9, v54, v52, s27
v_perm_b32 v10, v58, v56, s27
v_perm_b32 v11, v62, v60, s27
v_perm_b32 v12, v66, v64, s27
v_perm_b32 v13, v70, v68, s27
v_perm_b32 v14, v74, v72, s27
v_perm_b32 v15, v78, v76, s27
ds_write_b128 v6, v[8:11] offset:10240
ds_write_b128 v6, v[12:15] offset:11264
v_perm_b32 v8, v51, v49, s26
v_perm_b32 v9, v55, v53, s26
v_perm_b32 v10, v59, v57, s26
v_perm_b32 v11, v63, v61, s26
v_perm_b32 v12, v67, v65, s26
v_perm_b32 v13, v71, v69, s26
v_perm_b32 v14, v75, v73, s26
v_perm_b32 v15, v79, v77, s26
v_accvgpr_write_b32 a0, v8
v_accvgpr_write_b32 a1, v9
v_accvgpr_write_b32 a2, v10
v_accvgpr_write_b32 a3, v11
v_accvgpr_write_b32 a4, v12
v_accvgpr_write_b32 a5, v13
v_accvgpr_write_b32 a6, v14
v_accvgpr_write_b32 a7, v15
v_perm_b32 v8, v51, v49, s27
v_perm_b32 v9, v55, v53, s27
v_perm_b32 v10, v59, v57, s27
v_perm_b32 v11, v63, v61, s27
v_perm_b32 v12, v67, v65, s27
v_perm_b32 v13, v71, v69, s27
v_perm_b32 v14, v75, v73, s27
v_perm_b32 v15, v79, v77, s27
v_accvgpr_write_b32 a8, v8
v_accvgpr_write_b32 a9, v9
v_accvgpr_write_b32 a10, v10
v_accvgpr_write_b32 a11, v11
v_accvgpr_write_b32 a12, v12
v_accvgpr_write_b32 a13, v13
v_accvgpr_write_b32 a14, v14
v_accvgpr_write_b32 a15, v15
s_lshl_b32 s28, s19, 1
s_add_u32 s28, s28, 4
s_and_b32 s28, s28, 7
s_lshl_b32 s28, s28, 19
s_add_u32 s28, s28, s21
s_add_u32 s25, s28, 0
buffer_load_dwordx2 v[48:49], v3, s[4:7], s25 offen
s_add_u32 s25, s28, 8192
buffer_load_dwordx2 v[50:51], v3, s[4:7], s25 offen
s_add_u32 s25, s28, 65536
buffer_load_dwordx2 v[52:53], v3, s[4:7], s25 offen
s_add_u32 s25, s28, 73728
buffer_load_dwordx2 v[54:55], v3, s[4:7], s25 offen
s_add_u32 s25, s28, 16384
buffer_load_dwordx2 v[56:57], v3, s[4:7], s25 offen
s_add_u32 s25, s28, 24576
buffer_load_dwordx2 v[58:59], v3, s[4:7], s25 offen
s_add_u32 s25, s28, 81920
buffer_load_dwordx2 v[60:61], v3, s[4:7], s25 offen
s_add_u32 s25, s28, 90112
buffer_load_dwordx2 v[62:63], v3, s[4:7], s25 offen
s_add_u32 s25, s28, 262144
buffer_load_dwordx2 v[64:65], v3, s[4:7], s25 offen
s_add_u32 s25, s28, 270336
buffer_load_dwordx2 v[66:67], v3, s[4:7], s25 offen
s_add_u32 s25, s28, 327680
buffer_load_dwordx2 v[68:69], v3, s[4:7], s25 offen
s_add_u32 s25, s28, 335872
buffer_load_dwordx2 v[70:71], v3, s[4:7], s25 offen
s_add_u32 s25, s28, 278528
buffer_load_dwordx2 v[72:73], v3, s[4:7], s25 offen
s_add_u32 s25, s28, 286720
buffer_load_dwordx2 v[74:75], v3, s[4:7], s25 offen
s_add_u32 s25, s28, 344064
buffer_load_dwordx2 v[76:77], v3, s[4:7], s25 offen
s_add_u32 s25, s28, 352256
buffer_load_dwordx2 v[78:79], v3, s[4:7], s25 offen
s_waitcnt vmcnt(46)
v_perm_b32 v8, v82, v80, s26
s_waitcnt vmcnt(44)
v_perm_b32 v9, v86, v84, s26
s_waitcnt vmcnt(42)
v_perm_b32 v10, v90, v88, s26
s_waitcnt vmcnt(40)
v_perm_b32 v11, v94, v92, s26
s_waitcnt vmcnt(38)
v_perm_b32 v12, v98, v96, s26
s_waitcnt vmcnt(36)
v_perm_b32 v13, v102, v100, s26
s_waitcnt vmcnt(34)
v_perm_b32 v14, v106, v104, s26
s_waitcnt vmcnt(32)
v_perm_b32 v15, v110, v108, s26
v_accvgpr_write_b32 a16, v8
v_accvgpr_write_b32 a17, v9
v_accvgpr_write_b32 a18, v10
v_accvgpr_write_b32 a19, v11
v_accvgpr_write_b32 a20, v12
v_accvgpr_write_b32 a21, v13
v_accvgpr_write_b32 a22, v14
v_accvgpr_write_b32 a23, v15
v_perm_b32 v8, v82, v80, s27
v_perm_b32 v9, v86, v84, s27
v_perm_b32 v10, v90, v88, s27
v_perm_b32 v11, v94, v92, s27
v_perm_b32 v12, v98, v96, s27
v_perm_b32 v13, v102, v100, s27
v_perm_b32 v14, v106, v104, s27
v_perm_b32 v15, v110, v108, s27
v_accvgpr_write_b32 a24, v8
v_accvgpr_write_b32 a25, v9
v_accvgpr_write_b32 a26, v10
v_accvgpr_write_b32 a27, v11
v_accvgpr_write_b32 a28, v12
v_accvgpr_write_b32 a29, v13
v_accvgpr_write_b32 a30, v14
v_accvgpr_write_b32 a31, v15
v_perm_b32 v8, v83, v81, s26
v_perm_b32 v9, v87, v85, s26
v_perm_b32 v10, v91, v89, s26
v_perm_b32 v11, v95, v93, s26
v_perm_b32 v12, v99, v97, s26
v_perm_b32 v13, v103, v101, s26
v_perm_b32 v14, v107, v105, s26
v_perm_b32 v15, v111, v109, s26
v_accvgpr_write_b32 a32, v8
v_accvgpr_write_b32 a33, v9
v_accvgpr_write_b32 a34, v10
v_accvgpr_write_b32 a35, v11
v_accvgpr_write_b32 a36, v12
v_accvgpr_write_b32 a37, v13
v_accvgpr_write_b32 a38, v14
v_accvgpr_write_b32 a39, v15
v_perm_b32 v8, v83, v81, s27
v_perm_b32 v9, v87, v85, s27
v_perm_b32 v10, v91, v89, s27
v_perm_b32 v11, v95, v93, s27
v_perm_b32 v12, v99, v97, s27
v_perm_b32 v13, v103, v101, s27
v_perm_b32 v14, v107, v105, s27
v_perm_b32 v15, v111, v109, s27
v_accvgpr_write_b32 a40, v8
v_accvgpr_write_b32 a41, v9
v_accvgpr_write_b32 a42, v10
v_accvgpr_write_b32 a43, v11
v_accvgpr_write_b32 a44, v12
v_accvgpr_write_b32 a45, v13
v_accvgpr_write_b32 a46, v14
v_accvgpr_write_b32 a47, v15
s_lshl_b32 s28, s19, 1
s_add_u32 s28, s28, 5
s_and_b32 s28, s28, 7
s_lshl_b32 s28, s28, 19
s_add_u32 s28, s28, s21
s_add_u32 s25, s28, 0
buffer_load_dwordx2 v[80:81], v3, s[4:7], s25 offen
s_add_u32 s25, s28, 8192
buffer_load_dwordx2 v[82:83], v3, s[4:7], s25 offen
s_add_u32 s25, s28, 65536
buffer_load_dwordx2 v[84:85], v3, s[4:7], s25 offen
s_add_u32 s25, s28, 73728
buffer_load_dwordx2 v[86:87], v3, s[4:7], s25 offen
s_add_u32 s25, s28, 16384
buffer_load_dwordx2 v[88:89], v3, s[4:7], s25 offen
s_add_u32 s25, s28, 24576
buffer_load_dwordx2 v[90:91], v3, s[4:7], s25 offen
s_add_u32 s25, s28, 81920
buffer_load_dwordx2 v[92:93], v3, s[4:7], s25 offen
s_add_u32 s25, s28, 90112
buffer_load_dwordx2 v[94:95], v3, s[4:7], s25 offen
s_add_u32 s25, s28, 262144
buffer_load_dwordx2 v[96:97], v3, s[4:7], s25 offen
s_add_u32 s25, s28, 270336
buffer_load_dwordx2 v[98:99], v3, s[4:7], s25 offen
s_add_u32 s25, s28, 327680
buffer_load_dwordx2 v[100:101], v3, s[4:7], s25 offen
s_add_u32 s25, s28, 335872
buffer_load_dwordx2 v[102:103], v3, s[4:7], s25 offen
s_add_u32 s25, s28, 278528
buffer_load_dwordx2 v[104:105], v3, s[4:7], s25 offen
s_add_u32 s25, s28, 286720
buffer_load_dwordx2 v[106:107], v3, s[4:7], s25 offen
s_add_u32 s25, s28, 344064
buffer_load_dwordx2 v[108:109], v3, s[4:7], s25 offen
s_add_u32 s25, s28, 352256
buffer_load_dwordx2 v[110:111], v3, s[4:7], s25 offen
s_waitcnt vmcnt(46)
v_perm_b32 v8, v18, v16, s26
s_waitcnt vmcnt(44)
v_perm_b32 v9, v22, v20, s26
s_waitcnt vmcnt(42)
v_perm_b32 v10, v26, v24, s26
s_waitcnt vmcnt(40)
v_perm_b32 v11, v30, v28, s26
s_waitcnt vmcnt(38)
v_perm_b32 v12, v34, v32, s26
s_waitcnt vmcnt(36)
v_perm_b32 v13, v38, v36, s26
s_waitcnt vmcnt(34)
v_perm_b32 v14, v42, v40, s26
s_waitcnt vmcnt(32)
v_perm_b32 v15, v46, v44, s26
v_accvgpr_write_b32 a48, v8
v_accvgpr_write_b32 a49, v9
v_accvgpr_write_b32 a50, v10
v_accvgpr_write_b32 a51, v11
v_accvgpr_write_b32 a52, v12
v_accvgpr_write_b32 a53, v13
v_accvgpr_write_b32 a54, v14
v_accvgpr_write_b32 a55, v15
v_perm_b32 v8, v18, v16, s27
v_perm_b32 v9, v22, v20, s27
v_perm_b32 v10, v26, v24, s27
v_perm_b32 v11, v30, v28, s27
v_perm_b32 v12, v34, v32, s27
v_perm_b32 v13, v38, v36, s27
v_perm_b32 v14, v42, v40, s27
v_perm_b32 v15, v46, v44, s27
v_accvgpr_write_b32 a56, v8
v_accvgpr_write_b32 a57, v9
v_accvgpr_write_b32 a58, v10
v_accvgpr_write_b32 a59, v11
v_accvgpr_write_b32 a60, v12
v_accvgpr_write_b32 a61, v13
v_accvgpr_write_b32 a62, v14
v_accvgpr_write_b32 a63, v15
v_perm_b32 v8, v19, v17, s26
v_perm_b32 v9, v23, v21, s26
v_perm_b32 v10, v27, v25, s26
v_perm_b32 v11, v31, v29, s26
v_perm_b32 v12, v35, v33, s26
v_perm_b32 v13, v39, v37, s26
v_perm_b32 v14, v43, v41, s26
v_perm_b32 v15, v47, v45, s26
v_accvgpr_write_b32 a64, v8
v_accvgpr_write_b32 a65, v9
v_accvgpr_write_b32 a66, v10
v_accvgpr_write_b32 a67, v11
v_accvgpr_write_b32 a68, v12
v_accvgpr_write_b32 a69, v13
v_accvgpr_write_b32 a70, v14
v_accvgpr_write_b32 a71, v15
v_perm_b32 v8, v19, v17, s27
v_perm_b32 v9, v23, v21, s27
v_perm_b32 v10, v27, v25, s27
v_perm_b32 v11, v31, v29, s27
v_perm_b32 v12, v35, v33, s27
v_perm_b32 v13, v39, v37, s27
v_perm_b32 v14, v43, v41, s27
v_perm_b32 v15, v47, v45, s27
v_accvgpr_write_b32 a72, v8
v_accvgpr_write_b32 a73, v9
v_accvgpr_write_b32 a74, v10
v_accvgpr_write_b32 a75, v11
v_accvgpr_write_b32 a76, v12
v_accvgpr_write_b32 a77, v13
v_accvgpr_write_b32 a78, v14
v_accvgpr_write_b32 a79, v15
s_lshl_b32 s28, s19, 1
s_add_u32 s28, s28, 6
s_and_b32 s28, s28, 7
s_lshl_b32 s28, s28, 19
s_add_u32 s28, s28, s21
s_add_u32 s25, s28, 0
buffer_load_dwordx2 v[16:17], v3, s[4:7], s25 offen
s_add_u32 s25, s28, 8192
buffer_load_dwordx2 v[18:19], v3, s[4:7], s25 offen
s_add_u32 s25, s28, 65536
buffer_load_dwordx2 v[20:21], v3, s[4:7], s25 offen
s_add_u32 s25, s28, 73728
buffer_load_dwordx2 v[22:23], v3, s[4:7], s25 offen
s_add_u32 s25, s28, 16384
buffer_load_dwordx2 v[24:25], v3, s[4:7], s25 offen
s_add_u32 s25, s28, 24576
buffer_load_dwordx2 v[26:27], v3, s[4:7], s25 offen
s_add_u32 s25, s28, 81920
buffer_load_dwordx2 v[28:29], v3, s[4:7], s25 offen
s_add_u32 s25, s28, 90112
buffer_load_dwordx2 v[30:31], v3, s[4:7], s25 offen
s_add_u32 s25, s28, 262144
buffer_load_dwordx2 v[32:33], v3, s[4:7], s25 offen
s_add_u32 s25, s28, 270336
buffer_load_dwordx2 v[34:35], v3, s[4:7], s25 offen
s_add_u32 s25, s28, 327680
buffer_load_dwordx2 v[36:37], v3, s[4:7], s25 offen
s_add_u32 s25, s28, 335872
buffer_load_dwordx2 v[38:39], v3, s[4:7], s25 offen
s_add_u32 s25, s28, 278528
buffer_load_dwordx2 v[40:41], v3, s[4:7], s25 offen
s_add_u32 s25, s28, 286720
buffer_load_dwordx2 v[42:43], v3, s[4:7], s25 offen
s_add_u32 s25, s28, 344064
buffer_load_dwordx2 v[44:45], v3, s[4:7], s25 offen
s_add_u32 s25, s28, 352256
buffer_load_dwordx2 v[46:47], v3, s[4:7], s25 offen
s_waitcnt vmcnt(46)
v_perm_b32 v8, v50, v48, s26
s_waitcnt vmcnt(44)
v_perm_b32 v9, v54, v52, s26
s_waitcnt vmcnt(42)
v_perm_b32 v10, v58, v56, s26
s_waitcnt vmcnt(40)
v_perm_b32 v11, v62, v60, s26
s_waitcnt vmcnt(38)
v_perm_b32 v12, v66, v64, s26
s_waitcnt vmcnt(36)
v_perm_b32 v13, v70, v68, s26
s_waitcnt vmcnt(34)
v_perm_b32 v14, v74, v72, s26
s_waitcnt vmcnt(32)
v_perm_b32 v15, v78, v76, s26
ds_write_b128 v6, v[8:11] offset:20480
ds_write_b128 v6, v[12:15] offset:21504
v_perm_b32 v8, v50, v48, s27
v_perm_b32 v9, v54, v52, s27
v_perm_b32 v10, v58, v56, s27
v_perm_b32 v11, v62, v60, s27
v_perm_b32 v12, v66, v64, s27
v_perm_b32 v13, v70, v68, s27
v_perm_b32 v14, v74, v72, s27
v_perm_b32 v15, v78, v76, s27
ds_write_b128 v6, v[8:11] offset:22528
ds_write_b128 v6, v[12:15] offset:23552
v_perm_b32 v8, v51, v49, s26
v_perm_b32 v9, v55, v53, s26
v_perm_b32 v10, v59, v57, s26
v_perm_b32 v11, v63, v61, s26
v_perm_b32 v12, v67, v65, s26
v_perm_b32 v13, v71, v69, s26
v_perm_b32 v14, v75, v73, s26
v_perm_b32 v15, v79, v77, s26
v_accvgpr_write_b32 a80, v8
v_accvgpr_write_b32 a81, v9
v_accvgpr_write_b32 a82, v10
v_accvgpr_write_b32 a83, v11
v_accvgpr_write_b32 a84, v12
v_accvgpr_write_b32 a85, v13
v_accvgpr_write_b32 a86, v14
v_accvgpr_write_b32 a87, v15
v_perm_b32 v8, v51, v49, s27
v_perm_b32 v9, v55, v53, s27
v_perm_b32 v10, v59, v57, s27
v_perm_b32 v11, v63, v61, s27
v_perm_b32 v12, v67, v65, s27
v_perm_b32 v13, v71, v69, s27
v_perm_b32 v14, v75, v73, s27
v_perm_b32 v15, v79, v77, s27
v_accvgpr_write_b32 a88, v8
v_accvgpr_write_b32 a89, v9
v_accvgpr_write_b32 a90, v10
v_accvgpr_write_b32 a91, v11
v_accvgpr_write_b32 a92, v12
v_accvgpr_write_b32 a93, v13
v_accvgpr_write_b32 a94, v14
v_accvgpr_write_b32 a95, v15
s_lshl_b32 s28, s19, 1
s_add_u32 s28, s28, 7
s_and_b32 s28, s28, 7
s_lshl_b32 s28, s28, 19
s_add_u32 s28, s28, s21
s_add_u32 s25, s28, 0
buffer_load_dwordx2 v[48:49], v3, s[4:7], s25 offen
s_add_u32 s25, s28, 8192
buffer_load_dwordx2 v[50:51], v3, s[4:7], s25 offen
s_add_u32 s25, s28, 65536
buffer_load_dwordx2 v[52:53], v3, s[4:7], s25 offen
s_add_u32 s25, s28, 73728
buffer_load_dwordx2 v[54:55], v3, s[4:7], s25 offen
s_add_u32 s25, s28, 16384
buffer_load_dwordx2 v[56:57], v3, s[4:7], s25 offen
s_add_u32 s25, s28, 24576
buffer_load_dwordx2 v[58:59], v3, s[4:7], s25 offen
s_add_u32 s25, s28, 81920
buffer_load_dwordx2 v[60:61], v3, s[4:7], s25 offen
s_add_u32 s25, s28, 90112
buffer_load_dwordx2 v[62:63], v3, s[4:7], s25 offen
s_add_u32 s25, s28, 262144
buffer_load_dwordx2 v[64:65], v3, s[4:7], s25 offen
s_add_u32 s25, s28, 270336
buffer_load_dwordx2 v[66:67], v3, s[4:7], s25 offen
s_add_u32 s25, s28, 327680
buffer_load_dwordx2 v[68:69], v3, s[4:7], s25 offen
s_add_u32 s25, s28, 335872
buffer_load_dwordx2 v[70:71], v3, s[4:7], s25 offen
s_add_u32 s25, s28, 278528
buffer_load_dwordx2 v[72:73], v3, s[4:7], s25 offen
s_add_u32 s25, s28, 286720
buffer_load_dwordx2 v[74:75], v3, s[4:7], s25 offen
s_add_u32 s25, s28, 344064
buffer_load_dwordx2 v[76:77], v3, s[4:7], s25 offen
s_add_u32 s25, s28, 352256
buffer_load_dwordx2 v[78:79], v3, s[4:7], s25 offen
s_waitcnt vmcnt(46)
v_perm_b32 v8, v82, v80, s26
s_waitcnt vmcnt(44)
v_perm_b32 v9, v86, v84, s26
s_waitcnt vmcnt(42)
v_perm_b32 v10, v90, v88, s26
s_waitcnt vmcnt(40)
v_perm_b32 v11, v94, v92, s26
s_waitcnt vmcnt(38)
v_perm_b32 v12, v98, v96, s26
s_waitcnt vmcnt(36)
v_perm_b32 v13, v102, v100, s26
s_waitcnt vmcnt(34)
v_perm_b32 v14, v106, v104, s26
s_waitcnt vmcnt(32)
v_perm_b32 v15, v110, v108, s26
ds_write_b128 v6, v[8:11] offset:12288
ds_write_b128 v6, v[12:15] offset:13312
v_perm_b32 v8, v82, v80, s27
v_perm_b32 v9, v86, v84, s27
v_perm_b32 v10, v90, v88, s27
v_perm_b32 v11, v94, v92, s27
v_perm_b32 v12, v98, v96, s27
v_perm_b32 v13, v102, v100, s27
v_perm_b32 v14, v106, v104, s27
v_perm_b32 v15, v110, v108, s27
ds_write_b128 v6, v[8:11] offset:14336
ds_write_b128 v6, v[12:15] offset:15360
v_perm_b32 v8, v83, v81, s26
v_perm_b32 v9, v87, v85, s26
v_perm_b32 v10, v91, v89, s26
v_perm_b32 v11, v95, v93, s26
v_perm_b32 v12, v99, v97, s26
v_perm_b32 v13, v103, v101, s26
v_perm_b32 v14, v107, v105, s26
v_perm_b32 v15, v111, v109, s26
ds_write_b128 v6, v[8:11] offset:16384
ds_write_b128 v6, v[12:15] offset:17408
v_perm_b32 v8, v83, v81, s27
v_perm_b32 v9, v87, v85, s27
v_perm_b32 v10, v91, v89, s27
v_perm_b32 v11, v95, v93, s27
v_perm_b32 v12, v99, v97, s27
v_perm_b32 v13, v103, v101, s27
v_perm_b32 v14, v107, v105, s27
v_perm_b32 v15, v111, v109, s27
ds_write_b128 v6, v[8:11] offset:18432
ds_write_b128 v6, v[12:15] offset:19456
s_add_u32 s25, s22, 0
buffer_load_dwordx2 v[80:81], v4, s[8:11], s25 offen
s_add_u32 s25, s22, 8192
buffer_load_dwordx2 v[82:83], v4, s[8:11], s25 offen
s_add_u32 s25, s22, 65536
buffer_load_dwordx2 v[84:85], v4, s[8:11], s25 offen
s_add_u32 s25, s22, 73728
buffer_load_dwordx2 v[86:87], v4, s[8:11], s25 offen
s_add_u32 s25, s22, 16384
buffer_load_dwordx2 v[88:89], v4, s[8:11], s25 offen
s_add_u32 s25, s22, 24576
buffer_load_dwordx2 v[90:91], v4, s[8:11], s25 offen
s_add_u32 s25, s22, 81920
buffer_load_dwordx2 v[92:93], v4, s[8:11], s25 offen
s_add_u32 s25, s22, 90112
buffer_load_dwordx2 v[94:95], v4, s[8:11], s25 offen
s_add_u32 s25, s22, 524288
buffer_load_dwordx2 v[96:97], v4, s[8:11], s25 offen
s_add_u32 s25, s22, 532480
buffer_load_dwordx2 v[98:99], v4, s[8:11], s25 offen
s_add_u32 s25, s22, 589824
buffer_load_dwordx2 v[100:101], v4, s[8:11], s25 offen
s_add_u32 s25, s22, 598016
buffer_load_dwordx2 v[102:103], v4, s[8:11], s25 offen
s_add_u32 s25, s22, 540672
buffer_load_dwordx2 v[104:105], v4, s[8:11], s25 offen
s_add_u32 s25, s22, 548864
buffer_load_dwordx2 v[106:107], v4, s[8:11], s25 offen
s_add_u32 s25, s22, 606208
buffer_load_dwordx2 v[108:109], v4, s[8:11], s25 offen
s_add_u32 s25, s22, 614400
buffer_load_dwordx2 v[110:111], v4, s[8:11], s25 offen
s_waitcnt vmcnt(46)
v_perm_b32 v8, v18, v16, s26
s_waitcnt vmcnt(44)
v_perm_b32 v9, v22, v20, s26
s_waitcnt vmcnt(42)
v_perm_b32 v10, v26, v24, s26
s_waitcnt vmcnt(40)
v_perm_b32 v11, v30, v28, s26
s_waitcnt vmcnt(38)
v_perm_b32 v12, v34, v32, s26
s_waitcnt vmcnt(36)
v_perm_b32 v13, v38, v36, s26
s_waitcnt vmcnt(34)
v_perm_b32 v14, v42, v40, s26
s_waitcnt vmcnt(32)
v_perm_b32 v15, v46, v44, s26
v_accvgpr_write_b32 a96, v8
v_accvgpr_write_b32 a97, v9
v_accvgpr_write_b32 a98, v10
v_accvgpr_write_b32 a99, v11
v_accvgpr_write_b32 a100, v12
v_accvgpr_write_b32 a101, v13
v_accvgpr_write_b32 a102, v14
v_accvgpr_write_b32 a103, v15
v_perm_b32 v8, v18, v16, s27
v_perm_b32 v9, v22, v20, s27
v_perm_b32 v10, v26, v24, s27
v_perm_b32 v11, v30, v28, s27
v_perm_b32 v12, v34, v32, s27
v_perm_b32 v13, v38, v36, s27
v_perm_b32 v14, v42, v40, s27
v_perm_b32 v15, v46, v44, s27
v_accvgpr_write_b32 a104, v8
v_accvgpr_write_b32 a105, v9
v_accvgpr_write_b32 a106, v10
v_accvgpr_write_b32 a107, v11
v_accvgpr_write_b32 a108, v12
v_accvgpr_write_b32 a109, v13
v_accvgpr_write_b32 a110, v14
v_accvgpr_write_b32 a111, v15
v_perm_b32 v8, v19, v17, s26
v_perm_b32 v9, v23, v21, s26
v_perm_b32 v10, v27, v25, s26
v_perm_b32 v11, v31, v29, s26
v_perm_b32 v12, v35, v33, s26
v_perm_b32 v13, v39, v37, s26
v_perm_b32 v14, v43, v41, s26
v_perm_b32 v15, v47, v45, s26
v_accvgpr_write_b32 a112, v8
v_accvgpr_write_b32 a113, v9
v_accvgpr_write_b32 a114, v10
v_accvgpr_write_b32 a115, v11
v_accvgpr_write_b32 a116, v12
v_accvgpr_write_b32 a117, v13
v_accvgpr_write_b32 a118, v14
v_accvgpr_write_b32 a119, v15
v_perm_b32 v8, v19, v17, s27
v_perm_b32 v9, v23, v21, s27
v_perm_b32 v10, v27, v25, s27
v_perm_b32 v11, v31, v29, s27
v_perm_b32 v12, v35, v33, s27
v_perm_b32 v13, v39, v37, s27
v_perm_b32 v14, v43, v41, s27
v_perm_b32 v15, v47, v45, s27
v_accvgpr_write_b32 a120, v8
v_accvgpr_write_b32 a121, v9
v_accvgpr_write_b32 a122, v10
v_accvgpr_write_b32 a123, v11
v_accvgpr_write_b32 a124, v12
v_accvgpr_write_b32 a125, v13
v_accvgpr_write_b32 a126, v14
v_accvgpr_write_b32 a127, v15
s_add_u32 s25, s22, 1048576
buffer_load_dwordx2 v[16:17], v4, s[8:11], s25 offen
s_add_u32 s25, s22, 1056768
buffer_load_dwordx2 v[18:19], v4, s[8:11], s25 offen
s_add_u32 s25, s22, 1114112
buffer_load_dwordx2 v[20:21], v4, s[8:11], s25 offen
s_add_u32 s25, s22, 1122304
buffer_load_dwordx2 v[22:23], v4, s[8:11], s25 offen
s_add_u32 s25, s22, 1064960
buffer_load_dwordx2 v[24:25], v4, s[8:11], s25 offen
s_add_u32 s25, s22, 1073152
buffer_load_dwordx2 v[26:27], v4, s[8:11], s25 offen
s_add_u32 s25, s22, 1130496
buffer_load_dwordx2 v[28:29], v4, s[8:11], s25 offen
s_add_u32 s25, s22, 1138688
buffer_load_dwordx2 v[30:31], v4, s[8:11], s25 offen
s_add_u32 s25, s22, 1572864
buffer_load_dwordx2 v[32:33], v4, s[8:11], s25 offen
s_add_u32 s25, s22, 1581056
buffer_load_dwordx2 v[34:35], v4, s[8:11], s25 offen
s_add_u32 s25, s22, 1638400
buffer_load_dwordx2 v[36:37], v4, s[8:11], s25 offen
s_add_u32 s25, s22, 1646592
buffer_load_dwordx2 v[38:39], v4, s[8:11], s25 offen
s_add_u32 s25, s22, 1589248
buffer_load_dwordx2 v[40:41], v4, s[8:11], s25 offen
s_add_u32 s25, s22, 1597440
buffer_load_dwordx2 v[42:43], v4, s[8:11], s25 offen
s_add_u32 s25, s22, 1654784
buffer_load_dwordx2 v[44:45], v4, s[8:11], s25 offen
s_add_u32 s25, s22, 1662976
buffer_load_dwordx2 v[46:47], v4, s[8:11], s25 offen
s_waitcnt vmcnt(46)
v_perm_b32 v8, v50, v48, s26
s_waitcnt vmcnt(44)
v_perm_b32 v9, v54, v52, s26
s_waitcnt vmcnt(42)
v_perm_b32 v10, v58, v56, s26
s_waitcnt vmcnt(40)
v_perm_b32 v11, v62, v60, s26
s_waitcnt vmcnt(38)
v_perm_b32 v12, v66, v64, s26
s_waitcnt vmcnt(36)
v_perm_b32 v13, v70, v68, s26
s_waitcnt vmcnt(34)
v_perm_b32 v14, v74, v72, s26
s_waitcnt vmcnt(32)
v_perm_b32 v15, v78, v76, s26
v_accvgpr_write_b32 a128, v8
v_accvgpr_write_b32 a129, v9
v_accvgpr_write_b32 a130, v10
v_accvgpr_write_b32 a131, v11
v_accvgpr_write_b32 a132, v12
v_accvgpr_write_b32 a133, v13
v_accvgpr_write_b32 a134, v14
v_accvgpr_write_b32 a135, v15
v_perm_b32 v8, v50, v48, s27
v_perm_b32 v9, v54, v52, s27
v_perm_b32 v10, v58, v56, s27
v_perm_b32 v11, v62, v60, s27
v_perm_b32 v12, v66, v64, s27
v_perm_b32 v13, v70, v68, s27
v_perm_b32 v14, v74, v72, s27
v_perm_b32 v15, v78, v76, s27
v_accvgpr_write_b32 a136, v8
v_accvgpr_write_b32 a137, v9
v_accvgpr_write_b32 a138, v10
v_accvgpr_write_b32 a139, v11
v_accvgpr_write_b32 a140, v12
v_accvgpr_write_b32 a141, v13
v_accvgpr_write_b32 a142, v14
v_accvgpr_write_b32 a143, v15
v_perm_b32 v8, v51, v49, s26
v_perm_b32 v9, v55, v53, s26
v_perm_b32 v10, v59, v57, s26
v_perm_b32 v11, v63, v61, s26
v_perm_b32 v12, v67, v65, s26
v_perm_b32 v13, v71, v69, s26
v_perm_b32 v14, v75, v73, s26
v_perm_b32 v15, v79, v77, s26
v_accvgpr_write_b32 a144, v8
v_accvgpr_write_b32 a145, v9
v_accvgpr_write_b32 a146, v10
v_accvgpr_write_b32 a147, v11
v_accvgpr_write_b32 a148, v12
v_accvgpr_write_b32 a149, v13
v_accvgpr_write_b32 a150, v14
v_accvgpr_write_b32 a151, v15
v_perm_b32 v8, v51, v49, s27
v_perm_b32 v9, v55, v53, s27
v_perm_b32 v10, v59, v57, s27
v_perm_b32 v11, v63, v61, s27
v_perm_b32 v12, v67, v65, s27
v_perm_b32 v13, v71, v69, s27
v_perm_b32 v14, v75, v73, s27
v_perm_b32 v15, v79, v77, s27
v_accvgpr_write_b32 a152, v8
v_accvgpr_write_b32 a153, v9
v_accvgpr_write_b32 a154, v10
v_accvgpr_write_b32 a155, v11
v_accvgpr_write_b32 a156, v12
v_accvgpr_write_b32 a157, v13
v_accvgpr_write_b32 a158, v14
v_accvgpr_write_b32 a159, v15
s_add_u32 s25, s22, 2097152
buffer_load_dwordx2 v[48:49], v4, s[8:11], s25 offen
s_add_u32 s25, s22, 2105344
buffer_load_dwordx2 v[50:51], v4, s[8:11], s25 offen
s_add_u32 s25, s22, 2162688
buffer_load_dwordx2 v[52:53], v4, s[8:11], s25 offen
s_add_u32 s25, s22, 2170880
buffer_load_dwordx2 v[54:55], v4, s[8:11], s25 offen
s_add_u32 s25, s22, 2113536
buffer_load_dwordx2 v[56:57], v4, s[8:11], s25 offen
s_add_u32 s25, s22, 2121728
buffer_load_dwordx2 v[58:59], v4, s[8:11], s25 offen
s_add_u32 s25, s22, 2179072
buffer_load_dwordx2 v[60:61], v4, s[8:11], s25 offen
s_add_u32 s25, s22, 2187264
buffer_load_dwordx2 v[62:63], v4, s[8:11], s25 offen
s_add_u32 s25, s22, 2621440
buffer_load_dwordx2 v[64:65], v4, s[8:11], s25 offen
s_add_u32 s25, s22, 2629632
buffer_load_dwordx2 v[66:67], v4, s[8:11], s25 offen
s_add_u32 s25, s22, 2686976
buffer_load_dwordx2 v[68:69], v4, s[8:11], s25 offen
s_add_u32 s25, s22, 2695168
buffer_load_dwordx2 v[70:71], v4, s[8:11], s25 offen
s_add_u32 s25, s22, 2637824
buffer_load_dwordx2 v[72:73], v4, s[8:11], s25 offen
s_add_u32 s25, s22, 2646016
buffer_load_dwordx2 v[74:75], v4, s[8:11], s25 offen
s_add_u32 s25, s22, 2703360
buffer_load_dwordx2 v[76:77], v4, s[8:11], s25 offen
s_add_u32 s25, s22, 2711552
buffer_load_dwordx2 v[78:79], v4, s[8:11], s25 offen
s_load_dwordx2 s[62:63], s[0:1], 88
v_lshlrev_b32_e64 v120, 2, v0
s_waitcnt lgkmcnt(0)
global_load_dword v120, v120, s[62:63] sc1
s_mov_b64 vcc, s[30:31]
s_waitcnt vmcnt(48)
v_cndmask_b32_dpp v112, v81, v80, vcc quad_perm:[0,0,2,2] row_mask:0xf bank_mask:0xf
s_waitcnt vmcnt(47)
v_cndmask_b32_dpp v113, v83, v82, vcc quad_perm:[0,0,2,2] row_mask:0xf bank_mask:0xf
s_waitcnt vmcnt(46)
v_cndmask_b32_dpp v114, v85, v84, vcc quad_perm:[0,0,2,2] row_mask:0xf bank_mask:0xf
s_waitcnt vmcnt(45)
v_cndmask_b32_dpp v115, v87, v86, vcc quad_perm:[0,0,2,2] row_mask:0xf bank_mask:0xf
s_waitcnt vmcnt(44)
v_cndmask_b32_dpp v116, v89, v88, vcc quad_perm:[0,0,2,2] row_mask:0xf bank_mask:0xf
s_waitcnt vmcnt(43)
v_cndmask_b32_dpp v117, v91, v90, vcc quad_perm:[0,0,2,2] row_mask:0xf bank_mask:0xf
s_waitcnt vmcnt(42)
v_cndmask_b32_dpp v118, v93, v92, vcc quad_perm:[0,0,2,2] row_mask:0xf bank_mask:0xf
s_waitcnt vmcnt(41)
v_cndmask_b32_dpp v119, v95, v94, vcc quad_perm:[0,0,2,2] row_mask:0xf bank_mask:0xf
s_not_b64 vcc, vcc
v_cndmask_b32_dpp v81, v80, v81, vcc quad_perm:[1,1,3,3] row_mask:0xf bank_mask:0xf
v_cndmask_b32_dpp v83, v82, v83, vcc quad_perm:[1,1,3,3] row_mask:0xf bank_mask:0xf
v_cndmask_b32_dpp v85, v84, v85, vcc quad_perm:[1,1,3,3] row_mask:0xf bank_mask:0xf
v_cndmask_b32_dpp v87, v86, v87, vcc quad_perm:[1,1,3,3] row_mask:0xf bank_mask:0xf
v_cndmask_b32_dpp v89, v88, v89, vcc quad_perm:[1,1,3,3] row_mask:0xf bank_mask:0xf
v_cndmask_b32_dpp v91, v90, v91, vcc quad_perm:[1,1,3,3] row_mask:0xf bank_mask:0xf
v_cndmask_b32_dpp v93, v92, v93, vcc quad_perm:[1,1,3,3] row_mask:0xf bank_mask:0xf
v_cndmask_b32_dpp v95, v94, v95, vcc quad_perm:[1,1,3,3] row_mask:0xf bank_mask:0xf
v_perm_b32 v8, v113, v112, s26
v_perm_b32 v9, v115, v114, s26
v_perm_b32 v10, v117, v116, s26
v_perm_b32 v11, v119, v118, s26
v_perm_b32 v12, v83, v81, s26
v_perm_b32 v13, v87, v85, s26
v_perm_b32 v14, v91, v89, s26
v_perm_b32 v15, v95, v93, s26
v_accvgpr_write_b32 a160, v8
v_accvgpr_write_b32 a161, v9
v_accvgpr_write_b32 a162, v10
v_accvgpr_write_b32 a163, v11
v_accvgpr_write_b32 a164, v12
v_accvgpr_write_b32 a165, v13
v_accvgpr_write_b32 a166, v14
v_accvgpr_write_b32 a167, v15
v_perm_b32 v8, v113, v112, s27
v_perm_b32 v9, v115, v114, s27
v_perm_b32 v10, v117, v116, s27
v_perm_b32 v11, v119, v118, s27
v_perm_b32 v12, v83, v81, s27
v_perm_b32 v13, v87, v85, s27
v_perm_b32 v14, v91, v89, s27
v_perm_b32 v15, v95, v93, s27
v_accvgpr_write_b32 a168, v8
v_accvgpr_write_b32 a169, v9
v_accvgpr_write_b32 a170, v10
v_accvgpr_write_b32 a171, v11
v_accvgpr_write_b32 a172, v12
v_accvgpr_write_b32 a173, v13
v_accvgpr_write_b32 a174, v14
v_accvgpr_write_b32 a175, v15
s_mov_b64 vcc, s[30:31]
s_waitcnt vmcnt(40)
v_cndmask_b32_dpp v112, v97, v96, vcc quad_perm:[0,0,2,2] row_mask:0xf bank_mask:0xf
s_waitcnt vmcnt(39)
v_cndmask_b32_dpp v113, v99, v98, vcc quad_perm:[0,0,2,2] row_mask:0xf bank_mask:0xf
s_waitcnt vmcnt(38)
v_cndmask_b32_dpp v114, v101, v100, vcc quad_perm:[0,0,2,2] row_mask:0xf bank_mask:0xf
s_waitcnt vmcnt(37)
v_cndmask_b32_dpp v115, v103, v102, vcc quad_perm:[0,0,2,2] row_mask:0xf bank_mask:0xf
s_waitcnt vmcnt(36)
v_cndmask_b32_dpp v116, v105, v104, vcc quad_perm:[0,0,2,2] row_mask:0xf bank_mask:0xf
s_waitcnt vmcnt(35)
v_cndmask_b32_dpp v117, v107, v106, vcc quad_perm:[0,0,2,2] row_mask:0xf bank_mask:0xf
s_waitcnt vmcnt(34)
v_cndmask_b32_dpp v118, v109, v108, vcc quad_perm:[0,0,2,2] row_mask:0xf bank_mask:0xf
s_waitcnt vmcnt(33)
v_cndmask_b32_dpp v119, v111, v110, vcc quad_perm:[0,0,2,2] row_mask:0xf bank_mask:0xf
s_not_b64 vcc, vcc
v_cndmask_b32_dpp v97, v96, v97, vcc quad_perm:[1,1,3,3] row_mask:0xf bank_mask:0xf
v_cndmask_b32_dpp v99, v98, v99, vcc quad_perm:[1,1,3,3] row_mask:0xf bank_mask:0xf
v_cndmask_b32_dpp v101, v100, v101, vcc quad_perm:[1,1,3,3] row_mask:0xf bank_mask:0xf
v_cndmask_b32_dpp v103, v102, v103, vcc quad_perm:[1,1,3,3] row_mask:0xf bank_mask:0xf
v_cndmask_b32_dpp v105, v104, v105, vcc quad_perm:[1,1,3,3] row_mask:0xf bank_mask:0xf
v_cndmask_b32_dpp v107, v106, v107, vcc quad_perm:[1,1,3,3] row_mask:0xf bank_mask:0xf
v_cndmask_b32_dpp v109, v108, v109, vcc quad_perm:[1,1,3,3] row_mask:0xf bank_mask:0xf
v_cndmask_b32_dpp v111, v110, v111, vcc quad_perm:[1,1,3,3] row_mask:0xf bank_mask:0xf
v_perm_b32 v8, v113, v112, s26
v_perm_b32 v9, v115, v114, s26
v_perm_b32 v10, v117, v116, s26
v_perm_b32 v11, v119, v118, s26
v_perm_b32 v12, v99, v97, s26
v_perm_b32 v13, v103, v101, s26
v_perm_b32 v14, v107, v105, s26
v_perm_b32 v15, v111, v109, s26
v_accvgpr_write_b32 a176, v8
v_accvgpr_write_b32 a177, v9
v_accvgpr_write_b32 a178, v10
v_accvgpr_write_b32 a179, v11
v_accvgpr_write_b32 a180, v12
v_accvgpr_write_b32 a181, v13
v_accvgpr_write_b32 a182, v14
v_accvgpr_write_b32 a183, v15
v_perm_b32 v8, v113, v112, s27
v_perm_b32 v9, v115, v114, s27
v_perm_b32 v10, v117, v116, s27
v_perm_b32 v11, v119, v118, s27
v_perm_b32 v12, v99, v97, s27
v_perm_b32 v13, v103, v101, s27
v_perm_b32 v14, v107, v105, s27
v_perm_b32 v15, v111, v109, s27
v_accvgpr_write_b32 a184, v8
v_accvgpr_write_b32 a185, v9
v_accvgpr_write_b32 a186, v10
v_accvgpr_write_b32 a187, v11
v_accvgpr_write_b32 a188, v12
v_accvgpr_write_b32 a189, v13
v_accvgpr_write_b32 a190, v14
v_accvgpr_write_b32 a191, v15
s_add_u32 s25, s22, 3145728
buffer_load_dwordx2 v[80:81], v4, s[8:11], s25 offen
s_add_u32 s25, s22, 3153920
buffer_load_dwordx2 v[82:83], v4, s[8:11], s25 offen
s_add_u32 s25, s22, 3211264
buffer_load_dwordx2 v[84:85], v4, s[8:11], s25 offen
s_add_u32 s25, s22, 3219456
buffer_load_dwordx2 v[86:87], v4, s[8:11], s25 offen
s_add_u32 s25, s22, 3162112
buffer_load_dwordx2 v[88:89], v4, s[8:11], s25 offen
s_add_u32 s25, s22, 3170304
buffer_load_dwordx2 v[90:91], v4, s[8:11], s25 offen
s_add_u32 s25, s22, 3227648
buffer_load_dwordx2 v[92:93], v4, s[8:11], s25 offen
s_add_u32 s25, s22, 3235840
buffer_load_dwordx2 v[94:95], v4, s[8:11], s25 offen
s_add_u32 s25, s22, 3670016
buffer_load_dwordx2 v[96:97], v4, s[8:11], s25 offen
s_add_u32 s25, s22, 3678208
buffer_load_dwordx2 v[98:99], v4, s[8:11], s25 offen
s_add_u32 s25, s22, 3735552
buffer_load_dwordx2 v[100:101], v4, s[8:11], s25 offen
s_add_u32 s25, s22, 3743744
buffer_load_dwordx2 v[102:103], v4, s[8:11], s25 offen
s_add_u32 s25, s22, 3686400
buffer_load_dwordx2 v[104:105], v4, s[8:11], s25 offen
s_add_u32 s25, s22, 3694592
buffer_load_dwordx2 v[106:107], v4, s[8:11], s25 offen
s_add_u32 s25, s22, 3751936
buffer_load_dwordx2 v[108:109], v4, s[8:11], s25 offen
s_add_u32 s25, s22, 3760128
buffer_load_dwordx2 v[110:111], v4, s[8:11], s25 offen
s_mov_b64 vcc, s[30:31]
s_waitcnt vmcnt(48)
v_cndmask_b32_dpp v112, v17, v16, vcc quad_perm:[0,0,2,2] row_mask:0xf bank_mask:0xf
s_waitcnt vmcnt(47)
v_cndmask_b32_dpp v113, v19, v18, vcc quad_perm:[0,0,2,2] row_mask:0xf bank_mask:0xf
s_waitcnt vmcnt(46)
v_cndmask_b32_dpp v114, v21, v20, vcc quad_perm:[0,0,2,2] row_mask:0xf bank_mask:0xf
s_waitcnt vmcnt(45)
v_cndmask_b32_dpp v115, v23, v22, vcc quad_perm:[0,0,2,2] row_mask:0xf bank_mask:0xf
s_waitcnt vmcnt(44)
v_cndmask_b32_dpp v116, v25, v24, vcc quad_perm:[0,0,2,2] row_mask:0xf bank_mask:0xf
s_waitcnt vmcnt(43)
v_cndmask_b32_dpp v117, v27, v26, vcc quad_perm:[0,0,2,2] row_mask:0xf bank_mask:0xf
s_waitcnt vmcnt(42)
v_cndmask_b32_dpp v118, v29, v28, vcc quad_perm:[0,0,2,2] row_mask:0xf bank_mask:0xf
s_waitcnt vmcnt(41)
v_cndmask_b32_dpp v119, v31, v30, vcc quad_perm:[0,0,2,2] row_mask:0xf bank_mask:0xf
s_not_b64 vcc, vcc
v_cndmask_b32_dpp v17, v16, v17, vcc quad_perm:[1,1,3,3] row_mask:0xf bank_mask:0xf
v_cndmask_b32_dpp v19, v18, v19, vcc quad_perm:[1,1,3,3] row_mask:0xf bank_mask:0xf
v_cndmask_b32_dpp v21, v20, v21, vcc quad_perm:[1,1,3,3] row_mask:0xf bank_mask:0xf
v_cndmask_b32_dpp v23, v22, v23, vcc quad_perm:[1,1,3,3] row_mask:0xf bank_mask:0xf
v_cndmask_b32_dpp v25, v24, v25, vcc quad_perm:[1,1,3,3] row_mask:0xf bank_mask:0xf
v_cndmask_b32_dpp v27, v26, v27, vcc quad_perm:[1,1,3,3] row_mask:0xf bank_mask:0xf
v_cndmask_b32_dpp v29, v28, v29, vcc quad_perm:[1,1,3,3] row_mask:0xf bank_mask:0xf
v_cndmask_b32_dpp v31, v30, v31, vcc quad_perm:[1,1,3,3] row_mask:0xf bank_mask:0xf
v_perm_b32 v8, v113, v112, s26
v_perm_b32 v9, v115, v114, s26
v_perm_b32 v10, v117, v116, s26
v_perm_b32 v11, v119, v118, s26
v_perm_b32 v12, v19, v17, s26
v_perm_b32 v13, v23, v21, s26
v_perm_b32 v14, v27, v25, s26
v_perm_b32 v15, v31, v29, s26
v_accvgpr_write_b32 a192, v8
v_accvgpr_write_b32 a193, v9
v_accvgpr_write_b32 a194, v10
v_accvgpr_write_b32 a195, v11
v_accvgpr_write_b32 a196, v12
v_accvgpr_write_b32 a197, v13
v_accvgpr_write_b32 a198, v14
v_accvgpr_write_b32 a199, v15
v_perm_b32 v8, v113, v112, s27
v_perm_b32 v9, v115, v114, s27
v_perm_b32 v10, v117, v116, s27
v_perm_b32 v11, v119, v118, s27
v_perm_b32 v12, v19, v17, s27
v_perm_b32 v13, v23, v21, s27
v_perm_b32 v14, v27, v25, s27
v_perm_b32 v15, v31, v29, s27
v_accvgpr_write_b32 a200, v8
v_accvgpr_write_b32 a201, v9
v_accvgpr_write_b32 a202, v10
v_accvgpr_write_b32 a203, v11
v_accvgpr_write_b32 a204, v12
v_accvgpr_write_b32 a205, v13
v_accvgpr_write_b32 a206, v14
v_accvgpr_write_b32 a207, v15
s_mov_b64 vcc, s[30:31]
s_waitcnt vmcnt(40)
v_cndmask_b32_dpp v112, v33, v32, vcc quad_perm:[0,0,2,2] row_mask:0xf bank_mask:0xf
s_waitcnt vmcnt(39)
v_cndmask_b32_dpp v113, v35, v34, vcc quad_perm:[0,0,2,2] row_mask:0xf bank_mask:0xf
s_waitcnt vmcnt(38)
v_cndmask_b32_dpp v114, v37, v36, vcc quad_perm:[0,0,2,2] row_mask:0xf bank_mask:0xf
s_waitcnt vmcnt(37)
v_cndmask_b32_dpp v115, v39, v38, vcc quad_perm:[0,0,2,2] row_mask:0xf bank_mask:0xf
s_waitcnt vmcnt(36)
v_cndmask_b32_dpp v116, v41, v40, vcc quad_perm:[0,0,2,2] row_mask:0xf bank_mask:0xf
s_waitcnt vmcnt(35)
v_cndmask_b32_dpp v117, v43, v42, vcc quad_perm:[0,0,2,2] row_mask:0xf bank_mask:0xf
s_waitcnt vmcnt(34)
v_cndmask_b32_dpp v118, v45, v44, vcc quad_perm:[0,0,2,2] row_mask:0xf bank_mask:0xf
s_waitcnt vmcnt(33)
v_cndmask_b32_dpp v119, v47, v46, vcc quad_perm:[0,0,2,2] row_mask:0xf bank_mask:0xf
s_not_b64 vcc, vcc
v_cndmask_b32_dpp v33, v32, v33, vcc quad_perm:[1,1,3,3] row_mask:0xf bank_mask:0xf
v_cndmask_b32_dpp v35, v34, v35, vcc quad_perm:[1,1,3,3] row_mask:0xf bank_mask:0xf
v_cndmask_b32_dpp v37, v36, v37, vcc quad_perm:[1,1,3,3] row_mask:0xf bank_mask:0xf
v_cndmask_b32_dpp v39, v38, v39, vcc quad_perm:[1,1,3,3] row_mask:0xf bank_mask:0xf
v_cndmask_b32_dpp v41, v40, v41, vcc quad_perm:[1,1,3,3] row_mask:0xf bank_mask:0xf
v_cndmask_b32_dpp v43, v42, v43, vcc quad_perm:[1,1,3,3] row_mask:0xf bank_mask:0xf
v_cndmask_b32_dpp v45, v44, v45, vcc quad_perm:[1,1,3,3] row_mask:0xf bank_mask:0xf
v_cndmask_b32_dpp v47, v46, v47, vcc quad_perm:[1,1,3,3] row_mask:0xf bank_mask:0xf
v_perm_b32 v8, v113, v112, s26
v_perm_b32 v9, v115, v114, s26
v_perm_b32 v10, v117, v116, s26
v_perm_b32 v11, v119, v118, s26
v_perm_b32 v12, v35, v33, s26
v_perm_b32 v13, v39, v37, s26
v_perm_b32 v14, v43, v41, s26
v_perm_b32 v15, v47, v45, s26
v_accvgpr_write_b32 a208, v8
v_accvgpr_write_b32 a209, v9
v_accvgpr_write_b32 a210, v10
v_accvgpr_write_b32 a211, v11
v_accvgpr_write_b32 a212, v12
v_accvgpr_write_b32 a213, v13
v_accvgpr_write_b32 a214, v14
v_accvgpr_write_b32 a215, v15
v_perm_b32 v8, v113, v112, s27
v_perm_b32 v9, v115, v114, s27
v_perm_b32 v10, v117, v116, s27
v_perm_b32 v11, v119, v118, s27
v_perm_b32 v12, v35, v33, s27
v_perm_b32 v13, v39, v37, s27
v_perm_b32 v14, v43, v41, s27
v_perm_b32 v15, v47, v45, s27
v_accvgpr_write_b32 a216, v8
v_accvgpr_write_b32 a217, v9
v_accvgpr_write_b32 a218, v10
v_accvgpr_write_b32 a219, v11
v_accvgpr_write_b32 a220, v12
v_accvgpr_write_b32 a221, v13
v_accvgpr_write_b32 a222, v14
v_accvgpr_write_b32 a223, v15
s_add_u32 s25, s23, 0
buffer_load_dwordx2 v[16:17], v5, s[48:51], s25 offen
s_add_u32 s25, s23, 2048
buffer_load_dwordx2 v[18:19], v5, s[48:51], s25 offen
s_add_u32 s25, s23, 4096
buffer_load_dwordx2 v[20:21], v5, s[48:51], s25 offen
s_add_u32 s25, s23, 6144
buffer_load_dwordx2 v[22:23], v5, s[48:51], s25 offen
s_add_u32 s25, s23, 1024
buffer_load_dwordx2 v[24:25], v5, s[48:51], s25 offen
s_add_u32 s25, s23, 3072
buffer_load_dwordx2 v[26:27], v5, s[48:51], s25 offen
s_add_u32 s25, s23, 5120
buffer_load_dwordx2 v[28:29], v5, s[48:51], s25 offen
s_add_u32 s25, s23, 7168
buffer_load_dwordx2 v[30:31], v5, s[48:51], s25 offen
s_add_u32 s25, s23, 16384
buffer_load_dwordx2 v[32:33], v5, s[48:51], s25 offen
s_add_u32 s25, s23, 18432
buffer_load_dwordx2 v[34:35], v5, s[48:51], s25 offen
s_add_u32 s25, s23, 20480
buffer_load_dwordx2 v[36:37], v5, s[48:51], s25 offen
s_add_u32 s25, s23, 22528
buffer_load_dwordx2 v[38:39], v5, s[48:51], s25 offen
s_add_u32 s25, s23, 17408
buffer_load_dwordx2 v[40:41], v5, s[48:51], s25 offen
s_add_u32 s25, s23, 19456
buffer_load_dwordx2 v[42:43], v5, s[48:51], s25 offen
s_add_u32 s25, s23, 21504
buffer_load_dwordx2 v[44:45], v5, s[48:51], s25 offen
s_add_u32 s25, s23, 23552
buffer_load_dwordx2 v[46:47], v5, s[48:51], s25 offen
s_waitcnt vmcnt(32)
v_readlane_b32 s60, v120, 52
s_nop 1
v_mov_b32 v124, s60
s_cmp_eq_u32 s92, 1
s_cbranch_scc1 OG_3
s_mov_b32 s64, 0x50005
s_mov_b32 s65, 0x50005
s_mov_b64 exec, s[64:65]
v_cmp_ne_u32_e64 vcc, -1, v120
s_mov_b64 s[66:67], vcc
s_lshl_b64 exec, s[64:65], 1
v_cmp_ne_u32 vcc, 0x2000, v120
s_mov_b64 exec, -1
s_or_b64 vcc, vcc, s[66:67]
s_cbranch_scc1 OV_4
s_mov_b32 s18, 1
s_mov_b32 s92, 1
OV_4:
s_cmp_eq_u32 s92, 1
s_cbranch_scc1 VK_7
s_mov_b32 s61, 0
VW_5:
s_add_u32 s61, s61, 1
s_cmp_gt_u32 s61, 2097152
s_cbranch_scc1 FAIL
s_sleep 16
s_load_dwordx2 s[62:63], s[0:1], 88
v_mbcnt_lo_u32_b32 v120, -1, 0
v_and_b32_e64 v121, 3, v120
v_lshrrev_b32_e64 v120, 2, v120
v_lshlrev_b32 v120, 3, v120
v_lshl_add_u32 v120, v121, 6, v120
s_mov_b64 exec, 0xff
s_waitcnt lgkmcnt(0)
global_load_dwordx2 v[120:121], v120, s[62:63] sc1
s_mov_b64 exec, -1
VE_6:
s_mov_b64 exec, 0xff
s_waitcnt vmcnt(0)
v_cmp_eq_u32 vcc, -1, v120
s_mov_b64 exec, vcc
v_cmp_eq_u32 vcc, 0x2000, v121
s_mov_b64 exec, -1
s_cmp_eq_u32 vcc_lo, 0xff
s_cbranch_scc1 VG_8
s_mov_b32 s64, 0
s_mov_b32 s65, 0
s_mov_b32 s66, 1
s_mov_b32 s67, 1
v_readlane_b32 s68, v121, 0
v_readlane_b32 s69, v120, 0
s_cmp_eq_u32 s68, 0x2000
s_cselect_b32 s67, s67, 0
s_cmp_eq_u32 s69, -1
s_cselect_b32 s67, s67, 0
s_lshr_b32 s68, s68, 8
s_add_u32 s64, s64, s68
s_cmp_gt_u32 s91, 0
s_cselect_b32 s69, s68, 0
s_add_u32 s65, s65, s69
s_cmp_eq_u32 s68, 32
s_cselect_b32 s66, s66, 0
v_readlane_b32 s68, v121, 1
v_readlane_b32 s69, v120, 1
s_cmp_eq_u32 s68, 0x2000
s_cselect_b32 s67, s67, 0
s_cmp_eq_u32 s69, -1
s_cselect_b32 s67, s67, 0
s_lshr_b32 s68, s68, 8
s_add_u32 s64, s64, s68
s_cmp_gt_u32 s91, 1
s_cselect_b32 s69, s68, 0
s_add_u32 s65, s65, s69
s_cmp_eq_u32 s68, 32
s_cselect_b32 s66, s66, 0
v_readlane_b32 s68, v121, 2
v_readlane_b32 s69, v120, 2
s_cmp_eq_u32 s68, 0x2000
s_cselect_b32 s67, s67, 0
s_cmp_eq_u32 s69, -1
s_cselect_b32 s67, s67, 0
s_lshr_b32 s68, s68, 8
s_add_u32 s64, s64, s68
s_cmp_gt_u32 s91, 2
s_cselect_b32 s69, s68, 0
s_add_u32 s65, s65, s69
s_cmp_eq_u32 s68, 32
s_cselect_b32 s66, s66, 0
v_readlane_b32 s68, v121, 3
v_readlane_b32 s69, v120, 3
s_cmp_eq_u32 s68, 0x2000
s_cselect_b32 s67, s67, 0
s_cmp_eq_u32 s69, -1
s_cselect_b32 s67, s67, 0
s_lshr_b32 s68, s68, 8
s_add_u32 s64, s64, s68
s_cmp_gt_u32 s91, 3
s_cselect_b32 s69, s68, 0
s_add_u32 s65, s65, s69
s_cmp_eq_u32 s68, 32
s_cselect_b32 s66, s66, 0
v_readlane_b32 s68, v121, 4
v_readlane_b32 s69, v120, 4
s_cmp_eq_u32 s68, 0x2000
s_cselect_b32 s67, s67, 0
s_cmp_eq_u32 s69, -1
s_cselect_b32 s67, s67, 0
s_lshr_b32 s68, s68, 8
s_add_u32 s64, s64, s68
s_cmp_gt_u32 s91, 4
s_cselect_b32 s69, s68, 0
s_add_u32 s65, s65, s69
s_cmp_eq_u32 s68, 32
s_cselect_b32 s66, s66, 0
v_readlane_b32 s68, v121, 5
v_readlane_b32 s69, v120, 5
s_cmp_eq_u32 s68, 0x2000
s_cselect_b32 s67, s67, 0
s_cmp_eq_u32 s69, -1
s_cselect_b32 s67, s67, 0
s_lshr_b32 s68, s68, 8
s_add_u32 s64, s64, s68
s_cmp_gt_u32 s91, 5
s_cselect_b32 s69, s68, 0
s_add_u32 s65, s65, s69
s_cmp_eq_u32 s68, 32
s_cselect_b32 s66, s66, 0
v_readlane_b32 s68, v121, 6
v_readlane_b32 s69, v120, 6
s_cmp_eq_u32 s68, 0x2000
s_cselect_b32 s67, s67, 0
s_cmp_eq_u32 s69, -1
s_cselect_b32 s67, s67, 0
s_lshr_b32 s68, s68, 8
s_add_u32 s64, s64, s68
s_cmp_gt_u32 s91, 6
s_cselect_b32 s69, s68, 0
s_add_u32 s65, s65, s69
s_cmp_eq_u32 s68, 32
s_cselect_b32 s66, s66, 0
v_readlane_b32 s68, v121, 7
v_readlane_b32 s69, v120, 7
s_cmp_eq_u32 s68, 0x2000
s_cselect_b32 s67, s67, 0
s_cmp_eq_u32 s69, -1
s_cselect_b32 s67, s67, 0
s_lshr_b32 s68, s68, 8
s_add_u32 s64, s64, s68
s_cmp_gt_u32 s91, 7
s_cselect_b32 s69, s68, 0
s_add_u32 s65, s65, s69
s_cmp_eq_u32 s68, 32
s_cselect_b32 s66, s66, 0
s_cmp_lt_u32 s64, 256
s_cbranch_scc1 VW_5
s_cmp_gt_u32 s64, 256
s_cbranch_scc1 FAIL
s_cmp_eq_u32 s67, 0
s_cbranch_scc1 REROLE
VG_8:
s_mov_b32 s18, 1
s_mov_b32 s92, 1
VK_7:
OG_3:
s_mov_b64 vcc, s[30:31]
v_cndmask_b32_dpp v112, v49, v48, vcc quad_perm:[0,0,2,2] row_mask:0xf bank_mask:0xf
v_cndmask_b32_dpp v113, v51, v50, vcc quad_perm:[0,0,2,2] row_mask:0xf bank_mask:0xf
v_cndmask_b32_dpp v114, v53, v52, vcc quad_perm:[0,0,2,2] row_mask:0xf bank_mask:0xf
v_cndmask_b32_dpp v115, v55, v54, vcc quad_perm:[0,0,2,2] row_mask:0xf bank_mask:0xf
v_cndmask_b32_dpp v116, v57, v56, vcc quad_perm:[0,0,2,2] row_mask:0xf bank_mask:0xf
v_cndmask_b32_dpp v117, v59, v58, vcc quad_perm:[0,0,2,2] row_mask:0xf bank_mask:0xf
v_cndmask_b32_dpp v118, v61, v60, vcc quad_perm:[0,0,2,2] row_mask:0xf bank_mask:0xf
v_cndmask_b32_dpp v119, v63, v62, vcc quad_perm:[0,0,2,2] row_mask:0xf bank_mask:0xf
s_not_b64 vcc, vcc
v_cndmask_b32_dpp v49, v48, v49, vcc quad_perm:[1,1,3,3] row_mask:0xf bank_mask:0xf
v_cndmask_b32_dpp v51, v50, v51, vcc quad_perm:[1,1,3,3] row_mask:0xf bank_mask:0xf
v_cndmask_b32_dpp v53, v52, v53, vcc quad_perm:[1,1,3,3] row_mask:0xf bank_mask:0xf
v_cndmask_b32_dpp v55, v54, v55, vcc quad_perm:[1,1,3,3] row_mask:0xf bank_mask:0xf
v_cndmask_b32_dpp v57, v56, v57, vcc quad_perm:[1,1,3,3] row_mask:0xf bank_mask:0xf
v_cndmask_b32_dpp v59, v58, v59, vcc quad_perm:[1,1,3,3] row_mask:0xf bank_mask:0xf
v_cndmask_b32_dpp v61, v60, v61, vcc quad_perm:[1,1,3,3] row_mask:0xf bank_mask:0xf
v_cndmask_b32_dpp v63, v62, v63, vcc quad_perm:[1,1,3,3] row_mask:0xf bank_mask:0xf
v_perm_b32 v8, v113, v112, s26
v_perm_b32 v9, v115, v114, s26
v_perm_b32 v10, v117, v116, s26
v_perm_b32 v11, v119, v118, s26
v_perm_b32 v12, v51, v49, s26
v_perm_b32 v13, v55, v53, s26
v_perm_b32 v14, v59, v57, s26
v_perm_b32 v15, v63, v61, s26
v_accvgpr_write_b32 a224, v8
v_accvgpr_write_b32 a225, v9
v_accvgpr_write_b32 a226, v10
v_accvgpr_write_b32 a227, v11
v_accvgpr_write_b32 a228, v12
v_accvgpr_write_b32 a229, v13
v_accvgpr_write_b32 a230, v14
v_accvgpr_write_b32 a231, v15
v_perm_b32 v8, v113, v112, s27
v_perm_b32 v9, v115, v114, s27
v_perm_b32 v10, v117, v116, s27
v_perm_b32 v11, v119, v118, s27
v_perm_b32 v12, v51, v49, s27
v_perm_b32 v13, v55, v53, s27
v_perm_b32 v14, v59, v57, s27
v_perm_b32 v15, v63, v61, s27
v_accvgpr_write_b32 a232, v8
v_accvgpr_write_b32 a233, v9
v_accvgpr_write_b32 a234, v10
v_accvgpr_write_b32 a235, v11
v_accvgpr_write_b32 a236, v12
v_accvgpr_write_b32 a237, v13
v_accvgpr_write_b32 a238, v14
v_accvgpr_write_b32 a239, v15
s_mov_b64 vcc, s[30:31]
v_cndmask_b32_dpp v112, v65, v64, vcc quad_perm:[0,0,2,2] row_mask:0xf bank_mask:0xf
v_cndmask_b32_dpp v113, v67, v66, vcc quad_perm:[0,0,2,2] row_mask:0xf bank_mask:0xf
v_cndmask_b32_dpp v114, v69, v68, vcc quad_perm:[0,0,2,2] row_mask:0xf bank_mask:0xf
v_cndmask_b32_dpp v115, v71, v70, vcc quad_perm:[0,0,2,2] row_mask:0xf bank_mask:0xf
v_cndmask_b32_dpp v116, v73, v72, vcc quad_perm:[0,0,2,2] row_mask:0xf bank_mask:0xf
v_cndmask_b32_dpp v117, v75, v74, vcc quad_perm:[0,0,2,2] row_mask:0xf bank_mask:0xf
v_cndmask_b32_dpp v118, v77, v76, vcc quad_perm:[0,0,2,2] row_mask:0xf bank_mask:0xf
v_cndmask_b32_dpp v119, v79, v78, vcc quad_perm:[0,0,2,2] row_mask:0xf bank_mask:0xf
s_not_b64 vcc, vcc
v_cndmask_b32_dpp v65, v64, v65, vcc quad_perm:[1,1,3,3] row_mask:0xf bank_mask:0xf
v_cndmask_b32_dpp v67, v66, v67, vcc quad_perm:[1,1,3,3] row_mask:0xf bank_mask:0xf
v_cndmask_b32_dpp v69, v68, v69, vcc quad_perm:[1,1,3,3] row_mask:0xf bank_mask:0xf
v_cndmask_b32_dpp v71, v70, v71, vcc quad_perm:[1,1,3,3] row_mask:0xf bank_mask:0xf
v_cndmask_b32_dpp v73, v72, v73, vcc quad_perm:[1,1,3,3] row_mask:0xf bank_mask:0xf
v_cndmask_b32_dpp v75, v74, v75, vcc quad_perm:[1,1,3,3] row_mask:0xf bank_mask:0xf
v_cndmask_b32_dpp v77, v76, v77, vcc quad_perm:[1,1,3,3] row_mask:0xf bank_mask:0xf
v_cndmask_b32_dpp v79, v78, v79, vcc quad_perm:[1,1,3,3] row_mask:0xf bank_mask:0xf
v_perm_b32 v8, v113, v112, s26
v_perm_b32 v9, v115, v114, s26
v_perm_b32 v10, v117, v116, s26
v_perm_b32 v11, v119, v118, s26
v_perm_b32 v12, v67, v65, s26
v_perm_b32 v13, v71, v69, s26
v_perm_b32 v14, v75, v73, s26
v_perm_b32 v15, v79, v77, s26
v_accvgpr_write_b32 a240, v8
v_accvgpr_write_b32 a241, v9
v_accvgpr_write_b32 a242, v10
v_accvgpr_write_b32 a243, v11
v_accvgpr_write_b32 a244, v12
v_accvgpr_write_b32 a245, v13
v_accvgpr_write_b32 a246, v14
v_accvgpr_write_b32 a247, v15
v_perm_b32 v8, v113, v112, s27
v_perm_b32 v9, v115, v114, s27
v_perm_b32 v10, v117, v116, s27
v_perm_b32 v11, v119, v118, s27
v_perm_b32 v12, v67, v65, s27
v_perm_b32 v13, v71, v69, s27
v_perm_b32 v14, v75, v73, s27
v_perm_b32 v15, v79, v77, s27
v_accvgpr_write_b32 a248, v8
v_accvgpr_write_b32 a249, v9
v_accvgpr_write_b32 a250, v10
v_accvgpr_write_b32 a251, v11
v_accvgpr_write_b32 a252, v12
v_accvgpr_write_b32 a253, v13
v_accvgpr_write_b32 a254, v14
v_accvgpr_write_b32 a255, v15
v_readlane_b32 s79, v124, 0
v_mbcnt_lo_u32_b32 v113, -1, 0
v_lshlrev_b32 v112, 4, v113
s_lshl_b32 s3, s17, 5
s_add_u32 s3, s3, s16
s_lshl_b32 s76, s3, 8
s_add_u32 s76, s76, 159383552
s_mov_b64 exec, 0xfff
buffer_load_dword v7, v112, s[12:15], s76 offen sc1
s_mov_b64 exec, -1
s_add_u32 s25, s29, 0
buffer_load_dwordx2 v[48:49], v5, s[48:51], s25 offen
s_add_u32 s25, s29, 2048
buffer_load_dwordx2 v[50:51], v5, s[48:51], s25 offen
s_add_u32 s25, s29, 4096
buffer_load_dwordx2 v[52:53], v5, s[48:51], s25 offen
s_add_u32 s25, s29, 6144
buffer_load_dwordx2 v[54:55], v5, s[48:51], s25 offen
s_add_u32 s25, s29, 1024
buffer_load_dwordx2 v[56:57], v5, s[48:51], s25 offen
s_add_u32 s25, s29, 3072
buffer_load_dwordx2 v[58:59], v5, s[48:51], s25 offen
s_add_u32 s25, s29, 5120
buffer_load_dwordx2 v[60:61], v5, s[48:51], s25 offen
s_add_u32 s25, s29, 7168
buffer_load_dwordx2 v[62:63], v5, s[48:51], s25 offen
s_add_u32 s25, s29, 16384
buffer_load_dwordx2 v[64:65], v5, s[48:51], s25 offen
s_add_u32 s25, s29, 18432
buffer_load_dwordx2 v[66:67], v5, s[48:51], s25 offen
s_add_u32 s25, s29, 20480
buffer_load_dwordx2 v[68:69], v5, s[48:51], s25 offen
s_add_u32 s25, s29, 22528
buffer_load_dwordx2 v[70:71], v5, s[48:51], s25 offen
s_add_u32 s25, s29, 17408
buffer_load_dwordx2 v[72:73], v5, s[48:51], s25 offen
s_add_u32 s25, s29, 19456
buffer_load_dwordx2 v[74:75], v5, s[48:51], s25 offen
s_add_u32 s25, s29, 21504
buffer_load_dwordx2 v[76:77], v5, s[48:51], s25 offen
s_add_u32 s25, s29, 23552
buffer_load_dwordx2 v[78:79], v5, s[48:51], s25 offen
s_mov_b64 vcc, s[30:31]
s_waitcnt vmcnt(48)
v_cndmask_b32_dpp v112, v81, v80, vcc quad_perm:[0,0,2,2] row_mask:0xf bank_mask:0xf
s_waitcnt vmcnt(47)
v_cndmask_b32_dpp v113, v83, v82, vcc quad_perm:[0,0,2,2] row_mask:0xf bank_mask:0xf
s_waitcnt vmcnt(46)
v_cndmask_b32_dpp v114, v85, v84, vcc quad_perm:[0,0,2,2] row_mask:0xf bank_mask:0xf
s_waitcnt vmcnt(45)
v_cndmask_b32_dpp v115, v87, v86, vcc quad_perm:[0,0,2,2] row_mask:0xf bank_mask:0xf
s_waitcnt vmcnt(44)
v_cndmask_b32_dpp v116, v89, v88, vcc quad_perm:[0,0,2,2] row_mask:0xf bank_mask:0xf
s_waitcnt vmcnt(43)
v_cndmask_b32_dpp v117, v91, v90, vcc quad_perm:[0,0,2,2] row_mask:0xf bank_mask:0xf
s_waitcnt vmcnt(42)
v_cndmask_b32_dpp v118, v93, v92, vcc quad_perm:[0,0,2,2] row_mask:0xf bank_mask:0xf
s_waitcnt vmcnt(41)
v_cndmask_b32_dpp v119, v95, v94, vcc quad_perm:[0,0,2,2] row_mask:0xf bank_mask:0xf
s_not_b64 vcc, vcc
v_cndmask_b32_dpp v81, v80, v81, vcc quad_perm:[1,1,3,3] row_mask:0xf bank_mask:0xf
v_cndmask_b32_dpp v83, v82, v83, vcc quad_perm:[1,1,3,3] row_mask:0xf bank_mask:0xf
v_cndmask_b32_dpp v85, v84, v85, vcc quad_perm:[1,1,3,3] row_mask:0xf bank_mask:0xf
v_cndmask_b32_dpp v87, v86, v87, vcc quad_perm:[1,1,3,3] row_mask:0xf bank_mask:0xf
v_cndmask_b32_dpp v89, v88, v89, vcc quad_perm:[1,1,3,3] row_mask:0xf bank_mask:0xf
v_cndmask_b32_dpp v91, v90, v91, vcc quad_perm:[1,1,3,3] row_mask:0xf bank_mask:0xf
v_cndmask_b32_dpp v93, v92, v93, vcc quad_perm:[1,1,3,3] row_mask:0xf bank_mask:0xf
v_cndmask_b32_dpp v95, v94, v95, vcc quad_perm:[1,1,3,3] row_mask:0xf bank_mask:0xf
v_perm_b32 v128, v113, v112, s26
v_perm_b32 v129, v115, v114, s26
v_perm_b32 v130, v117, v116, s26
v_perm_b32 v131, v119, v118, s26
v_perm_b32 v132, v83, v81, s26
v_perm_b32 v133, v87, v85, s26
v_perm_b32 v134, v91, v89, s26
v_perm_b32 v135, v95, v93, s26
v_perm_b32 v136, v113, v112, s27
v_perm_b32 v137, v115, v114, s27
v_perm_b32 v138, v117, v116, s27
v_perm_b32 v139, v119, v118, s27
v_perm_b32 v140, v83, v81, s27
v_perm_b32 v141, v87, v85, s27
v_perm_b32 v142, v91, v89, s27
v_perm_b32 v143, v95, v93, s27
s_mov_b64 vcc, s[30:31]
s_waitcnt vmcnt(40)
v_cndmask_b32_dpp v112, v97, v96, vcc quad_perm:[0,0,2,2] row_mask:0xf bank_mask:0xf
s_waitcnt vmcnt(39)
v_cndmask_b32_dpp v113, v99, v98, vcc quad_perm:[0,0,2,2] row_mask:0xf bank_mask:0xf
s_waitcnt vmcnt(38)
v_cndmask_b32_dpp v114, v101, v100, vcc quad_perm:[0,0,2,2] row_mask:0xf bank_mask:0xf
s_waitcnt vmcnt(37)
v_cndmask_b32_dpp v115, v103, v102, vcc quad_perm:[0,0,2,2] row_mask:0xf bank_mask:0xf
s_waitcnt vmcnt(36)
v_cndmask_b32_dpp v116, v105, v104, vcc quad_perm:[0,0,2,2] row_mask:0xf bank_mask:0xf
s_waitcnt vmcnt(35)
v_cndmask_b32_dpp v117, v107, v106, vcc quad_perm:[0,0,2,2] row_mask:0xf bank_mask:0xf
s_waitcnt vmcnt(34)
v_cndmask_b32_dpp v118, v109, v108, vcc quad_perm:[0,0,2,2] row_mask:0xf bank_mask:0xf
s_waitcnt vmcnt(33)
v_cndmask_b32_dpp v119, v111, v110, vcc quad_perm:[0,0,2,2] row_mask:0xf bank_mask:0xf
s_not_b64 vcc, vcc
v_cndmask_b32_dpp v97, v96, v97, vcc quad_perm:[1,1,3,3] row_mask:0xf bank_mask:0xf
v_cndmask_b32_dpp v99, v98, v99, vcc quad_perm:[1,1,3,3] row_mask:0xf bank_mask:0xf
v_cndmask_b32_dpp v101, v100, v101, vcc quad_perm:[1,1,3,3] row_mask:0xf bank_mask:0xf
v_cndmask_b32_dpp v103, v102, v103, vcc quad_perm:[1,1,3,3] row_mask:0xf bank_mask:0xf
v_cndmask_b32_dpp v105, v104, v105, vcc quad_perm:[1,1,3,3] row_mask:0xf bank_mask:0xf
v_cndmask_b32_dpp v107, v106, v107, vcc quad_perm:[1,1,3,3] row_mask:0xf bank_mask:0xf
v_cndmask_b32_dpp v109, v108, v109, vcc quad_perm:[1,1,3,3] row_mask:0xf bank_mask:0xf
v_cndmask_b32_dpp v111, v110, v111, vcc quad_perm:[1,1,3,3] row_mask:0xf bank_mask:0xf
v_perm_b32 v144, v113, v112, s26
v_perm_b32 v145, v115, v114, s26
v_perm_b32 v146, v117, v116, s26
v_perm_b32 v147, v119, v118, s26
v_perm_b32 v148, v99, v97, s26
v_perm_b32 v149, v103, v101, s26
v_perm_b32 v150, v107, v105, s26
v_perm_b32 v151, v111, v109, s26
v_perm_b32 v152, v113, v112, s27
v_perm_b32 v153, v115, v114, s27
v_perm_b32 v154, v117, v116, s27
v_perm_b32 v155, v119, v118, s27
v_perm_b32 v156, v99, v97, s27
v_perm_b32 v157, v103, v101, s27
v_perm_b32 v158, v107, v105, s27
v_perm_b32 v159, v111, v109, s27
s_add_u32 s25, s23, 65536
buffer_load_dwordx2 v[80:81], v5, s[48:51], s25 offen
s_add_u32 s25, s23, 67584
buffer_load_dwordx2 v[82:83], v5, s[48:51], s25 offen
s_add_u32 s25, s23, 69632
buffer_load_dwordx2 v[84:85], v5, s[48:51], s25 offen
s_add_u32 s25, s23, 71680
buffer_load_dwordx2 v[86:87], v5, s[48:51], s25 offen
s_add_u32 s25, s23, 66560
buffer_load_dwordx2 v[88:89], v5, s[48:51], s25 offen
s_add_u32 s25, s23, 68608
buffer_load_dwordx2 v[90:91], v5, s[48:51], s25 offen
s_add_u32 s25, s23, 70656
buffer_load_dwordx2 v[92:93], v5, s[48:51], s25 offen
s_add_u32 s25, s23, 72704
buffer_load_dwordx2 v[94:95], v5, s[48:51], s25 offen
s_add_u32 s25, s23, 81920
buffer_load_dwordx2 v[96:97], v5, s[48:51], s25 offen
s_add_u32 s25, s23, 83968
buffer_load_dwordx2 v[98:99], v5, s[48:51], s25 offen
s_add_u32 s25, s23, 86016
buffer_load_dwordx2 v[100:101], v5, s[48:51], s25 offen
s_add_u32 s25, s23, 88064
buffer_load_dwordx2 v[102:103], v5, s[48:51], s25 offen
s_add_u32 s25, s23, 82944
buffer_load_dwordx2 v[104:105], v5, s[48:51], s25 offen
s_add_u32 s25, s23, 84992
buffer_load_dwordx2 v[106:107], v5, s[48:51], s25 offen
s_add_u32 s25, s23, 87040
buffer_load_dwordx2 v[108:109], v5, s[48:51], s25 offen
s_add_u32 s25, s23, 89088
buffer_load_dwordx2 v[110:111], v5, s[48:51], s25 offen
s_waitcnt vmcnt(47)
v_perm_b32 v160, v18, v16, s26
s_waitcnt vmcnt(45)
v_perm_b32 v161, v22, v20, s26
s_waitcnt vmcnt(43)
v_perm_b32 v162, v26, v24, s26
s_waitcnt vmcnt(41)
v_perm_b32 v163, v30, v28, s26
s_waitcnt vmcnt(39)
v_perm_b32 v164, v34, v32, s26
s_waitcnt vmcnt(37)
v_perm_b32 v165, v38, v36, s26
s_waitcnt vmcnt(35)
v_perm_b32 v166, v42, v40, s26
s_waitcnt vmcnt(33)
v_perm_b32 v167, v46, v44, s26
v_perm_b32 v168, v18, v16, s27
v_perm_b32 v169, v22, v20, s27
v_perm_b32 v170, v26, v24, s27
v_perm_b32 v171, v30, v28, s27
v_perm_b32 v172, v34, v32, s27
v_perm_b32 v173, v38, v36, s27
v_perm_b32 v174, v42, v40, s27
v_perm_b32 v175, v46, v44, s27
v_perm_b32 v176, v19, v17, s26
v_perm_b32 v177, v23, v21, s26
v_perm_b32 v178, v27, v25, s26
v_perm_b32 v179, v31, v29, s26
v_perm_b32 v180, v35, v33, s26
v_perm_b32 v181, v39, v37, s26
v_perm_b32 v182, v43, v41, s26
v_perm_b32 v183, v47, v45, s26
v_perm_b32 v184, v19, v17, s27
v_perm_b32 v185, v23, v21, s27
v_perm_b32 v186, v27, v25, s27
v_perm_b32 v187, v31, v29, s27
v_perm_b32 v188, v35, v33, s27
v_perm_b32 v189, v39, v37, s27
v_perm_b32 v190, v43, v41, s27
v_perm_b32 v191, v47, v45, s27
s_add_u32 s25, s29, 65536
buffer_load_dwordx2 v[16:17], v5, s[48:51], s25 offen
s_add_u32 s25, s29, 67584
buffer_load_dwordx2 v[18:19], v5, s[48:51], s25 offen
s_add_u32 s25, s29, 69632
buffer_load_dwordx2 v[20:21], v5, s[48:51], s25 offen
s_add_u32 s25, s29, 71680
buffer_load_dwordx2 v[22:23], v5, s[48:51], s25 offen
s_add_u32 s25, s29, 66560
buffer_load_dwordx2 v[24:25], v5, s[48:51], s25 offen
s_add_u32 s25, s29, 68608
buffer_load_dwordx2 v[26:27], v5, s[48:51], s25 offen
s_add_u32 s25, s29, 70656
buffer_load_dwordx2 v[28:29], v5, s[48:51], s25 offen
s_add_u32 s25, s29, 72704
buffer_load_dwordx2 v[30:31], v5, s[48:51], s25 offen
s_add_u32 s25, s29, 81920
buffer_load_dwordx2 v[32:33], v5, s[48:51], s25 offen
s_add_u32 s25, s29, 83968
buffer_load_dwordx2 v[34:35], v5, s[48:51], s25 offen
s_add_u32 s25, s29, 86016
buffer_load_dwordx2 v[36:37], v5, s[48:51], s25 offen
s_add_u32 s25, s29, 88064
buffer_load_dwordx2 v[38:39], v5, s[48:51], s25 offen
s_add_u32 s25, s29, 82944
buffer_load_dwordx2 v[40:41], v5, s[48:51], s25 offen
s_add_u32 s25, s29, 84992
buffer_load_dwordx2 v[42:43], v5, s[48:51], s25 offen
s_add_u32 s25, s29, 87040
buffer_load_dwordx2 v[44:45], v5, s[48:51], s25 offen
s_add_u32 s25, s29, 89088
buffer_load_dwordx2 v[46:47], v5, s[48:51], s25 offen
s_waitcnt vmcnt(46)
v_perm_b32 v192, v50, v48, s26
s_waitcnt vmcnt(44)
v_perm_b32 v193, v54, v52, s26
s_waitcnt vmcnt(42)
v_perm_b32 v194, v58, v56, s26
s_waitcnt vmcnt(40)
v_perm_b32 v195, v62, v60, s26
s_waitcnt vmcnt(38)
v_perm_b32 v196, v66, v64, s26
s_waitcnt vmcnt(36)
v_perm_b32 v197, v70, v68, s26
s_waitcnt vmcnt(34)
v_perm_b32 v198, v74, v72, s26
s_waitcnt vmcnt(32)
v_perm_b32 v199, v78, v76, s26
v_perm_b32 v200, v50, v48, s27
v_perm_b32 v201, v54, v52, s27
v_perm_b32 v202, v58, v56, s27
v_perm_b32 v203, v62, v60, s27
v_perm_b32 v204, v66, v64, s27
v_perm_b32 v205, v70, v68, s27
v_perm_b32 v206, v74, v72, s27
v_perm_b32 v207, v78, v76, s27
v_perm_b32 v208, v51, v49, s26
v_perm_b32 v209, v55, v53, s26
v_perm_b32 v210, v59, v57, s26
v_perm_b32 v211, v63, v61, s26
v_perm_b32 v212, v67, v65, s26
v_perm_b32 v213, v71, v69, s26
v_perm_b32 v214, v75, v73, s26
v_perm_b32 v215, v79, v77, s26
v_perm_b32 v216, v51, v49, s27
v_perm_b32 v217, v55, v53, s27
v_perm_b32 v218, v59, v57, s27
v_perm_b32 v219, v63, v61, s27
v_perm_b32 v220, v67, v65, s27
v_perm_b32 v221, v71, v69, s27
v_perm_b32 v222, v75, v73, s27
v_perm_b32 v223, v79, v77, s27
s_mov_b64 exec, 0xfff
v_cmp_gt_u32_e64 vcc, 2, v7
s_mov_b64 exec, -1
s_cmp_eq_u64 vcc, 0
s_cselect_b32 s76, s79, 0
s_cmp_ge_u32 s76, 48
s_cselect_b32 s78, 1, 0
s_cbranch_scc0 CNL_9
s_load_dwordx2 s[72:73], s[0:1], 8
s_mov_b32 s74, 8192
s_mov_b32 s75, 0x20000
v_mbcnt_lo_u32_b32 v113, -1, 0
v_mbcnt_hi_u32_b32 v113, -1, v113
v_lshlrev_b32 v112, 4, v113
s_lshl_b32 s3, s17, 5
s_add_u32 s3, s3, s16
s_lshl_b32 s3, s3, 6
s_mul_i32 s77, s3, 24576
s_lshl_b32 s3, s19, 12
s_add_u32 m0, s3, 8192
s_add_u32 s3, s3, s77
buffer_load_dwordx4 v112, s[12:15], s3 offen offset:0 sc1 lds
buffer_load_dwordx4 v112, s[12:15], s3 offen offset:1024 sc1 lds
buffer_load_dwordx4 v112, s[12:15], s3 offen offset:2048 sc1 lds
buffer_load_dwordx4 v112, s[12:15], s3 offen offset:3072 sc1 lds
v_and_b32_e64 v114, 1, v113
v_bfe_u32 v115, v113, 2, 2
v_lshl_add_u32 v114, v115, 1, v114
v_lshrrev_b32_e64 v115, 4, v113
v_bfe_u32 v113, v113, 1, 1
v_lshlrev_b32_e64 v114, 10, v114
v_lshl_add_u32 v114, v115, 5, v114
v_lshl_add_u32 v114, v113, 4, v114
s_lshl_b32 s3, s19, 11
s_add_u32 s3, s3, s77
s_add_u32 s3, s3, 16384
buffer_load_dwordx4 v[116:119], v112, s[12:15], s3 offen sc1
buffer_load_dwordx4 v[120:123], v112, s[12:15], s3 offen offset:1024 sc1
s_lshl_b32 s3, s17, 19
s_lshl_b32 s76, s16, 13
s_add_u32 s3, s3, s76
s_and_b32 s76, s19, 1
s_lshl_b32 s76, s76, 18
s_add_u32 s3, s3, s76
s_add_u32 s3, s3, 153092096
s_lshl_b32 s76, s17, 15
s_lshl_b32 s77, s16, 10
s_add_u32 s76, s76, s77
s_add_u32 s76, s76, 154140672
s_cmp_lt_u32 s19, 2
s_cselect_b32 s3, s3, s76
s_cselect_b32 s76, 3, 0
v_lshlrev_b32 v115, s76, v112
buffer_load_dword v115, v115, s[12:15], s3 offen sc1
s_waitcnt lgkmcnt(0)
s_lshl_b32 s3, s19, 11
s_add_u32 m0, s3, 0
s_lshl_b32 s3, s19, 8
s_add_u32 s3, s3, 0
buffer_load_dwordx4 v114, s[72:75], s3 offen lds
s_lshl_b32 s3, s19, 11
s_add_u32 m0, s3, 1024
s_lshl_b32 s3, s19, 8
s_add_u32 s3, s3, 128
buffer_load_dwordx4 v114, s[72:75], s3 offen lds
CNL_9:
s_waitcnt vmcnt(30)
v_perm_b32 v224, v82, v80, s26
s_waitcnt vmcnt(28)
v_perm_b32 v225, v86, v84, s26
s_waitcnt vmcnt(26)
v_perm_b32 v226, v90, v88, s26
s_waitcnt vmcnt(24)
v_perm_b32 v227, v94, v92, s26
s_waitcnt vmcnt(22)
v_perm_b32 v228, v98, v96, s26
s_waitcnt vmcnt(20)
v_perm_b32 v229, v102, v100, s26
s_waitcnt vmcnt(18)
v_perm_b32 v230, v106, v104, s26
s_waitcnt vmcnt(16)
v_perm_b32 v231, v110, v108, s26
v_perm_b32 v232, v82, v80, s27
v_perm_b32 v233, v86, v84, s27
v_perm_b32 v234, v90, v88, s27
v_perm_b32 v235, v94, v92, s27
v_perm_b32 v236, v98, v96, s27
v_perm_b32 v237, v102, v100, s27
v_perm_b32 v238, v106, v104, s27
v_perm_b32 v239, v110, v108, s27
v_perm_b32 v240, v83, v81, s26
v_perm_b32 v241, v87, v85, s26
v_perm_b32 v242, v91, v89, s26
v_perm_b32 v243, v95, v93, s26
v_perm_b32 v244, v99, v97, s26
v_perm_b32 v245, v103, v101, s26
v_perm_b32 v246, v107, v105, s26
v_perm_b32 v247, v111, v109, s26
v_perm_b32 v248, v83, v81, s27
v_perm_b32 v249, v87, v85, s27
v_perm_b32 v250, v91, v89, s27
v_perm_b32 v251, v95, v93, s27
v_perm_b32 v252, v99, v97, s27
v_perm_b32 v253, v103, v101, s27
v_perm_b32 v254, v107, v105, s27
v_perm_b32 v255, v111, v109, s27
s_waitcnt vmcnt(14)
v_perm_b32 v8, v18, v16, s26
s_waitcnt vmcnt(12)
v_perm_b32 v9, v22, v20, s26
s_waitcnt vmcnt(10)
v_perm_b32 v10, v26, v24, s26
s_waitcnt vmcnt(8)
v_perm_b32 v11, v30, v28, s26
s_waitcnt vmcnt(6)
v_perm_b32 v12, v34, v32, s26
s_waitcnt vmcnt(4)
v_perm_b32 v13, v38, v36, s26
s_waitcnt vmcnt(2)
v_perm_b32 v14, v42, v40, s26
s_waitcnt vmcnt(0)
v_perm_b32 v15, v46, v44, s26
ds_write_b128 v6, v[8:11] offset:24576
ds_write_b128 v6, v[12:15] offset:25600
v_perm_b32 v8, v18, v16, s27
v_perm_b32 v9, v22, v20, s27
v_perm_b32 v10, v26, v24, s27
v_perm_b32 v11, v30, v28, s27
v_perm_b32 v12, v34, v32, s27
v_perm_b32 v13, v38, v36, s27
v_perm_b32 v14, v42, v40, s27
v_perm_b32 v15, v46, v44, s27
ds_write_b128 v6, v[8:11] offset:26624
ds_write_b128 v6, v[12:15] offset:27648
v_perm_b32 v8, v19, v17, s26
v_perm_b32 v9, v23, v21, s26
v_perm_b32 v10, v27, v25, s26
v_perm_b32 v11, v31, v29, s26
v_perm_b32 v12, v35, v33, s26
v_perm_b32 v13, v39, v37, s26
v_perm_b32 v14, v43, v41, s26
v_perm_b32 v15, v47, v45, s26
ds_write_b128 v6, v[8:11] offset:28672
ds_write_b128 v6, v[12:15] offset:29696
v_perm_b32 v8, v19, v17, s27
v_perm_b32 v9, v23, v21, s27
v_perm_b32 v10, v27, v25, s27
v_perm_b32 v11, v31, v29, s27
v_perm_b32 v12, v35, v33, s27
v_perm_b32 v13, v39, v37, s27
v_perm_b32 v14, v43, v41, s27
v_perm_b32 v15, v47, v45, s27
ds_write_b128 v6, v[8:11] offset:30720
ds_write_b128 v6, v[12:15] offset:31744
v_mov_b64 v[12:13], 0
v_mov_b64 v[14:15], 0
v_lshlrev_b32_e64 v8, 4, v0
ds_write_b128 v8, v[12:15] offset:31232
v_mov_b32 v125, v7
s_waitcnt lgkmcnt(0)
s_cmp_eq_u32 s19, 1
s_cbranch_scc1 CW1
s_cmp_eq_u32 s19, 2
s_cbranch_scc1 CW2
s_cmp_eq_u32 s19, 3
s_cbranch_scc1 CW3
CW0:
v_and_b32 v20, 15, v0
v_lshrrev_b32 v21, 4, v0
v_lshrrev_b32 v22, 2, v20
v_and_b32 v23, 1, v20
v_lshl_add_u32 v24, v22, 1, v23
v_bfe_u32 v25, v20, 1, 1
v_mov_b32_e64 v26, v0
v_lshlrev_b32 v0, 4, v26
v_add_u32 v1, 32768, v0
s_movk_i32 s3, 144
v_lshrrev_b32_e64 v27, 1, v20
v_mul_lo_u32 v27, v27, s3
v_lshl_add_u32 v27, v21, 5, v27
v_lshl_add_u32 v27, v23, 3, v27
v_add_u32 v2, 24576, v27
v_mul_lo_u32 v27, v21, s3
v_lshl_add_u32 v27, v24, 4, v27
v_add_u32 v3, 24576, v27
v_lshl_add_u32 v27, v21, 1, v25
v_mul_lo_u32 v27, v27, s3
v_lshl_add_u32 v27, v24, 4, v27
v_add_u32 v4, 26880, v27
v_mul_u32_u24 v27, 0xaaaa, v25
v_add_u32 v5, 0x4444, v27
v_lshlrev_b32_e64 v27, 13, v22
v_lshl_add_u32 v27, v21, 11, v27
v_and_b32_e64 v28, 3, v20
v_lshl_add_u32 v27, v28, 4, v27
s_lshl_b32 s3, s16, 6
s_add_u32 s3, s3, 0
v_add_u32_e64 v6, s3, v27
s_mov_b32 s60, 0x30003
s_mov_b32 s61, 0x30003
s_mov_b32 s62, 0xc000c
s_mov_b32 s63, 0xc000c
s_mov_b32 s64, 0x300030
s_mov_b32 s65, 0x300030
s_mov_b32 s66, 0xc000c0
s_mov_b32 s67, 0xc000c0
v_lshlrev_b32_e64 v28, 10, v24
v_lshl_add_u32 v28, v21, 5, v28
v_lshl_add_u32 v28, v25, 4, v28
s_mov_b32 s40, 0xc0000
s_mov_b32 s41, 0xcccccccc
s_mov_b32 s42, 0x4c0004
s_mov_b32 s43, 0xcccccccc
s_mov_b32 s44, 0x4c0004
s_mov_b32 s45, 0xcccccccc
s_mov_b32 s46, 0xcc000c
s_mov_b32 s47, 0xcccccccc
s_mov_b32 s48, 0xccc00cc
s_mov_b32 s49, 0xcccccccc
s_mov_b32 s50, 0x4ccc04cc
s_mov_b32 s51, 0xcccccccc
s_mov_b32 s52, 0x4ccc04cc
s_mov_b32 s53, 0xcccccccc
s_mov_b32 s54, 0xcccc0ccc
s_mov_b32 s55, 0xcccccccc
s_mov_b32 s56, 0x33333333
s_mov_b32 s57, 0x33333333
s_mov_b32 s58, 0xcccccccc
s_mov_b32 s59, 0xcccccccc
s_mov_b32 s38, 0x3e0293ee
s_mov_b32 s39, 0x3e0293ee
s_mov_b32 s20, 0
s_lshl_b32 s3, s17, 5
s_add_u32 s3, s3, s16
s_lshl_b32 s3, s3, 6
s_mul_i32 s21, s3, 24576
s_lshl_b32 s23, s3, 13
s_add_u32 s23, s23, 100663296
s_lshl_b32 s34, s17, 19
s_add_u32 s34, s34, 153092096
s_lshl_b32 s35, s17, 15
s_add_u32 s35, s35, 154140672
s_lshl_b32 s3, s17, 5
s_add_u32 s3, s3, s16
s_lshl_b32 s3, s3, 8
s_add_u32 s31, s3, 159383552
s_mov_b32 s30, 0
s_cmp_eq_u32 s78, 1
s_cbranch_scc1 CK_11
CF_10:
s_add_u32 s30, s30, 1
s_cmp_gt_u32 s30, 2097152
s_cbranch_scc1 FAIL
s_cmp_ge_u32 s79, 48
s_cbranch_scc1 CG_12
s_load_dwordx2 s[70:71], s[0:1], 88
v_mov_b32 v114, 208
s_waitcnt lgkmcnt(0)
s_mov_b64 exec, 1
global_load_dword v124, v114, s[70:71] sc1
s_mov_b64 exec, -1
CG_12:
s_waitcnt vmcnt(0)
v_readlane_b32 s79, v124, 0
v_mbcnt_lo_u32_b32 v113, -1, 0
v_lshlrev_b32_e64 v112, 4, v113
s_lshl_b32 s3, s17, 5
s_add_u32 s3, s3, s16
s_lshl_b32 s76, s3, 8
s_add_u32 s76, s76, 159383552
s_mov_b64 exec, 0xfff
buffer_load_dword v125, v112, s[12:15], s76 offen sc1
s_mov_b64 exec, -1
s_mov_b64 exec, 0xfff
s_waitcnt vmcnt(0)
v_cmp_gt_u32 vcc, 1, v125
s_mov_b64 exec, -1
s_cmp_eq_u64 vcc, 0
s_cselect_b32 s76, s79, 0
s_cmp_ge_u32 s76, 48
s_cbranch_scc0 CF_10
s_load_dwordx2 s[72:73], s[0:1], 8
s_mov_b32 s74, 8192
s_mov_b32 s75, 0x20000
v_mbcnt_lo_u32_b32 v113, -1, 0
v_mbcnt_hi_u32_b32 v113, -1, v113
v_lshlrev_b32 v112, 4, v113
s_lshl_b32 s3, s17, 5
s_add_u32 s3, s3, s16
s_lshl_b32 s3, s3, 6
s_mul_i32 s77, s3, 24576
s_lshl_b32 s3, s19, 12
s_add_u32 m0, s3, 8192
s_add_u32 s3, s3, s77
buffer_load_dwordx4 v112, s[12:15], s3 offen offset:0 sc1 lds
buffer_load_dwordx4 v112, s[12:15], s3 offen offset:1024 sc1 lds
buffer_load_dwordx4 v112, s[12:15], s3 offen offset:2048 sc1 lds
buffer_load_dwordx4 v112, s[12:15], s3 offen offset:3072 sc1 lds
v_and_b32_e64 v114, 1, v113
v_bfe_u32 v115, v113, 2, 2
v_lshl_add_u32 v114, v115, 1, v114
v_lshrrev_b32_e64 v115, 4, v113
v_bfe_u32 v113, v113, 1, 1
v_lshlrev_b32_e64 v114, 10, v114
v_lshl_add_u32 v114, v115, 5, v114
v_lshl_add_u32 v114, v113, 4, v114
s_lshl_b32 s3, s19, 11
s_add_u32 s3, s3, s77
s_add_u32 s3, s3, 16384
buffer_load_dwordx4 v[116:119], v112, s[12:15], s3 offen sc1
buffer_load_dwordx4 v[120:123], v112, s[12:15], s3 offen offset:1024 sc1
s_lshl_b32 s3, s17, 19
s_lshl_b32 s76, s16, 13
s_add_u32 s3, s3, s76
s_and_b32 s76, s19, 1
s_lshl_b32 s76, s76, 18
s_add_u32 s3, s3, s76
s_add_u32 s3, s3, 153092096
s_lshl_b32 s76, s17, 15
s_lshl_b32 s77, s16, 10
s_add_u32 s76, s76, s77
s_add_u32 s76, s76, 154140672
s_cmp_lt_u32 s19, 2
s_cselect_b32 s3, s3, s76
s_cselect_b32 s76, 3, 0
v_lshlrev_b32 v115, s76, v112
buffer_load_dword v115, v115, s[12:15], s3 offen sc1
s_waitcnt lgkmcnt(0)
s_lshl_b32 s3, s19, 11
s_add_u32 m0, s3, 0
s_lshl_b32 s3, s19, 8
s_add_u32 s3, s3, 0
buffer_load_dwordx4 v114, s[72:75], s3 offen lds
s_lshl_b32 s3, s19, 11
s_add_u32 m0, s3, 1024
s_lshl_b32 s3, s19, 8
s_add_u32 s3, s3, 128
buffer_load_dwordx4 v114, s[72:75], s3 offen lds
s_mov_b32 s32, 2
s_mov_b64 exec, 0xfff
FW_13:
s_add_u32 s30, s30, 1
s_cmp_gt_u32 s30, 2097152
s_cbranch_scc1 FAIL
buffer_load_dword v9, v0, s[12:15], s31 offen sc1
s_waitcnt vmcnt(0)
v_cmp_gt_u32 vcc, s32, v9
s_cbranch_vccnz FW_13
FOK_14:
s_mov_b64 exec, -1
v_mov_b32 v125, v9
CK_11:
v_mov_b32 v9, v125
s_waitcnt vmcnt(0)
ds_read_b128 v[12:15], v0 offset:0
ds_read_b128 v[16:19], v0 offset:1024
ds_read_b128 v[60:63], v1 offset:0
ds_read_b128 v[64:67], v1 offset:1024
ds_read_b128 v[68:71], v1 offset:2048
ds_read_b128 v[72:75], v1 offset:3072
ds_read_b128 v[76:79], v1 offset:4096
ds_read_b128 v[80:83], v1 offset:5120
ds_read_b128 v[84:87], v1 offset:6144
ds_read_b128 v[88:91], v1 offset:7168
ds_read_b128 v[92:95], v1 offset:8192
ds_read_b128 v[96:99], v1 offset:9216
ds_read_b128 v[100:103], v1 offset:10240
ds_read_b128 v[104:107], v1 offset:11264
v_mov_b64 v[44:45], 0
v_mov_b64 v[46:47], 0
v_mov_b64 v[48:49], 0
v_mov_b64 v[50:51], 0
v_mov_b64 v[52:53], 0
v_mov_b64 v[54:55], 0
v_mov_b64_e64 v[56:57], 0
v_mov_b64 v[58:59], 0
s_mov_b32 s68, 268435456
s_waitcnt lgkmcnt(0)
s_cmp_eq_u32 s18, 0
s_cbranch_scc1 CS0
s_add_u32 s36, s21, 16384
s_add_u32 s22, s21, 24576
s_add_u32 s37, s22, 0
v_lshlrev_b32 v7, 3, v0
s_branch CL_15
H2_22:
MT_23:
s_waitcnt vmcnt(1)
v_max_u32 v10, v12, v14
s_waitcnt vmcnt(0)
v_max3_u32 v10, v10, v16, v18
v_cmp_eq_u32_e64 vcc, -1, v10
ds_write_b128 v0, v[12:15] offset:0
ds_write_b128 v0, v[16:19] offset:1024
s_cbranch_vccnz MRE_24
CL_15:
s_waitcnt lgkmcnt(12)
v_smfmac_f32_16x16x64_bf16 v[44:47], v[12:15], v[60:67], v5
s_waitcnt lgkmcnt(10)
v_smfmac_f32_16x16x64_bf16 v[48:51], v[12:15], v[68:75], v5
s_waitcnt lgkmcnt(8)
v_smfmac_f32_16x16x64_bf16 v[52:55], v[12:15], v[76:83], v5
s_waitcnt lgkmcnt(0)
s_barrier
ds_read_b128 v[20:23], v0 offset:2048
ds_read_b128 v[24:27], v0 offset:3072
v_smfmac_f32_16x16x64_bf16 v[56:59], v[12:15], v[84:91], v5
ds_read_b128 v[28:31], v0 offset:4096
ds_read_b128 v[32:35], v0 offset:5120
buffer_store_dwordx4 v[108:111], v0, s[12:15], s68 offen offset:0 sc1
v_smfmac_f32_16x16x64_bf16 v[44:47], v[16:19], v[92:99], v5
buffer_store_dwordx4 v[112:115], v0, s[12:15], s68 offen offset:1024 sc1
ds_read_b128 v[36:39], v0 offset:6144
ds_read_b128 v[40:43], v0 offset:7168
v_smfmac_f32_16x16x64_bf16 v[48:51], v[16:19], v[100:107], v5
v_smfmac_f32_16x16x64_bf16 v[52:55], v[16:19], a[0:7], v5
ds_read_b128 v[92:95], v1 offset:20480
v_smfmac_f32_16x16x64_bf16 v[56:59], v[16:19], a[8:15], v5
ds_read_b128 v[96:99], v1 offset:21504
s_waitcnt lgkmcnt(7)
v_smfmac_f32_16x16x64_bf16 v[44:47], v[20:23], a[16:23], v5
ds_read_b128 v[100:103], v1 offset:22528
v_smfmac_f32_16x16x64_bf16 v[48:51], v[20:23], a[24:31], v5
ds_read_b128 v[104:107], v1 offset:23552
v_smfmac_f32_16x16x64_bf16 v[52:55], v[20:23], a[32:39], v5
ds_read_b128 v[60:63], v1 offset:12288
v_smfmac_f32_16x16x64_bf16 v[56:59], v[20:23], a[40:47], v5
ds_read_b128 v[64:67], v1 offset:13312
s_waitcnt lgkmcnt(10)
v_smfmac_f32_16x16x64_bf16 v[44:47], v[24:27], a[48:55], v5
ds_read_b128 v[68:71], v1 offset:14336
v_smfmac_f32_16x16x64_bf16 v[48:51], v[24:27], a[56:63], v5
ds_read_b128 v[72:75], v1 offset:15360
v_mov_b64_e64 v[108:109], 0
v_smfmac_f32_16x16x64_bf16 v[52:55], v[24:27], a[64:71], v5
ds_read_b128 v[76:79], v1 offset:16384
v_mov_b64_e64 v[110:111], 0
v_smfmac_f32_16x16x64_bf16 v[56:59], v[24:27], a[72:79], v5
ds_read_b128 v[80:83], v1 offset:17408
v_mov_b64 v[112:113], 0
s_waitcnt lgkmcnt(8)
v_smfmac_f32_16x16x64_bf16 v[44:47], v[28:31], v[92:99], v5
ds_read_b128 v[84:87], v1 offset:18432
v_mov_b64 v[114:115], 0
s_waitcnt lgkmcnt(7)
v_smfmac_f32_16x16x64_bf16 v[48:51], v[28:31], v[100:107], v5
ds_read_b128 v[88:91], v1 offset:19456
v_smfmac_f32_16x16x64_bf16 v[52:55], v[28:31], a[80:87], v5
v_mov_b32_dpp v100, v116 quad_perm:[0,1,0,1] row_mask:0xf bank_mask:0xf
v_smfmac_f32_16x16x64_bf16 v[56:59], v[28:31], a[88:95], v5
v_mov_b32_dpp v101, v117 quad_perm:[0,1,0,1] row_mask:0xf bank_mask:0xf
s_waitcnt lgkmcnt(6)
v_smfmac_f32_16x16x64_bf16 v[44:47], v[32:35], v[60:67], v5
v_mov_b32_dpp v102, v118 quad_perm:[0,1,0,1] row_mask:0xf bank_mask:0xf
s_waitcnt lgkmcnt(4)
v_smfmac_f32_16x16x64_bf16 v[48:51], v[32:35], v[68:75], v5
ds_read_b128 v[60:63], v0 offset:8192
v_mov_b32_dpp v103, v119 quad_perm:[0,1,0,1] row_mask:0xf bank_mask:0xf
s_waitcnt lgkmcnt(3)
v_smfmac_f32_16x16x64_bf16 v[52:55], v[32:35], v[76:83], v5
ds_read_b128 v[64:67], v0 offset:9216
v_mov_b32_dpp v104, v120 quad_perm:[0,1,0,1] row_mask:0xf bank_mask:0xf
s_waitcnt lgkmcnt(2)
v_smfmac_f32_16x16x64_bf16 v[56:59], v[32:35], v[84:91], v5
ds_read_b128 v[68:71], v0 offset:10240
v_mov_b32_dpp v105, v121 quad_perm:[0,1,0,1] row_mask:0xf bank_mask:0xf
v_smfmac_f32_16x16x64_bf16 v[44:47], v[36:39], a[96:103], v5
ds_read_b128 v[72:75], v0 offset:11264
v_mov_b32_dpp v106, v122 quad_perm:[0,1,0,1] row_mask:0xf bank_mask:0xf
v_smfmac_f32_16x16x64_bf16 v[44:47], v[40:43], a[128:135], v5
ds_read_b128 v[76:79], v0 offset:12288
v_mov_b32_dpp v107, v123 quad_perm:[0,1,0,1] row_mask:0xf bank_mask:0xf
v_smfmac_f32_16x16x64_bf16 v[48:51], v[36:39], a[104:111], v5
ds_read_b128 v[80:83], v0 offset:13312
v_mov_b32 v11, 0xf149f2ca
v_smfmac_f32_16x16x64_bf16 v[48:51], v[40:43], a[136:143], v5
ds_read_b128 v[84:87], v0 offset:14336
v_add_f32_e64 v44, v44, v46
v_smfmac_f32_16x16x64_bf16 v[52:55], v[36:39], a[112:119], v5
ds_read_b128 v[88:91], v0 offset:15360
v_add_f32_e64 v45, v45, v47
v_smfmac_f32_16x16x64_bf16 v[52:55], v[40:43], a[144:151], v5
v_add_f32_e64 v48, v48, v50
v_smfmac_f32_16x16x64_bf16 v[56:59], v[36:39], a[120:127], v5
v_add_f32_e64 v49, v49, v51
v_smfmac_f32_16x16x64_bf16 v[56:59], v[40:43], a[152:159], v5
v_add_f32 v52, v52, v54
v_add_f32 v53, v53, v55
v_cvt_pk_bf16_f32 v124, v44, v48
v_cvt_pk_bf16_f32 v126, v45, v49
v_cndmask_b32 v44, 0, v11, s[40:41]
v_cndmask_b32 v45, 0, v11, s[42:43]
s_nop 1
v_add_f32 v56, v56, v58
v_add_f32_e64 v57, v57, v59
v_cvt_pk_bf16_f32 v125, v52, v56
v_cvt_pk_bf16_f32 v127, v53, v57
ds_write_b64 v2, v[124:125] offset:0
ds_write_b64 v2, v[126:127] offset:16
v_smfmac_f32_16x16x64_bf16 v[108:111], v[12:15], a[160:167], v5
s_mov_b32 m0, 8192
s_add_u32 s32, s22, 0
v_cndmask_b32 v46, 0, v11, s[44:45]
v_smfmac_f32_16x16x64_bf16 v[112:115], v[12:15], a[168:175], v5
v_cndmask_b32 v47, 0, v11, s[46:47]
v_smfmac_f32_16x16x64_bf16 v[108:111], v[16:19], a[176:183], v5
v_cndmask_b32 v48, 0, v11, s[48:49]
v_smfmac_f32_16x16x64_bf16 v[112:115], v[16:19], a[184:191], v5
v_cndmask_b32 v49, 0, v11, s[50:51]
v_smfmac_f32_16x16x64_bf16 v[108:111], v[20:23], a[192:199], v5
v_cndmask_b32 v50, 0, v11, s[52:53]
s_waitcnt lgkmcnt(0)
s_barrier
s_mov_b64 exec, s[56:57]
ds_read_b128 v[116:119], v3 offset:0
ds_read_b128 v[120:123], v3 offset:576
ds_read_b128 v[100:103], v3 offset:1152
ds_read_b128 v[104:107], v3 offset:1728
s_mov_b64 exec, -1
ds_read_b128 v[92:95], v4 offset:0
ds_read_b128 v[96:99], v4 offset:1152
v_smfmac_f32_16x16x64_bf16 v[112:115], v[20:23], a[200:207], v5
v_cndmask_b32 v51, 0, v11, s[54:55]
v_smfmac_f32_16x16x64_bf16 v[108:111], v[24:27], a[208:215], v5
v_mov_b32 v53, 0
v_smfmac_f32_16x16x64_bf16 v[112:115], v[24:27], a[216:223], v5
v_mov_b32 v54, 0
v_smfmac_f32_16x16x64_bf16 v[108:111], v[28:31], a[224:231], v5
v_mov_b64 v[124:125], 0
v_smfmac_f32_16x16x64_bf16 v[112:115], v[28:31], a[232:239], v5
v_mov_b64 v[126:127], 0
s_waitcnt lgkmcnt(5)
v_mfma_f32_16x16x32_bf16 v[44:47], v[60:63], v[116:119], v[44:47]
v_mfma_f32_16x16x32_bf16 v[48:51], v[76:79], v[116:119], v[48:51]
ds_read_b128 v[60:63], v0 offset:16384
s_waitcnt lgkmcnt(5)
v_mfma_f32_16x16x32_bf16 v[44:47], v[64:67], v[120:123], v[44:47]
ds_read_b128 v[76:79], v0 offset:20480
v_mfma_f32_16x16x32_bf16 v[48:51], v[80:83], v[120:123], v[48:51]
ds_read_b128 v[64:67], v0 offset:17408
s_waitcnt lgkmcnt(4)
v_smfmac_f32_16x16x64_bf16 v[124:127], v[92:95], v[116:123], v5
ds_read_b128 v[80:83], v0 offset:21504
v_mfma_f32_16x16x32_bf16 v[44:47], v[68:71], v[100:103], v[44:47]
s_mov_b64 exec, 0xfff
buffer_load_dword v9, v0, s[12:15], s31 offen sc1
s_mov_b64 exec, -1
v_mfma_f32_16x16x32_bf16 v[48:51], v[84:87], v[100:103], v[48:51]
ds_read_b128 v[68:71], v0 offset:18432
s_waitcnt lgkmcnt(5)
v_smfmac_f32_16x16x64_bf16 v[124:127], v[96:99], v[100:107], v5
ds_read_b128 v[84:87], v0 offset:22528
v_mfma_f32_16x16x32_bf16 v[44:47], v[72:75], v[104:107], v[44:47]
v_mfma_f32_16x16x32_bf16 v[48:51], v[88:91], v[104:107], v[48:51]
ds_read_b128 v[72:75], v0 offset:19456
ds_read_b128 v[88:91], v0 offset:23552
v_add_f32 v124, v124, v126
v_add_f32 v125, v125, v127
v_max3_f32 v10, v124, v125, v44
v_max3_f32 v10, v10, v45, v46
v_smfmac_f32_16x16x64_bf16 v[108:111], v[32:35], a[240:247], v5
s_nop 0
v_max3_f32 v10, v10, v47, v48
v_max3_f32 v10, v10, v49, v50
v_max_f32 v11, v10, v51
v_max_f32_e64 v10, v10, v51
v_smfmac_f32_16x16x64_bf16 v[112:115], v[32:35], a[248:255], v5
s_nop 0
v_permlane16_swap_b32 v10, v11
v_max_f32 v10, v10, v11
v_mov_b32 v11, v10
v_smfmac_f32_16x16x64_bf16 v[108:111], v[36:39], v[128:135], v5
s_nop 0
v_permlane32_swap_b32 v10, v11
v_max_f32 v10, v10, v11
v_mul_f32 v10, s38, v10
v_fma_f32 v124, v124, s38, -v10
v_fma_f32 v125, v125, s38, -v10
v_pk_fma_f32 v[44:45], v[44:45], s[38:39], v[10:11] op_sel_hi:[1,1,0] neg_lo:[0,0,1] neg_hi:[0,0,1]
v_pk_fma_f32 v[46:47], v[46:47], s[38:39], v[10:11] op_sel_hi:[1,1,0] neg_lo:[0,0,1] neg_hi:[0,0,1]
v_pk_fma_f32 v[48:49], v[48:49], s[38:39], v[10:11] op_sel_hi:[1,1,0] neg_lo:[0,0,1] neg_hi:[0,0,1]
v_pk_fma_f32 v[50:51], v[50:51], s[38:39], v[10:11] op_sel_hi:[1,1,0] neg_lo:[0,0,1] neg_hi:[0,0,1]
v_smfmac_f32_16x16x64_bf16 v[112:115], v[36:39], v[136:143], v5
buffer_load_dwordx4 v0, s[12:15], s32 offen offset:0 sc1 lds
v_exp_f32 v44, v44
v_smfmac_f32_16x16x64_bf16 v[108:111], v[40:43], v[144:151], v5
v_exp_f32 v45, v45
v_smfmac_f32_16x16x64_bf16 v[112:115], v[40:43], v[152:159], v5
buffer_load_dwordx4 v0, s[12:15], s32 offen offset:1024 sc1 lds
v_exp_f32 v46, v46
v_exp_f32 v47, v47
v_exp_f32 v48, v48
v_exp_f32 v49, v49
v_exp_f32 v50, v50
v_exp_f32 v51, v51
v_exp_f32 v124, v124
v_exp_f32 v125, v125
v_pk_add_f32 v[108:109], v[108:109], v[110:111]
v_pk_add_f32 v[10:11], v[44:45], v[46:47]
v_pk_add_f32 v[126:127], v[48:49], v[50:51]
v_pk_add_f32 v[10:11], v[10:11], v[124:125]
v_pk_add_f32 v[10:11], v[10:11], v[126:127]
v_pk_add_f32 v[112:113], v[112:113], v[114:115]
v_add_f32 v126, v10, v11
v_add_f32 v10, v10, v11
v_cvt_pk_bf16_f32 v108, v108, v109
v_cvt_pk_bf16_f32 v109, v112, v113
v_permlane16_swap_b32 v10, v126
v_add_f32 v11, v10, v126
v_add_f32 v10, v10, v126
ds_write_b64 v0, v[108:109] offset:29184
s_mov_b64 vcc, s[56:57]
v_permlane32_swap_b32 v10, v11
v_add_f32 v10, v10, v11
v_rcp_f32_e64 v10, v10
s_mov_b32 m0, 16384
v_pk_mul_f32 v[44:45], v[44:45], v[10:11] op_sel_hi:[1,0]
v_pk_mul_f32 v[46:47], v[46:47], v[10:11] op_sel_hi:[1,0]
v_pk_mul_f32 v[48:49], v[48:49], v[10:11] op_sel_hi:[1,0]
v_pk_mul_f32 v[50:51], v[50:51], v[10:11] op_sel_hi:[1,0]
v_pk_mul_f32 v[124:125], v[124:125], v[10:11] op_sel_hi:[1,0]
v_cvt_pk_bf16_f32 v56, v44, v45
v_cvt_pk_bf16_f32 v57, v46, v47
v_cvt_pk_bf16_f32 v58, v48, v49
v_cvt_pk_bf16_f32 v59, v50, v51
v_cvt_pk_bf16_f32 v52, v124, v125
v_cvt_pk_bf16_f32 v55, v124, v125
s_waitcnt lgkmcnt(8)
v_mfma_f32_16x16x32_bf16 v[92:95], v[60:63], v[56:59], 0
s_waitcnt lgkmcnt(0)
s_barrier
ds_read_b128 v[116:119], v0 offset:29184
ds_read_b128 v[120:123], v0 offset:30208
v_mfma_f32_16x16x32_bf16 v[96:99], v[64:67], v[56:59], 0
s_add_u32 s33, s22, 8192
s_cmp_eq_u32 s20, 63
v_mov_b64 v[12:13], 0
v_mov_b64 v[14:15], 0
v_mfma_f32_16x16x32_bf16 v[100:103], v[68:71], v[56:59], 0
v_mov_b64 v[16:17], 0
v_mov_b64 v[18:19], 0
v_mfma_f32_16x16x32_bf16 v[104:107], v[72:75], v[56:59], 0
v_mov_b64 v[20:21], 0
v_mov_b64 v[22:23], 0
v_mfma_f32_16x16x32_bf16 v[60:63], v[76:79], v[56:59], 0
v_mov_b64 v[24:25], 0
v_mov_b64 v[26:27], 0
s_waitcnt lgkmcnt(1)
v_mfma_f32_16x16x16_bf16 v[92:95], v[116:117], v[52:53], v[92:95]
v_mov_b64 v[28:29], 0
v_mov_b64 v[30:31], 0
v_mfma_f32_16x16x16_bf16 v[96:99], v[116:117], v[54:55], v[96:99]
v_mov_b64 v[32:33], 0
v_mov_b64 v[34:35], 0
v_mfma_f32_16x16x16_bf16 v[100:103], v[118:119], v[52:53], v[100:103]
buffer_load_dwordx4 v0, s[12:15], s33 offen offset:0 sc1 lds
v_cvt_pk_bf16_f32 v108, v92, v93
v_cvt_pk_bf16_f32 v109, v94, v95
v_mfma_f32_16x16x16_bf16 v[104:107], v[118:119], v[54:55], v[104:107]
v_cvt_pk_bf16_f32 v110, v96, v97
v_cvt_pk_bf16_f32 v111, v98, v99
v_mfma_f32_16x16x32_bf16 v[64:67], v[80:83], v[56:59], 0
v_cvt_pk_bf16_f32 v112, v100, v101
v_cvt_pk_bf16_f32 v113, v102, v103
s_waitcnt lgkmcnt(0)
v_mfma_f32_16x16x16_bf16 v[60:63], v[120:121], v[52:53], v[60:63]
v_cvt_pk_bf16_f32 v114, v104, v105
v_cvt_pk_bf16_f32 v115, v106, v107
v_mfma_f32_16x16x32_bf16 v[68:71], v[84:87], v[56:59], 0
buffer_load_dwordx4 v0, s[12:15], s33 offen offset:1024 sc1 lds
v_cndmask_b32_dpp v100, v109, v108, vcc quad_perm:[0,1,0,1] row_mask:0xf bank_mask:0xf
v_cndmask_b32_dpp v101, v111, v110, vcc quad_perm:[0,1,0,1] row_mask:0xf bank_mask:0xf
v_mfma_f32_16x16x16_bf16 v[64:67], v[120:121], v[54:55], v[64:67]
v_cndmask_b32_dpp v102, v113, v112, vcc quad_perm:[0,1,0,1] row_mask:0xf bank_mask:0xf
v_cndmask_b32_dpp v103, v115, v114, vcc quad_perm:[0,1,0,1] row_mask:0xf bank_mask:0xf
v_mfma_f32_16x16x32_bf16 v[72:75], v[88:91], v[56:59], 0
v_cvt_pk_bf16_f32 v116, v60, v61
v_cvt_pk_bf16_f32 v117, v62, v63
v_mfma_f32_16x16x16_bf16 v[68:71], v[122:123], v[52:53], v[68:71]
v_cvt_pk_bf16_f32 v118, v64, v65
v_cvt_pk_bf16_f32 v119, v66, v67
v_mfma_f32_16x16x16_bf16 v[72:75], v[122:123], v[54:55], v[72:75]
s_cbranch_scc1 CLAST_16
v_cndmask_b32_dpp v104, v117, v116, vcc quad_perm:[0,1,0,1] row_mask:0xf bank_mask:0xf
v_cndmask_b32_dpp v105, v119, v118, vcc quad_perm:[0,1,0,1] row_mask:0xf bank_mask:0xf
v_smfmac_f32_16x16x64_bf16 v[12:15], v[100:103], v[160:167], v5
ds_read_b128 v[44:47], v1 offset:24576
ds_read_b128 v[48:51], v1 offset:25600
s_and_b32 s32, s20, 1
v_cvt_pk_bf16_f32 v120, v68, v69
v_smfmac_f32_16x16x64_bf16 v[16:19], v[100:103], v[168:175], v5
ds_read_b128 v[92:95], v1 offset:26624
s_lshl_b32 s32, s32, 18
v_cvt_pk_bf16_f32 v121, v70, v71
v_cvt_pk_bf16_f32 v122, v72, v73
v_smfmac_f32_16x16x64_bf16 v[20:23], v[100:103], v[176:183], v5
ds_read_b128 v[96:99], v1 offset:27648
s_add_u32 s25, s34, s32
v_cvt_pk_bf16_f32 v123, v74, v75
v_smfmac_f32_16x16x64_bf16 v[24:27], v[100:103], v[184:191], v5
v_cndmask_b32_dpp v106, v121, v120, vcc quad_perm:[0,1,0,1] row_mask:0xf bank_mask:0xf
v_cndmask_b32_dpp v107, v123, v122, vcc quad_perm:[0,1,0,1] row_mask:0xf bank_mask:0xf
s_add_u32 s26, s25, 32768
s_bfe_u32 s69, s20, 0x10001
v_smfmac_f32_16x16x64_bf16 v[12:15], v[104:107], v[224:231], v5
ds_read_b128 v[76:79], v1 offset:28672
v_mov_b64 v[36:37], 0
v_mov_b64 v[40:41], 0
v_smfmac_f32_16x16x64_bf16 v[16:19], v[104:107], v[232:239], v5
ds_read_b128 v[80:83], v1 offset:29696
v_mov_b64 v[38:39], 0
v_mov_b64 v[42:43], 0
v_smfmac_f32_16x16x64_bf16 v[20:23], v[104:107], v[240:247], v5
ds_read_b128 v[84:87], v1 offset:30720
v_add_f32_e64 v12, v12, v14
v_smfmac_f32_16x16x64_bf16 v[24:27], v[104:107], v[248:255], v5
ds_read_b128 v[88:91], v1 offset:31744
v_add_f32_e64 v13, v13, v15
v_smfmac_f32_16x16x64_bf16 v[28:31], v[100:103], v[192:199], v5
v_add_f32 v16, v16, v18
v_add_f32 v17, v17, v19
v_smfmac_f32_16x16x64_bf16 v[32:35], v[100:103], v[200:207], v5
v_add_f32 v20, v20, v22
v_add_f32 v21, v21, v23
v_smfmac_f32_16x16x64_bf16 v[36:39], v[100:103], v[208:215], v5
v_add_f32_e64 v24, v24, v26
v_add_f32 v25, v25, v27
v_smfmac_f32_16x16x64_bf16 v[40:43], v[100:103], v[216:223], v5
v_cvt_pk_bf16_f32 v52, v12, v16
v_cvt_pk_bf16_f32 v53, v20, v24
s_waitcnt lgkmcnt(6)
v_smfmac_f32_16x16x64_bf16 v[28:31], v[104:107], v[44:51], v5
v_cvt_pk_bf16_f32 v54, v13, v17
v_cvt_pk_bf16_f32 v55, v21, v25
s_waitcnt lgkmcnt(4)
v_smfmac_f32_16x16x64_bf16 v[32:35], v[104:107], v[92:99], v5
v_and_or_b32 v52, v52, -2, s69
s_waitcnt lgkmcnt(2)
v_smfmac_f32_16x16x64_bf16 v[36:39], v[104:107], v[76:83], v5
buffer_store_dwordx4 v[52:55], v6, s[12:15], s25 offen
v_add_f32 v28, v28, v30
s_waitcnt lgkmcnt(0)
v_smfmac_f32_16x16x64_bf16 v[40:43], v[104:107], v[84:91], v5
v_add_f32 v29, v29, v31
v_add_f32 v32, v32, v34
v_add_f32_e64 v33, v33, v35
v_cvt_pk_bf16_f32 v56, v28, v32
v_add_f32 v36, v36, v38
v_add_f32 v37, v37, v39
v_cvt_pk_bf16_f32 v58, v29, v33
v_and_or_b32 v56, v56, -2, s69
v_pk_add_f32 v[40:41], v[40:41], v[42:43]
v_cvt_pk_bf16_f32 v57, v36, v40
v_cvt_pk_bf16_f32 v59, v37, v41
buffer_store_dwordx4 v[56:59], v6, s[12:15], s26 offen
s_lshl_b32 s32, s16, 13
s_add_u32 s25, s25, s32
s_add_u32 s25, s25, 0
v_and_b32 v10, 16, v0
v_mov_b32 v11, 0x3f80
v_lshlrev_b32_e64 v10, v10, v11
v_cndmask_b32 v124, 0, v10, s[60:61]
v_cndmask_b32 v125, 0, v10, s[62:63]
v_cndmask_b32 v126, 0, v10, s[64:65]
v_cndmask_b32 v127, 0, v10, s[66:67]
v_mov_b64 v[32:33], -1
v_bfe_u32 v10, v0, 4, 1
v_lshrrev_b32 v11, 8, v0
v_lshl_add_u32 v10, v11, 1, v10
v_and_b32_e64 v11, 32, v0
v_lshl_add_u32 v35, v10, 3, v11
s_and_b32 s32, s20, 3
s_lshl_b32 s32, s32, 13
s_add_u32 s27, s35, s32
s_add_u32 s29, s27, 0
s_xor_b32 s32, s32, 16384
s_add_u32 s28, s35, s32
s_lshl_b32 s32, s16, 8
s_add_u32 s27, s27, s32
s_add_u32 s28, s28, s32
s_mov_b32 s68, s23
s_mov_b32 m0, 0
s_mov_b32 s30, 0
s_mov_b64 vcc, s[58:59]
v_cndmask_b32_dpp v108, v116, v108, vcc quad_perm:[2,3,2,3] row_mask:0xf bank_mask:0xf
v_cndmask_b32_dpp v109, v117, v109, vcc quad_perm:[2,3,2,3] row_mask:0xf bank_mask:0xf
v_cndmask_b32_dpp v110, v118, v110, vcc quad_perm:[2,3,2,3] row_mask:0xf bank_mask:0xf
v_cndmask_b32_dpp v111, v119, v111, vcc quad_perm:[2,3,2,3] row_mask:0xf bank_mask:0xf
v_cndmask_b32_dpp v112, v120, v112, vcc quad_perm:[2,3,2,3] row_mask:0xf bank_mask:0xf
v_cndmask_b32_dpp v113, v121, v113, vcc quad_perm:[2,3,2,3] row_mask:0xf bank_mask:0xf
v_cndmask_b32_dpp v114, v122, v114, vcc quad_perm:[2,3,2,3] row_mask:0xf bank_mask:0xf
v_cndmask_b32_dpp v115, v123, v115, vcc quad_perm:[2,3,2,3] row_mask:0xf bank_mask:0xf
v_min_u32 v108, -2, v108
v_min_u32 v112, -2, v112
ds_read_b128 v[60:63], v1 offset:0
ds_read_b128 v[64:67], v1 offset:1024
ds_read_b128 v[68:71], v1 offset:2048
ds_read_b128 v[72:75], v1 offset:3072
ds_read_b128 v[76:79], v1 offset:4096
ds_read_b128 v[80:83], v1 offset:5120
ds_read_b128 v[84:87], v1 offset:6144
ds_read_b128 v[88:91], v1 offset:7168
ds_read_b128 v[92:95], v1 offset:8192
ds_read_b128 v[96:99], v1 offset:9216
ds_read_b128 v[100:103], v1 offset:10240
ds_read_b128 v[104:107], v1 offset:11264
v_mov_b64 v[44:45], 0
v_mov_b64 v[46:47], 0
v_mov_b64 v[48:49], 0
v_mov_b64 v[50:51], 0
buffer_load_dwordx4 v[20:23], v0, s[12:15], s25 offen offset:0 sc1
buffer_load_dwordx4 v[24:27], v0, s[12:15], s25 offen offset:1024 sc1
v_mov_b64_e64 v[52:53], 0
v_mov_b64_e64 v[54:55], 0
v_mov_b64_e64 v[56:57], 0
v_mov_b64 v[58:59], 0
RT_19:
s_waitcnt vmcnt(1)
v_mfma_f32_16x16x32_bf16 v[28:31], v[124:127], v[20:23], 0
v_xor_b32 v10, s69, v20
s_waitcnt vmcnt(0)
v_bitop3_b32 v10, v10, v24, s69 bitop3:0xf6
v_and_b32 v10, 1, v10
v_cmp_ne_u32_e64 vcc, 0, v10
v_mfma_f32_16x16x32_bf16 v[28:31], v[124:127], v[24:27], v[28:31]
s_cbranch_vccz RG_21
s_mov_b64 exec, vcc
buffer_load_dwordx4 v[20:23], v0, s[12:15], s25 offen offset:0 sc1
buffer_load_dwordx4 v[24:27], v0, s[12:15], s25 offen offset:1024 sc1
s_mov_b64 exec, -1
s_add_u32 s30, s30, 1
s_cmp_gt_u32 s30, 2097152
s_cbranch_scc1 FAIL
s_branch RT_19
RG_21:
s_nop 6
v_add_f32_dpp v28, v28, v28 row_ror:4 row_mask:0xf bank_mask:0xf
v_add_f32_dpp v29, v29, v29 row_ror:4 row_mask:0xf bank_mask:0xf
v_add_f32_dpp v30, v30, v30 row_ror:4 row_mask:0xf bank_mask:0xf
v_add_f32_dpp v31, v31, v31 row_ror:4 row_mask:0xf bank_mask:0xf
v_add_f32_dpp v28, v28, v28 row_ror:8 row_mask:0xf bank_mask:0xf
v_add_f32_dpp v29, v29, v29 row_ror:8 row_mask:0xf bank_mask:0xf
v_add_f32_dpp v30, v30, v30 row_ror:8 row_mask:0xf bank_mask:0xf
v_add_f32_dpp v31, v31, v31 row_ror:8 row_mask:0xf bank_mask:0xf
v_cvt_pk_bf16_f32 v10, v28, v29
v_cvt_pk_bf16_f32 v11, v30, v31
v_min_u32_e64 v10, -2, v10
s_mov_b64 exec, 0xf000f
buffer_store_dwordx2 v[10:11], v35, s[12:15], s27 offen offset:0
buffer_store_dwordx2 v[32:33], v35, s[12:15], s28 offen offset:0
s_mov_b64 exec, -1
s_add_u32 s20, s20, 1
s_mov_b32 s21, s22
s_add_u32 s23, s23, 8192
s_add_u32 s36, s21, 16384
s_add_u32 s22, s21, 24576
s_add_u32 s37, s22, 0
buffer_load_dwordx4 v[116:119], v0, s[12:15], s36 offen offset:0 sc1
buffer_load_dwordx4 v[120:123], v0, s[12:15], s36 offen offset:1024 sc1
s_add_u32 s32, s20, 2
s_min_u32 s32, s32, 64
s_mov_b64 exec, 0xfff
v_cmp_gt_u32 vcc, s32, v9
s_mov_b64 exec, -1
s_cbranch_vccnz FSL_17
FRET_18:
s_waitcnt vmcnt(0)
buffer_load_dwordx4 v[12:15], v0, s[12:15], s29 offen offset:0 sc1
buffer_load_dwordx4 v[16:19], v0, s[12:15], s29 offen offset:1024 sc1
s_branch H2_22
ROK_20:
s_mov_b64 exec, vcc
buffer_load_dwordx4 v[20:23], v0, s[12:15], s25 offen offset:0 sc1
buffer_load_dwordx4 v[24:27], v0, s[12:15], s25 offen offset:1024 sc1
s_mov_b64 exec, -1
s_add_u32 s30, s30, 1
s_cmp_gt_u32 s30, 2097152
s_cbranch_scc1 FAIL
s_branch RT_19
MRE_24:
s_mov_b64 exec, vcc
buffer_load_dwordx4 v[12:15], v0, s[12:15], s29 offen offset:0 sc1
buffer_load_dwordx4 v[16:19], v0, s[12:15], s29 offen offset:1024 sc1
s_mov_b64 exec, -1
s_add_u32 s30, s30, 1
s_cmp_gt_u32 s30, 2097152
s_cbranch_scc1 FAIL
s_branch MT_23
FSL_17:
s_mov_b64 exec, 0xfff
FW_25:
s_add_u32 s30, s30, 1
s_cmp_gt_u32 s30, 2097152
s_cbranch_scc1 FAIL
buffer_load_dword v9, v0, s[12:15], s31 offen sc1
s_waitcnt vmcnt(0)
v_cmp_gt_u32_e64 vcc, s32, v9
s_cbranch_vccnz FW_25
FOK_26:
s_mov_b64 exec, -1
s_branch FRET_18
CLAST_16:
s_nop 2
v_cvt_pk_bf16_f32 v120, v68, v69
v_cvt_pk_bf16_f32 v121, v70, v71
s_nop 1
v_cvt_pk_bf16_f32 v122, v72, v73
v_cvt_pk_bf16_f32 v123, v74, v75
s_mov_b64 vcc, s[58:59]
v_cndmask_b32_dpp v108, v116, v108, vcc quad_perm:[2,3,2,3] row_mask:0xf bank_mask:0xf
v_cndmask_b32_dpp v109, v117, v109, vcc quad_perm:[2,3,2,3] row_mask:0xf bank_mask:0xf
v_cndmask_b32_dpp v110, v118, v110, vcc quad_perm:[2,3,2,3] row_mask:0xf bank_mask:0xf
v_cndmask_b32_dpp v111, v119, v111, vcc quad_perm:[2,3,2,3] row_mask:0xf bank_mask:0xf
v_cndmask_b32_dpp v112, v120, v112, vcc quad_perm:[2,3,2,3] row_mask:0xf bank_mask:0xf
v_cndmask_b32_dpp v113, v121, v113, vcc quad_perm:[2,3,2,3] row_mask:0xf bank_mask:0xf
v_cndmask_b32_dpp v114, v122, v114, vcc quad_perm:[2,3,2,3] row_mask:0xf bank_mask:0xf
v_cndmask_b32_dpp v115, v123, v115, vcc quad_perm:[2,3,2,3] row_mask:0xf bank_mask:0xf
v_min_u32 v108, -2, v108
v_min_u32 v112, -2, v112
buffer_store_dwordx4 v[108:111], v0, s[12:15], s23 offen offset:0 sc1
buffer_store_dwordx4 v[112:115], v0, s[12:15], s23 offen offset:1024 sc1
s_branch FIN
CS0:
s_add_u32 s36, s21, 16384
s_add_u32 s22, s21, 24576
s_add_u32 s37, s22, 0
v_lshlrev_b32 v7, 3, v0
s_branch CL_27
H2_34:
MT_35:
s_waitcnt vmcnt(1)
v_max_u32 v10, v12, v14
s_waitcnt vmcnt(0)
v_max3_u32 v10, v10, v16, v18
v_cmp_eq_u32 vcc, -1, v10
ds_write_b128 v0, v[12:15] offset:0
ds_write_b128 v0, v[16:19] offset:1024
s_cbranch_vccnz MRE_36
CL_27:
s_waitcnt lgkmcnt(12)
v_smfmac_f32_16x16x64_bf16 v[44:47], v[12:15], v[60:67], v5
s_waitcnt lgkmcnt(10)
v_smfmac_f32_16x16x64_bf16 v[48:51], v[12:15], v[68:75], v5
s_waitcnt lgkmcnt(8)
v_smfmac_f32_16x16x64_bf16 v[52:55], v[12:15], v[76:83], v5
s_waitcnt lgkmcnt(0)
s_barrier
ds_read_b128 v[20:23], v0 offset:2048
ds_read_b128 v[24:27], v0 offset:3072
v_smfmac_f32_16x16x64_bf16 v[56:59], v[12:15], v[84:91], v5
ds_read_b128 v[28:31], v0 offset:4096
ds_read_b128 v[32:35], v0 offset:5120
buffer_store_dwordx4 v[108:111], v0, s[12:15], s68 offen offset:0 sc1
v_smfmac_f32_16x16x64_bf16 v[44:47], v[16:19], v[92:99], v5
buffer_store_dwordx4 v[112:115], v0, s[12:15], s68 offen offset:1024 sc1
ds_read_b128 v[36:39], v0 offset:6144
ds_read_b128 v[40:43], v0 offset:7168
v_smfmac_f32_16x16x64_bf16 v[48:51], v[16:19], v[100:107], v5
v_smfmac_f32_16x16x64_bf16 v[52:55], v[16:19], a[0:7], v5
ds_read_b128 v[92:95], v1 offset:20480
v_smfmac_f32_16x16x64_bf16 v[56:59], v[16:19], a[8:15], v5
ds_read_b128 v[96:99], v1 offset:21504
s_waitcnt lgkmcnt(7)
v_smfmac_f32_16x16x64_bf16 v[44:47], v[20:23], a[16:23], v5
ds_read_b128 v[100:103], v1 offset:22528
v_smfmac_f32_16x16x64_bf16 v[48:51], v[20:23], a[24:31], v5
ds_read_b128 v[104:107], v1 offset:23552
v_smfmac_f32_16x16x64_bf16 v[52:55], v[20:23], a[32:39], v5
ds_read_b128 v[60:63], v1 offset:12288
v_smfmac_f32_16x16x64_bf16 v[56:59], v[20:23], a[40:47], v5
ds_read_b128 v[64:67], v1 offset:13312
s_waitcnt lgkmcnt(10)
v_smfmac_f32_16x16x64_bf16 v[44:47], v[24:27], a[48:55], v5
ds_read_b128 v[68:71], v1 offset:14336
v_smfmac_f32_16x16x64_bf16 v[48:51], v[24:27], a[56:63], v5
ds_read_b128 v[72:75], v1 offset:15360
v_mov_b64_e64 v[108:109], 0
v_smfmac_f32_16x16x64_bf16 v[52:55], v[24:27], a[64:71], v5
ds_read_b128 v[76:79], v1 offset:16384
v_mov_b64_e64 v[110:111], 0
v_smfmac_f32_16x16x64_bf16 v[56:59], v[24:27], a[72:79], v5
ds_read_b128 v[80:83], v1 offset:17408
v_mov_b64 v[112:113], 0
s_waitcnt lgkmcnt(8)
v_smfmac_f32_16x16x64_bf16 v[44:47], v[28:31], v[92:99], v5
ds_read_b128 v[84:87], v1 offset:18432
v_mov_b64 v[114:115], 0
s_waitcnt lgkmcnt(7)
v_smfmac_f32_16x16x64_bf16 v[48:51], v[28:31], v[100:107], v5
ds_read_b128 v[88:91], v1 offset:19456
v_smfmac_f32_16x16x64_bf16 v[52:55], v[28:31], a[80:87], v5
v_mov_b32_dpp v100, v116 quad_perm:[0,1,0,1] row_mask:0xf bank_mask:0xf
v_smfmac_f32_16x16x64_bf16 v[56:59], v[28:31], a[88:95], v5
v_mov_b32_dpp v101, v117 quad_perm:[0,1,0,1] row_mask:0xf bank_mask:0xf
s_waitcnt lgkmcnt(6)
v_smfmac_f32_16x16x64_bf16 v[44:47], v[32:35], v[60:67], v5
v_mov_b32_dpp v102, v118 quad_perm:[0,1,0,1] row_mask:0xf bank_mask:0xf
s_waitcnt lgkmcnt(4)
v_smfmac_f32_16x16x64_bf16 v[48:51], v[32:35], v[68:75], v5
ds_read_b128 v[60:63], v0 offset:8192
v_mov_b32_dpp v103, v119 quad_perm:[0,1,0,1] row_mask:0xf bank_mask:0xf
s_waitcnt lgkmcnt(3)
v_smfmac_f32_16x16x64_bf16 v[52:55], v[32:35], v[76:83], v5
ds_read_b128 v[64:67], v0 offset:9216
v_mov_b32_dpp v104, v120 quad_perm:[0,1,0,1] row_mask:0xf bank_mask:0xf
s_waitcnt lgkmcnt(2)
v_smfmac_f32_16x16x64_bf16 v[56:59], v[32:35], v[84:91], v5
ds_read_b128 v[68:71], v0 offset:10240
v_mov_b32_dpp v105, v121 quad_perm:[0,1,0,1] row_mask:0xf bank_mask:0xf
v_smfmac_f32_16x16x64_bf16 v[44:47], v[36:39], a[96:103], v5
ds_read_b128 v[72:75], v0 offset:11264
v_mov_b32_dpp v106, v122 quad_perm:[0,1,0,1] row_mask:0xf bank_mask:0xf
v_smfmac_f32_16x16x64_bf16 v[44:47], v[40:43], a[128:135], v5
ds_read_b128 v[76:79], v0 offset:12288
v_mov_b32_dpp v107, v123 quad_perm:[0,1,0,1] row_mask:0xf bank_mask:0xf
v_smfmac_f32_16x16x64_bf16 v[48:51], v[36:39], a[104:111], v5
ds_read_b128 v[80:83], v0 offset:13312
v_mov_b32 v11, 0xf149f2ca
v_smfmac_f32_16x16x64_bf16 v[48:51], v[40:43], a[136:143], v5
ds_read_b128 v[84:87], v0 offset:14336
v_add_f32_e64 v44, v44, v46
v_smfmac_f32_16x16x64_bf16 v[52:55], v[36:39], a[112:119], v5
ds_read_b128 v[88:91], v0 offset:15360
v_add_f32_e64 v45, v45, v47
v_smfmac_f32_16x16x64_bf16 v[52:55], v[40:43], a[144:151], v5
v_add_f32_e64 v48, v48, v50
v_smfmac_f32_16x16x64_bf16 v[56:59], v[36:39], a[120:127], v5
v_add_f32_e64 v49, v49, v51
v_smfmac_f32_16x16x64_bf16 v[56:59], v[40:43], a[152:159], v5
v_add_f32 v52, v52, v54
v_add_f32 v53, v53, v55
v_cvt_pk_bf16_f32 v124, v44, v48
v_cvt_pk_bf16_f32 v126, v45, v49
v_cndmask_b32 v44, 0, v11, s[40:41]
v_cndmask_b32 v45, 0, v11, s[42:43]
s_nop 1
v_add_f32 v56, v56, v58
v_add_f32_e64 v57, v57, v59
v_cvt_pk_bf16_f32 v125, v52, v56
v_cvt_pk_bf16_f32 v127, v53, v57
ds_write_b64 v2, v[124:125] offset:0
ds_write_b64 v2, v[126:127] offset:16
v_smfmac_f32_16x16x64_bf16 v[108:111], v[12:15], a[160:167], v5
s_mov_b32 m0, 8192
s_add_u32 s32, s22, 0
v_cndmask_b32 v46, 0, v11, s[44:45]
v_smfmac_f32_16x16x64_bf16 v[112:115], v[12:15], a[168:175], v5
v_cndmask_b32 v47, 0, v11, s[46:47]
v_smfmac_f32_16x16x64_bf16 v[108:111], v[16:19], a[176:183], v5
v_cndmask_b32 v48, 0, v11, s[48:49]
v_smfmac_f32_16x16x64_bf16 v[112:115], v[16:19], a[184:191], v5
v_cndmask_b32 v49, 0, v11, s[50:51]
v_smfmac_f32_16x16x64_bf16 v[108:111], v[20:23], a[192:199], v5
v_cndmask_b32 v50, 0, v11, s[52:53]
s_waitcnt lgkmcnt(0)
s_barrier
s_mov_b64 exec, s[56:57]
ds_read_b128 v[116:119], v3 offset:0
ds_read_b128 v[120:123], v3 offset:576
ds_read_b128 v[100:103], v3 offset:1152
ds_read_b128 v[104:107], v3 offset:1728
s_mov_b64 exec, -1
ds_read_b128 v[92:95], v4 offset:0
ds_read_b128 v[96:99], v4 offset:1152
v_smfmac_f32_16x16x64_bf16 v[112:115], v[20:23], a[200:207], v5
v_cndmask_b32 v51, 0, v11, s[54:55]
v_smfmac_f32_16x16x64_bf16 v[108:111], v[24:27], a[208:215], v5
v_mov_b32 v53, 0
v_smfmac_f32_16x16x64_bf16 v[112:115], v[24:27], a[216:223], v5
v_mov_b32 v54, 0
v_smfmac_f32_16x16x64_bf16 v[108:111], v[28:31], a[224:231], v5
v_mov_b64 v[124:125], 0
v_smfmac_f32_16x16x64_bf16 v[112:115], v[28:31], a[232:239], v5
v_mov_b64 v[126:127], 0
s_waitcnt lgkmcnt(5)
v_mfma_f32_16x16x32_bf16 v[44:47], v[60:63], v[116:119], v[44:47]
v_mfma_f32_16x16x32_bf16 v[48:51], v[76:79], v[116:119], v[48:51]
ds_read_b128 v[60:63], v0 offset:16384
s_waitcnt lgkmcnt(5)
v_mfma_f32_16x16x32_bf16 v[44:47], v[64:67], v[120:123], v[44:47]
ds_read_b128 v[76:79], v0 offset:20480
v_mfma_f32_16x16x32_bf16 v[48:51], v[80:83], v[120:123], v[48:51]
ds_read_b128 v[64:67], v0 offset:17408
s_waitcnt lgkmcnt(4)
v_smfmac_f32_16x16x64_bf16 v[124:127], v[92:95], v[116:123], v5
ds_read_b128 v[80:83], v0 offset:21504
v_mfma_f32_16x16x32_bf16 v[44:47], v[68:71], v[100:103], v[44:47]
s_mov_b64 exec, 0xfff
buffer_load_dword v9, v0, s[12:15], s31 offen sc1
s_mov_b64 exec, -1
v_mfma_f32_16x16x32_bf16 v[48:51], v[84:87], v[100:103], v[48:51]
ds_read_b128 v[68:71], v0 offset:18432
s_waitcnt lgkmcnt(5)
v_smfmac_f32_16x16x64_bf16 v[124:127], v[96:99], v[100:107], v5
ds_read_b128 v[84:87], v0 offset:22528
v_mfma_f32_16x16x32_bf16 v[44:47], v[72:75], v[104:107], v[44:47]
v_mfma_f32_16x16x32_bf16 v[48:51], v[88:91], v[104:107], v[48:51]
ds_read_b128 v[72:75], v0 offset:19456
ds_read_b128 v[88:91], v0 offset:23552
v_add_f32 v124, v124, v126
v_add_f32 v125, v125, v127
v_max3_f32 v10, v124, v125, v44
v_max3_f32 v10, v10, v45, v46
v_smfmac_f32_16x16x64_bf16 v[108:111], v[32:35], a[240:247], v5
s_nop 0
v_max3_f32 v10, v10, v47, v48
v_max3_f32 v10, v10, v49, v50
v_max_f32 v11, v10, v51
v_max_f32_e64 v10, v10, v51
v_smfmac_f32_16x16x64_bf16 v[112:115], v[32:35], a[248:255], v5
s_nop 0
v_permlane16_swap_b32 v10, v11
v_max_f32 v10, v10, v11
v_mov_b32 v11, v10
v_smfmac_f32_16x16x64_bf16 v[108:111], v[36:39], v[128:135], v5
s_nop 0
v_permlane32_swap_b32 v10, v11
v_max_f32 v10, v10, v11
v_mul_f32 v10, s38, v10
v_fma_f32 v124, v124, s38, -v10
v_fma_f32 v125, v125, s38, -v10
v_pk_fma_f32 v[44:45], v[44:45], s[38:39], v[10:11] op_sel_hi:[1,1,0] neg_lo:[0,0,1] neg_hi:[0,0,1]
v_pk_fma_f32 v[46:47], v[46:47], s[38:39], v[10:11] op_sel_hi:[1,1,0] neg_lo:[0,0,1] neg_hi:[0,0,1]
v_pk_fma_f32 v[48:49], v[48:49], s[38:39], v[10:11] op_sel_hi:[1,1,0] neg_lo:[0,0,1] neg_hi:[0,0,1]
v_pk_fma_f32 v[50:51], v[50:51], s[38:39], v[10:11] op_sel_hi:[1,1,0] neg_lo:[0,0,1] neg_hi:[0,0,1]
v_smfmac_f32_16x16x64_bf16 v[112:115], v[36:39], v[136:143], v5
buffer_load_dwordx4 v0, s[12:15], s32 offen offset:0 sc1 lds
v_exp_f32 v44, v44
v_smfmac_f32_16x16x64_bf16 v[108:111], v[40:43], v[144:151], v5
v_exp_f32 v45, v45
v_smfmac_f32_16x16x64_bf16 v[112:115], v[40:43], v[152:159], v5
buffer_load_dwordx4 v0, s[12:15], s32 offen offset:1024 sc1 lds
v_exp_f32 v46, v46
v_exp_f32 v47, v47
v_exp_f32 v48, v48
v_exp_f32 v49, v49
v_exp_f32 v50, v50
v_exp_f32 v51, v51
v_exp_f32 v124, v124
v_exp_f32 v125, v125
v_pk_add_f32 v[108:109], v[108:109], v[110:111]
v_pk_add_f32 v[10:11], v[44:45], v[46:47]
v_pk_add_f32 v[126:127], v[48:49], v[50:51]
v_pk_add_f32 v[10:11], v[10:11], v[124:125]
v_pk_add_f32 v[10:11], v[10:11], v[126:127]
v_pk_add_f32 v[112:113], v[112:113], v[114:115]
v_add_f32 v126, v10, v11
v_add_f32 v10, v10, v11
v_cvt_pk_bf16_f32 v108, v108, v109
v_cvt_pk_bf16_f32 v109, v112, v113
v_permlane16_swap_b32 v10, v126
v_add_f32 v11, v10, v126
v_add_f32 v10, v10, v126
ds_write_b64 v0, v[108:109] offset:29184
s_mov_b64 vcc, s[56:57]
v_permlane32_swap_b32 v10, v11
v_add_f32 v10, v10, v11
v_rcp_f32_e64 v10, v10
s_mov_b32 m0, 16384
v_pk_mul_f32 v[44:45], v[44:45], v[10:11] op_sel_hi:[1,0]
v_pk_mul_f32 v[46:47], v[46:47], v[10:11] op_sel_hi:[1,0]
v_pk_mul_f32 v[48:49], v[48:49], v[10:11] op_sel_hi:[1,0]
v_pk_mul_f32 v[50:51], v[50:51], v[10:11] op_sel_hi:[1,0]
v_pk_mul_f32 v[124:125], v[124:125], v[10:11] op_sel_hi:[1,0]
v_cvt_pk_bf16_f32 v56, v44, v45
v_cvt_pk_bf16_f32 v57, v46, v47
v_cvt_pk_bf16_f32 v58, v48, v49
v_cvt_pk_bf16_f32 v59, v50, v51
v_cvt_pk_bf16_f32 v52, v124, v125
v_cvt_pk_bf16_f32 v55, v124, v125
s_waitcnt lgkmcnt(8)
v_mfma_f32_16x16x32_bf16 v[92:95], v[60:63], v[56:59], 0
s_waitcnt lgkmcnt(0)
s_barrier
ds_read_b128 v[116:119], v0 offset:29184
ds_read_b128 v[120:123], v0 offset:30208
v_mfma_f32_16x16x32_bf16 v[96:99], v[64:67], v[56:59], 0
s_add_u32 s33, s22, 8192
s_cmp_eq_u32 s20, 63
v_mov_b64 v[12:13], 0
v_mov_b64 v[14:15], 0
v_mfma_f32_16x16x32_bf16 v[100:103], v[68:71], v[56:59], 0
v_mov_b64 v[16:17], 0
v_mov_b64 v[18:19], 0
v_mfma_f32_16x16x32_bf16 v[104:107], v[72:75], v[56:59], 0
v_mov_b64 v[20:21], 0
v_mov_b64 v[22:23], 0
v_mfma_f32_16x16x32_bf16 v[60:63], v[76:79], v[56:59], 0
v_mov_b64 v[24:25], 0
v_mov_b64 v[26:27], 0
s_waitcnt lgkmcnt(1)
v_mfma_f32_16x16x16_bf16 v[92:95], v[116:117], v[52:53], v[92:95]
v_mov_b64 v[28:29], 0
v_mov_b64 v[30:31], 0
v_mfma_f32_16x16x16_bf16 v[96:99], v[116:117], v[54:55], v[96:99]
v_mov_b64 v[32:33], 0
v_mov_b64 v[34:35], 0
v_mfma_f32_16x16x16_bf16 v[100:103], v[118:119], v[52:53], v[100:103]
buffer_load_dwordx4 v0, s[12:15], s33 offen offset:0 sc1 lds
v_cvt_pk_bf16_f32 v108, v92, v93
v_cvt_pk_bf16_f32 v109, v94, v95
v_mfma_f32_16x16x16_bf16 v[104:107], v[118:119], v[54:55], v[104:107]
v_cvt_pk_bf16_f32 v110, v96, v97
v_cvt_pk_bf16_f32 v111, v98, v99
v_mfma_f32_16x16x32_bf16 v[64:67], v[80:83], v[56:59], 0
v_cvt_pk_bf16_f32 v112, v100, v101
v_cvt_pk_bf16_f32 v113, v102, v103
s_waitcnt lgkmcnt(0)
v_mfma_f32_16x16x16_bf16 v[60:63], v[120:121], v[52:53], v[60:63]
v_cvt_pk_bf16_f32 v114, v104, v105
v_cvt_pk_bf16_f32 v115, v106, v107
v_mfma_f32_16x16x32_bf16 v[68:71], v[84:87], v[56:59], 0
buffer_load_dwordx4 v0, s[12:15], s33 offen offset:1024 sc1 lds
v_cndmask_b32_dpp v100, v109, v108, vcc quad_perm:[0,1,0,1] row_mask:0xf bank_mask:0xf
v_cndmask_b32_dpp v101, v111, v110, vcc quad_perm:[0,1,0,1] row_mask:0xf bank_mask:0xf
v_mfma_f32_16x16x16_bf16 v[64:67], v[120:121], v[54:55], v[64:67]
v_cndmask_b32_dpp v102, v113, v112, vcc quad_perm:[0,1,0,1] row_mask:0xf bank_mask:0xf
v_cndmask_b32_dpp v103, v115, v114, vcc quad_perm:[0,1,0,1] row_mask:0xf bank_mask:0xf
v_mfma_f32_16x16x32_bf16 v[72:75], v[88:91], v[56:59], 0
v_cvt_pk_bf16_f32 v116, v60, v61
v_cvt_pk_bf16_f32 v117, v62, v63
v_mfma_f32_16x16x16_bf16 v[68:71], v[122:123], v[52:53], v[68:71]
v_cvt_pk_bf16_f32 v118, v64, v65
v_cvt_pk_bf16_f32 v119, v66, v67
v_mfma_f32_16x16x16_bf16 v[72:75], v[122:123], v[54:55], v[72:75]
s_cbranch_scc1 CLAST_28
v_cndmask_b32_dpp v104, v117, v116, vcc quad_perm:[0,1,0,1] row_mask:0xf bank_mask:0xf
v_cndmask_b32_dpp v105, v119, v118, vcc quad_perm:[0,1,0,1] row_mask:0xf bank_mask:0xf
v_smfmac_f32_16x16x64_bf16 v[12:15], v[100:103], v[160:167], v5
ds_read_b128 v[44:47], v1 offset:24576
ds_read_b128 v[48:51], v1 offset:25600
s_and_b32 s32, s20, 1
v_cvt_pk_bf16_f32 v120, v68, v69
v_smfmac_f32_16x16x64_bf16 v[16:19], v[100:103], v[168:175], v5
ds_read_b128 v[92:95], v1 offset:26624
s_lshl_b32 s32, s32, 18
v_cvt_pk_bf16_f32 v121, v70, v71
v_cvt_pk_bf16_f32 v122, v72, v73
v_smfmac_f32_16x16x64_bf16 v[20:23], v[100:103], v[176:183], v5
ds_read_b128 v[96:99], v1 offset:27648
s_add_u32 s25, s34, s32
v_cvt_pk_bf16_f32 v123, v74, v75
v_smfmac_f32_16x16x64_bf16 v[24:27], v[100:103], v[184:191], v5
v_cndmask_b32_dpp v106, v121, v120, vcc quad_perm:[0,1,0,1] row_mask:0xf bank_mask:0xf
v_cndmask_b32_dpp v107, v123, v122, vcc quad_perm:[0,1,0,1] row_mask:0xf bank_mask:0xf
s_add_u32 s26, s25, 32768
s_bfe_u32 s69, s20, 0x10001
v_smfmac_f32_16x16x64_bf16 v[12:15], v[104:107], v[224:231], v5
ds_read_b128 v[76:79], v1 offset:28672
v_mov_b64 v[36:37], 0
v_mov_b64 v[40:41], 0
v_smfmac_f32_16x16x64_bf16 v[16:19], v[104:107], v[232:239], v5
ds_read_b128 v[80:83], v1 offset:29696
v_mov_b64 v[38:39], 0
v_mov_b64 v[42:43], 0
v_smfmac_f32_16x16x64_bf16 v[20:23], v[104:107], v[240:247], v5
ds_read_b128 v[84:87], v1 offset:30720
v_add_f32_e64 v12, v12, v14
v_smfmac_f32_16x16x64_bf16 v[24:27], v[104:107], v[248:255], v5
ds_read_b128 v[88:91], v1 offset:31744
v_add_f32_e64 v13, v13, v15
v_smfmac_f32_16x16x64_bf16 v[28:31], v[100:103], v[192:199], v5
v_add_f32 v16, v16, v18
v_add_f32 v17, v17, v19
v_smfmac_f32_16x16x64_bf16 v[32:35], v[100:103], v[200:207], v5
v_add_f32 v20, v20, v22
v_add_f32 v21, v21, v23
v_smfmac_f32_16x16x64_bf16 v[36:39], v[100:103], v[208:215], v5
v_add_f32_e64 v24, v24, v26
v_add_f32 v25, v25, v27
v_smfmac_f32_16x16x64_bf16 v[40:43], v[100:103], v[216:223], v5
v_cvt_pk_bf16_f32 v52, v12, v16
v_cvt_pk_bf16_f32 v53, v20, v24
s_waitcnt lgkmcnt(6)
v_smfmac_f32_16x16x64_bf16 v[28:31], v[104:107], v[44:51], v5
v_cvt_pk_bf16_f32 v54, v13, v17
v_cvt_pk_bf16_f32 v55, v21, v25
s_waitcnt lgkmcnt(4)
v_smfmac_f32_16x16x64_bf16 v[32:35], v[104:107], v[92:99], v5
v_and_or_b32 v52, v52, -2, s69
s_waitcnt lgkmcnt(2)
v_smfmac_f32_16x16x64_bf16 v[36:39], v[104:107], v[76:83], v5
buffer_store_dwordx4 v[52:55], v6, s[12:15], s25 offen sc1
v_add_f32 v28, v28, v30
s_waitcnt lgkmcnt(0)
v_smfmac_f32_16x16x64_bf16 v[40:43], v[104:107], v[84:91], v5
v_add_f32 v29, v29, v31
v_add_f32 v32, v32, v34
v_add_f32_e64 v33, v33, v35
v_cvt_pk_bf16_f32 v56, v28, v32
v_add_f32 v36, v36, v38
v_add_f32 v37, v37, v39
v_cvt_pk_bf16_f32 v58, v29, v33
v_and_or_b32 v56, v56, -2, s69
v_pk_add_f32 v[40:41], v[40:41], v[42:43]
v_cvt_pk_bf16_f32 v57, v36, v40
v_cvt_pk_bf16_f32 v59, v37, v41
buffer_store_dwordx4 v[56:59], v6, s[12:15], s26 offen sc1
s_lshl_b32 s32, s16, 13
s_add_u32 s25, s25, s32
s_add_u32 s25, s25, 0
v_and_b32 v10, 16, v0
v_mov_b32 v11, 0x3f80
v_lshlrev_b32_e64 v10, v10, v11
v_cndmask_b32 v124, 0, v10, s[60:61]
v_cndmask_b32 v125, 0, v10, s[62:63]
v_cndmask_b32 v126, 0, v10, s[64:65]
v_cndmask_b32 v127, 0, v10, s[66:67]
v_mov_b64 v[32:33], -1
v_bfe_u32 v10, v0, 4, 1
v_lshrrev_b32 v11, 8, v0
v_lshl_add_u32 v10, v11, 1, v10
v_and_b32_e64 v11, 32, v0
v_lshl_add_u32 v35, v10, 3, v11
s_and_b32 s32, s20, 3
s_lshl_b32 s32, s32, 13
s_add_u32 s27, s35, s32
s_add_u32 s29, s27, 0
s_xor_b32 s32, s32, 16384
s_add_u32 s28, s35, s32
s_lshl_b32 s32, s16, 8
s_add_u32 s27, s27, s32
s_add_u32 s28, s28, s32
s_mov_b32 s68, s23
s_mov_b32 m0, 0
s_mov_b32 s30, 0
s_mov_b64 vcc, s[58:59]
v_cndmask_b32_dpp v108, v116, v108, vcc quad_perm:[2,3,2,3] row_mask:0xf bank_mask:0xf
v_cndmask_b32_dpp v109, v117, v109, vcc quad_perm:[2,3,2,3] row_mask:0xf bank_mask:0xf
v_cndmask_b32_dpp v110, v118, v110, vcc quad_perm:[2,3,2,3] row_mask:0xf bank_mask:0xf
v_cndmask_b32_dpp v111, v119, v111, vcc quad_perm:[2,3,2,3] row_mask:0xf bank_mask:0xf
v_cndmask_b32_dpp v112, v120, v112, vcc quad_perm:[2,3,2,3] row_mask:0xf bank_mask:0xf
v_cndmask_b32_dpp v113, v121, v113, vcc quad_perm:[2,3,2,3] row_mask:0xf bank_mask:0xf
v_cndmask_b32_dpp v114, v122, v114, vcc quad_perm:[2,3,2,3] row_mask:0xf bank_mask:0xf
v_cndmask_b32_dpp v115, v123, v115, vcc quad_perm:[2,3,2,3] row_mask:0xf bank_mask:0xf
v_min_u32 v108, -2, v108
v_min_u32 v112, -2, v112
ds_read_b128 v[60:63], v1 offset:0
ds_read_b128 v[64:67], v1 offset:1024
ds_read_b128 v[68:71], v1 offset:2048
ds_read_b128 v[72:75], v1 offset:3072
ds_read_b128 v[76:79], v1 offset:4096
ds_read_b128 v[80:83], v1 offset:5120
ds_read_b128 v[84:87], v1 offset:6144
ds_read_b128 v[88:91], v1 offset:7168
ds_read_b128 v[92:95], v1 offset:8192
ds_read_b128 v[96:99], v1 offset:9216
ds_read_b128 v[100:103], v1 offset:10240
ds_read_b128 v[104:107], v1 offset:11264
v_mov_b64 v[44:45], 0
v_mov_b64 v[46:47], 0
v_mov_b64 v[48:49], 0
v_mov_b64 v[50:51], 0
buffer_load_dwordx4 v[20:23], v0, s[12:15], s25 offen offset:0 sc1
buffer_load_dwordx4 v[24:27], v0, s[12:15], s25 offen offset:1024 sc1
v_mov_b64_e64 v[52:53], 0
v_mov_b64_e64 v[54:55], 0
v_mov_b64_e64 v[56:57], 0
v_mov_b64 v[58:59], 0
RT_31:
s_waitcnt vmcnt(1)
v_mfma_f32_16x16x32_bf16 v[28:31], v[124:127], v[20:23], 0
v_xor_b32 v10, s69, v20
s_waitcnt vmcnt(0)
v_bitop3_b32 v10, v10, v24, s69 bitop3:0xf6
v_and_b32 v10, 1, v10
v_cmp_ne_u32_e64 vcc, 0, v10
v_mfma_f32_16x16x32_bf16 v[28:31], v[124:127], v[24:27], v[28:31]
s_cbranch_vccz RG_33
s_mov_b64 exec, vcc
buffer_load_dwordx4 v[20:23], v0, s[12:15], s25 offen offset:0 sc1
buffer_load_dwordx4 v[24:27], v0, s[12:15], s25 offen offset:1024 sc1
s_mov_b64 exec, -1
s_add_u32 s30, s30, 1
s_cmp_gt_u32 s30, 2097152
s_cbranch_scc1 FAIL
s_branch RT_31
RG_33:
s_nop 6
v_add_f32_dpp v28, v28, v28 row_ror:4 row_mask:0xf bank_mask:0xf
v_add_f32_dpp v29, v29, v29 row_ror:4 row_mask:0xf bank_mask:0xf
v_add_f32_dpp v30, v30, v30 row_ror:4 row_mask:0xf bank_mask:0xf
v_add_f32_dpp v31, v31, v31 row_ror:4 row_mask:0xf bank_mask:0xf
v_add_f32_dpp v28, v28, v28 row_ror:8 row_mask:0xf bank_mask:0xf
v_add_f32_dpp v29, v29, v29 row_ror:8 row_mask:0xf bank_mask:0xf
v_add_f32_dpp v30, v30, v30 row_ror:8 row_mask:0xf bank_mask:0xf
v_add_f32_dpp v31, v31, v31 row_ror:8 row_mask:0xf bank_mask:0xf
v_cvt_pk_bf16_f32 v10, v28, v29
v_cvt_pk_bf16_f32 v11, v30, v31
v_min_u32_e64 v10, -2, v10
s_mov_b64 exec, 0xf000f
buffer_store_dwordx2 v[10:11], v35, s[12:15], s27 offen offset:0 sc1
buffer_store_dwordx2 v[32:33], v35, s[12:15], s28 offen offset:0 sc1
s_mov_b64 exec, -1
s_add_u32 s20, s20, 1
s_mov_b32 s21, s22
s_add_u32 s23, s23, 8192
s_add_u32 s36, s21, 16384
s_add_u32 s22, s21, 24576
s_add_u32 s37, s22, 0
buffer_load_dwordx4 v[116:119], v0, s[12:15], s36 offen offset:0 sc1
buffer_load_dwordx4 v[120:123], v0, s[12:15], s36 offen offset:1024 sc1
s_add_u32 s32, s20, 2
s_min_u32 s32, s32, 64
s_mov_b64 exec, 0xfff
v_cmp_gt_u32 vcc, s32, v9
s_mov_b64 exec, -1
s_cbranch_vccnz FSL_29
FRET_30:
s_waitcnt vmcnt(0)
buffer_load_dwordx4 v[12:15], v0, s[12:15], s29 offen offset:0 sc1
buffer_load_dwordx4 v[16:19], v0, s[12:15], s29 offen offset:1024 sc1
s_branch H2_34
ROK_32:
s_mov_b64 exec, vcc
buffer_load_dwordx4 v[20:23], v0, s[12:15], s25 offen offset:0 sc1
buffer_load_dwordx4 v[24:27], v0, s[12:15], s25 offen offset:1024 sc1
s_mov_b64 exec, -1
s_add_u32 s30, s30, 1
s_cmp_gt_u32 s30, 2097152
s_cbranch_scc1 FAIL
s_branch RT_31
MRE_36:
s_mov_b64 exec, vcc
buffer_load_dwordx4 v[12:15], v0, s[12:15], s29 offen offset:0 sc1
buffer_load_dwordx4 v[16:19], v0, s[12:15], s29 offen offset:1024 sc1
s_mov_b64 exec, -1
s_add_u32 s30, s30, 1
s_cmp_gt_u32 s30, 2097152
s_cbranch_scc1 FAIL
s_branch MT_35
FSL_29:
s_mov_b64 exec, 0xfff
FW_37:
s_add_u32 s30, s30, 1
s_cmp_gt_u32 s30, 2097152
s_cbranch_scc1 FAIL
buffer_load_dword v9, v0, s[12:15], s31 offen sc1
s_waitcnt vmcnt(0)
v_cmp_gt_u32_e64 vcc, s32, v9
s_cbranch_vccnz FW_37
FOK_38:
s_mov_b64 exec, -1
s_branch FRET_30
CLAST_28:
s_nop 2
v_cvt_pk_bf16_f32 v120, v68, v69
v_cvt_pk_bf16_f32 v121, v70, v71
s_nop 1
v_cvt_pk_bf16_f32 v122, v72, v73
v_cvt_pk_bf16_f32 v123, v74, v75
s_mov_b64 vcc, s[58:59]
v_cndmask_b32_dpp v108, v116, v108, vcc quad_perm:[2,3,2,3] row_mask:0xf bank_mask:0xf
v_cndmask_b32_dpp v109, v117, v109, vcc quad_perm:[2,3,2,3] row_mask:0xf bank_mask:0xf
v_cndmask_b32_dpp v110, v118, v110, vcc quad_perm:[2,3,2,3] row_mask:0xf bank_mask:0xf
v_cndmask_b32_dpp v111, v119, v111, vcc quad_perm:[2,3,2,3] row_mask:0xf bank_mask:0xf
v_cndmask_b32_dpp v112, v120, v112, vcc quad_perm:[2,3,2,3] row_mask:0xf bank_mask:0xf
v_cndmask_b32_dpp v113, v121, v113, vcc quad_perm:[2,3,2,3] row_mask:0xf bank_mask:0xf
v_cndmask_b32_dpp v114, v122, v114, vcc quad_perm:[2,3,2,3] row_mask:0xf bank_mask:0xf
v_cndmask_b32_dpp v115, v123, v115, vcc quad_perm:[2,3,2,3] row_mask:0xf bank_mask:0xf
v_min_u32 v108, -2, v108
v_min_u32 v112, -2, v112
buffer_store_dwordx4 v[108:111], v0, s[12:15], s23 offen offset:0 sc1
buffer_store_dwordx4 v[112:115], v0, s[12:15], s23 offen offset:1024 sc1
s_branch FIN
CW1:
v_and_b32 v20, 15, v0
v_lshrrev_b32 v21, 4, v0
v_lshrrev_b32 v22, 2, v20
v_and_b32_e64 v23, 1, v20
v_lshl_add_u32 v24, v22, 1, v23
v_bfe_u32 v25, v20, 1, 1
v_mov_b32 v26, v0
v_lshlrev_b32 v0, 4, v26
v_add_u32 v1, 65536, v0
s_movk_i32 s3, 144
v_lshrrev_b32 v27, 1, v20
v_mul_lo_u32 v27, v27, s3
v_lshl_add_u32 v27, v21, 5, v27
v_lshl_add_u32 v27, v23, 3, v27
v_add_u32 v2, 25728, v27
v_mul_lo_u32 v27, v21, s3
v_lshl_add_u32 v27, v24, 4, v27
v_add_u32 v3, 24576, v27
v_lshl_add_u32 v27, v21, 1, v25
v_mul_lo_u32 v27, v27, s3
v_lshl_add_u32 v27, v24, 4, v27
v_add_u32 v4, 26880, v27
v_mul_u32_u24 v27, 0xaaaa, v25
v_add_u32 v5, 0x4444, v27
v_lshlrev_b32_e64 v27, 13, v22
v_lshl_add_u32 v27, v21, 11, v27
v_and_b32 v28, 3, v20
v_lshl_add_u32 v27, v28, 4, v27
s_lshl_b32 s3, s16, 6
s_add_u32 s3, s3, 65536
v_add_u32_e64 v6, s3, v27
s_mov_b32 s60, 0x30003
s_mov_b32 s61, 0x30003
s_mov_b32 s62, 0xc000c
s_mov_b32 s63, 0xc000c
s_mov_b32 s64, 0x300030
s_mov_b32 s65, 0x300030
s_mov_b32 s66, 0xc000c0
s_mov_b32 s67, 0xc000c0
v_lshlrev_b32_e64 v28, 10, v24
v_lshl_add_u32 v28, v21, 5, v28
v_lshl_add_u32 v28, v25, 4, v28
s_mov_b32 s40, 0x0
s_mov_b32 s41, 0xc0000
s_mov_b32 s42, 0x0
s_mov_b32 s43, 0x4c0004
s_mov_b32 s44, 0x0
s_mov_b32 s45, 0x4c0004
s_mov_b32 s46, 0x0
s_mov_b32 s47, 0xcc000c
s_mov_b32 s48, 0x0
s_mov_b32 s49, 0xccc00cc
s_mov_b32 s50, 0x0
s_mov_b32 s51, 0x4ccc04cc
s_mov_b32 s52, 0x0
s_mov_b32 s53, 0x4ccc04cc
s_mov_b32 s54, 0x0
s_mov_b32 s55, 0xcccc0ccc
s_mov_b32 s56, 0x33333333
s_mov_b32 s57, 0x33333333
s_mov_b32 s58, 0xcccccccc
s_mov_b32 s59, 0xcccccccc
s_mov_b32 s38, 0x3e0293ee
s_mov_b32 s39, 0x3e0293ee
s_mov_b32 s20, 0
s_lshl_b32 s3, s17, 5
s_add_u32 s3, s3, s16
s_lshl_b32 s3, s3, 6
s_mul_i32 s21, s3, 24576
s_lshl_b32 s23, s3, 13
s_add_u32 s23, s23, 100665344
s_lshl_b32 s34, s17, 19
s_add_u32 s34, s34, 153092096
s_lshl_b32 s35, s17, 15
s_add_u32 s35, s35, 154140672
s_lshl_b32 s3, s17, 5
s_add_u32 s3, s3, s16
s_lshl_b32 s3, s3, 8
s_add_u32 s31, s3, 159383552
s_mov_b32 s30, 0
s_cmp_eq_u32 s78, 1
s_cbranch_scc1 CK_40
CF_39:
s_add_u32 s30, s30, 1
s_cmp_gt_u32 s30, 2097152
s_cbranch_scc1 FAIL
s_cmp_ge_u32 s79, 48
s_cbranch_scc1 CG_41
s_load_dwordx2 s[70:71], s[0:1], 88
v_mov_b32 v114, 208
s_waitcnt lgkmcnt(0)
s_mov_b64 exec, 1
global_load_dword v124, v114, s[70:71] sc1
s_mov_b64 exec, -1
CG_41:
s_waitcnt vmcnt(0)
v_readlane_b32 s79, v124, 0
v_mbcnt_lo_u32_b32 v113, -1, 0
v_lshlrev_b32_e64 v112, 4, v113
s_lshl_b32 s3, s17, 5
s_add_u32 s3, s3, s16
s_lshl_b32 s76, s3, 8
s_add_u32 s76, s76, 159383552
s_mov_b64 exec, 0xfff
buffer_load_dword v125, v112, s[12:15], s76 offen sc1
s_mov_b64 exec, -1
s_mov_b64 exec, 0xfff
s_waitcnt vmcnt(0)
v_cmp_gt_u32 vcc, 1, v125
s_mov_b64 exec, -1
s_cmp_eq_u64 vcc, 0
s_cselect_b32 s76, s79, 0
s_cmp_ge_u32 s76, 48
s_cbranch_scc0 CF_39
s_load_dwordx2 s[72:73], s[0:1], 8
s_mov_b32 s74, 8192
s_mov_b32 s75, 0x20000
v_mbcnt_lo_u32_b32 v113, -1, 0
v_mbcnt_hi_u32_b32 v113, -1, v113
v_lshlrev_b32 v112, 4, v113
s_lshl_b32 s3, s17, 5
s_add_u32 s3, s3, s16
s_lshl_b32 s3, s3, 6
s_mul_i32 s77, s3, 24576
s_lshl_b32 s3, s19, 12
s_add_u32 m0, s3, 8192
s_add_u32 s3, s3, s77
buffer_load_dwordx4 v112, s[12:15], s3 offen offset:0 sc1 lds
buffer_load_dwordx4 v112, s[12:15], s3 offen offset:1024 sc1 lds
buffer_load_dwordx4 v112, s[12:15], s3 offen offset:2048 sc1 lds
buffer_load_dwordx4 v112, s[12:15], s3 offen offset:3072 sc1 lds
v_and_b32_e64 v114, 1, v113
v_bfe_u32 v115, v113, 2, 2
v_lshl_add_u32 v114, v115, 1, v114
v_lshrrev_b32_e64 v115, 4, v113
v_bfe_u32 v113, v113, 1, 1
v_lshlrev_b32_e64 v114, 10, v114
v_lshl_add_u32 v114, v115, 5, v114
v_lshl_add_u32 v114, v113, 4, v114
s_lshl_b32 s3, s19, 11
s_add_u32 s3, s3, s77
s_add_u32 s3, s3, 16384
buffer_load_dwordx4 v[116:119], v112, s[12:15], s3 offen sc1
buffer_load_dwordx4 v[120:123], v112, s[12:15], s3 offen offset:1024 sc1
s_lshl_b32 s3, s17, 19
s_lshl_b32 s76, s16, 13
s_add_u32 s3, s3, s76
s_and_b32 s76, s19, 1
s_lshl_b32 s76, s76, 18
s_add_u32 s3, s3, s76
s_add_u32 s3, s3, 153092096
s_lshl_b32 s76, s17, 15
s_lshl_b32 s77, s16, 10
s_add_u32 s76, s76, s77
s_add_u32 s76, s76, 154140672
s_cmp_lt_u32 s19, 2
s_cselect_b32 s3, s3, s76
s_cselect_b32 s76, 3, 0
v_lshlrev_b32 v115, s76, v112
buffer_load_dword v115, v115, s[12:15], s3 offen sc1
s_waitcnt lgkmcnt(0)
s_lshl_b32 s3, s19, 11
s_add_u32 m0, s3, 0
s_lshl_b32 s3, s19, 8
s_add_u32 s3, s3, 0
buffer_load_dwordx4 v114, s[72:75], s3 offen lds
s_lshl_b32 s3, s19, 11
s_add_u32 m0, s3, 1024
s_lshl_b32 s3, s19, 8
s_add_u32 s3, s3, 128
buffer_load_dwordx4 v114, s[72:75], s3 offen lds
CK_40:
v_mov_b32 v9, v125
s_waitcnt vmcnt(0)
ds_read_b128 v[12:15], v0 offset:2048
ds_read_b128 v[16:19], v0 offset:3072
ds_read_b128 v[60:63], v1 offset:0
ds_read_b128 v[64:67], v1 offset:1024
ds_read_b128 v[68:71], v1 offset:2048
ds_read_b128 v[72:75], v1 offset:3072
ds_read_b128 v[76:79], v1 offset:4096
ds_read_b128 v[80:83], v1 offset:5120
ds_read_b128 v[84:87], v1 offset:6144
ds_read_b128 v[88:91], v1 offset:7168
ds_read_b128 v[92:95], v1 offset:8192
ds_read_b128 v[96:99], v1 offset:9216
ds_read_b128 v[100:103], v1 offset:10240
ds_read_b128 v[104:107], v1 offset:11264
v_mov_b64 v[44:45], 0
v_mov_b64 v[46:47], 0
v_mov_b64 v[48:49], 0
v_mov_b64 v[50:51], 0
v_mov_b64_e64 v[52:53], 0
v_mov_b64_e64 v[54:55], 0
v_mov_b64_e64 v[56:57], 0
v_mov_b64 v[58:59], 0
s_mov_b32 s68, 268435456
s_waitcnt lgkmcnt(0)
s_cmp_eq_u32 s18, 0
s_cbranch_scc1 CS1
s_add_u32 s36, s21, 18432
s_add_u32 s22, s21, 24576
s_add_u32 s37, s22, 0
v_lshlrev_b32 v7, 3, v0
s_branch CL_42
H2_49:
MT_50:
s_waitcnt vmcnt(1)
v_max_u32 v10, v12, v14
s_waitcnt vmcnt(0)
v_max3_u32 v10, v10, v16, v18
v_cmp_eq_u32_e64 vcc, -1, v10
ds_write_b128 v0, v[12:15] offset:2048
ds_write_b128 v0, v[16:19] offset:3072
s_cbranch_vccnz MRE_51
CL_42:
s_waitcnt lgkmcnt(12)
v_smfmac_f32_16x16x64_bf16 v[44:47], v[12:15], v[60:67], v5
s_waitcnt lgkmcnt(10)
v_smfmac_f32_16x16x64_bf16 v[48:51], v[12:15], v[68:75], v5
s_waitcnt lgkmcnt(8)
v_smfmac_f32_16x16x64_bf16 v[52:55], v[12:15], v[76:83], v5
s_waitcnt lgkmcnt(0)
s_barrier
ds_read_b128 v[20:23], v0 offset:4096
ds_read_b128 v[24:27], v0 offset:5120
v_smfmac_f32_16x16x64_bf16 v[56:59], v[12:15], v[84:91], v5
ds_read_b128 v[28:31], v0 offset:6144
ds_read_b128 v[32:35], v0 offset:7168
v_smfmac_f32_16x16x64_bf16 v[44:47], v[16:19], v[92:99], v5
ds_read_b128 v[36:39], v0 offset:0
ds_read_b128 v[40:43], v0 offset:1024
buffer_store_dwordx4 v[108:111], v0, s[12:15], s68 offen offset:0 sc1
v_smfmac_f32_16x16x64_bf16 v[48:51], v[16:19], v[100:107], v5
buffer_store_dwordx4 v[112:115], v0, s[12:15], s68 offen offset:1024 sc1
v_smfmac_f32_16x16x64_bf16 v[52:55], v[16:19], a[0:7], v5
ds_read_b128 v[92:95], v1 offset:20480
v_smfmac_f32_16x16x64_bf16 v[56:59], v[16:19], a[8:15], v5
ds_read_b128 v[96:99], v1 offset:21504
s_waitcnt lgkmcnt(7)
v_smfmac_f32_16x16x64_bf16 v[44:47], v[20:23], a[16:23], v5
ds_read_b128 v[100:103], v1 offset:22528
v_smfmac_f32_16x16x64_bf16 v[48:51], v[20:23], a[24:31], v5
ds_read_b128 v[104:107], v1 offset:23552
v_smfmac_f32_16x16x64_bf16 v[52:55], v[20:23], a[32:39], v5
ds_read_b128 v[60:63], v1 offset:12288
v_smfmac_f32_16x16x64_bf16 v[56:59], v[20:23], a[40:47], v5
ds_read_b128 v[64:67], v1 offset:13312
s_waitcnt lgkmcnt(10)
v_smfmac_f32_16x16x64_bf16 v[44:47], v[24:27], a[48:55], v5
ds_read_b128 v[68:71], v1 offset:14336
v_smfmac_f32_16x16x64_bf16 v[48:51], v[24:27], a[56:63], v5
ds_read_b128 v[72:75], v1 offset:15360
v_mov_b64_e64 v[108:109], 0
v_smfmac_f32_16x16x64_bf16 v[52:55], v[24:27], a[64:71], v5
ds_read_b128 v[76:79], v1 offset:16384
v_mov_b64_e64 v[110:111], 0
v_smfmac_f32_16x16x64_bf16 v[56:59], v[24:27], a[72:79], v5
ds_read_b128 v[80:83], v1 offset:17408
v_mov_b64 v[112:113], 0
s_waitcnt lgkmcnt(8)
v_smfmac_f32_16x16x64_bf16 v[44:47], v[28:31], v[92:99], v5
ds_read_b128 v[84:87], v1 offset:18432
v_mov_b64 v[114:115], 0
s_waitcnt lgkmcnt(7)
v_smfmac_f32_16x16x64_bf16 v[48:51], v[28:31], v[100:107], v5
ds_read_b128 v[88:91], v1 offset:19456
v_smfmac_f32_16x16x64_bf16 v[52:55], v[28:31], a[80:87], v5
v_mov_b32_dpp v100, v116 quad_perm:[0,1,0,1] row_mask:0xf bank_mask:0xf
v_smfmac_f32_16x16x64_bf16 v[56:59], v[28:31], a[88:95], v5
v_mov_b32_dpp v101, v117 quad_perm:[0,1,0,1] row_mask:0xf bank_mask:0xf
s_waitcnt lgkmcnt(6)
v_smfmac_f32_16x16x64_bf16 v[44:47], v[32:35], v[60:67], v5
v_mov_b32_dpp v102, v118 quad_perm:[0,1,0,1] row_mask:0xf bank_mask:0xf
s_waitcnt lgkmcnt(4)
v_smfmac_f32_16x16x64_bf16 v[48:51], v[32:35], v[68:75], v5
ds_read_b128 v[60:63], v0 offset:8192
v_mov_b32_dpp v103, v119 quad_perm:[0,1,0,1] row_mask:0xf bank_mask:0xf
s_waitcnt lgkmcnt(3)
v_smfmac_f32_16x16x64_bf16 v[52:55], v[32:35], v[76:83], v5
ds_read_b128 v[64:67], v0 offset:9216
v_mov_b32_dpp v104, v120 quad_perm:[0,1,0,1] row_mask:0xf bank_mask:0xf
s_waitcnt lgkmcnt(2)
v_smfmac_f32_16x16x64_bf16 v[56:59], v[32:35], v[84:91], v5
ds_read_b128 v[68:71], v0 offset:10240
v_mov_b32_dpp v105, v121 quad_perm:[0,1,0,1] row_mask:0xf bank_mask:0xf
v_smfmac_f32_16x16x64_bf16 v[44:47], v[36:39], a[96:103], v5
ds_read_b128 v[72:75], v0 offset:11264
v_mov_b32_dpp v106, v122 quad_perm:[0,1,0,1] row_mask:0xf bank_mask:0xf
v_smfmac_f32_16x16x64_bf16 v[44:47], v[40:43], a[128:135], v5
ds_read_b128 v[76:79], v0 offset:12288
v_mov_b32_dpp v107, v123 quad_perm:[0,1,0,1] row_mask:0xf bank_mask:0xf
v_smfmac_f32_16x16x64_bf16 v[48:51], v[36:39], a[104:111], v5
ds_read_b128 v[80:83], v0 offset:13312
v_mov_b32 v11, 0xf149f2ca
v_smfmac_f32_16x16x64_bf16 v[48:51], v[40:43], a[136:143], v5
ds_read_b128 v[84:87], v0 offset:14336
v_add_f32_e64 v44, v44, v46
v_smfmac_f32_16x16x64_bf16 v[52:55], v[36:39], a[112:119], v5
ds_read_b128 v[88:91], v0 offset:15360
v_add_f32_e64 v45, v45, v47
v_smfmac_f32_16x16x64_bf16 v[52:55], v[40:43], a[144:151], v5
v_add_f32_e64 v48, v48, v50
v_smfmac_f32_16x16x64_bf16 v[56:59], v[36:39], a[120:127], v5
v_add_f32_e64 v49, v49, v51
v_smfmac_f32_16x16x64_bf16 v[56:59], v[40:43], a[152:159], v5
v_add_f32 v52, v52, v54
v_add_f32 v53, v53, v55
v_cvt_pk_bf16_f32 v124, v44, v48
v_cvt_pk_bf16_f32 v126, v45, v49
v_cndmask_b32 v44, 0, v11, s[40:41]
v_cndmask_b32 v45, 0, v11, s[42:43]
s_nop 1
v_add_f32 v56, v56, v58
v_add_f32_e64 v57, v57, v59
v_cvt_pk_bf16_f32 v125, v52, v56
v_cvt_pk_bf16_f32 v127, v53, v57
ds_write_b64 v2, v[124:125] offset:0
ds_write_b64 v2, v[126:127] offset:16
v_smfmac_f32_16x16x64_bf16 v[108:111], v[36:39], a[160:167], v5
s_mov_b32 m0, 10240
s_add_u32 s32, s22, 2048
v_cndmask_b32 v46, 0, v11, s[44:45]
v_smfmac_f32_16x16x64_bf16 v[112:115], v[36:39], a[168:175], v5
v_cndmask_b32 v47, 0, v11, s[46:47]
v_smfmac_f32_16x16x64_bf16 v[108:111], v[40:43], a[176:183], v5
v_cndmask_b32 v48, 0, v11, s[48:49]
v_smfmac_f32_16x16x64_bf16 v[112:115], v[40:43], a[184:191], v5
v_cndmask_b32 v49, 0, v11, s[50:51]
v_smfmac_f32_16x16x64_bf16 v[108:111], v[12:15], a[192:199], v5
v_cndmask_b32 v50, 0, v11, s[52:53]
s_waitcnt lgkmcnt(0)
s_barrier
s_mov_b64 exec, s[56:57]
ds_read_b128 v[116:119], v3 offset:0
ds_read_b128 v[120:123], v3 offset:576
ds_read_b128 v[100:103], v3 offset:1152
ds_read_b128 v[104:107], v3 offset:1728
s_mov_b64 exec, -1
ds_read_b128 v[92:95], v4 offset:0
ds_read_b128 v[96:99], v4 offset:1152
v_smfmac_f32_16x16x64_bf16 v[112:115], v[12:15], a[200:207], v5
v_cndmask_b32 v51, 0, v11, s[54:55]
v_smfmac_f32_16x16x64_bf16 v[108:111], v[16:19], a[208:215], v5
v_mov_b32_e64 v53, 0
v_smfmac_f32_16x16x64_bf16 v[112:115], v[16:19], a[216:223], v5
v_mov_b32_e64 v54, 0
v_smfmac_f32_16x16x64_bf16 v[108:111], v[20:23], a[224:231], v5
v_mov_b64_e64 v[124:125], 0
v_smfmac_f32_16x16x64_bf16 v[112:115], v[20:23], a[232:239], v5
v_mov_b64_e64 v[126:127], 0
s_waitcnt lgkmcnt(5)
v_mfma_f32_16x16x32_bf16 v[44:47], v[60:63], v[116:119], v[44:47]
v_mfma_f32_16x16x32_bf16 v[48:51], v[76:79], v[116:119], v[48:51]
ds_read_b128 v[60:63], v0 offset:16384
s_waitcnt lgkmcnt(5)
v_mfma_f32_16x16x32_bf16 v[44:47], v[64:67], v[120:123], v[44:47]
ds_read_b128 v[76:79], v0 offset:20480
v_mfma_f32_16x16x32_bf16 v[48:51], v[80:83], v[120:123], v[48:51]
ds_read_b128 v[64:67], v0 offset:17408
s_waitcnt lgkmcnt(4)
v_smfmac_f32_16x16x64_bf16 v[124:127], v[92:95], v[116:123], v5
ds_read_b128 v[80:83], v0 offset:21504
v_mfma_f32_16x16x32_bf16 v[44:47], v[68:71], v[100:103], v[44:47]
v_mfma_f32_16x16x32_bf16 v[48:51], v[84:87], v[100:103], v[48:51]
ds_read_b128 v[68:71], v0 offset:18432
s_waitcnt lgkmcnt(5)
v_smfmac_f32_16x16x64_bf16 v[124:127], v[96:99], v[100:107], v5
ds_read_b128 v[84:87], v0 offset:22528
v_mfma_f32_16x16x32_bf16 v[44:47], v[72:75], v[104:107], v[44:47]
v_mfma_f32_16x16x32_bf16 v[48:51], v[88:91], v[104:107], v[48:51]
ds_read_b128 v[72:75], v0 offset:19456
ds_read_b128 v[88:91], v0 offset:23552
v_add_f32 v124, v124, v126
v_add_f32 v125, v125, v127
v_max3_f32 v10, v124, v125, v44
v_max3_f32 v10, v10, v45, v46
v_smfmac_f32_16x16x64_bf16 v[108:111], v[24:27], a[240:247], v5
s_nop 0
v_max3_f32 v10, v10, v47, v48
v_max3_f32 v10, v10, v49, v50
v_max_f32 v11, v10, v51
v_max_f32_e64 v10, v10, v51
v_smfmac_f32_16x16x64_bf16 v[112:115], v[24:27], a[248:255], v5
s_nop 0
v_permlane16_swap_b32 v10, v11
v_max_f32 v10, v10, v11
v_mov_b32 v11, v10
v_smfmac_f32_16x16x64_bf16 v[108:111], v[28:31], v[128:135], v5
s_nop 0
v_permlane32_swap_b32 v10, v11
v_max_f32 v10, v10, v11
v_mul_f32 v10, s38, v10
v_fma_f32 v124, v124, s38, -v10
v_fma_f32 v125, v125, s38, -v10
v_pk_fma_f32 v[44:45], v[44:45], s[38:39], v[10:11] op_sel_hi:[1,1,0] neg_lo:[0,0,1] neg_hi:[0,0,1]
v_pk_fma_f32 v[46:47], v[46:47], s[38:39], v[10:11] op_sel_hi:[1,1,0] neg_lo:[0,0,1] neg_hi:[0,0,1]
v_pk_fma_f32 v[48:49], v[48:49], s[38:39], v[10:11] op_sel_hi:[1,1,0] neg_lo:[0,0,1] neg_hi:[0,0,1]
v_pk_fma_f32 v[50:51], v[50:51], s[38:39], v[10:11] op_sel_hi:[1,1,0] neg_lo:[0,0,1] neg_hi:[0,0,1]
v_smfmac_f32_16x16x64_bf16 v[112:115], v[28:31], v[136:143], v5
buffer_load_dwordx4 v0, s[12:15], s32 offen offset:0 sc1 lds
v_exp_f32 v44, v44
v_smfmac_f32_16x16x64_bf16 v[108:111], v[32:35], v[144:151], v5
v_exp_f32 v45, v45
v_smfmac_f32_16x16x64_bf16 v[112:115], v[32:35], v[152:159], v5
buffer_load_dwordx4 v0, s[12:15], s32 offen offset:1024 sc1 lds
v_exp_f32 v46, v46
v_exp_f32 v47, v47
v_exp_f32 v48, v48
v_exp_f32 v49, v49
v_exp_f32 v50, v50
v_exp_f32 v51, v51
v_exp_f32 v124, v124
v_exp_f32 v125, v125
v_pk_add_f32 v[108:109], v[108:109], v[110:111]
v_pk_add_f32 v[10:11], v[44:45], v[46:47]
v_pk_add_f32 v[126:127], v[48:49], v[50:51]
v_pk_add_f32 v[10:11], v[10:11], v[124:125]
v_pk_add_f32 v[10:11], v[10:11], v[126:127]
v_pk_add_f32 v[112:113], v[112:113], v[114:115]
v_add_f32 v126, v10, v11
v_add_f32 v10, v10, v11
v_cvt_pk_bf16_f32 v108, v108, v109
v_cvt_pk_bf16_f32 v109, v112, v113
v_permlane16_swap_b32 v10, v126
v_add_f32 v11, v10, v126
v_add_f32 v10, v10, v126
ds_write_b64 v0, v[108:109] offset:29192
s_mov_b64 vcc, s[56:57]
v_permlane32_swap_b32 v10, v11
v_add_f32 v10, v10, v11
v_rcp_f32_e64 v10, v10
s_mov_b32 m0, 18432
v_pk_mul_f32 v[44:45], v[44:45], v[10:11] op_sel_hi:[1,0]
v_pk_mul_f32 v[46:47], v[46:47], v[10:11] op_sel_hi:[1,0]
v_pk_mul_f32 v[48:49], v[48:49], v[10:11] op_sel_hi:[1,0]
v_pk_mul_f32 v[50:51], v[50:51], v[10:11] op_sel_hi:[1,0]
v_pk_mul_f32 v[124:125], v[124:125], v[10:11] op_sel_hi:[1,0]
v_cvt_pk_bf16_f32 v56, v44, v45
v_cvt_pk_bf16_f32 v57, v46, v47
v_cvt_pk_bf16_f32 v58, v48, v49
v_cvt_pk_bf16_f32 v59, v50, v51
v_cvt_pk_bf16_f32 v52, v124, v125
v_cvt_pk_bf16_f32 v55, v124, v125
s_waitcnt lgkmcnt(8)
v_mfma_f32_16x16x32_bf16 v[92:95], v[60:63], v[56:59], 0
s_waitcnt lgkmcnt(0)
s_barrier
ds_read_b128 v[116:119], v0 offset:29184
ds_read_b128 v[120:123], v0 offset:30208
v_mfma_f32_16x16x32_bf16 v[96:99], v[64:67], v[56:59], 0
s_add_u32 s33, s22, 10240
s_cmp_eq_u32 s20, 63
v_mov_b64 v[12:13], 0
v_mov_b64 v[14:15], 0
v_mfma_f32_16x16x32_bf16 v[100:103], v[68:71], v[56:59], 0
v_mov_b64 v[16:17], 0
v_mov_b64 v[18:19], 0
v_mfma_f32_16x16x32_bf16 v[104:107], v[72:75], v[56:59], 0
v_mov_b64 v[20:21], 0
v_mov_b64 v[22:23], 0
v_mfma_f32_16x16x32_bf16 v[60:63], v[76:79], v[56:59], 0
v_mov_b64 v[24:25], 0
v_mov_b64 v[26:27], 0
s_waitcnt lgkmcnt(1)
v_mfma_f32_16x16x16_bf16 v[92:95], v[116:117], v[52:53], v[92:95]
v_mov_b64 v[28:29], 0
v_mov_b64 v[30:31], 0
v_mfma_f32_16x16x16_bf16 v[96:99], v[116:117], v[54:55], v[96:99]
v_mov_b64 v[32:33], 0
v_mov_b64 v[34:35], 0
v_mfma_f32_16x16x16_bf16 v[100:103], v[118:119], v[52:53], v[100:103]
v_cvt_pk_bf16_f32 v108, v92, v93
v_cvt_pk_bf16_f32 v109, v94, v95
v_mfma_f32_16x16x16_bf16 v[104:107], v[118:119], v[54:55], v[104:107]
buffer_load_dwordx4 v0, s[12:15], s33 offen offset:0 sc1 lds
v_cvt_pk_bf16_f32 v110, v96, v97
v_cvt_pk_bf16_f32 v111, v98, v99
v_mfma_f32_16x16x32_bf16 v[64:67], v[80:83], v[56:59], 0
v_cvt_pk_bf16_f32 v112, v100, v101
v_cvt_pk_bf16_f32 v113, v102, v103
s_waitcnt lgkmcnt(0)
v_mfma_f32_16x16x16_bf16 v[60:63], v[120:121], v[52:53], v[60:63]
v_cvt_pk_bf16_f32 v114, v104, v105
v_cvt_pk_bf16_f32 v115, v106, v107
v_mfma_f32_16x16x32_bf16 v[68:71], v[84:87], v[56:59], 0
v_cndmask_b32_dpp v100, v109, v108, vcc quad_perm:[0,1,0,1] row_mask:0xf bank_mask:0xf
v_cndmask_b32_dpp v101, v111, v110, vcc quad_perm:[0,1,0,1] row_mask:0xf bank_mask:0xf
v_mfma_f32_16x16x16_bf16 v[64:67], v[120:121], v[54:55], v[64:67]
buffer_load_dwordx4 v0, s[12:15], s33 offen offset:1024 sc1 lds
v_cndmask_b32_dpp v102, v113, v112, vcc quad_perm:[0,1,0,1] row_mask:0xf bank_mask:0xf
v_cndmask_b32_dpp v103, v115, v114, vcc quad_perm:[0,1,0,1] row_mask:0xf bank_mask:0xf
v_mfma_f32_16x16x32_bf16 v[72:75], v[88:91], v[56:59], 0
v_cvt_pk_bf16_f32 v116, v60, v61
v_cvt_pk_bf16_f32 v117, v62, v63
v_mfma_f32_16x16x16_bf16 v[68:71], v[122:123], v[52:53], v[68:71]
v_cvt_pk_bf16_f32 v118, v64, v65
v_cvt_pk_bf16_f32 v119, v66, v67
v_mfma_f32_16x16x16_bf16 v[72:75], v[122:123], v[54:55], v[72:75]
s_cbranch_scc1 CLAST_43
v_cndmask_b32_dpp v104, v117, v116, vcc quad_perm:[0,1,0,1] row_mask:0xf bank_mask:0xf
v_cndmask_b32_dpp v105, v119, v118, vcc quad_perm:[0,1,0,1] row_mask:0xf bank_mask:0xf
v_smfmac_f32_16x16x64_bf16 v[12:15], v[100:103], v[160:167], v5
ds_read_b128 v[44:47], v1 offset:24576
ds_read_b128 v[48:51], v1 offset:25600
s_and_b32 s32, s20, 1
v_cvt_pk_bf16_f32 v120, v68, v69
v_smfmac_f32_16x16x64_bf16 v[16:19], v[100:103], v[168:175], v5
ds_read_b128 v[92:95], v1 offset:26624
s_lshl_b32 s32, s32, 18
v_cvt_pk_bf16_f32 v121, v70, v71
v_cvt_pk_bf16_f32 v122, v72, v73
v_smfmac_f32_16x16x64_bf16 v[20:23], v[100:103], v[176:183], v5
ds_read_b128 v[96:99], v1 offset:27648
s_add_u32 s25, s34, s32
v_cvt_pk_bf16_f32 v123, v74, v75
v_smfmac_f32_16x16x64_bf16 v[24:27], v[100:103], v[184:191], v5
v_cndmask_b32_dpp v106, v121, v120, vcc quad_perm:[0,1,0,1] row_mask:0xf bank_mask:0xf
v_cndmask_b32_dpp v107, v123, v122, vcc quad_perm:[0,1,0,1] row_mask:0xf bank_mask:0xf
s_add_u32 s26, s25, 32768
s_bfe_u32 s69, s20, 0x10001
v_smfmac_f32_16x16x64_bf16 v[12:15], v[104:107], v[224:231], v5
ds_read_b128 v[76:79], v1 offset:28672
v_mov_b64 v[36:37], 0
v_mov_b64 v[40:41], 0
v_smfmac_f32_16x16x64_bf16 v[16:19], v[104:107], v[232:239], v5
ds_read_b128 v[80:83], v1 offset:29696
v_mov_b64 v[38:39], 0
v_mov_b64 v[42:43], 0
v_smfmac_f32_16x16x64_bf16 v[20:23], v[104:107], v[240:247], v5
ds_read_b128 v[84:87], v1 offset:30720
v_add_f32_e64 v12, v12, v14
v_smfmac_f32_16x16x64_bf16 v[24:27], v[104:107], v[248:255], v5
ds_read_b128 v[88:91], v1 offset:31744
v_add_f32_e64 v13, v13, v15
v_smfmac_f32_16x16x64_bf16 v[28:31], v[100:103], v[192:199], v5
v_add_f32 v16, v16, v18
v_add_f32 v17, v17, v19
v_smfmac_f32_16x16x64_bf16 v[32:35], v[100:103], v[200:207], v5
v_add_f32 v20, v20, v22
v_add_f32 v21, v21, v23
v_smfmac_f32_16x16x64_bf16 v[36:39], v[100:103], v[208:215], v5
v_add_f32_e64 v24, v24, v26
v_add_f32 v25, v25, v27
v_smfmac_f32_16x16x64_bf16 v[40:43], v[100:103], v[216:223], v5
v_cvt_pk_bf16_f32 v52, v12, v16
v_cvt_pk_bf16_f32 v53, v20, v24
s_waitcnt lgkmcnt(6)
v_smfmac_f32_16x16x64_bf16 v[28:31], v[104:107], v[44:51], v5
v_cvt_pk_bf16_f32 v54, v13, v17
v_cvt_pk_bf16_f32 v55, v21, v25
s_waitcnt lgkmcnt(4)
v_smfmac_f32_16x16x64_bf16 v[32:35], v[104:107], v[92:99], v5
v_and_or_b32 v52, v52, -2, s69
s_waitcnt lgkmcnt(2)
v_smfmac_f32_16x16x64_bf16 v[36:39], v[104:107], v[76:83], v5
buffer_store_dwordx4 v[52:55], v6, s[12:15], s25 offen
v_add_f32 v28, v28, v30
s_waitcnt lgkmcnt(0)
v_smfmac_f32_16x16x64_bf16 v[40:43], v[104:107], v[84:91], v5
v_add_f32 v29, v29, v31
v_add_f32 v32, v32, v34
v_add_f32_e64 v33, v33, v35
v_cvt_pk_bf16_f32 v56, v28, v32
v_add_f32 v36, v36, v38
v_add_f32 v37, v37, v39
v_cvt_pk_bf16_f32 v58, v29, v33
v_and_or_b32 v56, v56, -2, s69
v_pk_add_f32 v[40:41], v[40:41], v[42:43]
v_cvt_pk_bf16_f32 v57, v36, v40
v_cvt_pk_bf16_f32 v59, v37, v41
buffer_store_dwordx4 v[56:59], v6, s[12:15], s26 offen
s_lshl_b32 s32, s16, 13
s_add_u32 s25, s25, s32
s_add_u32 s25, s25, 2048
v_and_b32 v10, 16, v0
v_mov_b32 v11, 0x3f80
v_lshlrev_b32 v10, v10, v11
v_cndmask_b32 v124, 0, v10, s[60:61]
v_cndmask_b32 v125, 0, v10, s[62:63]
v_cndmask_b32 v126, 0, v10, s[64:65]
v_cndmask_b32 v127, 0, v10, s[66:67]
v_mov_b64 v[32:33], -1
v_bfe_u32 v10, v0, 4, 1
v_lshrrev_b32 v11, 8, v0
v_lshl_add_u32 v10, v11, 1, v10
v_and_b32_e64 v11, 32, v0
v_lshl_add_u32 v35, v10, 3, v11
s_and_b32 s32, s20, 3
s_lshl_b32 s32, s32, 13
s_add_u32 s27, s35, s32
s_add_u32 s29, s27, 2048
s_xor_b32 s32, s32, 16384
s_add_u32 s28, s35, s32
s_lshl_b32 s32, s16, 8
s_add_u32 s27, s27, s32
s_add_u32 s28, s28, s32
s_mov_b32 s68, s23
s_mov_b32 m0, 2048
s_mov_b32 s30, 0
s_mov_b64 vcc, s[58:59]
v_cndmask_b32_dpp v108, v116, v108, vcc quad_perm:[2,3,2,3] row_mask:0xf bank_mask:0xf
v_cndmask_b32_dpp v109, v117, v109, vcc quad_perm:[2,3,2,3] row_mask:0xf bank_mask:0xf
v_cndmask_b32_dpp v110, v118, v110, vcc quad_perm:[2,3,2,3] row_mask:0xf bank_mask:0xf
v_cndmask_b32_dpp v111, v119, v111, vcc quad_perm:[2,3,2,3] row_mask:0xf bank_mask:0xf
v_cndmask_b32_dpp v112, v120, v112, vcc quad_perm:[2,3,2,3] row_mask:0xf bank_mask:0xf
v_cndmask_b32_dpp v113, v121, v113, vcc quad_perm:[2,3,2,3] row_mask:0xf bank_mask:0xf
v_cndmask_b32_dpp v114, v122, v114, vcc quad_perm:[2,3,2,3] row_mask:0xf bank_mask:0xf
v_cndmask_b32_dpp v115, v123, v115, vcc quad_perm:[2,3,2,3] row_mask:0xf bank_mask:0xf
v_min_u32 v108, -2, v108
v_min_u32 v112, -2, v112
ds_read_b128 v[60:63], v1 offset:0
ds_read_b128 v[64:67], v1 offset:1024
ds_read_b128 v[68:71], v1 offset:2048
ds_read_b128 v[72:75], v1 offset:3072
ds_read_b128 v[76:79], v1 offset:4096
ds_read_b128 v[80:83], v1 offset:5120
ds_read_b128 v[84:87], v1 offset:6144
ds_read_b128 v[88:91], v1 offset:7168
ds_read_b128 v[92:95], v1 offset:8192
ds_read_b128 v[96:99], v1 offset:9216
ds_read_b128 v[100:103], v1 offset:10240
ds_read_b128 v[104:107], v1 offset:11264
v_mov_b64 v[44:45], 0
v_mov_b64 v[46:47], 0
v_mov_b64 v[48:49], 0
v_mov_b64 v[50:51], 0
buffer_load_dwordx4 v[20:23], v0, s[12:15], s25 offen offset:0 sc1
buffer_load_dwordx4 v[24:27], v0, s[12:15], s25 offen offset:1024 sc1
v_mov_b64 v[52:53], 0
v_mov_b64 v[54:55], 0
v_mov_b64 v[56:57], 0
v_mov_b64 v[58:59], 0
RT_46:
s_waitcnt vmcnt(1)
v_mfma_f32_16x16x32_bf16 v[28:31], v[124:127], v[20:23], 0
v_xor_b32 v10, s69, v20
s_waitcnt vmcnt(0)
v_bitop3_b32 v10, v10, v24, s69 bitop3:0xf6
v_and_b32 v10, 1, v10
v_cmp_ne_u32 vcc, 0, v10
v_mfma_f32_16x16x32_bf16 v[28:31], v[124:127], v[24:27], v[28:31]
s_cbranch_vccz RG_48
s_mov_b64 exec, vcc
buffer_load_dwordx4 v[20:23], v0, s[12:15], s25 offen offset:0 sc1
buffer_load_dwordx4 v[24:27], v0, s[12:15], s25 offen offset:1024 sc1
s_mov_b64 exec, -1
s_add_u32 s30, s30, 1
s_cmp_gt_u32 s30, 2097152
s_cbranch_scc1 FAIL
s_branch RT_46
RG_48:
s_nop 6
v_add_f32_dpp v28, v28, v28 row_ror:4 row_mask:0xf bank_mask:0xf
v_add_f32_dpp v29, v29, v29 row_ror:4 row_mask:0xf bank_mask:0xf
v_add_f32_dpp v30, v30, v30 row_ror:4 row_mask:0xf bank_mask:0xf
v_add_f32_dpp v31, v31, v31 row_ror:4 row_mask:0xf bank_mask:0xf
v_add_f32_dpp v28, v28, v28 row_ror:8 row_mask:0xf bank_mask:0xf
v_add_f32_dpp v29, v29, v29 row_ror:8 row_mask:0xf bank_mask:0xf
v_add_f32_dpp v30, v30, v30 row_ror:8 row_mask:0xf bank_mask:0xf
v_add_f32_dpp v31, v31, v31 row_ror:8 row_mask:0xf bank_mask:0xf
v_cvt_pk_bf16_f32 v10, v28, v29
v_cvt_pk_bf16_f32 v11, v30, v31
v_min_u32 v10, -2, v10
s_mov_b64 exec, 0xf000f
buffer_store_dwordx2 v[10:11], v35, s[12:15], s27 offen offset:64
buffer_store_dwordx2 v[32:33], v35, s[12:15], s28 offen offset:64
s_mov_b64 exec, -1
s_add_u32 s20, s20, 1
s_mov_b32 s21, s22
s_add_u32 s23, s23, 8192
s_add_u32 s36, s21, 18432
s_add_u32 s22, s21, 24576
s_add_u32 s37, s22, 0
buffer_load_dwordx4 v[116:119], v0, s[12:15], s36 offen offset:0 sc1
buffer_load_dwordx4 v[120:123], v0, s[12:15], s36 offen offset:1024 sc1
s_waitcnt vmcnt(0)
buffer_load_dwordx4 v[12:15], v0, s[12:15], s29 offen offset:0 sc1
buffer_load_dwordx4 v[16:19], v0, s[12:15], s29 offen offset:1024 sc1
s_branch H2_49
ROK_47:
s_mov_b64 exec, vcc
buffer_load_dwordx4 v[20:23], v0, s[12:15], s25 offen offset:0 sc1
buffer_load_dwordx4 v[24:27], v0, s[12:15], s25 offen offset:1024 sc1
s_mov_b64 exec, -1
s_add_u32 s30, s30, 1
s_cmp_gt_u32 s30, 2097152
s_cbranch_scc1 FAIL
s_branch RT_46
MRE_51:
s_mov_b64 exec, vcc
buffer_load_dwordx4 v[12:15], v0, s[12:15], s29 offen offset:0 sc1
buffer_load_dwordx4 v[16:19], v0, s[12:15], s29 offen offset:1024 sc1
s_mov_b64 exec, -1
s_add_u32 s30, s30, 1
s_cmp_gt_u32 s30, 2097152
s_cbranch_scc1 FAIL
s_branch MT_50
CLAST_43:
s_nop 2
v_cvt_pk_bf16_f32 v120, v68, v69
v_cvt_pk_bf16_f32 v121, v70, v71
s_nop 1
v_cvt_pk_bf16_f32 v122, v72, v73
v_cvt_pk_bf16_f32 v123, v74, v75
s_mov_b64 vcc, s[58:59]
v_cndmask_b32_dpp v108, v116, v108, vcc quad_perm:[2,3,2,3] row_mask:0xf bank_mask:0xf
v_cndmask_b32_dpp v109, v117, v109, vcc quad_perm:[2,3,2,3] row_mask:0xf bank_mask:0xf
v_cndmask_b32_dpp v110, v118, v110, vcc quad_perm:[2,3,2,3] row_mask:0xf bank_mask:0xf
v_cndmask_b32_dpp v111, v119, v111, vcc quad_perm:[2,3,2,3] row_mask:0xf bank_mask:0xf
v_cndmask_b32_dpp v112, v120, v112, vcc quad_perm:[2,3,2,3] row_mask:0xf bank_mask:0xf
v_cndmask_b32_dpp v113, v121, v113, vcc quad_perm:[2,3,2,3] row_mask:0xf bank_mask:0xf
v_cndmask_b32_dpp v114, v122, v114, vcc quad_perm:[2,3,2,3] row_mask:0xf bank_mask:0xf
v_cndmask_b32_dpp v115, v123, v115, vcc quad_perm:[2,3,2,3] row_mask:0xf bank_mask:0xf
v_min_u32 v108, -2, v108
v_min_u32 v112, -2, v112
buffer_store_dwordx4 v[108:111], v0, s[12:15], s23 offen offset:0 sc1
buffer_store_dwordx4 v[112:115], v0, s[12:15], s23 offen offset:1024 sc1
s_branch FIN
CS1:
s_add_u32 s36, s21, 18432
s_add_u32 s22, s21, 24576
s_add_u32 s37, s22, 0
v_lshlrev_b32 v7, 3, v0
s_branch CL_52
H2_59:
MT_60:
s_waitcnt vmcnt(1)
v_max_u32 v10, v12, v14
s_waitcnt vmcnt(0)
v_max3_u32 v10, v10, v16, v18
v_cmp_eq_u32 vcc, -1, v10
ds_write_b128 v0, v[12:15] offset:2048
ds_write_b128 v0, v[16:19] offset:3072
s_cbranch_vccnz MRE_61
CL_52:
s_waitcnt lgkmcnt(12)
v_smfmac_f32_16x16x64_bf16 v[44:47], v[12:15], v[60:67], v5
s_waitcnt lgkmcnt(10)
v_smfmac_f32_16x16x64_bf16 v[48:51], v[12:15], v[68:75], v5
s_waitcnt lgkmcnt(8)
v_smfmac_f32_16x16x64_bf16 v[52:55], v[12:15], v[76:83], v5
s_waitcnt lgkmcnt(0)
s_barrier
ds_read_b128 v[20:23], v0 offset:4096
ds_read_b128 v[24:27], v0 offset:5120
v_smfmac_f32_16x16x64_bf16 v[56:59], v[12:15], v[84:91], v5
ds_read_b128 v[28:31], v0 offset:6144
ds_read_b128 v[32:35], v0 offset:7168
v_smfmac_f32_16x16x64_bf16 v[44:47], v[16:19], v[92:99], v5
ds_read_b128 v[36:39], v0 offset:0
ds_read_b128 v[40:43], v0 offset:1024
buffer_store_dwordx4 v[108:111], v0, s[12:15], s68 offen offset:0 sc1
v_smfmac_f32_16x16x64_bf16 v[48:51], v[16:19], v[100:107], v5
buffer_store_dwordx4 v[112:115], v0, s[12:15], s68 offen offset:1024 sc1
v_smfmac_f32_16x16x64_bf16 v[52:55], v[16:19], a[0:7], v5
ds_read_b128 v[92:95], v1 offset:20480
v_smfmac_f32_16x16x64_bf16 v[56:59], v[16:19], a[8:15], v5
ds_read_b128 v[96:99], v1 offset:21504
s_waitcnt lgkmcnt(7)
v_smfmac_f32_16x16x64_bf16 v[44:47], v[20:23], a[16:23], v5
ds_read_b128 v[100:103], v1 offset:22528
v_smfmac_f32_16x16x64_bf16 v[48:51], v[20:23], a[24:31], v5
ds_read_b128 v[104:107], v1 offset:23552
v_smfmac_f32_16x16x64_bf16 v[52:55], v[20:23], a[32:39], v5
ds_read_b128 v[60:63], v1 offset:12288
v_smfmac_f32_16x16x64_bf16 v[56:59], v[20:23], a[40:47], v5
ds_read_b128 v[64:67], v1 offset:13312
s_waitcnt lgkmcnt(10)
v_smfmac_f32_16x16x64_bf16 v[44:47], v[24:27], a[48:55], v5
ds_read_b128 v[68:71], v1 offset:14336
v_smfmac_f32_16x16x64_bf16 v[48:51], v[24:27], a[56:63], v5
ds_read_b128 v[72:75], v1 offset:15360
v_mov_b64_e64 v[108:109], 0
v_smfmac_f32_16x16x64_bf16 v[52:55], v[24:27], a[64:71], v5
ds_read_b128 v[76:79], v1 offset:16384
v_mov_b64_e64 v[110:111], 0
v_smfmac_f32_16x16x64_bf16 v[56:59], v[24:27], a[72:79], v5
ds_read_b128 v[80:83], v1 offset:17408
v_mov_b64 v[112:113], 0
s_waitcnt lgkmcnt(8)
v_smfmac_f32_16x16x64_bf16 v[44:47], v[28:31], v[92:99], v5
ds_read_b128 v[84:87], v1 offset:18432
v_mov_b64 v[114:115], 0
s_waitcnt lgkmcnt(7)
v_smfmac_f32_16x16x64_bf16 v[48:51], v[28:31], v[100:107], v5
ds_read_b128 v[88:91], v1 offset:19456
v_smfmac_f32_16x16x64_bf16 v[52:55], v[28:31], a[80:87], v5
v_mov_b32_dpp v100, v116 quad_perm:[0,1,0,1] row_mask:0xf bank_mask:0xf
v_smfmac_f32_16x16x64_bf16 v[56:59], v[28:31], a[88:95], v5
v_mov_b32_dpp v101, v117 quad_perm:[0,1,0,1] row_mask:0xf bank_mask:0xf
s_waitcnt lgkmcnt(6)
v_smfmac_f32_16x16x64_bf16 v[44:47], v[32:35], v[60:67], v5
v_mov_b32_dpp v102, v118 quad_perm:[0,1,0,1] row_mask:0xf bank_mask:0xf
s_waitcnt lgkmcnt(4)
v_smfmac_f32_16x16x64_bf16 v[48:51], v[32:35], v[68:75], v5
ds_read_b128 v[60:63], v0 offset:8192
v_mov_b32_dpp v103, v119 quad_perm:[0,1,0,1] row_mask:0xf bank_mask:0xf
s_waitcnt lgkmcnt(3)
v_smfmac_f32_16x16x64_bf16 v[52:55], v[32:35], v[76:83], v5
ds_read_b128 v[64:67], v0 offset:9216
v_mov_b32_dpp v104, v120 quad_perm:[0,1,0,1] row_mask:0xf bank_mask:0xf
s_waitcnt lgkmcnt(2)
v_smfmac_f32_16x16x64_bf16 v[56:59], v[32:35], v[84:91], v5
ds_read_b128 v[68:71], v0 offset:10240
v_mov_b32_dpp v105, v121 quad_perm:[0,1,0,1] row_mask:0xf bank_mask:0xf
v_smfmac_f32_16x16x64_bf16 v[44:47], v[36:39], a[96:103], v5
ds_read_b128 v[72:75], v0 offset:11264
v_mov_b32_dpp v106, v122 quad_perm:[0,1,0,1] row_mask:0xf bank_mask:0xf
v_smfmac_f32_16x16x64_bf16 v[44:47], v[40:43], a[128:135], v5
ds_read_b128 v[76:79], v0 offset:12288
v_mov_b32_dpp v107, v123 quad_perm:[0,1,0,1] row_mask:0xf bank_mask:0xf
v_smfmac_f32_16x16x64_bf16 v[48:51], v[36:39], a[104:111], v5
ds_read_b128 v[80:83], v0 offset:13312
v_mov_b32 v11, 0xf149f2ca
v_smfmac_f32_16x16x64_bf16 v[48:51], v[40:43], a[136:143], v5
ds_read_b128 v[84:87], v0 offset:14336
v_add_f32_e64 v44, v44, v46
v_smfmac_f32_16x16x64_bf16 v[52:55], v[36:39], a[112:119], v5
ds_read_b128 v[88:91], v0 offset:15360
v_add_f32_e64 v45, v45, v47
v_smfmac_f32_16x16x64_bf16 v[52:55], v[40:43], a[144:151], v5
v_add_f32_e64 v48, v48, v50
v_smfmac_f32_16x16x64_bf16 v[56:59], v[36:39], a[120:127], v5
v_add_f32_e64 v49, v49, v51
v_smfmac_f32_16x16x64_bf16 v[56:59], v[40:43], a[152:159], v5
v_add_f32 v52, v52, v54
v_add_f32 v53, v53, v55
v_cvt_pk_bf16_f32 v124, v44, v48
v_cvt_pk_bf16_f32 v126, v45, v49
v_cndmask_b32 v44, 0, v11, s[40:41]
v_cndmask_b32 v45, 0, v11, s[42:43]
s_nop 1
v_add_f32 v56, v56, v58
v_add_f32_e64 v57, v57, v59
v_cvt_pk_bf16_f32 v125, v52, v56
v_cvt_pk_bf16_f32 v127, v53, v57
ds_write_b64 v2, v[124:125] offset:0
ds_write_b64 v2, v[126:127] offset:16
v_smfmac_f32_16x16x64_bf16 v[108:111], v[36:39], a[160:167], v5
s_mov_b32 m0, 10240
s_add_u32 s32, s22, 2048
v_cndmask_b32 v46, 0, v11, s[44:45]
v_smfmac_f32_16x16x64_bf16 v[112:115], v[36:39], a[168:175], v5
v_cndmask_b32 v47, 0, v11, s[46:47]
v_smfmac_f32_16x16x64_bf16 v[108:111], v[40:43], a[176:183], v5
v_cndmask_b32 v48, 0, v11, s[48:49]
v_smfmac_f32_16x16x64_bf16 v[112:115], v[40:43], a[184:191], v5
v_cndmask_b32 v49, 0, v11, s[50:51]
v_smfmac_f32_16x16x64_bf16 v[108:111], v[12:15], a[192:199], v5
v_cndmask_b32 v50, 0, v11, s[52:53]
s_waitcnt lgkmcnt(0)
s_barrier
s_mov_b64 exec, s[56:57]
ds_read_b128 v[116:119], v3 offset:0
ds_read_b128 v[120:123], v3 offset:576
ds_read_b128 v[100:103], v3 offset:1152
ds_read_b128 v[104:107], v3 offset:1728
s_mov_b64 exec, -1
ds_read_b128 v[92:95], v4 offset:0
ds_read_b128 v[96:99], v4 offset:1152
v_smfmac_f32_16x16x64_bf16 v[112:115], v[12:15], a[200:207], v5
v_cndmask_b32 v51, 0, v11, s[54:55]
v_smfmac_f32_16x16x64_bf16 v[108:111], v[16:19], a[208:215], v5
v_mov_b32_e64 v53, 0
v_smfmac_f32_16x16x64_bf16 v[112:115], v[16:19], a[216:223], v5
v_mov_b32_e64 v54, 0
v_smfmac_f32_16x16x64_bf16 v[108:111], v[20:23], a[224:231], v5
v_mov_b64_e64 v[124:125], 0
v_smfmac_f32_16x16x64_bf16 v[112:115], v[20:23], a[232:239], v5
v_mov_b64_e64 v[126:127], 0
s_waitcnt lgkmcnt(5)
v_mfma_f32_16x16x32_bf16 v[44:47], v[60:63], v[116:119], v[44:47]
v_mfma_f32_16x16x32_bf16 v[48:51], v[76:79], v[116:119], v[48:51]
ds_read_b128 v[60:63], v0 offset:16384
s_waitcnt lgkmcnt(5)
v_mfma_f32_16x16x32_bf16 v[44:47], v[64:67], v[120:123], v[44:47]
ds_read_b128 v[76:79], v0 offset:20480
v_mfma_f32_16x16x32_bf16 v[48:51], v[80:83], v[120:123], v[48:51]
ds_read_b128 v[64:67], v0 offset:17408
s_waitcnt lgkmcnt(4)
v_smfmac_f32_16x16x64_bf16 v[124:127], v[92:95], v[116:123], v5
ds_read_b128 v[80:83], v0 offset:21504
v_mfma_f32_16x16x32_bf16 v[44:47], v[68:71], v[100:103], v[44:47]
v_mfma_f32_16x16x32_bf16 v[48:51], v[84:87], v[100:103], v[48:51]
ds_read_b128 v[68:71], v0 offset:18432
s_waitcnt lgkmcnt(5)
v_smfmac_f32_16x16x64_bf16 v[124:127], v[96:99], v[100:107], v5
ds_read_b128 v[84:87], v0 offset:22528
v_mfma_f32_16x16x32_bf16 v[44:47], v[72:75], v[104:107], v[44:47]
v_mfma_f32_16x16x32_bf16 v[48:51], v[88:91], v[104:107], v[48:51]
ds_read_b128 v[72:75], v0 offset:19456
ds_read_b128 v[88:91], v0 offset:23552
v_add_f32 v124, v124, v126
v_add_f32 v125, v125, v127
v_max3_f32 v10, v124, v125, v44
v_max3_f32 v10, v10, v45, v46
v_smfmac_f32_16x16x64_bf16 v[108:111], v[24:27], a[240:247], v5
s_nop 0
v_max3_f32 v10, v10, v47, v48
v_max3_f32 v10, v10, v49, v50
v_max_f32 v11, v10, v51
v_max_f32_e64 v10, v10, v51
v_smfmac_f32_16x16x64_bf16 v[112:115], v[24:27], a[248:255], v5
s_nop 0
v_permlane16_swap_b32 v10, v11
v_max_f32 v10, v10, v11
v_mov_b32 v11, v10
v_smfmac_f32_16x16x64_bf16 v[108:111], v[28:31], v[128:135], v5
s_nop 0
v_permlane32_swap_b32 v10, v11
v_max_f32 v10, v10, v11
v_mul_f32 v10, s38, v10
v_fma_f32 v124, v124, s38, -v10
v_fma_f32 v125, v125, s38, -v10
v_pk_fma_f32 v[44:45], v[44:45], s[38:39], v[10:11] op_sel_hi:[1,1,0] neg_lo:[0,0,1] neg_hi:[0,0,1]
v_pk_fma_f32 v[46:47], v[46:47], s[38:39], v[10:11] op_sel_hi:[1,1,0] neg_lo:[0,0,1] neg_hi:[0,0,1]
v_pk_fma_f32 v[48:49], v[48:49], s[38:39], v[10:11] op_sel_hi:[1,1,0] neg_lo:[0,0,1] neg_hi:[0,0,1]
v_pk_fma_f32 v[50:51], v[50:51], s[38:39], v[10:11] op_sel_hi:[1,1,0] neg_lo:[0,0,1] neg_hi:[0,0,1]
v_smfmac_f32_16x16x64_bf16 v[112:115], v[28:31], v[136:143], v5
buffer_load_dwordx4 v0, s[12:15], s32 offen offset:0 sc1 lds
v_exp_f32 v44, v44
v_smfmac_f32_16x16x64_bf16 v[108:111], v[32:35], v[144:151], v5
v_exp_f32 v45, v45
v_smfmac_f32_16x16x64_bf16 v[112:115], v[32:35], v[152:159], v5
buffer_load_dwordx4 v0, s[12:15], s32 offen offset:1024 sc1 lds
v_exp_f32 v46, v46
v_exp_f32 v47, v47
v_exp_f32 v48, v48
v_exp_f32 v49, v49
v_exp_f32 v50, v50
v_exp_f32 v51, v51
v_exp_f32 v124, v124
v_exp_f32 v125, v125
v_pk_add_f32 v[108:109], v[108:109], v[110:111]
v_pk_add_f32 v[10:11], v[44:45], v[46:47]
v_pk_add_f32 v[126:127], v[48:49], v[50:51]
v_pk_add_f32 v[10:11], v[10:11], v[124:125]
v_pk_add_f32 v[10:11], v[10:11], v[126:127]
v_pk_add_f32 v[112:113], v[112:113], v[114:115]
v_add_f32 v126, v10, v11
v_add_f32 v10, v10, v11
v_cvt_pk_bf16_f32 v108, v108, v109
v_cvt_pk_bf16_f32 v109, v112, v113
v_permlane16_swap_b32 v10, v126
v_add_f32 v11, v10, v126
v_add_f32 v10, v10, v126
ds_write_b64 v0, v[108:109] offset:29192
s_mov_b64 vcc, s[56:57]
v_permlane32_swap_b32 v10, v11
v_add_f32 v10, v10, v11
v_rcp_f32_e64 v10, v10
s_mov_b32 m0, 18432
v_pk_mul_f32 v[44:45], v[44:45], v[10:11] op_sel_hi:[1,0]
v_pk_mul_f32 v[46:47], v[46:47], v[10:11] op_sel_hi:[1,0]
v_pk_mul_f32 v[48:49], v[48:49], v[10:11] op_sel_hi:[1,0]
v_pk_mul_f32 v[50:51], v[50:51], v[10:11] op_sel_hi:[1,0]
v_pk_mul_f32 v[124:125], v[124:125], v[10:11] op_sel_hi:[1,0]
v_cvt_pk_bf16_f32 v56, v44, v45
v_cvt_pk_bf16_f32 v57, v46, v47
v_cvt_pk_bf16_f32 v58, v48, v49
v_cvt_pk_bf16_f32 v59, v50, v51
v_cvt_pk_bf16_f32 v52, v124, v125
v_cvt_pk_bf16_f32 v55, v124, v125
s_waitcnt lgkmcnt(8)
v_mfma_f32_16x16x32_bf16 v[92:95], v[60:63], v[56:59], 0
s_waitcnt lgkmcnt(0)
s_barrier
ds_read_b128 v[116:119], v0 offset:29184
ds_read_b128 v[120:123], v0 offset:30208
v_mfma_f32_16x16x32_bf16 v[96:99], v[64:67], v[56:59], 0
s_add_u32 s33, s22, 10240
s_cmp_eq_u32 s20, 63
v_mov_b64 v[12:13], 0
v_mov_b64 v[14:15], 0
v_mfma_f32_16x16x32_bf16 v[100:103], v[68:71], v[56:59], 0
v_mov_b64 v[16:17], 0
v_mov_b64 v[18:19], 0
v_mfma_f32_16x16x32_bf16 v[104:107], v[72:75], v[56:59], 0
v_mov_b64 v[20:21], 0
v_mov_b64 v[22:23], 0
v_mfma_f32_16x16x32_bf16 v[60:63], v[76:79], v[56:59], 0
v_mov_b64 v[24:25], 0
v_mov_b64 v[26:27], 0
s_waitcnt lgkmcnt(1)
v_mfma_f32_16x16x16_bf16 v[92:95], v[116:117], v[52:53], v[92:95]
v_mov_b64 v[28:29], 0
v_mov_b64 v[30:31], 0
v_mfma_f32_16x16x16_bf16 v[96:99], v[116:117], v[54:55], v[96:99]
v_mov_b64 v[32:33], 0
v_mov_b64 v[34:35], 0
v_mfma_f32_16x16x16_bf16 v[100:103], v[118:119], v[52:53], v[100:103]
v_cvt_pk_bf16_f32 v108, v92, v93
v_cvt_pk_bf16_f32 v109, v94, v95
v_mfma_f32_16x16x16_bf16 v[104:107], v[118:119], v[54:55], v[104:107]
buffer_load_dwordx4 v0, s[12:15], s33 offen offset:0 sc1 lds
v_cvt_pk_bf16_f32 v110, v96, v97
v_cvt_pk_bf16_f32 v111, v98, v99
v_mfma_f32_16x16x32_bf16 v[64:67], v[80:83], v[56:59], 0
v_cvt_pk_bf16_f32 v112, v100, v101
v_cvt_pk_bf16_f32 v113, v102, v103
s_waitcnt lgkmcnt(0)
v_mfma_f32_16x16x16_bf16 v[60:63], v[120:121], v[52:53], v[60:63]
v_cvt_pk_bf16_f32 v114, v104, v105
v_cvt_pk_bf16_f32 v115, v106, v107
v_mfma_f32_16x16x32_bf16 v[68:71], v[84:87], v[56:59], 0
v_cndmask_b32_dpp v100, v109, v108, vcc quad_perm:[0,1,0,1] row_mask:0xf bank_mask:0xf
v_cndmask_b32_dpp v101, v111, v110, vcc quad_perm:[0,1,0,1] row_mask:0xf bank_mask:0xf
v_mfma_f32_16x16x16_bf16 v[64:67], v[120:121], v[54:55], v[64:67]
buffer_load_dwordx4 v0, s[12:15], s33 offen offset:1024 sc1 lds
v_cndmask_b32_dpp v102, v113, v112, vcc quad_perm:[0,1,0,1] row_mask:0xf bank_mask:0xf
v_cndmask_b32_dpp v103, v115, v114, vcc quad_perm:[0,1,0,1] row_mask:0xf bank_mask:0xf
v_mfma_f32_16x16x32_bf16 v[72:75], v[88:91], v[56:59], 0
v_cvt_pk_bf16_f32 v116, v60, v61
v_cvt_pk_bf16_f32 v117, v62, v63
v_mfma_f32_16x16x16_bf16 v[68:71], v[122:123], v[52:53], v[68:71]
v_cvt_pk_bf16_f32 v118, v64, v65
v_cvt_pk_bf16_f32 v119, v66, v67
v_mfma_f32_16x16x16_bf16 v[72:75], v[122:123], v[54:55], v[72:75]
s_cbranch_scc1 CLAST_53
v_cndmask_b32_dpp v104, v117, v116, vcc quad_perm:[0,1,0,1] row_mask:0xf bank_mask:0xf
v_cndmask_b32_dpp v105, v119, v118, vcc quad_perm:[0,1,0,1] row_mask:0xf bank_mask:0xf
v_smfmac_f32_16x16x64_bf16 v[12:15], v[100:103], v[160:167], v5
ds_read_b128 v[44:47], v1 offset:24576
ds_read_b128 v[48:51], v1 offset:25600
s_and_b32 s32, s20, 1
v_cvt_pk_bf16_f32 v120, v68, v69
v_smfmac_f32_16x16x64_bf16 v[16:19], v[100:103], v[168:175], v5
ds_read_b128 v[92:95], v1 offset:26624
s_lshl_b32 s32, s32, 18
v_cvt_pk_bf16_f32 v121, v70, v71
v_cvt_pk_bf16_f32 v122, v72, v73
v_smfmac_f32_16x16x64_bf16 v[20:23], v[100:103], v[176:183], v5
ds_read_b128 v[96:99], v1 offset:27648
s_add_u32 s25, s34, s32
v_cvt_pk_bf16_f32 v123, v74, v75
v_smfmac_f32_16x16x64_bf16 v[24:27], v[100:103], v[184:191], v5
v_cndmask_b32_dpp v106, v121, v120, vcc quad_perm:[0,1,0,1] row_mask:0xf bank_mask:0xf
v_cndmask_b32_dpp v107, v123, v122, vcc quad_perm:[0,1,0,1] row_mask:0xf bank_mask:0xf
s_add_u32 s26, s25, 32768
s_bfe_u32 s69, s20, 0x10001
v_smfmac_f32_16x16x64_bf16 v[12:15], v[104:107], v[224:231], v5
ds_read_b128 v[76:79], v1 offset:28672
v_mov_b64 v[36:37], 0
v_mov_b64 v[40:41], 0
v_smfmac_f32_16x16x64_bf16 v[16:19], v[104:107], v[232:239], v5
ds_read_b128 v[80:83], v1 offset:29696
v_mov_b64 v[38:39], 0
v_mov_b64 v[42:43], 0
v_smfmac_f32_16x16x64_bf16 v[20:23], v[104:107], v[240:247], v5
ds_read_b128 v[84:87], v1 offset:30720
v_add_f32_e64 v12, v12, v14
v_smfmac_f32_16x16x64_bf16 v[24:27], v[104:107], v[248:255], v5
ds_read_b128 v[88:91], v1 offset:31744
v_add_f32_e64 v13, v13, v15
v_smfmac_f32_16x16x64_bf16 v[28:31], v[100:103], v[192:199], v5
v_add_f32 v16, v16, v18
v_add_f32 v17, v17, v19
v_smfmac_f32_16x16x64_bf16 v[32:35], v[100:103], v[200:207], v5
v_add_f32 v20, v20, v22
v_add_f32 v21, v21, v23
v_smfmac_f32_16x16x64_bf16 v[36:39], v[100:103], v[208:215], v5
v_add_f32_e64 v24, v24, v26
v_add_f32 v25, v25, v27
v_smfmac_f32_16x16x64_bf16 v[40:43], v[100:103], v[216:223], v5
v_cvt_pk_bf16_f32 v52, v12, v16
v_cvt_pk_bf16_f32 v53, v20, v24
s_waitcnt lgkmcnt(6)
v_smfmac_f32_16x16x64_bf16 v[28:31], v[104:107], v[44:51], v5
v_cvt_pk_bf16_f32 v54, v13, v17
v_cvt_pk_bf16_f32 v55, v21, v25
s_waitcnt lgkmcnt(4)
v_smfmac_f32_16x16x64_bf16 v[32:35], v[104:107], v[92:99], v5
v_and_or_b32 v52, v52, -2, s69
s_waitcnt lgkmcnt(2)
v_smfmac_f32_16x16x64_bf16 v[36:39], v[104:107], v[76:83], v5
buffer_store_dwordx4 v[52:55], v6, s[12:15], s25 offen sc1
v_add_f32 v28, v28, v30
s_waitcnt lgkmcnt(0)
v_smfmac_f32_16x16x64_bf16 v[40:43], v[104:107], v[84:91], v5
v_add_f32 v29, v29, v31
v_add_f32 v32, v32, v34
v_add_f32_e64 v33, v33, v35
v_cvt_pk_bf16_f32 v56, v28, v32
v_add_f32 v36, v36, v38
v_add_f32 v37, v37, v39
v_cvt_pk_bf16_f32 v58, v29, v33
v_and_or_b32 v56, v56, -2, s69
v_pk_add_f32 v[40:41], v[40:41], v[42:43]
v_cvt_pk_bf16_f32 v57, v36, v40
v_cvt_pk_bf16_f32 v59, v37, v41
buffer_store_dwordx4 v[56:59], v6, s[12:15], s26 offen sc1
s_lshl_b32 s32, s16, 13
s_add_u32 s25, s25, s32
s_add_u32 s25, s25, 2048
v_and_b32 v10, 16, v0
v_mov_b32 v11, 0x3f80
v_lshlrev_b32 v10, v10, v11
v_cndmask_b32 v124, 0, v10, s[60:61]
v_cndmask_b32 v125, 0, v10, s[62:63]
v_cndmask_b32 v126, 0, v10, s[64:65]
v_cndmask_b32 v127, 0, v10, s[66:67]
v_mov_b64 v[32:33], -1
v_bfe_u32 v10, v0, 4, 1
v_lshrrev_b32 v11, 8, v0
v_lshl_add_u32 v10, v11, 1, v10
v_and_b32_e64 v11, 32, v0
v_lshl_add_u32 v35, v10, 3, v11
s_and_b32 s32, s20, 3
s_lshl_b32 s32, s32, 13
s_add_u32 s27, s35, s32
s_add_u32 s29, s27, 2048
s_xor_b32 s32, s32, 16384
s_add_u32 s28, s35, s32
s_lshl_b32 s32, s16, 8
s_add_u32 s27, s27, s32
s_add_u32 s28, s28, s32
s_mov_b32 s68, s23
s_mov_b32 m0, 2048
s_mov_b32 s30, 0
s_mov_b64 vcc, s[58:59]
v_cndmask_b32_dpp v108, v116, v108, vcc quad_perm:[2,3,2,3] row_mask:0xf bank_mask:0xf
v_cndmask_b32_dpp v109, v117, v109, vcc quad_perm:[2,3,2,3] row_mask:0xf bank_mask:0xf
v_cndmask_b32_dpp v110, v118, v110, vcc quad_perm:[2,3,2,3] row_mask:0xf bank_mask:0xf
v_cndmask_b32_dpp v111, v119, v111, vcc quad_perm:[2,3,2,3] row_mask:0xf bank_mask:0xf
v_cndmask_b32_dpp v112, v120, v112, vcc quad_perm:[2,3,2,3] row_mask:0xf bank_mask:0xf
v_cndmask_b32_dpp v113, v121, v113, vcc quad_perm:[2,3,2,3] row_mask:0xf bank_mask:0xf
v_cndmask_b32_dpp v114, v122, v114, vcc quad_perm:[2,3,2,3] row_mask:0xf bank_mask:0xf
v_cndmask_b32_dpp v115, v123, v115, vcc quad_perm:[2,3,2,3] row_mask:0xf bank_mask:0xf
v_min_u32 v108, -2, v108
v_min_u32 v112, -2, v112
ds_read_b128 v[60:63], v1 offset:0
ds_read_b128 v[64:67], v1 offset:1024
ds_read_b128 v[68:71], v1 offset:2048
ds_read_b128 v[72:75], v1 offset:3072
ds_read_b128 v[76:79], v1 offset:4096
ds_read_b128 v[80:83], v1 offset:5120
ds_read_b128 v[84:87], v1 offset:6144
ds_read_b128 v[88:91], v1 offset:7168
ds_read_b128 v[92:95], v1 offset:8192
ds_read_b128 v[96:99], v1 offset:9216
ds_read_b128 v[100:103], v1 offset:10240
ds_read_b128 v[104:107], v1 offset:11264
v_mov_b64 v[44:45], 0
v_mov_b64 v[46:47], 0
v_mov_b64 v[48:49], 0
v_mov_b64 v[50:51], 0
buffer_load_dwordx4 v[20:23], v0, s[12:15], s25 offen offset:0 sc1
buffer_load_dwordx4 v[24:27], v0, s[12:15], s25 offen offset:1024 sc1
v_mov_b64 v[52:53], 0
v_mov_b64 v[54:55], 0
v_mov_b64 v[56:57], 0
v_mov_b64 v[58:59], 0
RT_56:
s_waitcnt vmcnt(1)
v_mfma_f32_16x16x32_bf16 v[28:31], v[124:127], v[20:23], 0
v_xor_b32 v10, s69, v20
s_waitcnt vmcnt(0)
v_bitop3_b32 v10, v10, v24, s69 bitop3:0xf6
v_and_b32 v10, 1, v10
v_cmp_ne_u32 vcc, 0, v10
v_mfma_f32_16x16x32_bf16 v[28:31], v[124:127], v[24:27], v[28:31]
s_cbranch_vccz RG_58
s_mov_b64 exec, vcc
buffer_load_dwordx4 v[20:23], v0, s[12:15], s25 offen offset:0 sc1
buffer_load_dwordx4 v[24:27], v0, s[12:15], s25 offen offset:1024 sc1
s_mov_b64 exec, -1
s_add_u32 s30, s30, 1
s_cmp_gt_u32 s30, 2097152
s_cbranch_scc1 FAIL
s_branch RT_56
RG_58:
s_nop 6
v_add_f32_dpp v28, v28, v28 row_ror:4 row_mask:0xf bank_mask:0xf
v_add_f32_dpp v29, v29, v29 row_ror:4 row_mask:0xf bank_mask:0xf
v_add_f32_dpp v30, v30, v30 row_ror:4 row_mask:0xf bank_mask:0xf
v_add_f32_dpp v31, v31, v31 row_ror:4 row_mask:0xf bank_mask:0xf
v_add_f32_dpp v28, v28, v28 row_ror:8 row_mask:0xf bank_mask:0xf
v_add_f32_dpp v29, v29, v29 row_ror:8 row_mask:0xf bank_mask:0xf
v_add_f32_dpp v30, v30, v30 row_ror:8 row_mask:0xf bank_mask:0xf
v_add_f32_dpp v31, v31, v31 row_ror:8 row_mask:0xf bank_mask:0xf
v_cvt_pk_bf16_f32 v10, v28, v29
v_cvt_pk_bf16_f32 v11, v30, v31
v_min_u32 v10, -2, v10
s_mov_b64 exec, 0xf000f
buffer_store_dwordx2 v[10:11], v35, s[12:15], s27 offen offset:64 sc1
buffer_store_dwordx2 v[32:33], v35, s[12:15], s28 offen offset:64 sc1
s_mov_b64 exec, -1
s_add_u32 s20, s20, 1
s_mov_b32 s21, s22
s_add_u32 s23, s23, 8192
s_add_u32 s36, s21, 18432
s_add_u32 s22, s21, 24576
s_add_u32 s37, s22, 0
buffer_load_dwordx4 v[116:119], v0, s[12:15], s36 offen offset:0 sc1
buffer_load_dwordx4 v[120:123], v0, s[12:15], s36 offen offset:1024 sc1
s_waitcnt vmcnt(0)
buffer_load_dwordx4 v[12:15], v0, s[12:15], s29 offen offset:0 sc1
buffer_load_dwordx4 v[16:19], v0, s[12:15], s29 offen offset:1024 sc1
s_branch H2_59
ROK_57:
s_mov_b64 exec, vcc
buffer_load_dwordx4 v[20:23], v0, s[12:15], s25 offen offset:0 sc1
buffer_load_dwordx4 v[24:27], v0, s[12:15], s25 offen offset:1024 sc1
s_mov_b64 exec, -1
s_add_u32 s30, s30, 1
s_cmp_gt_u32 s30, 2097152
s_cbranch_scc1 FAIL
s_branch RT_56
MRE_61:
s_mov_b64 exec, vcc
buffer_load_dwordx4 v[12:15], v0, s[12:15], s29 offen offset:0 sc1
buffer_load_dwordx4 v[16:19], v0, s[12:15], s29 offen offset:1024 sc1
s_mov_b64 exec, -1
s_add_u32 s30, s30, 1
s_cmp_gt_u32 s30, 2097152
s_cbranch_scc1 FAIL
s_branch MT_60
CLAST_53:
s_nop 2
v_cvt_pk_bf16_f32 v120, v68, v69
v_cvt_pk_bf16_f32 v121, v70, v71
s_nop 1
v_cvt_pk_bf16_f32 v122, v72, v73
v_cvt_pk_bf16_f32 v123, v74, v75
s_mov_b64 vcc, s[58:59]
v_cndmask_b32_dpp v108, v116, v108, vcc quad_perm:[2,3,2,3] row_mask:0xf bank_mask:0xf
v_cndmask_b32_dpp v109, v117, v109, vcc quad_perm:[2,3,2,3] row_mask:0xf bank_mask:0xf
v_cndmask_b32_dpp v110, v118, v110, vcc quad_perm:[2,3,2,3] row_mask:0xf bank_mask:0xf
v_cndmask_b32_dpp v111, v119, v111, vcc quad_perm:[2,3,2,3] row_mask:0xf bank_mask:0xf
v_cndmask_b32_dpp v112, v120, v112, vcc quad_perm:[2,3,2,3] row_mask:0xf bank_mask:0xf
v_cndmask_b32_dpp v113, v121, v113, vcc quad_perm:[2,3,2,3] row_mask:0xf bank_mask:0xf
v_cndmask_b32_dpp v114, v122, v114, vcc quad_perm:[2,3,2,3] row_mask:0xf bank_mask:0xf
v_cndmask_b32_dpp v115, v123, v115, vcc quad_perm:[2,3,2,3] row_mask:0xf bank_mask:0xf
v_min_u32 v108, -2, v108
v_min_u32 v112, -2, v112
buffer_store_dwordx4 v[108:111], v0, s[12:15], s23 offen offset:0 sc1
buffer_store_dwordx4 v[112:115], v0, s[12:15], s23 offen offset:1024 sc1
s_branch FIN
CW2:
v_and_b32 v20, 15, v0
v_lshrrev_b32 v21, 4, v0
v_lshrrev_b32 v22, 2, v20
v_and_b32_e64 v23, 1, v20
v_lshl_add_u32 v24, v22, 1, v23
v_bfe_u32 v25, v20, 1, 1
v_mov_b32_e64 v26, v0
v_lshlrev_b32_e64 v0, 4, v26
v_add_u32 v1, 98304, v0
s_movk_i32 s3, 144
v_lshlrev_b32 v27, 1, v22
v_mul_lo_u32 v27, v27, s3
v_lshl_add_u32 v27, v21, 5, v27
v_and_b32_e64 v28, 3, v20
v_lshl_add_u32 v27, v28, 2, v27
v_add_u32 v2, 26880, v27
v_mul_lo_u32 v27, v21, s3
v_lshl_add_u32 v27, v24, 4, v27
v_add_u32 v3, 24576, v27
v_lshl_add_u32 v27, v21, 1, v25
v_mul_lo_u32 v27, v27, s3
v_lshl_add_u32 v27, v24, 4, v27
v_add_u32 v4, 26880, v27
v_mul_u32_u24 v27, 0xaaaa, v25
v_add_u32 v5, 0x4444, v27
v_lshlrev_b32_e64 v27, 13, v22
v_lshl_add_u32 v27, v21, 11, v27
v_and_b32 v28, 3, v20
v_lshl_add_u32 v27, v28, 4, v27
s_lshl_b32 s3, s16, 6
s_add_u32 s3, s3, 131072
v_add_u32_e64 v6, s3, v27
s_mov_b32 s60, 0x30003
s_mov_b32 s61, 0x30003
s_mov_b32 s62, 0xc000c
s_mov_b32 s63, 0xc000c
s_mov_b32 s64, 0x300030
s_mov_b32 s65, 0x300030
s_mov_b32 s66, 0xc000c0
s_mov_b32 s67, 0xc000c0
v_lshlrev_b32_e64 v28, 10, v24
v_lshl_add_u32 v28, v21, 5, v28
v_lshl_add_u32 v28, v25, 4, v28
s_mov_b32 s40, 0xc0000
s_mov_b32 s41, 0xcccccccc
s_mov_b32 s42, 0xc0000
s_mov_b32 s43, 0xcccccccc
s_mov_b32 s44, 0x4c0004
s_mov_b32 s45, 0xcccccccc
s_mov_b32 s46, 0x4c0004
s_mov_b32 s47, 0xcccccccc
s_mov_b32 s48, 0xccc00cc
s_mov_b32 s49, 0xcccccccc
s_mov_b32 s50, 0xccc00cc
s_mov_b32 s51, 0xcccccccc
s_mov_b32 s52, 0x4ccc04cc
s_mov_b32 s53, 0xcccccccc
s_mov_b32 s54, 0x4ccc04cc
s_mov_b32 s55, 0xcccccccc
s_mov_b32 s56, 0x33333333
s_mov_b32 s57, 0x33333333
s_mov_b32 s58, 0xcccccccc
s_mov_b32 s59, 0xcccccccc
s_mov_b32 s38, 0x3e0293ee
s_mov_b32 s39, 0x3e0293ee
s_mov_b32 s20, 0
s_lshl_b32 s3, s17, 5
s_add_u32 s3, s3, s16
s_lshl_b32 s3, s3, 6
s_mul_i32 s21, s3, 24576
s_lshl_b32 s23, s3, 13
s_add_u32 s23, s23, 100667392
s_lshl_b32 s34, s17, 19
s_add_u32 s34, s34, 153092096
s_lshl_b32 s35, s17, 15
s_add_u32 s35, s35, 154140672
s_lshl_b32 s3, s17, 5
s_add_u32 s3, s3, s16
s_lshl_b32 s3, s3, 8
s_add_u32 s31, s3, 159383552
s_mov_b32 s30, 0
s_cmp_eq_u32 s78, 1
s_cbranch_scc1 CK_63
CF_62:
s_add_u32 s30, s30, 1
s_cmp_gt_u32 s30, 2097152
s_cbranch_scc1 FAIL
s_cmp_ge_u32 s79, 48
s_cbranch_scc1 CG_64
s_load_dwordx2 s[70:71], s[0:1], 88
v_mov_b32 v114, 208
s_waitcnt lgkmcnt(0)
s_mov_b64 exec, 1
global_load_dword v124, v114, s[70:71] sc1
s_mov_b64 exec, -1
CG_64:
s_waitcnt vmcnt(0)
v_readlane_b32 s79, v124, 0
v_mbcnt_lo_u32_b32 v113, -1, 0
v_lshlrev_b32_e64 v112, 4, v113
s_lshl_b32 s3, s17, 5
s_add_u32 s3, s3, s16
s_lshl_b32 s76, s3, 8
s_add_u32 s76, s76, 159383552
s_mov_b64 exec, 0xfff
buffer_load_dword v125, v112, s[12:15], s76 offen sc1
s_mov_b64 exec, -1
s_mov_b64 exec, 0xfff
s_waitcnt vmcnt(0)
v_cmp_gt_u32 vcc, 1, v125
s_mov_b64 exec, -1
s_cmp_eq_u64 vcc, 0
s_cselect_b32 s76, s79, 0
s_cmp_ge_u32 s76, 48
s_cbranch_scc0 CF_62
s_load_dwordx2 s[72:73], s[0:1], 8
s_mov_b32 s74, 8192
s_mov_b32 s75, 0x20000
v_mbcnt_lo_u32_b32 v113, -1, 0
v_mbcnt_hi_u32_b32 v113, -1, v113
v_lshlrev_b32 v112, 4, v113
s_lshl_b32 s3, s17, 5
s_add_u32 s3, s3, s16
s_lshl_b32 s3, s3, 6
s_mul_i32 s77, s3, 24576
s_lshl_b32 s3, s19, 12
s_add_u32 m0, s3, 8192
s_add_u32 s3, s3, s77
buffer_load_dwordx4 v112, s[12:15], s3 offen offset:0 sc1 lds
buffer_load_dwordx4 v112, s[12:15], s3 offen offset:1024 sc1 lds
buffer_load_dwordx4 v112, s[12:15], s3 offen offset:2048 sc1 lds
buffer_load_dwordx4 v112, s[12:15], s3 offen offset:3072 sc1 lds
v_and_b32_e64 v114, 1, v113
v_bfe_u32 v115, v113, 2, 2
v_lshl_add_u32 v114, v115, 1, v114
v_lshrrev_b32_e64 v115, 4, v113
v_bfe_u32 v113, v113, 1, 1
v_lshlrev_b32_e64 v114, 10, v114
v_lshl_add_u32 v114, v115, 5, v114
v_lshl_add_u32 v114, v113, 4, v114
s_lshl_b32 s3, s19, 11
s_add_u32 s3, s3, s77
s_add_u32 s3, s3, 16384
buffer_load_dwordx4 v[116:119], v112, s[12:15], s3 offen sc1
buffer_load_dwordx4 v[120:123], v112, s[12:15], s3 offen offset:1024 sc1
s_lshl_b32 s3, s17, 19
s_lshl_b32 s76, s16, 13
s_add_u32 s3, s3, s76
s_and_b32 s76, s19, 1
s_lshl_b32 s76, s76, 18
s_add_u32 s3, s3, s76
s_add_u32 s3, s3, 153092096
s_lshl_b32 s76, s17, 15
s_lshl_b32 s77, s16, 10
s_add_u32 s76, s76, s77
s_add_u32 s76, s76, 154140672
s_cmp_lt_u32 s19, 2
s_cselect_b32 s3, s3, s76
s_cselect_b32 s76, 3, 0
v_lshlrev_b32 v115, s76, v112
buffer_load_dword v115, v115, s[12:15], s3 offen sc1
s_waitcnt lgkmcnt(0)
s_lshl_b32 s3, s19, 11
s_add_u32 m0, s3, 0
s_lshl_b32 s3, s19, 8
s_add_u32 s3, s3, 0
buffer_load_dwordx4 v114, s[72:75], s3 offen lds
s_lshl_b32 s3, s19, 11
s_add_u32 m0, s3, 1024
s_lshl_b32 s3, s19, 8
s_add_u32 s3, s3, 128
buffer_load_dwordx4 v114, s[72:75], s3 offen lds
CK_63:
v_mov_b32 v9, v125
s_waitcnt vmcnt(0)
ds_read_b128 v[12:15], v0 offset:4096
ds_read_b128 v[16:19], v0 offset:5120
ds_read_b128 v[60:63], v1 offset:0
ds_read_b128 v[64:67], v1 offset:1024
ds_read_b128 v[68:71], v1 offset:2048
ds_read_b128 v[72:75], v1 offset:3072
ds_read_b128 v[76:79], v1 offset:4096
ds_read_b128 v[80:83], v1 offset:5120
ds_read_b128 v[84:87], v1 offset:6144
ds_read_b128 v[88:91], v1 offset:7168
ds_read_b128 v[92:95], v1 offset:8192
ds_read_b128 v[96:99], v1 offset:9216
ds_read_b128 v[100:103], v1 offset:10240
ds_read_b128 v[104:107], v1 offset:11264
v_mov_b64 v[44:45], 0
v_mov_b64 v[46:47], 0
v_mov_b64 v[48:49], 0
v_mov_b64 v[50:51], 0
v_mov_b64_e64 v[52:53], 0
v_mov_b64_e64 v[54:55], 0
v_mov_b64_e64 v[56:57], 0
v_mov_b64 v[58:59], 0
s_mov_b32 s68, 268435456
s_waitcnt lgkmcnt(0)
s_cmp_eq_u32 s18, 0
s_cbranch_scc1 CS2
s_add_u32 s36, s21, 20480
s_add_u32 s22, s21, 24576
s_add_u32 s37, s22, 8192
v_lshlrev_b32 v7, 3, v0
s_branch CL_65
H2_72:
MT_73:
s_waitcnt vmcnt(1)
v_max_u32 v10, v12, v14
s_waitcnt vmcnt(0)
v_max3_u32 v10, v10, v16, v18
v_cmp_eq_u32 vcc, -1, v10
ds_write_b128 v0, v[12:15] offset:4096
ds_write_b128 v0, v[16:19] offset:5120
s_cbranch_vccnz MRE_74
CL_65:
s_waitcnt lgkmcnt(12)
v_smfmac_f32_16x16x64_bf16 v[44:47], v[12:15], v[60:67], v5
s_waitcnt lgkmcnt(10)
v_smfmac_f32_16x16x64_bf16 v[48:51], v[12:15], v[68:75], v5
s_waitcnt lgkmcnt(8)
v_smfmac_f32_16x16x64_bf16 v[52:55], v[12:15], v[76:83], v5
s_waitcnt lgkmcnt(0)
s_barrier
ds_read_b128 v[20:23], v0 offset:6144
ds_read_b128 v[24:27], v0 offset:7168
v_smfmac_f32_16x16x64_bf16 v[56:59], v[12:15], v[84:91], v5
ds_read_b128 v[28:31], v0 offset:0
ds_read_b128 v[32:35], v0 offset:1024
v_smfmac_f32_16x16x64_bf16 v[44:47], v[16:19], v[92:99], v5
ds_read_b128 v[36:39], v0 offset:2048
ds_read_b128 v[40:43], v0 offset:3072
v_smfmac_f32_16x16x64_bf16 v[48:51], v[16:19], v[100:107], v5
buffer_store_dwordx4 v[108:111], v0, s[12:15], s68 offen offset:0 sc1
v_smfmac_f32_16x16x64_bf16 v[52:55], v[16:19], a[0:7], v5
buffer_store_dwordx4 v[112:115], v0, s[12:15], s68 offen offset:1024 sc1
ds_read_b128 v[92:95], v1 offset:20480
v_smfmac_f32_16x16x64_bf16 v[56:59], v[16:19], a[8:15], v5
ds_read_b128 v[96:99], v1 offset:21504
s_waitcnt lgkmcnt(7)
v_smfmac_f32_16x16x64_bf16 v[44:47], v[20:23], a[16:23], v5
ds_read_b128 v[100:103], v1 offset:22528
v_smfmac_f32_16x16x64_bf16 v[48:51], v[20:23], a[24:31], v5
ds_read_b128 v[104:107], v1 offset:23552
v_smfmac_f32_16x16x64_bf16 v[52:55], v[20:23], a[32:39], v5
ds_read_b128 v[60:63], v1 offset:12288
v_smfmac_f32_16x16x64_bf16 v[56:59], v[20:23], a[40:47], v5
ds_read_b128 v[64:67], v1 offset:13312
s_waitcnt lgkmcnt(10)
v_smfmac_f32_16x16x64_bf16 v[44:47], v[24:27], a[48:55], v5
ds_read_b128 v[68:71], v1 offset:14336
v_smfmac_f32_16x16x64_bf16 v[48:51], v[24:27], a[56:63], v5
ds_read_b128 v[72:75], v1 offset:15360
v_mov_b64_e64 v[108:109], 0
v_smfmac_f32_16x16x64_bf16 v[52:55], v[24:27], a[64:71], v5
ds_read_b128 v[76:79], v1 offset:16384
v_mov_b64_e64 v[110:111], 0
v_smfmac_f32_16x16x64_bf16 v[56:59], v[24:27], a[72:79], v5
ds_read_b128 v[80:83], v1 offset:17408
v_mov_b64 v[112:113], 0
s_waitcnt lgkmcnt(8)
v_smfmac_f32_16x16x64_bf16 v[44:47], v[28:31], v[92:99], v5
ds_read_b128 v[84:87], v1 offset:18432
v_mov_b64 v[114:115], 0
s_waitcnt lgkmcnt(7)
v_smfmac_f32_16x16x64_bf16 v[48:51], v[28:31], v[100:107], v5
ds_read_b128 v[88:91], v1 offset:19456
v_smfmac_f32_16x16x64_bf16 v[52:55], v[28:31], a[80:87], v5
v_mov_b32_dpp v100, v116 quad_perm:[0,1,0,1] row_mask:0xf bank_mask:0xf
v_smfmac_f32_16x16x64_bf16 v[56:59], v[28:31], a[88:95], v5
v_mov_b32_dpp v101, v117 quad_perm:[0,1,0,1] row_mask:0xf bank_mask:0xf
s_waitcnt lgkmcnt(6)
v_smfmac_f32_16x16x64_bf16 v[44:47], v[32:35], v[60:67], v5
v_mov_b32_dpp v102, v118 quad_perm:[0,1,0,1] row_mask:0xf bank_mask:0xf
s_waitcnt lgkmcnt(4)
v_smfmac_f32_16x16x64_bf16 v[48:51], v[32:35], v[68:75], v5
ds_read_b128 v[60:63], v0 offset:8192
v_mov_b32_dpp v103, v119 quad_perm:[0,1,0,1] row_mask:0xf bank_mask:0xf
s_waitcnt lgkmcnt(3)
v_smfmac_f32_16x16x64_bf16 v[52:55], v[32:35], v[76:83], v5
ds_read_b128 v[64:67], v0 offset:9216
v_mov_b32_dpp v104, v120 quad_perm:[0,1,0,1] row_mask:0xf bank_mask:0xf
s_waitcnt lgkmcnt(2)
v_smfmac_f32_16x16x64_bf16 v[56:59], v[32:35], v[84:91], v5
ds_read_b128 v[68:71], v0 offset:10240
v_mov_b32_dpp v105, v121 quad_perm:[0,1,0,1] row_mask:0xf bank_mask:0xf
v_smfmac_f32_16x16x64_bf16 v[44:47], v[36:39], a[96:103], v5
ds_read_b128 v[72:75], v0 offset:11264
v_mov_b32_dpp v106, v122 quad_perm:[0,1,0,1] row_mask:0xf bank_mask:0xf
v_smfmac_f32_16x16x64_bf16 v[44:47], v[40:43], a[128:135], v5
ds_read_b128 v[76:79], v0 offset:12288
v_mov_b32_dpp v107, v123 quad_perm:[0,1,0,1] row_mask:0xf bank_mask:0xf
v_smfmac_f32_16x16x64_bf16 v[48:51], v[36:39], a[104:111], v5
ds_read_b128 v[80:83], v0 offset:13312
v_mov_b32 v11, 0xf149f2ca
v_smfmac_f32_16x16x64_bf16 v[48:51], v[40:43], a[136:143], v5
ds_read_b128 v[84:87], v0 offset:14336
v_add_f32_e64 v44, v44, v46
v_smfmac_f32_16x16x64_bf16 v[52:55], v[36:39], a[112:119], v5
ds_read_b128 v[88:91], v0 offset:15360
v_add_f32_e64 v45, v45, v47
v_smfmac_f32_16x16x64_bf16 v[52:55], v[40:43], a[144:151], v5
v_add_f32_e64 v48, v48, v50
v_smfmac_f32_16x16x64_bf16 v[56:59], v[36:39], a[120:127], v5
v_add_f32_e64 v49, v49, v51
v_smfmac_f32_16x16x64_bf16 v[56:59], v[40:43], a[152:159], v5
v_add_f32 v52, v52, v54
v_add_f32 v53, v53, v55
v_cvt_pk_bf16_f32 v124, v44, v48
v_cvt_pk_bf16_f32 v126, v45, v49
v_cndmask_b32 v44, 0, v11, s[40:41]
v_cndmask_b32 v45, 0, v11, s[42:43]
s_nop 1
v_add_f32 v56, v56, v58
v_add_f32_e64 v57, v57, v59
v_cvt_pk_bf16_f32 v125, v52, v56
v_cvt_pk_bf16_f32 v127, v53, v57
ds_write2_b32 v2, v124, v125 offset0:0 offset1:36
ds_write2_b32 v2, v126, v127 offset0:4 offset1:40
v_smfmac_f32_16x16x64_bf16 v[108:111], v[28:31], a[160:167], v5
s_mov_b32 m0, 12288
s_add_u32 s32, s22, 4096
v_cndmask_b32 v46, 0, v11, s[44:45]
v_smfmac_f32_16x16x64_bf16 v[112:115], v[28:31], a[168:175], v5
v_cndmask_b32 v47, 0, v11, s[46:47]
v_smfmac_f32_16x16x64_bf16 v[108:111], v[32:35], a[176:183], v5
v_cndmask_b32 v48, 0, v11, s[48:49]
v_smfmac_f32_16x16x64_bf16 v[112:115], v[32:35], a[184:191], v5
v_cndmask_b32 v49, 0, v11, s[50:51]
v_smfmac_f32_16x16x64_bf16 v[108:111], v[36:39], a[192:199], v5
v_cndmask_b32 v50, 0, v11, s[52:53]
s_waitcnt lgkmcnt(0)
s_barrier
s_mov_b64 exec, s[56:57]
ds_read_b128 v[116:119], v3 offset:0
ds_read_b128 v[120:123], v3 offset:576
ds_read_b128 v[100:103], v3 offset:1152
ds_read_b128 v[104:107], v3 offset:1728
s_mov_b64 exec, -1
ds_read_b128 v[92:95], v4 offset:0
ds_read_b128 v[96:99], v4 offset:1152
v_smfmac_f32_16x16x64_bf16 v[112:115], v[36:39], a[200:207], v5
buffer_load_dword v8, v7, s[12:15], s37 offen sc1
v_cndmask_b32 v51, 0, v11, s[54:55]
v_smfmac_f32_16x16x64_bf16 v[108:111], v[40:43], a[208:215], v5
v_mov_b32 v53, 0
v_smfmac_f32_16x16x64_bf16 v[112:115], v[40:43], a[216:223], v5
v_mov_b32 v54, 0
v_smfmac_f32_16x16x64_bf16 v[108:111], v[12:15], a[224:231], v5
v_mov_b64_e64 v[124:125], 0
v_smfmac_f32_16x16x64_bf16 v[112:115], v[12:15], a[232:239], v5
v_mov_b64_e64 v[126:127], 0
s_waitcnt lgkmcnt(5)
v_mfma_f32_16x16x32_bf16 v[44:47], v[60:63], v[116:119], v[44:47]
v_mfma_f32_16x16x32_bf16 v[48:51], v[76:79], v[116:119], v[48:51]
ds_read_b128 v[60:63], v0 offset:16384
s_waitcnt lgkmcnt(5)
v_mfma_f32_16x16x32_bf16 v[44:47], v[64:67], v[120:123], v[44:47]
ds_read_b128 v[76:79], v0 offset:20480
v_mfma_f32_16x16x32_bf16 v[48:51], v[80:83], v[120:123], v[48:51]
ds_read_b128 v[64:67], v0 offset:17408
s_waitcnt lgkmcnt(4)
v_smfmac_f32_16x16x64_bf16 v[124:127], v[92:95], v[116:123], v5
ds_read_b128 v[80:83], v0 offset:21504
v_mfma_f32_16x16x32_bf16 v[44:47], v[68:71], v[100:103], v[44:47]
v_mfma_f32_16x16x32_bf16 v[48:51], v[84:87], v[100:103], v[48:51]
ds_read_b128 v[68:71], v0 offset:18432
s_waitcnt lgkmcnt(5)
v_smfmac_f32_16x16x64_bf16 v[124:127], v[96:99], v[100:107], v5
ds_read_b128 v[84:87], v0 offset:22528
v_mfma_f32_16x16x32_bf16 v[44:47], v[72:75], v[104:107], v[44:47]
v_mfma_f32_16x16x32_bf16 v[48:51], v[88:91], v[104:107], v[48:51]
ds_read_b128 v[72:75], v0 offset:19456
ds_read_b128 v[88:91], v0 offset:23552
v_add_f32 v124, v124, v126
v_add_f32 v125, v125, v127
v_max3_f32 v10, v124, v125, v44
v_max3_f32 v10, v10, v45, v46
v_smfmac_f32_16x16x64_bf16 v[108:111], v[16:19], a[240:247], v5
s_nop 0
v_max3_f32 v10, v10, v47, v48
v_max3_f32 v10, v10, v49, v50
v_max_f32 v11, v10, v51
v_max_f32_e64 v10, v10, v51
v_smfmac_f32_16x16x64_bf16 v[112:115], v[16:19], a[248:255], v5
s_nop 0
v_permlane16_swap_b32 v10, v11
v_max_f32 v10, v10, v11
v_mov_b32 v11, v10
v_smfmac_f32_16x16x64_bf16 v[108:111], v[20:23], v[128:135], v5
s_nop 0
v_permlane32_swap_b32 v10, v11
v_max_f32 v10, v10, v11
v_mul_f32 v10, s38, v10
v_fma_f32 v124, v124, s38, -v10
v_fma_f32 v125, v125, s38, -v10
v_pk_fma_f32 v[44:45], v[44:45], s[38:39], v[10:11] op_sel_hi:[1,1,0] neg_lo:[0,0,1] neg_hi:[0,0,1]
v_pk_fma_f32 v[46:47], v[46:47], s[38:39], v[10:11] op_sel_hi:[1,1,0] neg_lo:[0,0,1] neg_hi:[0,0,1]
v_pk_fma_f32 v[48:49], v[48:49], s[38:39], v[10:11] op_sel_hi:[1,1,0] neg_lo:[0,0,1] neg_hi:[0,0,1]
v_pk_fma_f32 v[50:51], v[50:51], s[38:39], v[10:11] op_sel_hi:[1,1,0] neg_lo:[0,0,1] neg_hi:[0,0,1]
v_smfmac_f32_16x16x64_bf16 v[112:115], v[20:23], v[136:143], v5
buffer_load_dwordx4 v0, s[12:15], s32 offen offset:0 sc1 lds
v_exp_f32 v44, v44
v_smfmac_f32_16x16x64_bf16 v[108:111], v[24:27], v[144:151], v5
v_exp_f32 v45, v45
v_smfmac_f32_16x16x64_bf16 v[112:115], v[24:27], v[152:159], v5
buffer_load_dwordx4 v0, s[12:15], s32 offen offset:1024 sc1 lds
v_exp_f32 v46, v46
v_exp_f32 v47, v47
v_exp_f32 v48, v48
v_exp_f32 v49, v49
v_exp_f32 v50, v50
v_exp_f32 v51, v51
v_exp_f32 v124, v124
v_exp_f32 v125, v125
v_pk_add_f32 v[108:109], v[108:109], v[110:111]
v_pk_add_f32 v[10:11], v[44:45], v[46:47]
v_pk_add_f32 v[126:127], v[48:49], v[50:51]
v_pk_add_f32 v[10:11], v[10:11], v[124:125]
v_pk_add_f32 v[10:11], v[10:11], v[126:127]
v_pk_add_f32 v[112:113], v[112:113], v[114:115]
v_add_f32 v126, v10, v11
v_add_f32 v10, v10, v11
v_cvt_pk_bf16_f32 v108, v108, v109
v_cvt_pk_bf16_f32 v109, v112, v113
v_permlane16_swap_b32 v10, v126
v_add_f32 v11, v10, v126
v_add_f32 v10, v10, v126
ds_write_b64 v0, v[108:109] offset:30208
s_mov_b64 vcc, s[56:57]
v_permlane32_swap_b32 v10, v11
v_add_f32 v10, v10, v11
v_rcp_f32_e64 v10, v10
s_mov_b32 m0, 20480
v_pk_mul_f32 v[44:45], v[44:45], v[10:11] op_sel_hi:[1,0]
v_pk_mul_f32 v[46:47], v[46:47], v[10:11] op_sel_hi:[1,0]
v_pk_mul_f32 v[48:49], v[48:49], v[10:11] op_sel_hi:[1,0]
v_pk_mul_f32 v[50:51], v[50:51], v[10:11] op_sel_hi:[1,0]
v_pk_mul_f32 v[124:125], v[124:125], v[10:11] op_sel_hi:[1,0]
v_cvt_pk_bf16_f32 v56, v44, v45
v_cvt_pk_bf16_f32 v57, v46, v47
v_cvt_pk_bf16_f32 v58, v48, v49
v_cvt_pk_bf16_f32 v59, v50, v51
v_cvt_pk_bf16_f32 v52, v124, v125
v_cvt_pk_bf16_f32 v55, v124, v125
s_waitcnt lgkmcnt(8)
v_mfma_f32_16x16x32_bf16 v[92:95], v[60:63], v[56:59], 0
s_waitcnt lgkmcnt(0)
s_barrier
ds_read_b128 v[116:119], v0 offset:29184
ds_read_b128 v[120:123], v0 offset:30208
v_mfma_f32_16x16x32_bf16 v[96:99], v[64:67], v[56:59], 0
s_add_u32 s33, s22, 12288
s_cmp_eq_u32 s20, 63
v_mov_b64 v[12:13], 0
v_mov_b64 v[14:15], 0
v_mfma_f32_16x16x32_bf16 v[100:103], v[68:71], v[56:59], 0
v_mov_b64 v[16:17], 0
v_mov_b64 v[18:19], 0
v_mfma_f32_16x16x32_bf16 v[104:107], v[72:75], v[56:59], 0
v_mov_b64 v[20:21], 0
v_mov_b64 v[22:23], 0
v_mfma_f32_16x16x32_bf16 v[60:63], v[76:79], v[56:59], 0
v_mov_b64 v[24:25], 0
v_mov_b64 v[26:27], 0
s_waitcnt lgkmcnt(1)
v_mfma_f32_16x16x16_bf16 v[92:95], v[116:117], v[52:53], v[92:95]
v_mov_b64 v[28:29], 0
v_mov_b64 v[30:31], 0
v_mfma_f32_16x16x16_bf16 v[96:99], v[116:117], v[54:55], v[96:99]
v_mov_b64 v[32:33], 0
v_mov_b64 v[34:35], 0
v_mfma_f32_16x16x16_bf16 v[100:103], v[118:119], v[52:53], v[100:103]
v_cvt_pk_bf16_f32 v108, v92, v93
v_cvt_pk_bf16_f32 v109, v94, v95
v_mfma_f32_16x16x16_bf16 v[104:107], v[118:119], v[54:55], v[104:107]
v_cvt_pk_bf16_f32 v110, v96, v97
v_cvt_pk_bf16_f32 v111, v98, v99
v_mfma_f32_16x16x32_bf16 v[64:67], v[80:83], v[56:59], 0
buffer_load_dwordx4 v0, s[12:15], s33 offen offset:0 sc1 lds
v_cvt_pk_bf16_f32 v112, v100, v101
v_cvt_pk_bf16_f32 v113, v102, v103
s_waitcnt lgkmcnt(0)
v_mfma_f32_16x16x16_bf16 v[60:63], v[120:121], v[52:53], v[60:63]
v_cvt_pk_bf16_f32 v114, v104, v105
v_cvt_pk_bf16_f32 v115, v106, v107
v_mfma_f32_16x16x32_bf16 v[68:71], v[84:87], v[56:59], 0
v_cndmask_b32_dpp v100, v109, v108, vcc quad_perm:[0,1,0,1] row_mask:0xf bank_mask:0xf
v_cndmask_b32_dpp v101, v111, v110, vcc quad_perm:[0,1,0,1] row_mask:0xf bank_mask:0xf
v_mfma_f32_16x16x16_bf16 v[64:67], v[120:121], v[54:55], v[64:67]
v_cndmask_b32_dpp v102, v113, v112, vcc quad_perm:[0,1,0,1] row_mask:0xf bank_mask:0xf
v_cndmask_b32_dpp v103, v115, v114, vcc quad_perm:[0,1,0,1] row_mask:0xf bank_mask:0xf
v_mfma_f32_16x16x32_bf16 v[72:75], v[88:91], v[56:59], 0
buffer_load_dwordx4 v0, s[12:15], s33 offen offset:1024 sc1 lds
v_cvt_pk_bf16_f32 v116, v60, v61
v_cvt_pk_bf16_f32 v117, v62, v63
v_mfma_f32_16x16x16_bf16 v[68:71], v[122:123], v[52:53], v[68:71]
v_cvt_pk_bf16_f32 v118, v64, v65
v_cvt_pk_bf16_f32 v119, v66, v67
v_mfma_f32_16x16x16_bf16 v[72:75], v[122:123], v[54:55], v[72:75]
s_cbranch_scc1 CLAST_66
v_cndmask_b32_dpp v104, v117, v116, vcc quad_perm:[0,1,0,1] row_mask:0xf bank_mask:0xf
v_cndmask_b32_dpp v105, v119, v118, vcc quad_perm:[0,1,0,1] row_mask:0xf bank_mask:0xf
v_smfmac_f32_16x16x64_bf16 v[12:15], v[100:103], v[160:167], v5
ds_read_b128 v[44:47], v1 offset:24576
ds_read_b128 v[48:51], v1 offset:25600
s_and_b32 s32, s20, 1
v_cvt_pk_bf16_f32 v120, v68, v69
v_smfmac_f32_16x16x64_bf16 v[16:19], v[100:103], v[168:175], v5
ds_read_b128 v[92:95], v1 offset:26624
s_lshl_b32 s32, s32, 18
v_cvt_pk_bf16_f32 v121, v70, v71
v_cvt_pk_bf16_f32 v122, v72, v73
v_smfmac_f32_16x16x64_bf16 v[20:23], v[100:103], v[176:183], v5
ds_read_b128 v[96:99], v1 offset:27648
s_add_u32 s25, s34, s32
v_cvt_pk_bf16_f32 v123, v74, v75
v_smfmac_f32_16x16x64_bf16 v[24:27], v[100:103], v[184:191], v5
v_cndmask_b32_dpp v106, v121, v120, vcc quad_perm:[0,1,0,1] row_mask:0xf bank_mask:0xf
v_cndmask_b32_dpp v107, v123, v122, vcc quad_perm:[0,1,0,1] row_mask:0xf bank_mask:0xf
s_add_u32 s26, s25, 32768
s_bfe_u32 s69, s20, 0x10001
v_smfmac_f32_16x16x64_bf16 v[12:15], v[104:107], v[224:231], v5
ds_read_b128 v[76:79], v1 offset:28672
v_mov_b64 v[36:37], 0
v_mov_b64 v[40:41], 0
v_smfmac_f32_16x16x64_bf16 v[16:19], v[104:107], v[232:239], v5
ds_read_b128 v[80:83], v1 offset:29696
v_mov_b64 v[38:39], 0
v_mov_b64 v[42:43], 0
v_smfmac_f32_16x16x64_bf16 v[20:23], v[104:107], v[240:247], v5
ds_read_b128 v[84:87], v1 offset:30720
v_add_f32_e64 v12, v12, v14
v_smfmac_f32_16x16x64_bf16 v[24:27], v[104:107], v[248:255], v5
ds_read_b128 v[88:91], v1 offset:31744
v_add_f32_e64 v13, v13, v15
v_smfmac_f32_16x16x64_bf16 v[28:31], v[100:103], v[192:199], v5
v_add_f32 v16, v16, v18
v_add_f32 v17, v17, v19
v_smfmac_f32_16x16x64_bf16 v[32:35], v[100:103], v[200:207], v5
v_add_f32 v20, v20, v22
v_add_f32 v21, v21, v23
v_smfmac_f32_16x16x64_bf16 v[36:39], v[100:103], v[208:215], v5
v_add_f32_e64 v24, v24, v26
v_add_f32 v25, v25, v27
v_smfmac_f32_16x16x64_bf16 v[40:43], v[100:103], v[216:223], v5
v_cvt_pk_bf16_f32 v52, v12, v16
v_cvt_pk_bf16_f32 v53, v20, v24
s_waitcnt lgkmcnt(6)
v_smfmac_f32_16x16x64_bf16 v[28:31], v[104:107], v[44:51], v5
v_cvt_pk_bf16_f32 v54, v13, v17
v_cvt_pk_bf16_f32 v55, v21, v25
s_waitcnt lgkmcnt(4)
v_smfmac_f32_16x16x64_bf16 v[32:35], v[104:107], v[92:99], v5
v_and_or_b32 v52, v52, -2, s69
s_waitcnt lgkmcnt(2)
v_smfmac_f32_16x16x64_bf16 v[36:39], v[104:107], v[76:83], v5
buffer_store_dwordx4 v[52:55], v6, s[12:15], s25 offen
v_add_f32 v28, v28, v30
s_waitcnt lgkmcnt(0)
v_smfmac_f32_16x16x64_bf16 v[40:43], v[104:107], v[84:91], v5
v_add_f32 v29, v29, v31
v_add_f32 v32, v32, v34
v_add_f32_e64 v33, v33, v35
v_cvt_pk_bf16_f32 v56, v28, v32
v_add_f32 v36, v36, v38
v_add_f32 v37, v37, v39
v_cvt_pk_bf16_f32 v58, v29, v33
v_and_or_b32 v56, v56, -2, s69
v_pk_add_f32 v[40:41], v[40:41], v[42:43]
v_cvt_pk_bf16_f32 v57, v36, v40
v_cvt_pk_bf16_f32 v59, v37, v41
buffer_store_dwordx4 v[56:59], v6, s[12:15], s26 offen
s_lshl_b32 s32, s16, 13
s_add_u32 s25, s25, s32
s_add_u32 s25, s25, 4096
v_and_b32 v10, 16, v0
v_mov_b32 v11, 0x3f80
v_lshlrev_b32 v10, v10, v11
v_cndmask_b32 v124, 0, v10, s[60:61]
v_cndmask_b32 v125, 0, v10, s[62:63]
v_cndmask_b32 v126, 0, v10, s[64:65]
v_cndmask_b32 v127, 0, v10, s[66:67]
v_mov_b64 v[32:33], -1
v_bfe_u32 v10, v0, 4, 1
v_lshrrev_b32 v11, 8, v0
v_lshl_add_u32 v10, v11, 1, v10
v_and_b32_e64 v11, 32, v0
v_lshl_add_u32 v35, v10, 3, v11
s_and_b32 s32, s20, 3
s_lshl_b32 s32, s32, 13
s_add_u32 s27, s35, s32
s_add_u32 s29, s27, 4096
s_xor_b32 s32, s32, 16384
s_add_u32 s28, s35, s32
s_lshl_b32 s32, s16, 8
s_add_u32 s27, s27, s32
s_add_u32 s28, s28, s32
s_mov_b32 s68, s23
s_mov_b32 m0, 4096
s_mov_b32 s30, 0
s_mov_b64 vcc, s[58:59]
v_cndmask_b32_dpp v108, v116, v108, vcc quad_perm:[2,3,2,3] row_mask:0xf bank_mask:0xf
v_cndmask_b32_dpp v109, v117, v109, vcc quad_perm:[2,3,2,3] row_mask:0xf bank_mask:0xf
v_cndmask_b32_dpp v110, v118, v110, vcc quad_perm:[2,3,2,3] row_mask:0xf bank_mask:0xf
v_cndmask_b32_dpp v111, v119, v111, vcc quad_perm:[2,3,2,3] row_mask:0xf bank_mask:0xf
v_cndmask_b32_dpp v112, v120, v112, vcc quad_perm:[2,3,2,3] row_mask:0xf bank_mask:0xf
v_cndmask_b32_dpp v113, v121, v113, vcc quad_perm:[2,3,2,3] row_mask:0xf bank_mask:0xf
v_cndmask_b32_dpp v114, v122, v114, vcc quad_perm:[2,3,2,3] row_mask:0xf bank_mask:0xf
v_cndmask_b32_dpp v115, v123, v115, vcc quad_perm:[2,3,2,3] row_mask:0xf bank_mask:0xf
v_min_u32 v108, -2, v108
v_min_u32 v112, -2, v112
ds_read_b128 v[60:63], v1 offset:0
ds_read_b128 v[64:67], v1 offset:1024
ds_read_b128 v[68:71], v1 offset:2048
ds_read_b128 v[72:75], v1 offset:3072
ds_read_b128 v[76:79], v1 offset:4096
ds_read_b128 v[80:83], v1 offset:5120
ds_read_b128 v[84:87], v1 offset:6144
ds_read_b128 v[88:91], v1 offset:7168
ds_read_b128 v[92:95], v1 offset:8192
ds_read_b128 v[96:99], v1 offset:9216
ds_read_b128 v[100:103], v1 offset:10240
ds_read_b128 v[104:107], v1 offset:11264
v_mov_b64 v[44:45], 0
v_mov_b64 v[46:47], 0
v_mov_b64 v[48:49], 0
v_mov_b64 v[50:51], 0
buffer_load_dwordx4 v[20:23], v0, s[12:15], s25 offen offset:0 sc1
buffer_load_dwordx4 v[24:27], v0, s[12:15], s25 offen offset:1024 sc1
v_mov_b64 v[52:53], 0
v_mov_b64 v[54:55], 0
v_mov_b64_e64 v[56:57], 0
v_mov_b64 v[58:59], 0
RT_69:
s_waitcnt vmcnt(1)
v_mfma_f32_16x16x32_bf16 v[28:31], v[124:127], v[20:23], 0
v_xor_b32 v10, s69, v20
s_waitcnt vmcnt(0)
v_bitop3_b32 v10, v10, v24, s69 bitop3:0xf6
v_and_b32 v10, 1, v10
v_cmp_ne_u32_e64 vcc, 0, v10
v_mfma_f32_16x16x32_bf16 v[28:31], v[124:127], v[24:27], v[28:31]
s_cbranch_vccz RG_71
s_mov_b64 exec, vcc
buffer_load_dwordx4 v[20:23], v0, s[12:15], s25 offen offset:0 sc1
buffer_load_dwordx4 v[24:27], v0, s[12:15], s25 offen offset:1024 sc1
s_mov_b64 exec, -1
s_add_u32 s30, s30, 1
s_cmp_gt_u32 s30, 2097152
s_cbranch_scc1 FAIL
s_branch RT_69
RG_71:
s_nop 6
v_add_f32_dpp v28, v28, v28 row_ror:4 row_mask:0xf bank_mask:0xf
v_add_f32_dpp v29, v29, v29 row_ror:4 row_mask:0xf bank_mask:0xf
v_add_f32_dpp v30, v30, v30 row_ror:4 row_mask:0xf bank_mask:0xf
v_add_f32_dpp v31, v31, v31 row_ror:4 row_mask:0xf bank_mask:0xf
v_add_f32_dpp v28, v28, v28 row_ror:8 row_mask:0xf bank_mask:0xf
v_add_f32_dpp v29, v29, v29 row_ror:8 row_mask:0xf bank_mask:0xf
v_add_f32_dpp v30, v30, v30 row_ror:8 row_mask:0xf bank_mask:0xf
v_add_f32_dpp v31, v31, v31 row_ror:8 row_mask:0xf bank_mask:0xf
v_cvt_pk_bf16_f32 v10, v28, v29
v_cvt_pk_bf16_f32 v11, v30, v31
v_min_u32_e64 v10, -2, v10
s_mov_b64 exec, 0xf000f
buffer_store_dwordx2 v[10:11], v35, s[12:15], s27 offen offset:128
buffer_store_dwordx2 v[32:33], v35, s[12:15], s28 offen offset:128
s_mov_b64 exec, -1
s_add_u32 s20, s20, 1
s_mov_b32 s21, s22
s_add_u32 s23, s23, 8192
s_add_u32 s36, s21, 20480
s_add_u32 s22, s21, 24576
s_add_u32 s37, s22, 8192
buffer_load_dwordx4 v[116:119], v0, s[12:15], s36 offen offset:0 sc1
buffer_load_dwordx4 v[120:123], v0, s[12:15], s36 offen offset:1024 sc1
s_waitcnt vmcnt(0)
buffer_load_dwordx4 v[12:15], v0, s[12:15], s29 offen offset:0 sc1
buffer_load_dwordx4 v[16:19], v0, s[12:15], s29 offen offset:1024 sc1
s_branch H2_72
ROK_70:
s_mov_b64 exec, vcc
buffer_load_dwordx4 v[20:23], v0, s[12:15], s25 offen offset:0 sc1
buffer_load_dwordx4 v[24:27], v0, s[12:15], s25 offen offset:1024 sc1
s_mov_b64 exec, -1
s_add_u32 s30, s30, 1
s_cmp_gt_u32 s30, 2097152
s_cbranch_scc1 FAIL
s_branch RT_69
MRE_74:
s_mov_b64 exec, vcc
buffer_load_dwordx4 v[12:15], v0, s[12:15], s29 offen offset:0 sc1
buffer_load_dwordx4 v[16:19], v0, s[12:15], s29 offen offset:1024 sc1
s_mov_b64 exec, -1
s_add_u32 s30, s30, 1
s_cmp_gt_u32 s30, 2097152
s_cbranch_scc1 FAIL
s_branch MT_73
CLAST_66:
s_nop 2
v_cvt_pk_bf16_f32 v120, v68, v69
v_cvt_pk_bf16_f32 v121, v70, v71
s_nop 1
v_cvt_pk_bf16_f32 v122, v72, v73
v_cvt_pk_bf16_f32 v123, v74, v75
s_mov_b64 vcc, s[58:59]
v_cndmask_b32_dpp v108, v116, v108, vcc quad_perm:[2,3,2,3] row_mask:0xf bank_mask:0xf
v_cndmask_b32_dpp v109, v117, v109, vcc quad_perm:[2,3,2,3] row_mask:0xf bank_mask:0xf
v_cndmask_b32_dpp v110, v118, v110, vcc quad_perm:[2,3,2,3] row_mask:0xf bank_mask:0xf
v_cndmask_b32_dpp v111, v119, v111, vcc quad_perm:[2,3,2,3] row_mask:0xf bank_mask:0xf
v_cndmask_b32_dpp v112, v120, v112, vcc quad_perm:[2,3,2,3] row_mask:0xf bank_mask:0xf
v_cndmask_b32_dpp v113, v121, v113, vcc quad_perm:[2,3,2,3] row_mask:0xf bank_mask:0xf
v_cndmask_b32_dpp v114, v122, v114, vcc quad_perm:[2,3,2,3] row_mask:0xf bank_mask:0xf
v_cndmask_b32_dpp v115, v123, v115, vcc quad_perm:[2,3,2,3] row_mask:0xf bank_mask:0xf
v_min_u32 v108, -2, v108
v_min_u32_e64 v112, -2, v112
buffer_store_dwordx4 v[108:111], v0, s[12:15], s23 offen offset:0 sc1
buffer_store_dwordx4 v[112:115], v0, s[12:15], s23 offen offset:1024 sc1
s_branch FIN
CS2:
s_add_u32 s36, s21, 20480
s_add_u32 s22, s21, 24576
s_add_u32 s37, s22, 8192
v_lshlrev_b32 v7, 3, v0
s_branch CL_75
H2_82:
MT_83:
s_waitcnt vmcnt(1)
v_max_u32_e64 v10, v12, v14
s_waitcnt vmcnt(0)
v_max3_u32 v10, v10, v16, v18
v_cmp_eq_u32_e64 vcc, -1, v10
ds_write_b128 v0, v[12:15] offset:4096
ds_write_b128 v0, v[16:19] offset:5120
s_cbranch_vccnz MRE_84
CL_75:
s_waitcnt lgkmcnt(12)
v_smfmac_f32_16x16x64_bf16 v[44:47], v[12:15], v[60:67], v5
s_waitcnt lgkmcnt(10)
v_smfmac_f32_16x16x64_bf16 v[48:51], v[12:15], v[68:75], v5
s_waitcnt lgkmcnt(8)
v_smfmac_f32_16x16x64_bf16 v[52:55], v[12:15], v[76:83], v5
s_waitcnt lgkmcnt(0)
s_barrier
ds_read_b128 v[20:23], v0 offset:6144
ds_read_b128 v[24:27], v0 offset:7168
v_smfmac_f32_16x16x64_bf16 v[56:59], v[12:15], v[84:91], v5
ds_read_b128 v[28:31], v0 offset:0
ds_read_b128 v[32:35], v0 offset:1024
v_smfmac_f32_16x16x64_bf16 v[44:47], v[16:19], v[92:99], v5
ds_read_b128 v[36:39], v0 offset:2048
ds_read_b128 v[40:43], v0 offset:3072
v_smfmac_f32_16x16x64_bf16 v[48:51], v[16:19], v[100:107], v5
buffer_store_dwordx4 v[108:111], v0, s[12:15], s68 offen offset:0 sc1
v_smfmac_f32_16x16x64_bf16 v[52:55], v[16:19], a[0:7], v5
buffer_store_dwordx4 v[112:115], v0, s[12:15], s68 offen offset:1024 sc1
ds_read_b128 v[92:95], v1 offset:20480
v_smfmac_f32_16x16x64_bf16 v[56:59], v[16:19], a[8:15], v5
ds_read_b128 v[96:99], v1 offset:21504
s_waitcnt lgkmcnt(7)
v_smfmac_f32_16x16x64_bf16 v[44:47], v[20:23], a[16:23], v5
ds_read_b128 v[100:103], v1 offset:22528
v_smfmac_f32_16x16x64_bf16 v[48:51], v[20:23], a[24:31], v5
ds_read_b128 v[104:107], v1 offset:23552
v_smfmac_f32_16x16x64_bf16 v[52:55], v[20:23], a[32:39], v5
ds_read_b128 v[60:63], v1 offset:12288
v_smfmac_f32_16x16x64_bf16 v[56:59], v[20:23], a[40:47], v5
ds_read_b128 v[64:67], v1 offset:13312
s_waitcnt lgkmcnt(10)
v_smfmac_f32_16x16x64_bf16 v[44:47], v[24:27], a[48:55], v5
ds_read_b128 v[68:71], v1 offset:14336
v_smfmac_f32_16x16x64_bf16 v[48:51], v[24:27], a[56:63], v5
ds_read_b128 v[72:75], v1 offset:15360
v_mov_b64_e64 v[108:109], 0
v_smfmac_f32_16x16x64_bf16 v[52:55], v[24:27], a[64:71], v5
ds_read_b128 v[76:79], v1 offset:16384
v_mov_b64_e64 v[110:111], 0
v_smfmac_f32_16x16x64_bf16 v[56:59], v[24:27], a[72:79], v5
ds_read_b128 v[80:83], v1 offset:17408
v_mov_b64 v[112:113], 0
s_waitcnt lgkmcnt(8)
v_smfmac_f32_16x16x64_bf16 v[44:47], v[28:31], v[92:99], v5
ds_read_b128 v[84:87], v1 offset:18432
v_mov_b64 v[114:115], 0
s_waitcnt lgkmcnt(7)
v_smfmac_f32_16x16x64_bf16 v[48:51], v[28:31], v[100:107], v5
ds_read_b128 v[88:91], v1 offset:19456
v_smfmac_f32_16x16x64_bf16 v[52:55], v[28:31], a[80:87], v5
v_mov_b32_dpp v100, v116 quad_perm:[0,1,0,1] row_mask:0xf bank_mask:0xf
v_smfmac_f32_16x16x64_bf16 v[56:59], v[28:31], a[88:95], v5
v_mov_b32_dpp v101, v117 quad_perm:[0,1,0,1] row_mask:0xf bank_mask:0xf
s_waitcnt lgkmcnt(6)
v_smfmac_f32_16x16x64_bf16 v[44:47], v[32:35], v[60:67], v5
v_mov_b32_dpp v102, v118 quad_perm:[0,1,0,1] row_mask:0xf bank_mask:0xf
s_waitcnt lgkmcnt(4)
v_smfmac_f32_16x16x64_bf16 v[48:51], v[32:35], v[68:75], v5
ds_read_b128 v[60:63], v0 offset:8192
v_mov_b32_dpp v103, v119 quad_perm:[0,1,0,1] row_mask:0xf bank_mask:0xf
s_waitcnt lgkmcnt(3)
v_smfmac_f32_16x16x64_bf16 v[52:55], v[32:35], v[76:83], v5
ds_read_b128 v[64:67], v0 offset:9216
v_mov_b32_dpp v104, v120 quad_perm:[0,1,0,1] row_mask:0xf bank_mask:0xf
s_waitcnt lgkmcnt(2)
v_smfmac_f32_16x16x64_bf16 v[56:59], v[32:35], v[84:91], v5
ds_read_b128 v[68:71], v0 offset:10240
v_mov_b32_dpp v105, v121 quad_perm:[0,1,0,1] row_mask:0xf bank_mask:0xf
v_smfmac_f32_16x16x64_bf16 v[44:47], v[36:39], a[96:103], v5
ds_read_b128 v[72:75], v0 offset:11264
v_mov_b32_dpp v106, v122 quad_perm:[0,1,0,1] row_mask:0xf bank_mask:0xf
v_smfmac_f32_16x16x64_bf16 v[44:47], v[40:43], a[128:135], v5
ds_read_b128 v[76:79], v0 offset:12288
v_mov_b32_dpp v107, v123 quad_perm:[0,1,0,1] row_mask:0xf bank_mask:0xf
v_smfmac_f32_16x16x64_bf16 v[48:51], v[36:39], a[104:111], v5
ds_read_b128 v[80:83], v0 offset:13312
v_mov_b32 v11, 0xf149f2ca
v_smfmac_f32_16x16x64_bf16 v[48:51], v[40:43], a[136:143], v5
ds_read_b128 v[84:87], v0 offset:14336
v_add_f32_e64 v44, v44, v46
v_smfmac_f32_16x16x64_bf16 v[52:55], v[36:39], a[112:119], v5
ds_read_b128 v[88:91], v0 offset:15360
v_add_f32_e64 v45, v45, v47
v_smfmac_f32_16x16x64_bf16 v[52:55], v[40:43], a[144:151], v5
v_add_f32_e64 v48, v48, v50
v_smfmac_f32_16x16x64_bf16 v[56:59], v[36:39], a[120:127], v5
v_add_f32_e64 v49, v49, v51
v_smfmac_f32_16x16x64_bf16 v[56:59], v[40:43], a[152:159], v5
v_add_f32 v52, v52, v54
v_add_f32 v53, v53, v55
v_cvt_pk_bf16_f32 v124, v44, v48
v_cvt_pk_bf16_f32 v126, v45, v49
v_cndmask_b32 v44, 0, v11, s[40:41]
v_cndmask_b32 v45, 0, v11, s[42:43]
s_nop 1
v_add_f32 v56, v56, v58
v_add_f32_e64 v57, v57, v59
v_cvt_pk_bf16_f32 v125, v52, v56
v_cvt_pk_bf16_f32 v127, v53, v57
ds_write2_b32 v2, v124, v125 offset0:0 offset1:36
ds_write2_b32 v2, v126, v127 offset0:4 offset1:40
v_smfmac_f32_16x16x64_bf16 v[108:111], v[28:31], a[160:167], v5
s_mov_b32 m0, 12288
s_add_u32 s32, s22, 4096
v_cndmask_b32 v46, 0, v11, s[44:45]
v_smfmac_f32_16x16x64_bf16 v[112:115], v[28:31], a[168:175], v5
v_cndmask_b32 v47, 0, v11, s[46:47]
v_smfmac_f32_16x16x64_bf16 v[108:111], v[32:35], a[176:183], v5
v_cndmask_b32 v48, 0, v11, s[48:49]
v_smfmac_f32_16x16x64_bf16 v[112:115], v[32:35], a[184:191], v5
v_cndmask_b32 v49, 0, v11, s[50:51]
v_smfmac_f32_16x16x64_bf16 v[108:111], v[36:39], a[192:199], v5
v_cndmask_b32 v50, 0, v11, s[52:53]
s_waitcnt lgkmcnt(0)
s_barrier
s_mov_b64 exec, s[56:57]
ds_read_b128 v[116:119], v3 offset:0
ds_read_b128 v[120:123], v3 offset:576
ds_read_b128 v[100:103], v3 offset:1152
ds_read_b128 v[104:107], v3 offset:1728
s_mov_b64 exec, -1
ds_read_b128 v[92:95], v4 offset:0
ds_read_b128 v[96:99], v4 offset:1152
v_smfmac_f32_16x16x64_bf16 v[112:115], v[36:39], a[200:207], v5
buffer_load_dword v8, v7, s[12:15], s37 offen sc1
v_cndmask_b32 v51, 0, v11, s[54:55]
v_smfmac_f32_16x16x64_bf16 v[108:111], v[40:43], a[208:215], v5
v_mov_b32 v53, 0
v_smfmac_f32_16x16x64_bf16 v[112:115], v[40:43], a[216:223], v5
v_mov_b32 v54, 0
v_smfmac_f32_16x16x64_bf16 v[108:111], v[12:15], a[224:231], v5
v_mov_b64_e64 v[124:125], 0
v_smfmac_f32_16x16x64_bf16 v[112:115], v[12:15], a[232:239], v5
v_mov_b64_e64 v[126:127], 0
s_waitcnt lgkmcnt(5)
v_mfma_f32_16x16x32_bf16 v[44:47], v[60:63], v[116:119], v[44:47]
v_mfma_f32_16x16x32_bf16 v[48:51], v[76:79], v[116:119], v[48:51]
ds_read_b128 v[60:63], v0 offset:16384
s_waitcnt lgkmcnt(5)
v_mfma_f32_16x16x32_bf16 v[44:47], v[64:67], v[120:123], v[44:47]
ds_read_b128 v[76:79], v0 offset:20480
v_mfma_f32_16x16x32_bf16 v[48:51], v[80:83], v[120:123], v[48:51]
ds_read_b128 v[64:67], v0 offset:17408
s_waitcnt lgkmcnt(4)
v_smfmac_f32_16x16x64_bf16 v[124:127], v[92:95], v[116:123], v5
ds_read_b128 v[80:83], v0 offset:21504
v_mfma_f32_16x16x32_bf16 v[44:47], v[68:71], v[100:103], v[44:47]
v_mfma_f32_16x16x32_bf16 v[48:51], v[84:87], v[100:103], v[48:51]
ds_read_b128 v[68:71], v0 offset:18432
s_waitcnt lgkmcnt(5)
v_smfmac_f32_16x16x64_bf16 v[124:127], v[96:99], v[100:107], v5
ds_read_b128 v[84:87], v0 offset:22528
v_mfma_f32_16x16x32_bf16 v[44:47], v[72:75], v[104:107], v[44:47]
v_mfma_f32_16x16x32_bf16 v[48:51], v[88:91], v[104:107], v[48:51]
ds_read_b128 v[72:75], v0 offset:19456
ds_read_b128 v[88:91], v0 offset:23552
v_add_f32 v124, v124, v126
v_add_f32 v125, v125, v127
v_max3_f32 v10, v124, v125, v44
v_max3_f32 v10, v10, v45, v46
v_smfmac_f32_16x16x64_bf16 v[108:111], v[16:19], a[240:247], v5
s_nop 0
v_max3_f32 v10, v10, v47, v48
v_max3_f32 v10, v10, v49, v50
v_max_f32 v11, v10, v51
v_max_f32_e64 v10, v10, v51
v_smfmac_f32_16x16x64_bf16 v[112:115], v[16:19], a[248:255], v5
s_nop 0
v_permlane16_swap_b32 v10, v11
v_max_f32 v10, v10, v11
v_mov_b32 v11, v10
v_smfmac_f32_16x16x64_bf16 v[108:111], v[20:23], v[128:135], v5
s_nop 0
v_permlane32_swap_b32 v10, v11
v_max_f32 v10, v10, v11
v_mul_f32 v10, s38, v10
v_fma_f32 v124, v124, s38, -v10
v_fma_f32 v125, v125, s38, -v10
v_pk_fma_f32 v[44:45], v[44:45], s[38:39], v[10:11] op_sel_hi:[1,1,0] neg_lo:[0,0,1] neg_hi:[0,0,1]
v_pk_fma_f32 v[46:47], v[46:47], s[38:39], v[10:11] op_sel_hi:[1,1,0] neg_lo:[0,0,1] neg_hi:[0,0,1]
v_pk_fma_f32 v[48:49], v[48:49], s[38:39], v[10:11] op_sel_hi:[1,1,0] neg_lo:[0,0,1] neg_hi:[0,0,1]
v_pk_fma_f32 v[50:51], v[50:51], s[38:39], v[10:11] op_sel_hi:[1,1,0] neg_lo:[0,0,1] neg_hi:[0,0,1]
v_smfmac_f32_16x16x64_bf16 v[112:115], v[20:23], v[136:143], v5
buffer_load_dwordx4 v0, s[12:15], s32 offen offset:0 sc1 lds
v_exp_f32 v44, v44
v_smfmac_f32_16x16x64_bf16 v[108:111], v[24:27], v[144:151], v5
v_exp_f32 v45, v45
v_smfmac_f32_16x16x64_bf16 v[112:115], v[24:27], v[152:159], v5
buffer_load_dwordx4 v0, s[12:15], s32 offen offset:1024 sc1 lds
v_exp_f32 v46, v46
v_exp_f32 v47, v47
v_exp_f32 v48, v48
v_exp_f32 v49, v49
v_exp_f32 v50, v50
v_exp_f32 v51, v51
v_exp_f32 v124, v124
v_exp_f32 v125, v125
v_pk_add_f32 v[108:109], v[108:109], v[110:111]
v_pk_add_f32 v[10:11], v[44:45], v[46:47]
v_pk_add_f32 v[126:127], v[48:49], v[50:51]
v_pk_add_f32 v[10:11], v[10:11], v[124:125]
v_pk_add_f32 v[10:11], v[10:11], v[126:127]
v_pk_add_f32 v[112:113], v[112:113], v[114:115]
v_add_f32 v126, v10, v11
v_add_f32 v10, v10, v11
v_cvt_pk_bf16_f32 v108, v108, v109
v_cvt_pk_bf16_f32 v109, v112, v113
v_permlane16_swap_b32 v10, v126
v_add_f32 v11, v10, v126
v_add_f32 v10, v10, v126
ds_write_b64 v0, v[108:109] offset:30208
s_mov_b64 vcc, s[56:57]
v_permlane32_swap_b32 v10, v11
v_add_f32 v10, v10, v11
v_rcp_f32_e64 v10, v10
s_mov_b32 m0, 20480
v_pk_mul_f32 v[44:45], v[44:45], v[10:11] op_sel_hi:[1,0]
v_pk_mul_f32 v[46:47], v[46:47], v[10:11] op_sel_hi:[1,0]
v_pk_mul_f32 v[48:49], v[48:49], v[10:11] op_sel_hi:[1,0]
v_pk_mul_f32 v[50:51], v[50:51], v[10:11] op_sel_hi:[1,0]
v_pk_mul_f32 v[124:125], v[124:125], v[10:11] op_sel_hi:[1,0]
v_cvt_pk_bf16_f32 v56, v44, v45
v_cvt_pk_bf16_f32 v57, v46, v47
v_cvt_pk_bf16_f32 v58, v48, v49
v_cvt_pk_bf16_f32 v59, v50, v51
v_cvt_pk_bf16_f32 v52, v124, v125
v_cvt_pk_bf16_f32 v55, v124, v125
s_waitcnt lgkmcnt(8)
v_mfma_f32_16x16x32_bf16 v[92:95], v[60:63], v[56:59], 0
s_waitcnt lgkmcnt(0)
s_barrier
ds_read_b128 v[116:119], v0 offset:29184
ds_read_b128 v[120:123], v0 offset:30208
v_mfma_f32_16x16x32_bf16 v[96:99], v[64:67], v[56:59], 0
s_add_u32 s33, s22, 12288
s_cmp_eq_u32 s20, 63
v_mov_b64 v[12:13], 0
v_mov_b64 v[14:15], 0
v_mfma_f32_16x16x32_bf16 v[100:103], v[68:71], v[56:59], 0
v_mov_b64 v[16:17], 0
v_mov_b64 v[18:19], 0
v_mfma_f32_16x16x32_bf16 v[104:107], v[72:75], v[56:59], 0
v_mov_b64 v[20:21], 0
v_mov_b64 v[22:23], 0
v_mfma_f32_16x16x32_bf16 v[60:63], v[76:79], v[56:59], 0
v_mov_b64 v[24:25], 0
v_mov_b64 v[26:27], 0
s_waitcnt lgkmcnt(1)
v_mfma_f32_16x16x16_bf16 v[92:95], v[116:117], v[52:53], v[92:95]
v_mov_b64 v[28:29], 0
v_mov_b64 v[30:31], 0
v_mfma_f32_16x16x16_bf16 v[96:99], v[116:117], v[54:55], v[96:99]
v_mov_b64 v[32:33], 0
v_mov_b64 v[34:35], 0
v_mfma_f32_16x16x16_bf16 v[100:103], v[118:119], v[52:53], v[100:103]
v_cvt_pk_bf16_f32 v108, v92, v93
v_cvt_pk_bf16_f32 v109, v94, v95
v_mfma_f32_16x16x16_bf16 v[104:107], v[118:119], v[54:55], v[104:107]
v_cvt_pk_bf16_f32 v110, v96, v97
v_cvt_pk_bf16_f32 v111, v98, v99
v_mfma_f32_16x16x32_bf16 v[64:67], v[80:83], v[56:59], 0
buffer_load_dwordx4 v0, s[12:15], s33 offen offset:0 sc1 lds
v_cvt_pk_bf16_f32 v112, v100, v101
v_cvt_pk_bf16_f32 v113, v102, v103
s_waitcnt lgkmcnt(0)
v_mfma_f32_16x16x16_bf16 v[60:63], v[120:121], v[52:53], v[60:63]
v_cvt_pk_bf16_f32 v114, v104, v105
v_cvt_pk_bf16_f32 v115, v106, v107
v_mfma_f32_16x16x32_bf16 v[68:71], v[84:87], v[56:59], 0
v_cndmask_b32_dpp v100, v109, v108, vcc quad_perm:[0,1,0,1] row_mask:0xf bank_mask:0xf
v_cndmask_b32_dpp v101, v111, v110, vcc quad_perm:[0,1,0,1] row_mask:0xf bank_mask:0xf
v_mfma_f32_16x16x16_bf16 v[64:67], v[120:121], v[54:55], v[64:67]
v_cndmask_b32_dpp v102, v113, v112, vcc quad_perm:[0,1,0,1] row_mask:0xf bank_mask:0xf
v_cndmask_b32_dpp v103, v115, v114, vcc quad_perm:[0,1,0,1] row_mask:0xf bank_mask:0xf
v_mfma_f32_16x16x32_bf16 v[72:75], v[88:91], v[56:59], 0
buffer_load_dwordx4 v0, s[12:15], s33 offen offset:1024 sc1 lds
v_cvt_pk_bf16_f32 v116, v60, v61
v_cvt_pk_bf16_f32 v117, v62, v63
v_mfma_f32_16x16x16_bf16 v[68:71], v[122:123], v[52:53], v[68:71]
v_cvt_pk_bf16_f32 v118, v64, v65
v_cvt_pk_bf16_f32 v119, v66, v67
v_mfma_f32_16x16x16_bf16 v[72:75], v[122:123], v[54:55], v[72:75]
s_cbranch_scc1 CLAST_76
v_cndmask_b32_dpp v104, v117, v116, vcc quad_perm:[0,1,0,1] row_mask:0xf bank_mask:0xf
v_cndmask_b32_dpp v105, v119, v118, vcc quad_perm:[0,1,0,1] row_mask:0xf bank_mask:0xf
v_smfmac_f32_16x16x64_bf16 v[12:15], v[100:103], v[160:167], v5
ds_read_b128 v[44:47], v1 offset:24576
ds_read_b128 v[48:51], v1 offset:25600
s_and_b32 s32, s20, 1
v_cvt_pk_bf16_f32 v120, v68, v69
v_smfmac_f32_16x16x64_bf16 v[16:19], v[100:103], v[168:175], v5
ds_read_b128 v[92:95], v1 offset:26624
s_lshl_b32 s32, s32, 18
v_cvt_pk_bf16_f32 v121, v70, v71
v_cvt_pk_bf16_f32 v122, v72, v73
v_smfmac_f32_16x16x64_bf16 v[20:23], v[100:103], v[176:183], v5
ds_read_b128 v[96:99], v1 offset:27648
s_add_u32 s25, s34, s32
v_cvt_pk_bf16_f32 v123, v74, v75
v_smfmac_f32_16x16x64_bf16 v[24:27], v[100:103], v[184:191], v5
v_cndmask_b32_dpp v106, v121, v120, vcc quad_perm:[0,1,0,1] row_mask:0xf bank_mask:0xf
v_cndmask_b32_dpp v107, v123, v122, vcc quad_perm:[0,1,0,1] row_mask:0xf bank_mask:0xf
s_add_u32 s26, s25, 32768
s_bfe_u32 s69, s20, 0x10001
v_smfmac_f32_16x16x64_bf16 v[12:15], v[104:107], v[224:231], v5
ds_read_b128 v[76:79], v1 offset:28672
v_mov_b64 v[36:37], 0
v_mov_b64 v[40:41], 0
v_smfmac_f32_16x16x64_bf16 v[16:19], v[104:107], v[232:239], v5
ds_read_b128 v[80:83], v1 offset:29696
v_mov_b64 v[38:39], 0
v_mov_b64 v[42:43], 0
v_smfmac_f32_16x16x64_bf16 v[20:23], v[104:107], v[240:247], v5
ds_read_b128 v[84:87], v1 offset:30720
v_add_f32_e64 v12, v12, v14
v_smfmac_f32_16x16x64_bf16 v[24:27], v[104:107], v[248:255], v5
ds_read_b128 v[88:91], v1 offset:31744
v_add_f32_e64 v13, v13, v15
v_smfmac_f32_16x16x64_bf16 v[28:31], v[100:103], v[192:199], v5
v_add_f32 v16, v16, v18
v_add_f32 v17, v17, v19
v_smfmac_f32_16x16x64_bf16 v[32:35], v[100:103], v[200:207], v5
v_add_f32 v20, v20, v22
v_add_f32 v21, v21, v23
v_smfmac_f32_16x16x64_bf16 v[36:39], v[100:103], v[208:215], v5
v_add_f32_e64 v24, v24, v26
v_add_f32 v25, v25, v27
v_smfmac_f32_16x16x64_bf16 v[40:43], v[100:103], v[216:223], v5
v_cvt_pk_bf16_f32 v52, v12, v16
v_cvt_pk_bf16_f32 v53, v20, v24
s_waitcnt lgkmcnt(6)
v_smfmac_f32_16x16x64_bf16 v[28:31], v[104:107], v[44:51], v5
v_cvt_pk_bf16_f32 v54, v13, v17
v_cvt_pk_bf16_f32 v55, v21, v25
s_waitcnt lgkmcnt(4)
v_smfmac_f32_16x16x64_bf16 v[32:35], v[104:107], v[92:99], v5
v_and_or_b32 v52, v52, -2, s69
s_waitcnt lgkmcnt(2)
v_smfmac_f32_16x16x64_bf16 v[36:39], v[104:107], v[76:83], v5
buffer_store_dwordx4 v[52:55], v6, s[12:15], s25 offen sc1
v_add_f32 v28, v28, v30
s_waitcnt lgkmcnt(0)
v_smfmac_f32_16x16x64_bf16 v[40:43], v[104:107], v[84:91], v5
v_add_f32 v29, v29, v31
v_add_f32 v32, v32, v34
v_add_f32_e64 v33, v33, v35
v_cvt_pk_bf16_f32 v56, v28, v32
v_add_f32 v36, v36, v38
v_add_f32 v37, v37, v39
v_cvt_pk_bf16_f32 v58, v29, v33
v_and_or_b32 v56, v56, -2, s69
v_pk_add_f32 v[40:41], v[40:41], v[42:43]
v_cvt_pk_bf16_f32 v57, v36, v40
v_cvt_pk_bf16_f32 v59, v37, v41
buffer_store_dwordx4 v[56:59], v6, s[12:15], s26 offen sc1
s_lshl_b32 s32, s16, 13
s_add_u32 s25, s25, s32
s_add_u32 s25, s25, 4096
v_and_b32 v10, 16, v0
v_mov_b32 v11, 0x3f80
v_lshlrev_b32 v10, v10, v11
v_cndmask_b32 v124, 0, v10, s[60:61]
v_cndmask_b32 v125, 0, v10, s[62:63]
v_cndmask_b32 v126, 0, v10, s[64:65]
v_cndmask_b32 v127, 0, v10, s[66:67]
v_mov_b64 v[32:33], -1
v_bfe_u32 v10, v0, 4, 1
v_lshrrev_b32 v11, 8, v0
v_lshl_add_u32 v10, v11, 1, v10
v_and_b32_e64 v11, 32, v0
v_lshl_add_u32 v35, v10, 3, v11
s_and_b32 s32, s20, 3
s_lshl_b32 s32, s32, 13
s_add_u32 s27, s35, s32
s_add_u32 s29, s27, 4096
s_xor_b32 s32, s32, 16384
s_add_u32 s28, s35, s32
s_lshl_b32 s32, s16, 8
s_add_u32 s27, s27, s32
s_add_u32 s28, s28, s32
s_mov_b32 s68, s23
s_mov_b32 m0, 4096
s_mov_b32 s30, 0
s_mov_b64 vcc, s[58:59]
v_cndmask_b32_dpp v108, v116, v108, vcc quad_perm:[2,3,2,3] row_mask:0xf bank_mask:0xf
v_cndmask_b32_dpp v109, v117, v109, vcc quad_perm:[2,3,2,3] row_mask:0xf bank_mask:0xf
v_cndmask_b32_dpp v110, v118, v110, vcc quad_perm:[2,3,2,3] row_mask:0xf bank_mask:0xf
v_cndmask_b32_dpp v111, v119, v111, vcc quad_perm:[2,3,2,3] row_mask:0xf bank_mask:0xf
v_cndmask_b32_dpp v112, v120, v112, vcc quad_perm:[2,3,2,3] row_mask:0xf bank_mask:0xf
v_cndmask_b32_dpp v113, v121, v113, vcc quad_perm:[2,3,2,3] row_mask:0xf bank_mask:0xf
v_cndmask_b32_dpp v114, v122, v114, vcc quad_perm:[2,3,2,3] row_mask:0xf bank_mask:0xf
v_cndmask_b32_dpp v115, v123, v115, vcc quad_perm:[2,3,2,3] row_mask:0xf bank_mask:0xf
v_min_u32 v108, -2, v108
v_min_u32 v112, -2, v112
ds_read_b128 v[60:63], v1 offset:0
ds_read_b128 v[64:67], v1 offset:1024
ds_read_b128 v[68:71], v1 offset:2048
ds_read_b128 v[72:75], v1 offset:3072
ds_read_b128 v[76:79], v1 offset:4096
ds_read_b128 v[80:83], v1 offset:5120
ds_read_b128 v[84:87], v1 offset:6144
ds_read_b128 v[88:91], v1 offset:7168
ds_read_b128 v[92:95], v1 offset:8192
ds_read_b128 v[96:99], v1 offset:9216
ds_read_b128 v[100:103], v1 offset:10240
ds_read_b128 v[104:107], v1 offset:11264
v_mov_b64 v[44:45], 0
v_mov_b64 v[46:47], 0
v_mov_b64 v[48:49], 0
v_mov_b64 v[50:51], 0
buffer_load_dwordx4 v[20:23], v0, s[12:15], s25 offen offset:0 sc1
buffer_load_dwordx4 v[24:27], v0, s[12:15], s25 offen offset:1024 sc1
v_mov_b64 v[52:53], 0
v_mov_b64 v[54:55], 0
v_mov_b64_e64 v[56:57], 0
v_mov_b64 v[58:59], 0
RT_79:
s_waitcnt vmcnt(1)
v_mfma_f32_16x16x32_bf16 v[28:31], v[124:127], v[20:23], 0
v_xor_b32 v10, s69, v20
s_waitcnt vmcnt(0)
v_bitop3_b32 v10, v10, v24, s69 bitop3:0xf6
v_and_b32 v10, 1, v10
v_cmp_ne_u32_e64 vcc, 0, v10
v_mfma_f32_16x16x32_bf16 v[28:31], v[124:127], v[24:27], v[28:31]
s_cbranch_vccz RG_81
s_mov_b64 exec, vcc
buffer_load_dwordx4 v[20:23], v0, s[12:15], s25 offen offset:0 sc1
buffer_load_dwordx4 v[24:27], v0, s[12:15], s25 offen offset:1024 sc1
s_mov_b64 exec, -1
s_add_u32 s30, s30, 1
s_cmp_gt_u32 s30, 2097152
s_cbranch_scc1 FAIL
s_branch RT_79
RG_81:
s_nop 6
v_add_f32_dpp v28, v28, v28 row_ror:4 row_mask:0xf bank_mask:0xf
v_add_f32_dpp v29, v29, v29 row_ror:4 row_mask:0xf bank_mask:0xf
v_add_f32_dpp v30, v30, v30 row_ror:4 row_mask:0xf bank_mask:0xf
v_add_f32_dpp v31, v31, v31 row_ror:4 row_mask:0xf bank_mask:0xf
v_add_f32_dpp v28, v28, v28 row_ror:8 row_mask:0xf bank_mask:0xf
v_add_f32_dpp v29, v29, v29 row_ror:8 row_mask:0xf bank_mask:0xf
v_add_f32_dpp v30, v30, v30 row_ror:8 row_mask:0xf bank_mask:0xf
v_add_f32_dpp v31, v31, v31 row_ror:8 row_mask:0xf bank_mask:0xf
v_cvt_pk_bf16_f32 v10, v28, v29
v_cvt_pk_bf16_f32 v11, v30, v31
v_min_u32_e64 v10, -2, v10
s_mov_b64 exec, 0xf000f
buffer_store_dwordx2 v[10:11], v35, s[12:15], s27 offen offset:128 sc1
buffer_store_dwordx2 v[32:33], v35, s[12:15], s28 offen offset:128 sc1
s_mov_b64 exec, -1
s_add_u32 s20, s20, 1
s_mov_b32 s21, s22
s_add_u32 s23, s23, 8192
s_add_u32 s36, s21, 20480
s_add_u32 s22, s21, 24576
s_add_u32 s37, s22, 8192
buffer_load_dwordx4 v[116:119], v0, s[12:15], s36 offen offset:0 sc1
buffer_load_dwordx4 v[120:123], v0, s[12:15], s36 offen offset:1024 sc1
s_waitcnt vmcnt(0)
buffer_load_dwordx4 v[12:15], v0, s[12:15], s29 offen offset:0 sc1
buffer_load_dwordx4 v[16:19], v0, s[12:15], s29 offen offset:1024 sc1
s_branch H2_82
ROK_80:
s_mov_b64 exec, vcc
buffer_load_dwordx4 v[20:23], v0, s[12:15], s25 offen offset:0 sc1
buffer_load_dwordx4 v[24:27], v0, s[12:15], s25 offen offset:1024 sc1
s_mov_b64 exec, -1
s_add_u32 s30, s30, 1
s_cmp_gt_u32 s30, 2097152
s_cbranch_scc1 FAIL
s_branch RT_79
MRE_84:
s_mov_b64 exec, vcc
buffer_load_dwordx4 v[12:15], v0, s[12:15], s29 offen offset:0 sc1
buffer_load_dwordx4 v[16:19], v0, s[12:15], s29 offen offset:1024 sc1
s_mov_b64 exec, -1
s_add_u32 s30, s30, 1
s_cmp_gt_u32 s30, 2097152
s_cbranch_scc1 FAIL
s_branch MT_83
CLAST_76:
s_nop 2
v_cvt_pk_bf16_f32 v120, v68, v69
v_cvt_pk_bf16_f32 v121, v70, v71
s_nop 1
v_cvt_pk_bf16_f32 v122, v72, v73
v_cvt_pk_bf16_f32 v123, v74, v75
s_mov_b64 vcc, s[58:59]
v_cndmask_b32_dpp v108, v116, v108, vcc quad_perm:[2,3,2,3] row_mask:0xf bank_mask:0xf
v_cndmask_b32_dpp v109, v117, v109, vcc quad_perm:[2,3,2,3] row_mask:0xf bank_mask:0xf
v_cndmask_b32_dpp v110, v118, v110, vcc quad_perm:[2,3,2,3] row_mask:0xf bank_mask:0xf
v_cndmask_b32_dpp v111, v119, v111, vcc quad_perm:[2,3,2,3] row_mask:0xf bank_mask:0xf
v_cndmask_b32_dpp v112, v120, v112, vcc quad_perm:[2,3,2,3] row_mask:0xf bank_mask:0xf
v_cndmask_b32_dpp v113, v121, v113, vcc quad_perm:[2,3,2,3] row_mask:0xf bank_mask:0xf
v_cndmask_b32_dpp v114, v122, v114, vcc quad_perm:[2,3,2,3] row_mask:0xf bank_mask:0xf
v_cndmask_b32_dpp v115, v123, v115, vcc quad_perm:[2,3,2,3] row_mask:0xf bank_mask:0xf
v_min_u32 v108, -2, v108
v_min_u32 v112, -2, v112
buffer_store_dwordx4 v[108:111], v0, s[12:15], s23 offen offset:0 sc1
buffer_store_dwordx4 v[112:115], v0, s[12:15], s23 offen offset:1024 sc1
s_branch FIN
CW3:
v_and_b32 v20, 15, v0
v_lshrrev_b32 v21, 4, v0
v_lshrrev_b32 v22, 2, v20
v_and_b32_e64 v23, 1, v20
v_lshl_add_u32 v24, v22, 1, v23
v_bfe_u32 v25, v20, 1, 1
v_mov_b32_e64 v26, v0
v_lshlrev_b32_e64 v0, 4, v26
v_add_u32 v1, 131072, v0
s_movk_i32 s3, 144
v_lshlrev_b32 v27, 1, v22
v_mul_lo_u32 v27, v27, s3
v_lshl_add_u32 v27, v21, 5, v27
v_and_b32_e64 v28, 3, v20
v_lshl_add_u32 v27, v28, 2, v27
v_add_u32 v2, 28032, v27
v_mul_lo_u32 v27, v21, s3
v_lshl_add_u32 v27, v24, 4, v27
v_add_u32 v3, 24576, v27
v_lshl_add_u32 v27, v21, 1, v25
v_mul_lo_u32 v27, v27, s3
v_lshl_add_u32 v27, v24, 4, v27
v_add_u32 v4, 26880, v27
v_mul_u32_u24 v27, 0xaaaa, v25
v_add_u32 v5, 0x4444, v27
v_lshlrev_b32_e64 v27, 13, v22
v_lshl_add_u32 v27, v21, 11, v27
v_and_b32 v28, 3, v20
v_lshl_add_u32 v27, v28, 4, v27
s_lshl_b32 s3, s16, 6
s_add_u32 s3, s3, 196608
v_add_u32_e64 v6, s3, v27
s_mov_b32 s60, 0x30003
s_mov_b32 s61, 0x30003
s_mov_b32 s62, 0xc000c
s_mov_b32 s63, 0xc000c
s_mov_b32 s64, 0x300030
s_mov_b32 s65, 0x300030
s_mov_b32 s66, 0xc000c0
s_mov_b32 s67, 0xc000c0
v_lshlrev_b32_e64 v28, 10, v24
v_lshl_add_u32 v28, v21, 5, v28
v_lshl_add_u32 v28, v25, 4, v28
s_mov_b32 s40, 0x0
s_mov_b32 s41, 0xc0000
s_mov_b32 s42, 0x0
s_mov_b32 s43, 0xc0000
s_mov_b32 s44, 0x0
s_mov_b32 s45, 0x4c0004
s_mov_b32 s46, 0x0
s_mov_b32 s47, 0x4c0004
s_mov_b32 s48, 0x0
s_mov_b32 s49, 0xccc00cc
s_mov_b32 s50, 0x0
s_mov_b32 s51, 0xccc00cc
s_mov_b32 s52, 0x0
s_mov_b32 s53, 0x4ccc04cc
s_mov_b32 s54, 0x0
s_mov_b32 s55, 0x4ccc04cc
s_mov_b32 s56, 0x33333333
s_mov_b32 s57, 0x33333333
s_mov_b32 s58, 0xcccccccc
s_mov_b32 s59, 0xcccccccc
s_mov_b32 s38, 0x3e0293ee
s_mov_b32 s39, 0x3e0293ee
s_mov_b32 s20, 0
s_lshl_b32 s3, s17, 5
s_add_u32 s3, s3, s16
s_lshl_b32 s3, s3, 6
s_mul_i32 s21, s3, 24576
s_lshl_b32 s23, s3, 13
s_add_u32 s23, s23, 100669440
s_lshl_b32 s34, s17, 19
s_add_u32 s34, s34, 153092096
s_lshl_b32 s35, s17, 15
s_add_u32 s35, s35, 154140672
s_lshl_b32 s3, s17, 5
s_add_u32 s3, s3, s16
s_lshl_b32 s3, s3, 8
s_add_u32 s31, s3, 159383552
s_mov_b32 s30, 0
s_cmp_eq_u32 s78, 1
s_cbranch_scc1 CK_86
CF_85:
s_add_u32 s30, s30, 1
s_cmp_gt_u32 s30, 2097152
s_cbranch_scc1 FAIL
s_cmp_ge_u32 s79, 48
s_cbranch_scc1 CG_87
s_load_dwordx2 s[70:71], s[0:1], 88
v_mov_b32 v114, 208
s_waitcnt lgkmcnt(0)
s_mov_b64 exec, 1
global_load_dword v124, v114, s[70:71] sc1
s_mov_b64 exec, -1
CG_87:
s_waitcnt vmcnt(0)
v_readlane_b32 s79, v124, 0
v_mbcnt_lo_u32_b32 v113, -1, 0
v_lshlrev_b32_e64 v112, 4, v113
s_lshl_b32 s3, s17, 5
s_add_u32 s3, s3, s16
s_lshl_b32 s76, s3, 8
s_add_u32 s76, s76, 159383552
s_mov_b64 exec, 0xfff
buffer_load_dword v125, v112, s[12:15], s76 offen sc1
s_mov_b64 exec, -1
s_mov_b64 exec, 0xfff
s_waitcnt vmcnt(0)
v_cmp_gt_u32 vcc, 1, v125
s_mov_b64 exec, -1
s_cmp_eq_u64 vcc, 0
s_cselect_b32 s76, s79, 0
s_cmp_ge_u32 s76, 48
s_cbranch_scc0 CF_85
s_load_dwordx2 s[72:73], s[0:1], 8
s_mov_b32 s74, 8192
s_mov_b32 s75, 0x20000
v_mbcnt_lo_u32_b32 v113, -1, 0
v_mbcnt_hi_u32_b32 v113, -1, v113
v_lshlrev_b32 v112, 4, v113
s_lshl_b32 s3, s17, 5
s_add_u32 s3, s3, s16
s_lshl_b32 s3, s3, 6
s_mul_i32 s77, s3, 24576
s_lshl_b32 s3, s19, 12
s_add_u32 m0, s3, 8192
s_add_u32 s3, s3, s77
buffer_load_dwordx4 v112, s[12:15], s3 offen offset:0 sc1 lds
buffer_load_dwordx4 v112, s[12:15], s3 offen offset:1024 sc1 lds
buffer_load_dwordx4 v112, s[12:15], s3 offen offset:2048 sc1 lds
buffer_load_dwordx4 v112, s[12:15], s3 offen offset:3072 sc1 lds
v_and_b32_e64 v114, 1, v113
v_bfe_u32 v115, v113, 2, 2
v_lshl_add_u32 v114, v115, 1, v114
v_lshrrev_b32_e64 v115, 4, v113
v_bfe_u32 v113, v113, 1, 1
v_lshlrev_b32_e64 v114, 10, v114
v_lshl_add_u32 v114, v115, 5, v114
v_lshl_add_u32 v114, v113, 4, v114
s_lshl_b32 s3, s19, 11
s_add_u32 s3, s3, s77
s_add_u32 s3, s3, 16384
buffer_load_dwordx4 v[116:119], v112, s[12:15], s3 offen sc1
buffer_load_dwordx4 v[120:123], v112, s[12:15], s3 offen offset:1024 sc1
s_lshl_b32 s3, s17, 19
s_lshl_b32 s76, s16, 13
s_add_u32 s3, s3, s76
s_and_b32 s76, s19, 1
s_lshl_b32 s76, s76, 18
s_add_u32 s3, s3, s76
s_add_u32 s3, s3, 153092096
s_lshl_b32 s76, s17, 15
s_lshl_b32 s77, s16, 10
s_add_u32 s76, s76, s77
s_add_u32 s76, s76, 154140672
s_cmp_lt_u32 s19, 2
s_cselect_b32 s3, s3, s76
s_cselect_b32 s76, 3, 0
v_lshlrev_b32 v115, s76, v112
buffer_load_dword v115, v115, s[12:15], s3 offen sc1
s_waitcnt lgkmcnt(0)
s_lshl_b32 s3, s19, 11
s_add_u32 m0, s3, 0
s_lshl_b32 s3, s19, 8
s_add_u32 s3, s3, 0
buffer_load_dwordx4 v114, s[72:75], s3 offen lds
s_lshl_b32 s3, s19, 11
s_add_u32 m0, s3, 1024
s_lshl_b32 s3, s19, 8
s_add_u32 s3, s3, 128
buffer_load_dwordx4 v114, s[72:75], s3 offen lds
CK_86:
v_mov_b32 v9, v125
s_waitcnt vmcnt(0)
ds_read_b128 v[12:15], v0 offset:6144
ds_read_b128 v[16:19], v0 offset:7168
ds_read_b128 v[60:63], v1 offset:0
ds_read_b128 v[64:67], v1 offset:1024
ds_read_b128 v[68:71], v1 offset:2048
ds_read_b128 v[72:75], v1 offset:3072
ds_read_b128 v[76:79], v1 offset:4096
ds_read_b128 v[80:83], v1 offset:5120
ds_read_b128 v[84:87], v1 offset:6144
ds_read_b128 v[88:91], v1 offset:7168
ds_read_b128 v[92:95], v1 offset:8192
ds_read_b128 v[96:99], v1 offset:9216
ds_read_b128 v[100:103], v1 offset:10240
ds_read_b128 v[104:107], v1 offset:11264
v_mov_b64 v[44:45], 0
v_mov_b64 v[46:47], 0
v_mov_b64 v[48:49], 0
v_mov_b64 v[50:51], 0
v_mov_b64_e64 v[52:53], 0
v_mov_b64_e64 v[54:55], 0
v_mov_b64_e64 v[56:57], 0
v_mov_b64 v[58:59], 0
s_mov_b32 s68, 268435456
s_waitcnt lgkmcnt(0)
s_cmp_eq_u32 s18, 0
s_cbranch_scc1 CS3
s_add_u32 s36, s21, 22528
s_add_u32 s22, s21, 24576
s_add_u32 s37, s22, 16384
v_lshlrev_b32 v7, 3, v0
s_branch CL_88
H2_95:
MT_96:
s_waitcnt vmcnt(1)
v_max_u32 v10, v12, v14
s_waitcnt vmcnt(0)
v_max3_u32 v10, v10, v16, v18
v_cmp_eq_u32 vcc, -1, v10
ds_write_b128 v0, v[12:15] offset:6144
ds_write_b128 v0, v[16:19] offset:7168
s_cbranch_vccnz MRE_97
CL_88:
s_waitcnt lgkmcnt(12)
v_smfmac_f32_16x16x64_bf16 v[44:47], v[12:15], v[60:67], v5
s_waitcnt lgkmcnt(10)
v_smfmac_f32_16x16x64_bf16 v[48:51], v[12:15], v[68:75], v5
s_waitcnt lgkmcnt(8)
v_smfmac_f32_16x16x64_bf16 v[52:55], v[12:15], v[76:83], v5
s_waitcnt lgkmcnt(0)
s_barrier
ds_read_b128 v[20:23], v0 offset:0
ds_read_b128 v[24:27], v0 offset:1024
v_smfmac_f32_16x16x64_bf16 v[56:59], v[12:15], v[84:91], v5
buffer_load_dword v8, v7, s[12:15], s37 offen sc1
ds_read_b128 v[28:31], v0 offset:2048
ds_read_b128 v[32:35], v0 offset:3072
v_smfmac_f32_16x16x64_bf16 v[44:47], v[16:19], v[92:99], v5
ds_read_b128 v[36:39], v0 offset:4096
ds_read_b128 v[40:43], v0 offset:5120
v_smfmac_f32_16x16x64_bf16 v[48:51], v[16:19], v[100:107], v5
v_smfmac_f32_16x16x64_bf16 v[52:55], v[16:19], a[0:7], v5
ds_read_b128 v[92:95], v1 offset:20480
v_smfmac_f32_16x16x64_bf16 v[56:59], v[16:19], a[8:15], v5
buffer_store_dwordx4 v[108:111], v0, s[12:15], s68 offen offset:0 sc1
ds_read_b128 v[96:99], v1 offset:21504
s_waitcnt lgkmcnt(7)
v_smfmac_f32_16x16x64_bf16 v[44:47], v[20:23], a[16:23], v5
ds_read_b128 v[100:103], v1 offset:22528
v_smfmac_f32_16x16x64_bf16 v[48:51], v[20:23], a[24:31], v5
ds_read_b128 v[104:107], v1 offset:23552
v_smfmac_f32_16x16x64_bf16 v[52:55], v[20:23], a[32:39], v5
ds_read_b128 v[60:63], v1 offset:12288
v_smfmac_f32_16x16x64_bf16 v[56:59], v[20:23], a[40:47], v5
buffer_store_dwordx4 v[112:115], v0, s[12:15], s68 offen offset:1024 sc1
ds_read_b128 v[64:67], v1 offset:13312
s_waitcnt lgkmcnt(10)
v_smfmac_f32_16x16x64_bf16 v[44:47], v[24:27], a[48:55], v5
ds_read_b128 v[68:71], v1 offset:14336
v_smfmac_f32_16x16x64_bf16 v[48:51], v[24:27], a[56:63], v5
ds_read_b128 v[72:75], v1 offset:15360
v_mov_b64_e64 v[108:109], 0
v_smfmac_f32_16x16x64_bf16 v[52:55], v[24:27], a[64:71], v5
ds_read_b128 v[76:79], v1 offset:16384
v_mov_b64_e64 v[110:111], 0
v_smfmac_f32_16x16x64_bf16 v[56:59], v[24:27], a[72:79], v5
ds_read_b128 v[80:83], v1 offset:17408
v_mov_b64 v[112:113], 0
s_waitcnt lgkmcnt(8)
v_smfmac_f32_16x16x64_bf16 v[44:47], v[28:31], v[92:99], v5
ds_read_b128 v[84:87], v1 offset:18432
v_mov_b64 v[114:115], 0
s_waitcnt lgkmcnt(7)
v_smfmac_f32_16x16x64_bf16 v[48:51], v[28:31], v[100:107], v5
ds_read_b128 v[88:91], v1 offset:19456
v_smfmac_f32_16x16x64_bf16 v[52:55], v[28:31], a[80:87], v5
v_mov_b32_dpp v100, v116 quad_perm:[0,1,0,1] row_mask:0xf bank_mask:0xf
v_smfmac_f32_16x16x64_bf16 v[56:59], v[28:31], a[88:95], v5
v_mov_b32_dpp v101, v117 quad_perm:[0,1,0,1] row_mask:0xf bank_mask:0xf
s_waitcnt lgkmcnt(6)
v_smfmac_f32_16x16x64_bf16 v[44:47], v[32:35], v[60:67], v5
v_mov_b32_dpp v102, v118 quad_perm:[0,1,0,1] row_mask:0xf bank_mask:0xf
s_waitcnt lgkmcnt(4)
v_smfmac_f32_16x16x64_bf16 v[48:51], v[32:35], v[68:75], v5
ds_read_b128 v[60:63], v0 offset:8192
v_mov_b32_dpp v103, v119 quad_perm:[0,1,0,1] row_mask:0xf bank_mask:0xf
s_waitcnt lgkmcnt(3)
v_smfmac_f32_16x16x64_bf16 v[52:55], v[32:35], v[76:83], v5
ds_read_b128 v[64:67], v0 offset:9216
v_mov_b32_dpp v104, v120 quad_perm:[0,1,0,1] row_mask:0xf bank_mask:0xf
s_waitcnt lgkmcnt(2)
v_smfmac_f32_16x16x64_bf16 v[56:59], v[32:35], v[84:91], v5
ds_read_b128 v[68:71], v0 offset:10240
v_mov_b32_dpp v105, v121 quad_perm:[0,1,0,1] row_mask:0xf bank_mask:0xf
v_smfmac_f32_16x16x64_bf16 v[44:47], v[36:39], a[96:103], v5
ds_read_b128 v[72:75], v0 offset:11264
v_mov_b32_dpp v106, v122 quad_perm:[0,1,0,1] row_mask:0xf bank_mask:0xf
v_smfmac_f32_16x16x64_bf16 v[44:47], v[40:43], a[128:135], v5
ds_read_b128 v[76:79], v0 offset:12288
v_mov_b32_dpp v107, v123 quad_perm:[0,1,0,1] row_mask:0xf bank_mask:0xf
v_smfmac_f32_16x16x64_bf16 v[48:51], v[36:39], a[104:111], v5
ds_read_b128 v[80:83], v0 offset:13312
v_mov_b32 v11, 0xf149f2ca
v_smfmac_f32_16x16x64_bf16 v[48:51], v[40:43], a[136:143], v5
ds_read_b128 v[84:87], v0 offset:14336
v_add_f32_e64 v44, v44, v46
v_smfmac_f32_16x16x64_bf16 v[52:55], v[36:39], a[112:119], v5
ds_read_b128 v[88:91], v0 offset:15360
v_add_f32 v45, v45, v47
v_smfmac_f32_16x16x64_bf16 v[52:55], v[40:43], a[144:151], v5
v_add_f32 v48, v48, v50
v_smfmac_f32_16x16x64_bf16 v[56:59], v[36:39], a[120:127], v5
v_add_f32_e64 v49, v49, v51
v_smfmac_f32_16x16x64_bf16 v[56:59], v[40:43], a[152:159], v5
v_add_f32 v52, v52, v54
v_add_f32 v53, v53, v55
v_cvt_pk_bf16_f32 v124, v44, v48
v_cvt_pk_bf16_f32 v126, v45, v49
v_cndmask_b32 v44, 0, v11, s[40:41]
v_cndmask_b32 v45, 0, v11, s[42:43]
s_nop 1
v_add_f32 v56, v56, v58
v_add_f32_e64 v57, v57, v59
v_cvt_pk_bf16_f32 v125, v52, v56
v_cvt_pk_bf16_f32 v127, v53, v57
ds_write2_b32 v2, v124, v125 offset0:0 offset1:36
ds_write2_b32 v2, v126, v127 offset0:4 offset1:40
v_smfmac_f32_16x16x64_bf16 v[108:111], v[20:23], a[160:167], v5
s_mov_b32 m0, 14336
s_add_u32 s32, s22, 6144
v_cndmask_b32 v46, 0, v11, s[44:45]
v_smfmac_f32_16x16x64_bf16 v[112:115], v[20:23], a[168:175], v5
v_cndmask_b32 v47, 0, v11, s[46:47]
v_smfmac_f32_16x16x64_bf16 v[108:111], v[24:27], a[176:183], v5
v_cndmask_b32 v48, 0, v11, s[48:49]
v_smfmac_f32_16x16x64_bf16 v[112:115], v[24:27], a[184:191], v5
v_cndmask_b32 v49, 0, v11, s[50:51]
v_smfmac_f32_16x16x64_bf16 v[108:111], v[28:31], a[192:199], v5
v_cndmask_b32 v50, 0, v11, s[52:53]
s_waitcnt lgkmcnt(0)
s_barrier
s_mov_b64 exec, s[56:57]
ds_read_b128 v[116:119], v3 offset:0
ds_read_b128 v[120:123], v3 offset:576
ds_read_b128 v[100:103], v3 offset:1152
ds_read_b128 v[104:107], v3 offset:1728
s_mov_b64 exec, -1
ds_read_b128 v[92:95], v4 offset:0
ds_read_b128 v[96:99], v4 offset:1152
v_smfmac_f32_16x16x64_bf16 v[112:115], v[28:31], a[200:207], v5
v_cndmask_b32 v51, 0, v11, s[54:55]
v_smfmac_f32_16x16x64_bf16 v[108:111], v[32:35], a[208:215], v5
v_mov_b32_e64 v53, 0
v_smfmac_f32_16x16x64_bf16 v[112:115], v[32:35], a[216:223], v5
v_mov_b32_e64 v54, 0
v_smfmac_f32_16x16x64_bf16 v[108:111], v[36:39], a[224:231], v5
v_mov_b64_e64 v[124:125], 0
v_smfmac_f32_16x16x64_bf16 v[112:115], v[36:39], a[232:239], v5
v_mov_b64_e64 v[126:127], 0
s_waitcnt lgkmcnt(5)
v_mfma_f32_16x16x32_bf16 v[44:47], v[60:63], v[116:119], v[44:47]
v_mfma_f32_16x16x32_bf16 v[48:51], v[76:79], v[116:119], v[48:51]
ds_read_b128 v[60:63], v0 offset:16384
s_waitcnt lgkmcnt(5)
v_mfma_f32_16x16x32_bf16 v[44:47], v[64:67], v[120:123], v[44:47]
ds_read_b128 v[76:79], v0 offset:20480
v_mfma_f32_16x16x32_bf16 v[48:51], v[80:83], v[120:123], v[48:51]
ds_read_b128 v[64:67], v0 offset:17408
s_waitcnt lgkmcnt(4)
v_smfmac_f32_16x16x64_bf16 v[124:127], v[92:95], v[116:123], v5
ds_read_b128 v[80:83], v0 offset:21504
v_mfma_f32_16x16x32_bf16 v[44:47], v[68:71], v[100:103], v[44:47]
v_mfma_f32_16x16x32_bf16 v[48:51], v[84:87], v[100:103], v[48:51]
ds_read_b128 v[68:71], v0 offset:18432
s_waitcnt lgkmcnt(5)
v_smfmac_f32_16x16x64_bf16 v[124:127], v[96:99], v[100:107], v5
ds_read_b128 v[84:87], v0 offset:22528
v_mfma_f32_16x16x32_bf16 v[44:47], v[72:75], v[104:107], v[44:47]
v_mfma_f32_16x16x32_bf16 v[48:51], v[88:91], v[104:107], v[48:51]
ds_read_b128 v[72:75], v0 offset:19456
ds_read_b128 v[88:91], v0 offset:23552
v_add_f32 v124, v124, v126
v_add_f32 v125, v125, v127
v_max3_f32 v10, v124, v125, v44
v_max3_f32 v10, v10, v45, v46
v_smfmac_f32_16x16x64_bf16 v[108:111], v[40:43], a[240:247], v5
s_nop 0
v_max3_f32 v10, v10, v47, v48
v_max3_f32 v10, v10, v49, v50
v_max_f32 v11, v10, v51
v_max_f32_e64 v10, v10, v51
v_smfmac_f32_16x16x64_bf16 v[112:115], v[40:43], a[248:255], v5
s_nop 0
v_permlane16_swap_b32 v10, v11
v_max_f32 v10, v10, v11
v_mov_b32 v11, v10
v_smfmac_f32_16x16x64_bf16 v[108:111], v[12:15], v[128:135], v5
s_nop 0
v_permlane32_swap_b32 v10, v11
v_max_f32 v10, v10, v11
v_mul_f32 v10, s38, v10
v_fma_f32 v124, v124, s38, -v10
v_fma_f32 v125, v125, s38, -v10
v_pk_fma_f32 v[44:45], v[44:45], s[38:39], v[10:11] op_sel_hi:[1,1,0] neg_lo:[0,0,1] neg_hi:[0,0,1]
v_pk_fma_f32 v[46:47], v[46:47], s[38:39], v[10:11] op_sel_hi:[1,1,0] neg_lo:[0,0,1] neg_hi:[0,0,1]
v_pk_fma_f32 v[48:49], v[48:49], s[38:39], v[10:11] op_sel_hi:[1,1,0] neg_lo:[0,0,1] neg_hi:[0,0,1]
v_pk_fma_f32 v[50:51], v[50:51], s[38:39], v[10:11] op_sel_hi:[1,1,0] neg_lo:[0,0,1] neg_hi:[0,0,1]
v_smfmac_f32_16x16x64_bf16 v[112:115], v[12:15], v[136:143], v5
buffer_load_dwordx4 v0, s[12:15], s32 offen offset:0 sc1 lds
v_exp_f32 v44, v44
v_smfmac_f32_16x16x64_bf16 v[108:111], v[16:19], v[144:151], v5
v_exp_f32 v45, v45
v_smfmac_f32_16x16x64_bf16 v[112:115], v[16:19], v[152:159], v5
buffer_load_dwordx4 v0, s[12:15], s32 offen offset:1024 sc1 lds
v_exp_f32 v46, v46
v_exp_f32 v47, v47
v_exp_f32 v48, v48
v_exp_f32 v49, v49
v_exp_f32 v50, v50
v_exp_f32 v51, v51
v_exp_f32 v124, v124
v_exp_f32 v125, v125
v_pk_add_f32 v[108:109], v[108:109], v[110:111]
v_pk_add_f32 v[10:11], v[44:45], v[46:47]
v_pk_add_f32 v[126:127], v[48:49], v[50:51]
v_pk_add_f32 v[10:11], v[10:11], v[124:125]
v_pk_add_f32 v[10:11], v[10:11], v[126:127]
v_pk_add_f32 v[112:113], v[112:113], v[114:115]
v_add_f32 v126, v10, v11
v_add_f32 v10, v10, v11
v_cvt_pk_bf16_f32 v108, v108, v109
v_cvt_pk_bf16_f32 v109, v112, v113
v_permlane16_swap_b32 v10, v126
v_add_f32 v11, v10, v126
v_add_f32 v10, v10, v126
ds_write_b64 v0, v[108:109] offset:30216
s_mov_b64 vcc, s[56:57]
v_permlane32_swap_b32 v10, v11
v_add_f32 v10, v10, v11
v_rcp_f32_e64 v10, v10
s_mov_b32 m0, 22528
v_pk_mul_f32 v[44:45], v[44:45], v[10:11] op_sel_hi:[1,0]
v_pk_mul_f32 v[46:47], v[46:47], v[10:11] op_sel_hi:[1,0]
v_pk_mul_f32 v[48:49], v[48:49], v[10:11] op_sel_hi:[1,0]
v_pk_mul_f32 v[50:51], v[50:51], v[10:11] op_sel_hi:[1,0]
v_pk_mul_f32 v[124:125], v[124:125], v[10:11] op_sel_hi:[1,0]
v_cvt_pk_bf16_f32 v56, v44, v45
v_cvt_pk_bf16_f32 v57, v46, v47
v_cvt_pk_bf16_f32 v58, v48, v49
v_cvt_pk_bf16_f32 v59, v50, v51
v_cvt_pk_bf16_f32 v52, v124, v125
v_cvt_pk_bf16_f32 v55, v124, v125
s_waitcnt lgkmcnt(8)
v_mfma_f32_16x16x32_bf16 v[92:95], v[60:63], v[56:59], 0
s_waitcnt lgkmcnt(0)
s_barrier
ds_read_b128 v[116:119], v0 offset:29184
ds_read_b128 v[120:123], v0 offset:30208
v_mfma_f32_16x16x32_bf16 v[96:99], v[64:67], v[56:59], 0
s_add_u32 s33, s22, 14336
s_cmp_eq_u32 s20, 63
v_mov_b64 v[12:13], 0
v_mov_b64 v[14:15], 0
v_mfma_f32_16x16x32_bf16 v[100:103], v[68:71], v[56:59], 0
v_mov_b64 v[16:17], 0
v_mov_b64 v[18:19], 0
v_mfma_f32_16x16x32_bf16 v[104:107], v[72:75], v[56:59], 0
v_mov_b64 v[20:21], 0
v_mov_b64 v[22:23], 0
v_mfma_f32_16x16x32_bf16 v[60:63], v[76:79], v[56:59], 0
v_mov_b64 v[24:25], 0
v_mov_b64 v[26:27], 0
s_waitcnt lgkmcnt(1)
v_mfma_f32_16x16x16_bf16 v[92:95], v[116:117], v[52:53], v[92:95]
v_mov_b64 v[28:29], 0
v_mov_b64 v[30:31], 0
v_mfma_f32_16x16x16_bf16 v[96:99], v[116:117], v[54:55], v[96:99]
v_mov_b64 v[32:33], 0
v_mov_b64 v[34:35], 0
v_mfma_f32_16x16x16_bf16 v[100:103], v[118:119], v[52:53], v[100:103]
v_cvt_pk_bf16_f32 v108, v92, v93
v_cvt_pk_bf16_f32 v109, v94, v95
v_mfma_f32_16x16x16_bf16 v[104:107], v[118:119], v[54:55], v[104:107]
v_cvt_pk_bf16_f32 v110, v96, v97
v_cvt_pk_bf16_f32 v111, v98, v99
v_mfma_f32_16x16x32_bf16 v[64:67], v[80:83], v[56:59], 0
v_cvt_pk_bf16_f32 v112, v100, v101
v_cvt_pk_bf16_f32 v113, v102, v103
s_waitcnt lgkmcnt(0)
v_mfma_f32_16x16x16_bf16 v[60:63], v[120:121], v[52:53], v[60:63]
buffer_load_dwordx4 v0, s[12:15], s33 offen offset:0 sc1 lds
v_cvt_pk_bf16_f32 v114, v104, v105
v_cvt_pk_bf16_f32 v115, v106, v107
v_mfma_f32_16x16x32_bf16 v[68:71], v[84:87], v[56:59], 0
v_cndmask_b32_dpp v100, v109, v108, vcc quad_perm:[0,1,0,1] row_mask:0xf bank_mask:0xf
v_cndmask_b32_dpp v101, v111, v110, vcc quad_perm:[0,1,0,1] row_mask:0xf bank_mask:0xf
v_mfma_f32_16x16x16_bf16 v[64:67], v[120:121], v[54:55], v[64:67]
v_cndmask_b32_dpp v102, v113, v112, vcc quad_perm:[0,1,0,1] row_mask:0xf bank_mask:0xf
v_cndmask_b32_dpp v103, v115, v114, vcc quad_perm:[0,1,0,1] row_mask:0xf bank_mask:0xf
v_mfma_f32_16x16x32_bf16 v[72:75], v[88:91], v[56:59], 0
v_cvt_pk_bf16_f32 v116, v60, v61
v_cvt_pk_bf16_f32 v117, v62, v63
v_mfma_f32_16x16x16_bf16 v[68:71], v[122:123], v[52:53], v[68:71]
buffer_load_dwordx4 v0, s[12:15], s33 offen offset:1024 sc1 lds
v_cvt_pk_bf16_f32 v118, v64, v65
v_cvt_pk_bf16_f32 v119, v66, v67
v_mfma_f32_16x16x16_bf16 v[72:75], v[122:123], v[54:55], v[72:75]
s_cbranch_scc1 CLAST_89
v_cndmask_b32_dpp v104, v117, v116, vcc quad_perm:[0,1,0,1] row_mask:0xf bank_mask:0xf
v_cndmask_b32_dpp v105, v119, v118, vcc quad_perm:[0,1,0,1] row_mask:0xf bank_mask:0xf
v_smfmac_f32_16x16x64_bf16 v[12:15], v[100:103], v[160:167], v5
ds_read_b128 v[44:47], v1 offset:24576
ds_read_b128 v[48:51], v1 offset:25600
s_and_b32 s32, s20, 1
v_cvt_pk_bf16_f32 v120, v68, v69
v_smfmac_f32_16x16x64_bf16 v[16:19], v[100:103], v[168:175], v5
ds_read_b128 v[92:95], v1 offset:26624
s_lshl_b32 s32, s32, 18
v_cvt_pk_bf16_f32 v121, v70, v71
v_cvt_pk_bf16_f32 v122, v72, v73
v_smfmac_f32_16x16x64_bf16 v[20:23], v[100:103], v[176:183], v5
ds_read_b128 v[96:99], v1 offset:27648
s_add_u32 s25, s34, s32
v_cvt_pk_bf16_f32 v123, v74, v75
v_smfmac_f32_16x16x64_bf16 v[24:27], v[100:103], v[184:191], v5
v_cndmask_b32_dpp v106, v121, v120, vcc quad_perm:[0,1,0,1] row_mask:0xf bank_mask:0xf
v_cndmask_b32_dpp v107, v123, v122, vcc quad_perm:[0,1,0,1] row_mask:0xf bank_mask:0xf
s_add_u32 s26, s25, 32768
s_bfe_u32 s69, s20, 0x10001
v_smfmac_f32_16x16x64_bf16 v[12:15], v[104:107], v[224:231], v5
ds_read_b128 v[76:79], v1 offset:28672
v_mov_b64 v[36:37], 0
v_mov_b64 v[40:41], 0
v_smfmac_f32_16x16x64_bf16 v[16:19], v[104:107], v[232:239], v5
ds_read_b128 v[80:83], v1 offset:29696
v_mov_b64 v[38:39], 0
v_mov_b64 v[42:43], 0
v_smfmac_f32_16x16x64_bf16 v[20:23], v[104:107], v[240:247], v5
ds_read_b128 v[84:87], v1 offset:30720
v_add_f32_e64 v12, v12, v14
v_smfmac_f32_16x16x64_bf16 v[24:27], v[104:107], v[248:255], v5
ds_read_b128 v[88:91], v1 offset:31744
v_add_f32_e64 v13, v13, v15
v_smfmac_f32_16x16x64_bf16 v[28:31], v[100:103], v[192:199], v5
v_add_f32 v16, v16, v18
v_add_f32 v17, v17, v19
v_smfmac_f32_16x16x64_bf16 v[32:35], v[100:103], v[200:207], v5
v_add_f32 v20, v20, v22
v_add_f32 v21, v21, v23
v_smfmac_f32_16x16x64_bf16 v[36:39], v[100:103], v[208:215], v5
v_add_f32_e64 v24, v24, v26
v_add_f32 v25, v25, v27
v_smfmac_f32_16x16x64_bf16 v[40:43], v[100:103], v[216:223], v5
v_cvt_pk_bf16_f32 v52, v12, v16
v_cvt_pk_bf16_f32 v53, v20, v24
s_waitcnt lgkmcnt(6)
v_smfmac_f32_16x16x64_bf16 v[28:31], v[104:107], v[44:51], v5
v_cvt_pk_bf16_f32 v54, v13, v17
v_cvt_pk_bf16_f32 v55, v21, v25
s_waitcnt lgkmcnt(4)
v_smfmac_f32_16x16x64_bf16 v[32:35], v[104:107], v[92:99], v5
v_and_or_b32 v52, v52, -2, s69
s_waitcnt lgkmcnt(2)
v_smfmac_f32_16x16x64_bf16 v[36:39], v[104:107], v[76:83], v5
buffer_store_dwordx4 v[52:55], v6, s[12:15], s25 offen
v_add_f32 v28, v28, v30
s_waitcnt lgkmcnt(0)
v_smfmac_f32_16x16x64_bf16 v[40:43], v[104:107], v[84:91], v5
v_add_f32 v29, v29, v31
v_add_f32 v32, v32, v34
v_add_f32_e64 v33, v33, v35
v_cvt_pk_bf16_f32 v56, v28, v32
v_add_f32 v36, v36, v38
v_add_f32 v37, v37, v39
v_cvt_pk_bf16_f32 v58, v29, v33
v_and_or_b32 v56, v56, -2, s69
v_pk_add_f32 v[40:41], v[40:41], v[42:43]
v_cvt_pk_bf16_f32 v57, v36, v40
v_cvt_pk_bf16_f32 v59, v37, v41
buffer_store_dwordx4 v[56:59], v6, s[12:15], s26 offen
s_lshl_b32 s32, s16, 13
s_add_u32 s25, s25, s32
s_add_u32 s25, s25, 6144
v_and_b32 v10, 16, v0
v_mov_b32 v11, 0x3f80
v_lshlrev_b32 v10, v10, v11
v_cndmask_b32 v124, 0, v10, s[60:61]
v_cndmask_b32 v125, 0, v10, s[62:63]
v_cndmask_b32 v126, 0, v10, s[64:65]
v_cndmask_b32 v127, 0, v10, s[66:67]
v_mov_b64 v[32:33], -1
v_bfe_u32 v10, v0, 4, 1
v_lshrrev_b32 v11, 8, v0
v_lshl_add_u32 v10, v11, 1, v10
v_and_b32_e64 v11, 32, v0
v_lshl_add_u32 v35, v10, 3, v11
s_and_b32 s32, s20, 3
s_lshl_b32 s32, s32, 13
s_add_u32 s27, s35, s32
s_add_u32 s29, s27, 6144
s_xor_b32 s32, s32, 16384
s_add_u32 s28, s35, s32
s_lshl_b32 s32, s16, 8
s_add_u32 s27, s27, s32
s_add_u32 s28, s28, s32
s_mov_b32 s68, s23
s_mov_b32 m0, 6144
s_mov_b32 s30, 0
s_mov_b64 vcc, s[58:59]
v_cndmask_b32_dpp v108, v116, v108, vcc quad_perm:[2,3,2,3] row_mask:0xf bank_mask:0xf
v_cndmask_b32_dpp v109, v117, v109, vcc quad_perm:[2,3,2,3] row_mask:0xf bank_mask:0xf
v_cndmask_b32_dpp v110, v118, v110, vcc quad_perm:[2,3,2,3] row_mask:0xf bank_mask:0xf
v_cndmask_b32_dpp v111, v119, v111, vcc quad_perm:[2,3,2,3] row_mask:0xf bank_mask:0xf
v_cndmask_b32_dpp v112, v120, v112, vcc quad_perm:[2,3,2,3] row_mask:0xf bank_mask:0xf
v_cndmask_b32_dpp v113, v121, v113, vcc quad_perm:[2,3,2,3] row_mask:0xf bank_mask:0xf
v_cndmask_b32_dpp v114, v122, v114, vcc quad_perm:[2,3,2,3] row_mask:0xf bank_mask:0xf
v_cndmask_b32_dpp v115, v123, v115, vcc quad_perm:[2,3,2,3] row_mask:0xf bank_mask:0xf
v_min_u32 v108, -2, v108
v_min_u32 v112, -2, v112
ds_read_b128 v[60:63], v1 offset:0
ds_read_b128 v[64:67], v1 offset:1024
ds_read_b128 v[68:71], v1 offset:2048
ds_read_b128 v[72:75], v1 offset:3072
ds_read_b128 v[76:79], v1 offset:4096
ds_read_b128 v[80:83], v1 offset:5120
ds_read_b128 v[84:87], v1 offset:6144
ds_read_b128 v[88:91], v1 offset:7168
ds_read_b128 v[92:95], v1 offset:8192
ds_read_b128 v[96:99], v1 offset:9216
ds_read_b128 v[100:103], v1 offset:10240
ds_read_b128 v[104:107], v1 offset:11264
v_mov_b64 v[44:45], 0
v_mov_b64 v[46:47], 0
v_mov_b64 v[48:49], 0
v_mov_b64 v[50:51], 0
buffer_load_dwordx4 v[20:23], v0, s[12:15], s25 offen offset:0 sc1
buffer_load_dwordx4 v[24:27], v0, s[12:15], s25 offen offset:1024 sc1
v_mov_b64 v[52:53], 0
v_mov_b64 v[54:55], 0
v_mov_b64_e64 v[56:57], 0
v_mov_b64 v[58:59], 0
RT_92:
s_waitcnt vmcnt(1)
v_mfma_f32_16x16x32_bf16 v[28:31], v[124:127], v[20:23], 0
v_xor_b32 v10, s69, v20
s_waitcnt vmcnt(0)
v_bitop3_b32 v10, v10, v24, s69 bitop3:0xf6
v_and_b32 v10, 1, v10
v_cmp_ne_u32_e64 vcc, 0, v10
v_mfma_f32_16x16x32_bf16 v[28:31], v[124:127], v[24:27], v[28:31]
s_cbranch_vccz RG_94
s_mov_b64 exec, vcc
buffer_load_dwordx4 v[20:23], v0, s[12:15], s25 offen offset:0 sc1
buffer_load_dwordx4 v[24:27], v0, s[12:15], s25 offen offset:1024 sc1
s_mov_b64 exec, -1
s_add_u32 s30, s30, 1
s_cmp_gt_u32 s30, 2097152
s_cbranch_scc1 FAIL
s_branch RT_92
RG_94:
s_nop 6
v_add_f32_dpp v28, v28, v28 row_ror:4 row_mask:0xf bank_mask:0xf
v_add_f32_dpp v29, v29, v29 row_ror:4 row_mask:0xf bank_mask:0xf
v_add_f32_dpp v30, v30, v30 row_ror:4 row_mask:0xf bank_mask:0xf
v_add_f32_dpp v31, v31, v31 row_ror:4 row_mask:0xf bank_mask:0xf
v_add_f32_dpp v28, v28, v28 row_ror:8 row_mask:0xf bank_mask:0xf
v_add_f32_dpp v29, v29, v29 row_ror:8 row_mask:0xf bank_mask:0xf
v_add_f32_dpp v30, v30, v30 row_ror:8 row_mask:0xf bank_mask:0xf
v_add_f32_dpp v31, v31, v31 row_ror:8 row_mask:0xf bank_mask:0xf
v_cvt_pk_bf16_f32 v10, v28, v29
v_cvt_pk_bf16_f32 v11, v30, v31
v_min_u32_e64 v10, -2, v10
s_mov_b64 exec, 0xf000f
buffer_store_dwordx2 v[10:11], v35, s[12:15], s27 offen offset:192
buffer_store_dwordx2 v[32:33], v35, s[12:15], s28 offen offset:192
s_mov_b64 exec, -1
s_add_u32 s20, s20, 1
s_mov_b32 s21, s22
s_add_u32 s23, s23, 8192
s_add_u32 s36, s21, 22528
s_add_u32 s22, s21, 24576
s_add_u32 s37, s22, 16384
buffer_load_dwordx4 v[116:119], v0, s[12:15], s36 offen offset:0 sc1
buffer_load_dwordx4 v[120:123], v0, s[12:15], s36 offen offset:1024 sc1
s_waitcnt vmcnt(0)
buffer_load_dwordx4 v[12:15], v0, s[12:15], s29 offen offset:0 sc1
buffer_load_dwordx4 v[16:19], v0, s[12:15], s29 offen offset:1024 sc1
s_branch H2_95
ROK_93:
s_mov_b64 exec, vcc
buffer_load_dwordx4 v[20:23], v0, s[12:15], s25 offen offset:0 sc1
buffer_load_dwordx4 v[24:27], v0, s[12:15], s25 offen offset:1024 sc1
s_mov_b64 exec, -1
s_add_u32 s30, s30, 1
s_cmp_gt_u32 s30, 2097152
s_cbranch_scc1 FAIL
s_branch RT_92
MRE_97:
s_mov_b64 exec, vcc
buffer_load_dwordx4 v[12:15], v0, s[12:15], s29 offen offset:0 sc1
buffer_load_dwordx4 v[16:19], v0, s[12:15], s29 offen offset:1024 sc1
s_mov_b64 exec, -1
s_add_u32 s30, s30, 1
s_cmp_gt_u32 s30, 2097152
s_cbranch_scc1 FAIL
s_branch MT_96
CLAST_89:
s_nop 2
v_cvt_pk_bf16_f32 v120, v68, v69
v_cvt_pk_bf16_f32 v121, v70, v71
s_nop 1
v_cvt_pk_bf16_f32 v122, v72, v73
v_cvt_pk_bf16_f32 v123, v74, v75
s_mov_b64 vcc, s[58:59]
v_cndmask_b32_dpp v108, v116, v108, vcc quad_perm:[2,3,2,3] row_mask:0xf bank_mask:0xf
v_cndmask_b32_dpp v109, v117, v109, vcc quad_perm:[2,3,2,3] row_mask:0xf bank_mask:0xf
v_cndmask_b32_dpp v110, v118, v110, vcc quad_perm:[2,3,2,3] row_mask:0xf bank_mask:0xf
v_cndmask_b32_dpp v111, v119, v111, vcc quad_perm:[2,3,2,3] row_mask:0xf bank_mask:0xf
v_cndmask_b32_dpp v112, v120, v112, vcc quad_perm:[2,3,2,3] row_mask:0xf bank_mask:0xf
v_cndmask_b32_dpp v113, v121, v113, vcc quad_perm:[2,3,2,3] row_mask:0xf bank_mask:0xf
v_cndmask_b32_dpp v114, v122, v114, vcc quad_perm:[2,3,2,3] row_mask:0xf bank_mask:0xf
v_cndmask_b32_dpp v115, v123, v115, vcc quad_perm:[2,3,2,3] row_mask:0xf bank_mask:0xf
v_min_u32 v108, -2, v108
v_min_u32_e64 v112, -2, v112
buffer_store_dwordx4 v[108:111], v0, s[12:15], s23 offen offset:0 sc1
buffer_store_dwordx4 v[112:115], v0, s[12:15], s23 offen offset:1024 sc1
s_branch FIN
CS3:
s_add_u32 s36, s21, 22528
s_add_u32 s22, s21, 24576
s_add_u32 s37, s22, 16384
v_lshlrev_b32 v7, 3, v0
s_branch CL_98
H2_105:
MT_106:
s_waitcnt vmcnt(1)
v_max_u32_e64 v10, v12, v14
s_waitcnt vmcnt(0)
v_max3_u32 v10, v10, v16, v18
v_cmp_eq_u32_e64 vcc, -1, v10
ds_write_b128 v0, v[12:15] offset:6144
ds_write_b128 v0, v[16:19] offset:7168
s_cbranch_vccnz MRE_107
CL_98:
s_waitcnt lgkmcnt(12)
v_smfmac_f32_16x16x64_bf16 v[44:47], v[12:15], v[60:67], v5
s_waitcnt lgkmcnt(10)
v_smfmac_f32_16x16x64_bf16 v[48:51], v[12:15], v[68:75], v5
s_waitcnt lgkmcnt(8)
v_smfmac_f32_16x16x64_bf16 v[52:55], v[12:15], v[76:83], v5
s_waitcnt lgkmcnt(0)
s_barrier
ds_read_b128 v[20:23], v0 offset:0
ds_read_b128 v[24:27], v0 offset:1024
v_smfmac_f32_16x16x64_bf16 v[56:59], v[12:15], v[84:91], v5
buffer_load_dword v8, v7, s[12:15], s37 offen sc1
ds_read_b128 v[28:31], v0 offset:2048
ds_read_b128 v[32:35], v0 offset:3072
v_smfmac_f32_16x16x64_bf16 v[44:47], v[16:19], v[92:99], v5
ds_read_b128 v[36:39], v0 offset:4096
ds_read_b128 v[40:43], v0 offset:5120
v_smfmac_f32_16x16x64_bf16 v[48:51], v[16:19], v[100:107], v5
v_smfmac_f32_16x16x64_bf16 v[52:55], v[16:19], a[0:7], v5
ds_read_b128 v[92:95], v1 offset:20480
v_smfmac_f32_16x16x64_bf16 v[56:59], v[16:19], a[8:15], v5
buffer_store_dwordx4 v[108:111], v0, s[12:15], s68 offen offset:0 sc1
ds_read_b128 v[96:99], v1 offset:21504
s_waitcnt lgkmcnt(7)
v_smfmac_f32_16x16x64_bf16 v[44:47], v[20:23], a[16:23], v5
ds_read_b128 v[100:103], v1 offset:22528
v_smfmac_f32_16x16x64_bf16 v[48:51], v[20:23], a[24:31], v5
ds_read_b128 v[104:107], v1 offset:23552
v_smfmac_f32_16x16x64_bf16 v[52:55], v[20:23], a[32:39], v5
ds_read_b128 v[60:63], v1 offset:12288
v_smfmac_f32_16x16x64_bf16 v[56:59], v[20:23], a[40:47], v5
buffer_store_dwordx4 v[112:115], v0, s[12:15], s68 offen offset:1024 sc1
ds_read_b128 v[64:67], v1 offset:13312
s_waitcnt lgkmcnt(10)
v_smfmac_f32_16x16x64_bf16 v[44:47], v[24:27], a[48:55], v5
ds_read_b128 v[68:71], v1 offset:14336
v_smfmac_f32_16x16x64_bf16 v[48:51], v[24:27], a[56:63], v5
ds_read_b128 v[72:75], v1 offset:15360
v_mov_b64_e64 v[108:109], 0
v_smfmac_f32_16x16x64_bf16 v[52:55], v[24:27], a[64:71], v5
ds_read_b128 v[76:79], v1 offset:16384
v_mov_b64_e64 v[110:111], 0
v_smfmac_f32_16x16x64_bf16 v[56:59], v[24:27], a[72:79], v5
ds_read_b128 v[80:83], v1 offset:17408
v_mov_b64 v[112:113], 0
s_waitcnt lgkmcnt(8)
v_smfmac_f32_16x16x64_bf16 v[44:47], v[28:31], v[92:99], v5
ds_read_b128 v[84:87], v1 offset:18432
v_mov_b64 v[114:115], 0
s_waitcnt lgkmcnt(7)
v_smfmac_f32_16x16x64_bf16 v[48:51], v[28:31], v[100:107], v5
ds_read_b128 v[88:91], v1 offset:19456
v_smfmac_f32_16x16x64_bf16 v[52:55], v[28:31], a[80:87], v5
v_mov_b32_dpp v100, v116 quad_perm:[0,1,0,1] row_mask:0xf bank_mask:0xf
v_smfmac_f32_16x16x64_bf16 v[56:59], v[28:31], a[88:95], v5
v_mov_b32_dpp v101, v117 quad_perm:[0,1,0,1] row_mask:0xf bank_mask:0xf
s_waitcnt lgkmcnt(6)
v_smfmac_f32_16x16x64_bf16 v[44:47], v[32:35], v[60:67], v5
v_mov_b32_dpp v102, v118 quad_perm:[0,1,0,1] row_mask:0xf bank_mask:0xf
s_waitcnt lgkmcnt(4)
v_smfmac_f32_16x16x64_bf16 v[48:51], v[32:35], v[68:75], v5
ds_read_b128 v[60:63], v0 offset:8192
v_mov_b32_dpp v103, v119 quad_perm:[0,1,0,1] row_mask:0xf bank_mask:0xf
s_waitcnt lgkmcnt(3)
v_smfmac_f32_16x16x64_bf16 v[52:55], v[32:35], v[76:83], v5
ds_read_b128 v[64:67], v0 offset:9216
v_mov_b32_dpp v104, v120 quad_perm:[0,1,0,1] row_mask:0xf bank_mask:0xf
s_waitcnt lgkmcnt(2)
v_smfmac_f32_16x16x64_bf16 v[56:59], v[32:35], v[84:91], v5
ds_read_b128 v[68:71], v0 offset:10240
v_mov_b32_dpp v105, v121 quad_perm:[0,1,0,1] row_mask:0xf bank_mask:0xf
v_smfmac_f32_16x16x64_bf16 v[44:47], v[36:39], a[96:103], v5
ds_read_b128 v[72:75], v0 offset:11264
v_mov_b32_dpp v106, v122 quad_perm:[0,1,0,1] row_mask:0xf bank_mask:0xf
v_smfmac_f32_16x16x64_bf16 v[44:47], v[40:43], a[128:135], v5
ds_read_b128 v[76:79], v0 offset:12288
v_mov_b32_dpp v107, v123 quad_perm:[0,1,0,1] row_mask:0xf bank_mask:0xf
v_smfmac_f32_16x16x64_bf16 v[48:51], v[36:39], a[104:111], v5
ds_read_b128 v[80:83], v0 offset:13312
v_mov_b32 v11, 0xf149f2ca
v_smfmac_f32_16x16x64_bf16 v[48:51], v[40:43], a[136:143], v5
ds_read_b128 v[84:87], v0 offset:14336
v_add_f32_e64 v44, v44, v46
v_smfmac_f32_16x16x64_bf16 v[52:55], v[36:39], a[112:119], v5
ds_read_b128 v[88:91], v0 offset:15360
v_add_f32 v45, v45, v47
v_smfmac_f32_16x16x64_bf16 v[52:55], v[40:43], a[144:151], v5
v_add_f32 v48, v48, v50
v_smfmac_f32_16x16x64_bf16 v[56:59], v[36:39], a[120:127], v5
v_add_f32_e64 v49, v49, v51
v_smfmac_f32_16x16x64_bf16 v[56:59], v[40:43], a[152:159], v5
v_add_f32 v52, v52, v54
v_add_f32 v53, v53, v55
v_cvt_pk_bf16_f32 v124, v44, v48
v_cvt_pk_bf16_f32 v126, v45, v49
v_cndmask_b32 v44, 0, v11, s[40:41]
v_cndmask_b32 v45, 0, v11, s[42:43]
s_nop 1
v_add_f32 v56, v56, v58
v_add_f32_e64 v57, v57, v59
v_cvt_pk_bf16_f32 v125, v52, v56
v_cvt_pk_bf16_f32 v127, v53, v57
ds_write2_b32 v2, v124, v125 offset0:0 offset1:36
ds_write2_b32 v2, v126, v127 offset0:4 offset1:40
v_smfmac_f32_16x16x64_bf16 v[108:111], v[20:23], a[160:167], v5
s_mov_b32 m0, 14336
s_add_u32 s32, s22, 6144
v_cndmask_b32 v46, 0, v11, s[44:45]
v_smfmac_f32_16x16x64_bf16 v[112:115], v[20:23], a[168:175], v5
v_cndmask_b32 v47, 0, v11, s[46:47]
v_smfmac_f32_16x16x64_bf16 v[108:111], v[24:27], a[176:183], v5
v_cndmask_b32 v48, 0, v11, s[48:49]
v_smfmac_f32_16x16x64_bf16 v[112:115], v[24:27], a[184:191], v5
v_cndmask_b32 v49, 0, v11, s[50:51]
v_smfmac_f32_16x16x64_bf16 v[108:111], v[28:31], a[192:199], v5
v_cndmask_b32 v50, 0, v11, s[52:53]
s_waitcnt lgkmcnt(0)
s_barrier
s_mov_b64 exec, s[56:57]
ds_read_b128 v[116:119], v3 offset:0
ds_read_b128 v[120:123], v3 offset:576
ds_read_b128 v[100:103], v3 offset:1152
ds_read_b128 v[104:107], v3 offset:1728
s_mov_b64 exec, -1
ds_read_b128 v[92:95], v4 offset:0
ds_read_b128 v[96:99], v4 offset:1152
v_smfmac_f32_16x16x64_bf16 v[112:115], v[28:31], a[200:207], v5
v_cndmask_b32 v51, 0, v11, s[54:55]
v_smfmac_f32_16x16x64_bf16 v[108:111], v[32:35], a[208:215], v5
v_mov_b32_e64 v53, 0
v_smfmac_f32_16x16x64_bf16 v[112:115], v[32:35], a[216:223], v5
v_mov_b32_e64 v54, 0
v_smfmac_f32_16x16x64_bf16 v[108:111], v[36:39], a[224:231], v5
v_mov_b64_e64 v[124:125], 0
v_smfmac_f32_16x16x64_bf16 v[112:115], v[36:39], a[232:239], v5
v_mov_b64_e64 v[126:127], 0
s_waitcnt lgkmcnt(5)
v_mfma_f32_16x16x32_bf16 v[44:47], v[60:63], v[116:119], v[44:47]
v_mfma_f32_16x16x32_bf16 v[48:51], v[76:79], v[116:119], v[48:51]
ds_read_b128 v[60:63], v0 offset:16384
s_waitcnt lgkmcnt(5)
v_mfma_f32_16x16x32_bf16 v[44:47], v[64:67], v[120:123], v[44:47]
ds_read_b128 v[76:79], v0 offset:20480
v_mfma_f32_16x16x32_bf16 v[48:51], v[80:83], v[120:123], v[48:51]
ds_read_b128 v[64:67], v0 offset:17408
s_waitcnt lgkmcnt(4)
v_smfmac_f32_16x16x64_bf16 v[124:127], v[92:95], v[116:123], v5
ds_read_b128 v[80:83], v0 offset:21504
v_mfma_f32_16x16x32_bf16 v[44:47], v[68:71], v[100:103], v[44:47]
v_mfma_f32_16x16x32_bf16 v[48:51], v[84:87], v[100:103], v[48:51]
ds_read_b128 v[68:71], v0 offset:18432
s_waitcnt lgkmcnt(5)
v_smfmac_f32_16x16x64_bf16 v[124:127], v[96:99], v[100:107], v5
ds_read_b128 v[84:87], v0 offset:22528
v_mfma_f32_16x16x32_bf16 v[44:47], v[72:75], v[104:107], v[44:47]
v_mfma_f32_16x16x32_bf16 v[48:51], v[88:91], v[104:107], v[48:51]
ds_read_b128 v[72:75], v0 offset:19456
ds_read_b128 v[88:91], v0 offset:23552
v_add_f32 v124, v124, v126
v_add_f32 v125, v125, v127
v_max3_f32 v10, v124, v125, v44
v_max3_f32 v10, v10, v45, v46
v_smfmac_f32_16x16x64_bf16 v[108:111], v[40:43], a[240:247], v5
s_nop 0
v_max3_f32 v10, v10, v47, v48
v_max3_f32 v10, v10, v49, v50
v_max_f32 v11, v10, v51
v_max_f32_e64 v10, v10, v51
v_smfmac_f32_16x16x64_bf16 v[112:115], v[40:43], a[248:255], v5
s_nop 0
v_permlane16_swap_b32 v10, v11
v_max_f32 v10, v10, v11
v_mov_b32 v11, v10
v_smfmac_f32_16x16x64_bf16 v[108:111], v[12:15], v[128:135], v5
s_nop 0
v_permlane32_swap_b32 v10, v11
v_max_f32 v10, v10, v11
v_mul_f32 v10, s38, v10
v_fma_f32 v124, v124, s38, -v10
v_fma_f32 v125, v125, s38, -v10
v_pk_fma_f32 v[44:45], v[44:45], s[38:39], v[10:11] op_sel_hi:[1,1,0] neg_lo:[0,0,1] neg_hi:[0,0,1]
v_pk_fma_f32 v[46:47], v[46:47], s[38:39], v[10:11] op_sel_hi:[1,1,0] neg_lo:[0,0,1] neg_hi:[0,0,1]
v_pk_fma_f32 v[48:49], v[48:49], s[38:39], v[10:11] op_sel_hi:[1,1,0] neg_lo:[0,0,1] neg_hi:[0,0,1]
v_pk_fma_f32 v[50:51], v[50:51], s[38:39], v[10:11] op_sel_hi:[1,1,0] neg_lo:[0,0,1] neg_hi:[0,0,1]
v_smfmac_f32_16x16x64_bf16 v[112:115], v[12:15], v[136:143], v5
buffer_load_dwordx4 v0, s[12:15], s32 offen offset:0 sc1 lds
v_exp_f32 v44, v44
v_smfmac_f32_16x16x64_bf16 v[108:111], v[16:19], v[144:151], v5
v_exp_f32 v45, v45
v_smfmac_f32_16x16x64_bf16 v[112:115], v[16:19], v[152:159], v5
buffer_load_dwordx4 v0, s[12:15], s32 offen offset:1024 sc1 lds
v_exp_f32 v46, v46
v_exp_f32 v47, v47
v_exp_f32 v48, v48
v_exp_f32 v49, v49
v_exp_f32 v50, v50
v_exp_f32 v51, v51
v_exp_f32 v124, v124
v_exp_f32 v125, v125
v_pk_add_f32 v[108:109], v[108:109], v[110:111]
v_pk_add_f32 v[10:11], v[44:45], v[46:47]
v_pk_add_f32 v[126:127], v[48:49], v[50:51]
v_pk_add_f32 v[10:11], v[10:11], v[124:125]
v_pk_add_f32 v[10:11], v[10:11], v[126:127]
v_pk_add_f32 v[112:113], v[112:113], v[114:115]
v_add_f32 v126, v10, v11
v_add_f32 v10, v10, v11
v_cvt_pk_bf16_f32 v108, v108, v109
v_cvt_pk_bf16_f32 v109, v112, v113
v_permlane16_swap_b32 v10, v126
v_add_f32 v11, v10, v126
v_add_f32 v10, v10, v126
ds_write_b64 v0, v[108:109] offset:30216
s_mov_b64 vcc, s[56:57]
v_permlane32_swap_b32 v10, v11
v_add_f32 v10, v10, v11
v_rcp_f32_e64 v10, v10
s_mov_b32 m0, 22528
v_pk_mul_f32 v[44:45], v[44:45], v[10:11] op_sel_hi:[1,0]
v_pk_mul_f32 v[46:47], v[46:47], v[10:11] op_sel_hi:[1,0]
v_pk_mul_f32 v[48:49], v[48:49], v[10:11] op_sel_hi:[1,0]
v_pk_mul_f32 v[50:51], v[50:51], v[10:11] op_sel_hi:[1,0]
v_pk_mul_f32 v[124:125], v[124:125], v[10:11] op_sel_hi:[1,0]
v_cvt_pk_bf16_f32 v56, v44, v45
v_cvt_pk_bf16_f32 v57, v46, v47
v_cvt_pk_bf16_f32 v58, v48, v49
v_cvt_pk_bf16_f32 v59, v50, v51
v_cvt_pk_bf16_f32 v52, v124, v125
v_cvt_pk_bf16_f32 v55, v124, v125
s_waitcnt lgkmcnt(8)
v_mfma_f32_16x16x32_bf16 v[92:95], v[60:63], v[56:59], 0
s_waitcnt lgkmcnt(0)
s_barrier
ds_read_b128 v[116:119], v0 offset:29184
ds_read_b128 v[120:123], v0 offset:30208
v_mfma_f32_16x16x32_bf16 v[96:99], v[64:67], v[56:59], 0
s_add_u32 s33, s22, 14336
s_cmp_eq_u32 s20, 63
v_mov_b64 v[12:13], 0
v_mov_b64 v[14:15], 0
v_mfma_f32_16x16x32_bf16 v[100:103], v[68:71], v[56:59], 0
v_mov_b64 v[16:17], 0
v_mov_b64 v[18:19], 0
v_mfma_f32_16x16x32_bf16 v[104:107], v[72:75], v[56:59], 0
v_mov_b64 v[20:21], 0
v_mov_b64 v[22:23], 0
v_mfma_f32_16x16x32_bf16 v[60:63], v[76:79], v[56:59], 0
v_mov_b64 v[24:25], 0
v_mov_b64 v[26:27], 0
s_waitcnt lgkmcnt(1)
v_mfma_f32_16x16x16_bf16 v[92:95], v[116:117], v[52:53], v[92:95]
v_mov_b64 v[28:29], 0
v_mov_b64 v[30:31], 0
v_mfma_f32_16x16x16_bf16 v[96:99], v[116:117], v[54:55], v[96:99]
v_mov_b64 v[32:33], 0
v_mov_b64 v[34:35], 0
v_mfma_f32_16x16x16_bf16 v[100:103], v[118:119], v[52:53], v[100:103]
v_cvt_pk_bf16_f32 v108, v92, v93
v_cvt_pk_bf16_f32 v109, v94, v95
v_mfma_f32_16x16x16_bf16 v[104:107], v[118:119], v[54:55], v[104:107]
v_cvt_pk_bf16_f32 v110, v96, v97
v_cvt_pk_bf16_f32 v111, v98, v99
v_mfma_f32_16x16x32_bf16 v[64:67], v[80:83], v[56:59], 0
v_cvt_pk_bf16_f32 v112, v100, v101
v_cvt_pk_bf16_f32 v113, v102, v103
s_waitcnt lgkmcnt(0)
v_mfma_f32_16x16x16_bf16 v[60:63], v[120:121], v[52:53], v[60:63]
buffer_load_dwordx4 v0, s[12:15], s33 offen offset:0 sc1 lds
v_cvt_pk_bf16_f32 v114, v104, v105
v_cvt_pk_bf16_f32 v115, v106, v107
v_mfma_f32_16x16x32_bf16 v[68:71], v[84:87], v[56:59], 0
v_cndmask_b32_dpp v100, v109, v108, vcc quad_perm:[0,1,0,1] row_mask:0xf bank_mask:0xf
v_cndmask_b32_dpp v101, v111, v110, vcc quad_perm:[0,1,0,1] row_mask:0xf bank_mask:0xf
v_mfma_f32_16x16x16_bf16 v[64:67], v[120:121], v[54:55], v[64:67]
v_cndmask_b32_dpp v102, v113, v112, vcc quad_perm:[0,1,0,1] row_mask:0xf bank_mask:0xf
v_cndmask_b32_dpp v103, v115, v114, vcc quad_perm:[0,1,0,1] row_mask:0xf bank_mask:0xf
v_mfma_f32_16x16x32_bf16 v[72:75], v[88:91], v[56:59], 0
v_cvt_pk_bf16_f32 v116, v60, v61
v_cvt_pk_bf16_f32 v117, v62, v63
v_mfma_f32_16x16x16_bf16 v[68:71], v[122:123], v[52:53], v[68:71]
buffer_load_dwordx4 v0, s[12:15], s33 offen offset:1024 sc1 lds
v_cvt_pk_bf16_f32 v118, v64, v65
v_cvt_pk_bf16_f32 v119, v66, v67
v_mfma_f32_16x16x16_bf16 v[72:75], v[122:123], v[54:55], v[72:75]
s_cbranch_scc1 CLAST_99
v_cndmask_b32_dpp v104, v117, v116, vcc quad_perm:[0,1,0,1] row_mask:0xf bank_mask:0xf
v_cndmask_b32_dpp v105, v119, v118, vcc quad_perm:[0,1,0,1] row_mask:0xf bank_mask:0xf
v_smfmac_f32_16x16x64_bf16 v[12:15], v[100:103], v[160:167], v5
ds_read_b128 v[44:47], v1 offset:24576
ds_read_b128 v[48:51], v1 offset:25600
s_and_b32 s32, s20, 1
v_cvt_pk_bf16_f32 v120, v68, v69
v_smfmac_f32_16x16x64_bf16 v[16:19], v[100:103], v[168:175], v5
ds_read_b128 v[92:95], v1 offset:26624
s_lshl_b32 s32, s32, 18
v_cvt_pk_bf16_f32 v121, v70, v71
v_cvt_pk_bf16_f32 v122, v72, v73
v_smfmac_f32_16x16x64_bf16 v[20:23], v[100:103], v[176:183], v5
ds_read_b128 v[96:99], v1 offset:27648
s_add_u32 s25, s34, s32
v_cvt_pk_bf16_f32 v123, v74, v75
v_smfmac_f32_16x16x64_bf16 v[24:27], v[100:103], v[184:191], v5
v_cndmask_b32_dpp v106, v121, v120, vcc quad_perm:[0,1,0,1] row_mask:0xf bank_mask:0xf
v_cndmask_b32_dpp v107, v123, v122, vcc quad_perm:[0,1,0,1] row_mask:0xf bank_mask:0xf
s_add_u32 s26, s25, 32768
s_bfe_u32 s69, s20, 0x10001
v_smfmac_f32_16x16x64_bf16 v[12:15], v[104:107], v[224:231], v5
ds_read_b128 v[76:79], v1 offset:28672
v_mov_b64 v[36:37], 0
v_mov_b64 v[40:41], 0
v_smfmac_f32_16x16x64_bf16 v[16:19], v[104:107], v[232:239], v5
ds_read_b128 v[80:83], v1 offset:29696
v_mov_b64 v[38:39], 0
v_mov_b64 v[42:43], 0
v_smfmac_f32_16x16x64_bf16 v[20:23], v[104:107], v[240:247], v5
ds_read_b128 v[84:87], v1 offset:30720
v_add_f32_e64 v12, v12, v14
v_smfmac_f32_16x16x64_bf16 v[24:27], v[104:107], v[248:255], v5
ds_read_b128 v[88:91], v1 offset:31744
v_add_f32_e64 v13, v13, v15
v_smfmac_f32_16x16x64_bf16 v[28:31], v[100:103], v[192:199], v5
v_add_f32 v16, v16, v18
v_add_f32 v17, v17, v19
v_smfmac_f32_16x16x64_bf16 v[32:35], v[100:103], v[200:207], v5
v_add_f32 v20, v20, v22
v_add_f32 v21, v21, v23
v_smfmac_f32_16x16x64_bf16 v[36:39], v[100:103], v[208:215], v5
v_add_f32_e64 v24, v24, v26
v_add_f32 v25, v25, v27
v_smfmac_f32_16x16x64_bf16 v[40:43], v[100:103], v[216:223], v5
v_cvt_pk_bf16_f32 v52, v12, v16
v_cvt_pk_bf16_f32 v53, v20, v24
s_waitcnt lgkmcnt(6)
v_smfmac_f32_16x16x64_bf16 v[28:31], v[104:107], v[44:51], v5
v_cvt_pk_bf16_f32 v54, v13, v17
v_cvt_pk_bf16_f32 v55, v21, v25
s_waitcnt lgkmcnt(4)
v_smfmac_f32_16x16x64_bf16 v[32:35], v[104:107], v[92:99], v5
v_and_or_b32 v52, v52, -2, s69
s_waitcnt lgkmcnt(2)
v_smfmac_f32_16x16x64_bf16 v[36:39], v[104:107], v[76:83], v5
buffer_store_dwordx4 v[52:55], v6, s[12:15], s25 offen sc1
v_add_f32 v28, v28, v30
s_waitcnt lgkmcnt(0)
v_smfmac_f32_16x16x64_bf16 v[40:43], v[104:107], v[84:91], v5
v_add_f32 v29, v29, v31
v_add_f32 v32, v32, v34
v_add_f32_e64 v33, v33, v35
v_cvt_pk_bf16_f32 v56, v28, v32
v_add_f32 v36, v36, v38
v_add_f32 v37, v37, v39
v_cvt_pk_bf16_f32 v58, v29, v33
v_and_or_b32 v56, v56, -2, s69
v_pk_add_f32 v[40:41], v[40:41], v[42:43]
v_cvt_pk_bf16_f32 v57, v36, v40
v_cvt_pk_bf16_f32 v59, v37, v41
buffer_store_dwordx4 v[56:59], v6, s[12:15], s26 offen sc1
s_lshl_b32 s32, s16, 13
s_add_u32 s25, s25, s32
s_add_u32 s25, s25, 6144
v_and_b32 v10, 16, v0
v_mov_b32 v11, 0x3f80
v_lshlrev_b32 v10, v10, v11
v_cndmask_b32 v124, 0, v10, s[60:61]
v_cndmask_b32 v125, 0, v10, s[62:63]
v_cndmask_b32 v126, 0, v10, s[64:65]
v_cndmask_b32 v127, 0, v10, s[66:67]
v_mov_b64 v[32:33], -1
v_bfe_u32 v10, v0, 4, 1
v_lshrrev_b32 v11, 8, v0
v_lshl_add_u32 v10, v11, 1, v10
v_and_b32_e64 v11, 32, v0
v_lshl_add_u32 v35, v10, 3, v11
s_and_b32 s32, s20, 3
s_lshl_b32 s32, s32, 13
s_add_u32 s27, s35, s32
s_add_u32 s29, s27, 6144
s_xor_b32 s32, s32, 16384
s_add_u32 s28, s35, s32
s_lshl_b32 s32, s16, 8
s_add_u32 s27, s27, s32
s_add_u32 s28, s28, s32
s_mov_b32 s68, s23
s_mov_b32 m0, 6144
s_mov_b32 s30, 0
s_mov_b64 vcc, s[58:59]
v_cndmask_b32_dpp v108, v116, v108, vcc quad_perm:[2,3,2,3] row_mask:0xf bank_mask:0xf
v_cndmask_b32_dpp v109, v117, v109, vcc quad_perm:[2,3,2,3] row_mask:0xf bank_mask:0xf
v_cndmask_b32_dpp v110, v118, v110, vcc quad_perm:[2,3,2,3] row_mask:0xf bank_mask:0xf
v_cndmask_b32_dpp v111, v119, v111, vcc quad_perm:[2,3,2,3] row_mask:0xf bank_mask:0xf
v_cndmask_b32_dpp v112, v120, v112, vcc quad_perm:[2,3,2,3] row_mask:0xf bank_mask:0xf
v_cndmask_b32_dpp v113, v121, v113, vcc quad_perm:[2,3,2,3] row_mask:0xf bank_mask:0xf
v_cndmask_b32_dpp v114, v122, v114, vcc quad_perm:[2,3,2,3] row_mask:0xf bank_mask:0xf
v_cndmask_b32_dpp v115, v123, v115, vcc quad_perm:[2,3,2,3] row_mask:0xf bank_mask:0xf
v_min_u32 v108, -2, v108
v_min_u32 v112, -2, v112
ds_read_b128 v[60:63], v1 offset:0
ds_read_b128 v[64:67], v1 offset:1024
ds_read_b128 v[68:71], v1 offset:2048
ds_read_b128 v[72:75], v1 offset:3072
ds_read_b128 v[76:79], v1 offset:4096
ds_read_b128 v[80:83], v1 offset:5120
ds_read_b128 v[84:87], v1 offset:6144
ds_read_b128 v[88:91], v1 offset:7168
ds_read_b128 v[92:95], v1 offset:8192
ds_read_b128 v[96:99], v1 offset:9216
ds_read_b128 v[100:103], v1 offset:10240
ds_read_b128 v[104:107], v1 offset:11264
v_mov_b64 v[44:45], 0
v_mov_b64 v[46:47], 0
v_mov_b64 v[48:49], 0
v_mov_b64 v[50:51], 0
buffer_load_dwordx4 v[20:23], v0, s[12:15], s25 offen offset:0 sc1
buffer_load_dwordx4 v[24:27], v0, s[12:15], s25 offen offset:1024 sc1
v_mov_b64 v[52:53], 0
v_mov_b64 v[54:55], 0
v_mov_b64_e64 v[56:57], 0
v_mov_b64 v[58:59], 0
RT_102:
s_waitcnt vmcnt(1)
v_mfma_f32_16x16x32_bf16 v[28:31], v[124:127], v[20:23], 0
v_xor_b32 v10, s69, v20
s_waitcnt vmcnt(0)
v_bitop3_b32 v10, v10, v24, s69 bitop3:0xf6
v_and_b32 v10, 1, v10
v_cmp_ne_u32_e64 vcc, 0, v10
v_mfma_f32_16x16x32_bf16 v[28:31], v[124:127], v[24:27], v[28:31]
s_cbranch_vccz RG_104
s_mov_b64 exec, vcc
buffer_load_dwordx4 v[20:23], v0, s[12:15], s25 offen offset:0 sc1
buffer_load_dwordx4 v[24:27], v0, s[12:15], s25 offen offset:1024 sc1
s_mov_b64 exec, -1
s_add_u32 s30, s30, 1
s_cmp_gt_u32 s30, 2097152
s_cbranch_scc1 FAIL
s_branch RT_102
RG_104:
s_nop 6
v_add_f32_dpp v28, v28, v28 row_ror:4 row_mask:0xf bank_mask:0xf
v_add_f32_dpp v29, v29, v29 row_ror:4 row_mask:0xf bank_mask:0xf
v_add_f32_dpp v30, v30, v30 row_ror:4 row_mask:0xf bank_mask:0xf
v_add_f32_dpp v31, v31, v31 row_ror:4 row_mask:0xf bank_mask:0xf
v_add_f32_dpp v28, v28, v28 row_ror:8 row_mask:0xf bank_mask:0xf
v_add_f32_dpp v29, v29, v29 row_ror:8 row_mask:0xf bank_mask:0xf
v_add_f32_dpp v30, v30, v30 row_ror:8 row_mask:0xf bank_mask:0xf
v_add_f32_dpp v31, v31, v31 row_ror:8 row_mask:0xf bank_mask:0xf
v_cvt_pk_bf16_f32 v10, v28, v29
v_cvt_pk_bf16_f32 v11, v30, v31
v_min_u32_e64 v10, -2, v10
s_mov_b64 exec, 0xf000f
buffer_store_dwordx2 v[10:11], v35, s[12:15], s27 offen offset:192 sc1
buffer_store_dwordx2 v[32:33], v35, s[12:15], s28 offen offset:192 sc1
s_mov_b64 exec, -1
s_add_u32 s20, s20, 1
s_mov_b32 s21, s22
s_add_u32 s23, s23, 8192
s_add_u32 s36, s21, 22528
s_add_u32 s22, s21, 24576
s_add_u32 s37, s22, 16384
buffer_load_dwordx4 v[116:119], v0, s[12:15], s36 offen offset:0 sc1
buffer_load_dwordx4 v[120:123], v0, s[12:15], s36 offen offset:1024 sc1
s_waitcnt vmcnt(0)
buffer_load_dwordx4 v[12:15], v0, s[12:15], s29 offen offset:0 sc1
buffer_load_dwordx4 v[16:19], v0, s[12:15], s29 offen offset:1024 sc1
s_branch H2_105
ROK_103:
s_mov_b64 exec, vcc
buffer_load_dwordx4 v[20:23], v0, s[12:15], s25 offen offset:0 sc1
buffer_load_dwordx4 v[24:27], v0, s[12:15], s25 offen offset:1024 sc1
s_mov_b64 exec, -1
s_add_u32 s30, s30, 1
s_cmp_gt_u32 s30, 2097152
s_cbranch_scc1 FAIL
s_branch RT_102
MRE_107:
s_mov_b64 exec, vcc
buffer_load_dwordx4 v[12:15], v0, s[12:15], s29 offen offset:0 sc1
buffer_load_dwordx4 v[16:19], v0, s[12:15], s29 offen offset:1024 sc1
s_mov_b64 exec, -1
s_add_u32 s30, s30, 1
s_cmp_gt_u32 s30, 2097152
s_cbranch_scc1 FAIL
s_branch MT_106
CLAST_99:
s_nop 2
v_cvt_pk_bf16_f32 v120, v68, v69
v_cvt_pk_bf16_f32 v121, v70, v71
s_nop 1
v_cvt_pk_bf16_f32 v122, v72, v73
v_cvt_pk_bf16_f32 v123, v74, v75
s_mov_b64 vcc, s[58:59]
v_cndmask_b32_dpp v108, v116, v108, vcc quad_perm:[2,3,2,3] row_mask:0xf bank_mask:0xf
v_cndmask_b32_dpp v109, v117, v109, vcc quad_perm:[2,3,2,3] row_mask:0xf bank_mask:0xf
v_cndmask_b32_dpp v110, v118, v110, vcc quad_perm:[2,3,2,3] row_mask:0xf bank_mask:0xf
v_cndmask_b32_dpp v111, v119, v111, vcc quad_perm:[2,3,2,3] row_mask:0xf bank_mask:0xf
v_cndmask_b32_dpp v112, v120, v112, vcc quad_perm:[2,3,2,3] row_mask:0xf bank_mask:0xf
v_cndmask_b32_dpp v113, v121, v113, vcc quad_perm:[2,3,2,3] row_mask:0xf bank_mask:0xf
v_cndmask_b32_dpp v114, v122, v114, vcc quad_perm:[2,3,2,3] row_mask:0xf bank_mask:0xf
v_cndmask_b32_dpp v115, v123, v115, vcc quad_perm:[2,3,2,3] row_mask:0xf bank_mask:0xf
v_min_u32 v108, -2, v108
v_min_u32_e64 v112, -2, v112
buffer_store_dwordx4 v[108:111], v0, s[12:15], s23 offen offset:0 sc1
buffer_store_dwordx4 v[112:115], v0, s[12:15], s23 offen offset:1024 sc1
s_branch FIN
ROLE_WB:
s_sub_u32 s21, s21, 64
s_and_b32 s16, s21, 15
s_lshr_b32 s17, s21, 4
s_bitcmp0_b32 s17, 0
s_cbranch_scc1 W0GO
s_lshr_b32 s21, s17, 1
s_lshl_b32 s21, s21, 4
s_add_u32 s21, s21, s16
s_load_dwordx2 s[52:53], s[0:1], 0
s_mov_b32 s54, 0x200000
s_mov_b32 s55, 0x20000
v_lshlrev_b32 v30, 4, v0
s_lshl_b32 s56, s21, 2
s_add_u32 s56, s56, s19
s_lshl_b32 s57, s56, 10
s_waitcnt lgkmcnt(0)
s_add_u32 s58, s57, 0
buffer_load_dwordx4 v[64:67], v30, s[52:55], s58 offen
s_add_u32 s58, s57, 196608
buffer_load_dwordx4 v[68:71], v30, s[52:55], s58 offen
s_add_u32 s58, s57, 393216
buffer_load_dwordx4 v[72:75], v30, s[52:55], s58 offen
s_add_u32 s58, s57, 589824
buffer_load_dwordx4 v[76:79], v30, s[52:55], s58 offen
s_add_u32 s58, s57, 786432
buffer_load_dwordx4 v[80:83], v30, s[52:55], s58 offen
s_add_u32 s58, s57, 983040
buffer_load_dwordx4 v[84:87], v30, s[52:55], s58 offen
s_add_u32 s58, s57, 1179648
buffer_load_dwordx4 v[88:91], v30, s[52:55], s58 offen
s_add_u32 s58, s57, 1376256
buffer_load_dwordx4 v[92:95], v30, s[52:55], s58 offen
s_add_u32 s58, s57, 1572864
buffer_load_dwordx4 v[96:99], v30, s[52:55], s58 offen
s_add_u32 s58, s57, 1769472
buffer_load_dwordx4 v[100:103], v30, s[52:55], s58 offen
s_add_u32 s58, s57, 1966080
buffer_load_dwordx4 v[104:107], v30, s[52:55], s58 offen
s_mov_b32 s50, 0x3b000000
s_mov_b32 s51, 0x3727c5ac
s_waitcnt vmcnt(10)
v_lshlrev_b32 v32, 16, v64
v_and_b32 v33, 0xffff0000, v64
v_lshlrev_b32_e64 v34, 16, v65
v_and_b32 v35, 0xffff0000, v65
v_lshlrev_b32_e64 v36, 16, v66
v_and_b32 v37, 0xffff0000, v66
v_lshlrev_b32_e64 v38, 16, v67
v_and_b32 v39, 0xffff0000, v67
v_add_f32 v40, v32, v33
v_mul_f32 v41, v32, v32
v_fmac_f32 v41, v33, v33
v_add_f32 v40, v40, v34
v_fmac_f32 v41, v34, v34
v_add_f32 v40, v40, v35
v_fmac_f32 v41, v35, v35
v_add_f32 v40, v40, v36
v_fmac_f32 v41, v36, v36
v_add_f32 v40, v40, v37
v_fmac_f32 v41, v37, v37
v_add_f32 v40, v40, v38
v_fmac_f32 v41, v38, v38
v_add_f32 v40, v40, v39
v_fmac_f32 v41, v39, v39
s_nop 0
v_add_f32_dpp v40, v40, v40 row_ror:8 row_mask:0xf bank_mask:0xf
v_add_f32_dpp v41, v41, v41 row_ror:8 row_mask:0xf bank_mask:0xf
s_nop 0
v_add_f32_dpp v40, v40, v40 row_ror:4 row_mask:0xf bank_mask:0xf
v_add_f32_dpp v41, v41, v41 row_ror:4 row_mask:0xf bank_mask:0xf
s_nop 0
v_add_f32_dpp v40, v40, v40 row_ror:2 row_mask:0xf bank_mask:0xf
v_add_f32_dpp v41, v41, v41 row_ror:2 row_mask:0xf bank_mask:0xf
s_nop 0
v_add_f32_dpp v40, v40, v40 row_ror:1 row_mask:0xf bank_mask:0xf
v_add_f32_dpp v41, v41, v41 row_ror:1 row_mask:0xf bank_mask:0xf
v_mov_b32 v42, v40
v_mov_b32 v43, v41
s_nop 0
v_permlane16_swap_b32 v40, v42
v_permlane16_swap_b32 v41, v43
v_pk_add_f32 v[40:41], v[40:41], v[42:43]
v_mov_b32 v42, v40
v_mov_b32 v43, v41
s_nop 0
v_permlane32_swap_b32 v40, v42
v_permlane32_swap_b32 v41, v43
v_pk_add_f32 v[40:41], v[40:41], v[42:43]
v_mul_f32 v40, s50, v40
v_mul_f32 v41, s50, v41
v_fma_f32 v41, -v40, v40, v41
v_max_f32 v41, 0, v41
v_add_f32 v41, s51, v41
v_rsq_f32 v42, v41
s_nop 0
v_mul_f32 v43, v40, v42
v_sub_f32_e64 v43, 0, v43
v_fma_f32 v32, v32, v42, v43
v_fma_f32 v33, v33, v42, v43
v_fma_f32 v34, v34, v42, v43
v_fma_f32 v35, v35, v42, v43
v_fma_f32 v36, v36, v42, v43
v_fma_f32 v37, v37, v42, v43
v_fma_f32 v38, v38, v42, v43
v_fma_f32 v39, v39, v42, v43
v_cvt_pk_bf16_f32 v64, v32, v33
v_cvt_pk_bf16_f32 v65, v34, v35
v_cvt_pk_bf16_f32 v66, v36, v37
v_cvt_pk_bf16_f32 v67, v38, v39
s_add_u32 s58, s57, 136314880
buffer_store_dwordx4 v[64:67], v30, s[12:15], s58 offen sc1
s_waitcnt vmcnt(10)
v_lshlrev_b32 v32, 16, v68
v_and_b32 v33, 0xffff0000, v68
v_lshlrev_b32_e64 v34, 16, v69
v_and_b32 v35, 0xffff0000, v69
v_lshlrev_b32_e64 v36, 16, v70
v_and_b32 v37, 0xffff0000, v70
v_lshlrev_b32_e64 v38, 16, v71
v_and_b32 v39, 0xffff0000, v71
v_add_f32 v40, v32, v33
v_mul_f32 v41, v32, v32
v_fmac_f32 v41, v33, v33
v_add_f32 v40, v40, v34
v_fmac_f32 v41, v34, v34
v_add_f32 v40, v40, v35
v_fmac_f32 v41, v35, v35
v_add_f32 v40, v40, v36
v_fmac_f32 v41, v36, v36
v_add_f32 v40, v40, v37
v_fmac_f32 v41, v37, v37
v_add_f32 v40, v40, v38
v_fmac_f32 v41, v38, v38
v_add_f32 v40, v40, v39
v_fmac_f32 v41, v39, v39
s_nop 0
v_add_f32_dpp v40, v40, v40 row_ror:8 row_mask:0xf bank_mask:0xf
v_add_f32_dpp v41, v41, v41 row_ror:8 row_mask:0xf bank_mask:0xf
s_nop 0
v_add_f32_dpp v40, v40, v40 row_ror:4 row_mask:0xf bank_mask:0xf
v_add_f32_dpp v41, v41, v41 row_ror:4 row_mask:0xf bank_mask:0xf
s_nop 0
v_add_f32_dpp v40, v40, v40 row_ror:2 row_mask:0xf bank_mask:0xf
v_add_f32_dpp v41, v41, v41 row_ror:2 row_mask:0xf bank_mask:0xf
s_nop 0
v_add_f32_dpp v40, v40, v40 row_ror:1 row_mask:0xf bank_mask:0xf
v_add_f32_dpp v41, v41, v41 row_ror:1 row_mask:0xf bank_mask:0xf
v_mov_b32 v42, v40
v_mov_b32 v43, v41
s_nop 0
v_permlane16_swap_b32 v40, v42
v_permlane16_swap_b32 v41, v43
v_pk_add_f32 v[40:41], v[40:41], v[42:43]
v_mov_b32 v42, v40
v_mov_b32 v43, v41
s_nop 0
v_permlane32_swap_b32 v40, v42
v_permlane32_swap_b32 v41, v43
v_pk_add_f32 v[40:41], v[40:41], v[42:43]
v_mul_f32 v40, s50, v40
v_mul_f32 v41, s50, v41
v_fma_f32 v41, -v40, v40, v41
v_max_f32 v41, 0, v41
v_add_f32 v41, s51, v41
v_rsq_f32 v42, v41
s_nop 0
v_mul_f32 v43, v40, v42
v_sub_f32_e64 v43, 0, v43
v_fma_f32 v32, v32, v42, v43
v_fma_f32 v33, v33, v42, v43
v_fma_f32 v34, v34, v42, v43
v_fma_f32 v35, v35, v42, v43
v_fma_f32 v36, v36, v42, v43
v_fma_f32 v37, v37, v42, v43
v_fma_f32 v38, v38, v42, v43
v_fma_f32 v39, v39, v42, v43
v_cvt_pk_bf16_f32 v68, v32, v33
v_cvt_pk_bf16_f32 v69, v34, v35
v_cvt_pk_bf16_f32 v70, v36, v37
v_cvt_pk_bf16_f32 v71, v38, v39
s_add_u32 s58, s57, 136511488
buffer_store_dwordx4 v[68:71], v30, s[12:15], s58 offen sc1
s_waitcnt vmcnt(10)
v_lshlrev_b32 v32, 16, v72
v_and_b32 v33, 0xffff0000, v72
v_lshlrev_b32_e64 v34, 16, v73
v_and_b32 v35, 0xffff0000, v73
v_lshlrev_b32_e64 v36, 16, v74
v_and_b32 v37, 0xffff0000, v74
v_lshlrev_b32_e64 v38, 16, v75
v_and_b32 v39, 0xffff0000, v75
v_add_f32 v40, v32, v33
v_mul_f32 v41, v32, v32
v_fmac_f32 v41, v33, v33
v_add_f32 v40, v40, v34
v_fmac_f32 v41, v34, v34
v_add_f32 v40, v40, v35
v_fmac_f32 v41, v35, v35
v_add_f32 v40, v40, v36
v_fmac_f32 v41, v36, v36
v_add_f32 v40, v40, v37
v_fmac_f32 v41, v37, v37
v_add_f32 v40, v40, v38
v_fmac_f32 v41, v38, v38
v_add_f32 v40, v40, v39
v_fmac_f32 v41, v39, v39
s_nop 0
v_add_f32_dpp v40, v40, v40 row_ror:8 row_mask:0xf bank_mask:0xf
v_add_f32_dpp v41, v41, v41 row_ror:8 row_mask:0xf bank_mask:0xf
s_nop 0
v_add_f32_dpp v40, v40, v40 row_ror:4 row_mask:0xf bank_mask:0xf
v_add_f32_dpp v41, v41, v41 row_ror:4 row_mask:0xf bank_mask:0xf
s_nop 0
v_add_f32_dpp v40, v40, v40 row_ror:2 row_mask:0xf bank_mask:0xf
v_add_f32_dpp v41, v41, v41 row_ror:2 row_mask:0xf bank_mask:0xf
s_nop 0
v_add_f32_dpp v40, v40, v40 row_ror:1 row_mask:0xf bank_mask:0xf
v_add_f32_dpp v41, v41, v41 row_ror:1 row_mask:0xf bank_mask:0xf
v_mov_b32 v42, v40
v_mov_b32 v43, v41
s_nop 0
v_permlane16_swap_b32 v40, v42
v_permlane16_swap_b32 v41, v43
v_pk_add_f32 v[40:41], v[40:41], v[42:43]
v_mov_b32 v42, v40
v_mov_b32 v43, v41
s_nop 0
v_permlane32_swap_b32 v40, v42
v_permlane32_swap_b32 v41, v43
v_pk_add_f32 v[40:41], v[40:41], v[42:43]
v_mul_f32 v40, s50, v40
v_mul_f32 v41, s50, v41
v_fma_f32 v41, -v40, v40, v41
v_max_f32 v41, 0, v41
v_add_f32 v41, s51, v41
v_rsq_f32 v42, v41
s_nop 0
v_mul_f32 v43, v40, v42
v_sub_f32_e64 v43, 0, v43
v_fma_f32 v32, v32, v42, v43
v_fma_f32 v33, v33, v42, v43
v_fma_f32 v34, v34, v42, v43
v_fma_f32 v35, v35, v42, v43
v_fma_f32 v36, v36, v42, v43
v_fma_f32 v37, v37, v42, v43
v_fma_f32 v38, v38, v42, v43
v_fma_f32 v39, v39, v42, v43
v_cvt_pk_bf16_f32 v72, v32, v33
v_cvt_pk_bf16_f32 v73, v34, v35
v_cvt_pk_bf16_f32 v74, v36, v37
v_cvt_pk_bf16_f32 v75, v38, v39
s_add_u32 s58, s57, 136708096
buffer_store_dwordx4 v[72:75], v30, s[12:15], s58 offen sc1
s_waitcnt vmcnt(10)
v_lshlrev_b32 v32, 16, v76
v_and_b32 v33, 0xffff0000, v76
v_lshlrev_b32_e64 v34, 16, v77
v_and_b32 v35, 0xffff0000, v77
v_lshlrev_b32_e64 v36, 16, v78
v_and_b32 v37, 0xffff0000, v78
v_lshlrev_b32_e64 v38, 16, v79
v_and_b32 v39, 0xffff0000, v79
v_add_f32 v40, v32, v33
v_mul_f32 v41, v32, v32
v_fmac_f32 v41, v33, v33
v_add_f32 v40, v40, v34
v_fmac_f32 v41, v34, v34
v_add_f32 v40, v40, v35
v_fmac_f32 v41, v35, v35
v_add_f32 v40, v40, v36
v_fmac_f32 v41, v36, v36
v_add_f32 v40, v40, v37
v_fmac_f32 v41, v37, v37
v_add_f32 v40, v40, v38
v_fmac_f32 v41, v38, v38
v_add_f32 v40, v40, v39
v_fmac_f32 v41, v39, v39
s_nop 0
v_add_f32_dpp v40, v40, v40 row_ror:8 row_mask:0xf bank_mask:0xf
v_add_f32_dpp v41, v41, v41 row_ror:8 row_mask:0xf bank_mask:0xf
s_nop 0
v_add_f32_dpp v40, v40, v40 row_ror:4 row_mask:0xf bank_mask:0xf
v_add_f32_dpp v41, v41, v41 row_ror:4 row_mask:0xf bank_mask:0xf
s_nop 0
v_add_f32_dpp v40, v40, v40 row_ror:2 row_mask:0xf bank_mask:0xf
v_add_f32_dpp v41, v41, v41 row_ror:2 row_mask:0xf bank_mask:0xf
s_nop 0
v_add_f32_dpp v40, v40, v40 row_ror:1 row_mask:0xf bank_mask:0xf
v_add_f32_dpp v41, v41, v41 row_ror:1 row_mask:0xf bank_mask:0xf
v_mov_b32 v42, v40
v_mov_b32 v43, v41
s_nop 0
v_permlane16_swap_b32 v40, v42
v_permlane16_swap_b32 v41, v43
v_pk_add_f32 v[40:41], v[40:41], v[42:43]
v_mov_b32 v42, v40
v_mov_b32 v43, v41
s_nop 0
v_permlane32_swap_b32 v40, v42
v_permlane32_swap_b32 v41, v43
v_pk_add_f32 v[40:41], v[40:41], v[42:43]
v_mul_f32 v40, s50, v40
v_mul_f32 v41, s50, v41
v_fma_f32 v41, -v40, v40, v41
v_max_f32 v41, 0, v41
v_add_f32 v41, s51, v41
v_rsq_f32 v42, v41
s_nop 0
v_mul_f32 v43, v40, v42
v_sub_f32_e64 v43, 0, v43
v_fma_f32 v32, v32, v42, v43
v_fma_f32 v33, v33, v42, v43
v_fma_f32 v34, v34, v42, v43
v_fma_f32 v35, v35, v42, v43
v_fma_f32 v36, v36, v42, v43
v_fma_f32 v37, v37, v42, v43
v_fma_f32 v38, v38, v42, v43
v_fma_f32 v39, v39, v42, v43
v_cvt_pk_bf16_f32 v76, v32, v33
v_cvt_pk_bf16_f32 v77, v34, v35
v_cvt_pk_bf16_f32 v78, v36, v37
v_cvt_pk_bf16_f32 v79, v38, v39
s_add_u32 s58, s57, 136904704
buffer_store_dwordx4 v[76:79], v30, s[12:15], s58 offen sc1
s_waitcnt vmcnt(10)
v_lshlrev_b32 v32, 16, v80
v_and_b32 v33, 0xffff0000, v80
v_lshlrev_b32_e64 v34, 16, v81
v_and_b32 v35, 0xffff0000, v81
v_lshlrev_b32_e64 v36, 16, v82
v_and_b32 v37, 0xffff0000, v82
v_lshlrev_b32_e64 v38, 16, v83
v_and_b32 v39, 0xffff0000, v83
v_add_f32 v40, v32, v33
v_mul_f32 v41, v32, v32
v_fmac_f32 v41, v33, v33
v_add_f32 v40, v40, v34
v_fmac_f32 v41, v34, v34
v_add_f32 v40, v40, v35
v_fmac_f32 v41, v35, v35
v_add_f32 v40, v40, v36
v_fmac_f32 v41, v36, v36
v_add_f32 v40, v40, v37
v_fmac_f32 v41, v37, v37
v_add_f32 v40, v40, v38
v_fmac_f32 v41, v38, v38
v_add_f32 v40, v40, v39
v_fmac_f32 v41, v39, v39
s_nop 0
v_add_f32_dpp v40, v40, v40 row_ror:8 row_mask:0xf bank_mask:0xf
v_add_f32_dpp v41, v41, v41 row_ror:8 row_mask:0xf bank_mask:0xf
s_nop 0
v_add_f32_dpp v40, v40, v40 row_ror:4 row_mask:0xf bank_mask:0xf
v_add_f32_dpp v41, v41, v41 row_ror:4 row_mask:0xf bank_mask:0xf
s_nop 0
v_add_f32_dpp v40, v40, v40 row_ror:2 row_mask:0xf bank_mask:0xf
v_add_f32_dpp v41, v41, v41 row_ror:2 row_mask:0xf bank_mask:0xf
s_nop 0
v_add_f32_dpp v40, v40, v40 row_ror:1 row_mask:0xf bank_mask:0xf
v_add_f32_dpp v41, v41, v41 row_ror:1 row_mask:0xf bank_mask:0xf
v_mov_b32 v42, v40
v_mov_b32 v43, v41
s_nop 0
v_permlane16_swap_b32 v40, v42
v_permlane16_swap_b32 v41, v43
v_pk_add_f32 v[40:41], v[40:41], v[42:43]
v_mov_b32 v42, v40
v_mov_b32 v43, v41
s_nop 0
v_permlane32_swap_b32 v40, v42
v_permlane32_swap_b32 v41, v43
v_pk_add_f32 v[40:41], v[40:41], v[42:43]
v_mul_f32 v40, s50, v40
v_mul_f32 v41, s50, v41
v_fma_f32 v41, -v40, v40, v41
v_max_f32 v41, 0, v41
v_add_f32 v41, s51, v41
v_rsq_f32 v42, v41
s_nop 0
v_mul_f32 v43, v40, v42
v_sub_f32_e64 v43, 0, v43
v_fma_f32 v32, v32, v42, v43
v_fma_f32 v33, v33, v42, v43
v_fma_f32 v34, v34, v42, v43
v_fma_f32 v35, v35, v42, v43
v_fma_f32 v36, v36, v42, v43
v_fma_f32 v37, v37, v42, v43
v_fma_f32 v38, v38, v42, v43
v_fma_f32 v39, v39, v42, v43
v_cvt_pk_bf16_f32 v80, v32, v33
v_cvt_pk_bf16_f32 v81, v34, v35
v_cvt_pk_bf16_f32 v82, v36, v37
v_cvt_pk_bf16_f32 v83, v38, v39
s_add_u32 s58, s57, 137101312
buffer_store_dwordx4 v[80:83], v30, s[12:15], s58 offen sc1
s_waitcnt vmcnt(10)
v_lshlrev_b32 v32, 16, v84
v_and_b32 v33, 0xffff0000, v84
v_lshlrev_b32_e64 v34, 16, v85
v_and_b32 v35, 0xffff0000, v85
v_lshlrev_b32_e64 v36, 16, v86
v_and_b32 v37, 0xffff0000, v86
v_lshlrev_b32_e64 v38, 16, v87
v_and_b32 v39, 0xffff0000, v87
v_add_f32 v40, v32, v33
v_mul_f32 v41, v32, v32
v_fmac_f32 v41, v33, v33
v_add_f32 v40, v40, v34
v_fmac_f32 v41, v34, v34
v_add_f32 v40, v40, v35
v_fmac_f32 v41, v35, v35
v_add_f32 v40, v40, v36
v_fmac_f32 v41, v36, v36
v_add_f32 v40, v40, v37
v_fmac_f32 v41, v37, v37
v_add_f32 v40, v40, v38
v_fmac_f32 v41, v38, v38
v_add_f32 v40, v40, v39
v_fmac_f32 v41, v39, v39
s_nop 0
v_add_f32_dpp v40, v40, v40 row_ror:8 row_mask:0xf bank_mask:0xf
v_add_f32_dpp v41, v41, v41 row_ror:8 row_mask:0xf bank_mask:0xf
s_nop 0
v_add_f32_dpp v40, v40, v40 row_ror:4 row_mask:0xf bank_mask:0xf
v_add_f32_dpp v41, v41, v41 row_ror:4 row_mask:0xf bank_mask:0xf
s_nop 0
v_add_f32_dpp v40, v40, v40 row_ror:2 row_mask:0xf bank_mask:0xf
v_add_f32_dpp v41, v41, v41 row_ror:2 row_mask:0xf bank_mask:0xf
s_nop 0
v_add_f32_dpp v40, v40, v40 row_ror:1 row_mask:0xf bank_mask:0xf
v_add_f32_dpp v41, v41, v41 row_ror:1 row_mask:0xf bank_mask:0xf
v_mov_b32 v42, v40
v_mov_b32 v43, v41
s_nop 0
v_permlane16_swap_b32 v40, v42
v_permlane16_swap_b32 v41, v43
v_pk_add_f32 v[40:41], v[40:41], v[42:43]
v_mov_b32 v42, v40
v_mov_b32 v43, v41
s_nop 0
v_permlane32_swap_b32 v40, v42
v_permlane32_swap_b32 v41, v43
v_pk_add_f32 v[40:41], v[40:41], v[42:43]
v_mul_f32 v40, s50, v40
v_mul_f32 v41, s50, v41
v_fma_f32 v41, -v40, v40, v41
v_max_f32 v41, 0, v41
v_add_f32 v41, s51, v41
v_rsq_f32 v42, v41
s_nop 0
v_mul_f32 v43, v40, v42
v_sub_f32_e64 v43, 0, v43
v_fma_f32 v32, v32, v42, v43
v_fma_f32 v33, v33, v42, v43
v_fma_f32 v34, v34, v42, v43
v_fma_f32 v35, v35, v42, v43
v_fma_f32 v36, v36, v42, v43
v_fma_f32 v37, v37, v42, v43
v_fma_f32 v38, v38, v42, v43
v_fma_f32 v39, v39, v42, v43
v_cvt_pk_bf16_f32 v84, v32, v33
v_cvt_pk_bf16_f32 v85, v34, v35
v_cvt_pk_bf16_f32 v86, v36, v37
v_cvt_pk_bf16_f32 v87, v38, v39
s_add_u32 s58, s57, 137297920
buffer_store_dwordx4 v[84:87], v30, s[12:15], s58 offen sc1
s_waitcnt vmcnt(10)
v_lshlrev_b32 v32, 16, v88
v_and_b32 v33, 0xffff0000, v88
v_lshlrev_b32_e64 v34, 16, v89
v_and_b32 v35, 0xffff0000, v89
v_lshlrev_b32_e64 v36, 16, v90
v_and_b32 v37, 0xffff0000, v90
v_lshlrev_b32_e64 v38, 16, v91
v_and_b32 v39, 0xffff0000, v91
v_add_f32 v40, v32, v33
v_mul_f32 v41, v32, v32
v_fmac_f32 v41, v33, v33
v_add_f32 v40, v40, v34
v_fmac_f32 v41, v34, v34
v_add_f32 v40, v40, v35
v_fmac_f32 v41, v35, v35
v_add_f32 v40, v40, v36
v_fmac_f32 v41, v36, v36
v_add_f32 v40, v40, v37
v_fmac_f32 v41, v37, v37
v_add_f32 v40, v40, v38
v_fmac_f32 v41, v38, v38
v_add_f32 v40, v40, v39
v_fmac_f32 v41, v39, v39
s_nop 0
v_add_f32_dpp v40, v40, v40 row_ror:8 row_mask:0xf bank_mask:0xf
v_add_f32_dpp v41, v41, v41 row_ror:8 row_mask:0xf bank_mask:0xf
s_nop 0
v_add_f32_dpp v40, v40, v40 row_ror:4 row_mask:0xf bank_mask:0xf
v_add_f32_dpp v41, v41, v41 row_ror:4 row_mask:0xf bank_mask:0xf
s_nop 0
v_add_f32_dpp v40, v40, v40 row_ror:2 row_mask:0xf bank_mask:0xf
v_add_f32_dpp v41, v41, v41 row_ror:2 row_mask:0xf bank_mask:0xf
s_nop 0
v_add_f32_dpp v40, v40, v40 row_ror:1 row_mask:0xf bank_mask:0xf
v_add_f32_dpp v41, v41, v41 row_ror:1 row_mask:0xf bank_mask:0xf
v_mov_b32 v42, v40
v_mov_b32 v43, v41
s_nop 0
v_permlane16_swap_b32 v40, v42
v_permlane16_swap_b32 v41, v43
v_pk_add_f32 v[40:41], v[40:41], v[42:43]
v_mov_b32 v42, v40
v_mov_b32 v43, v41
s_nop 0
v_permlane32_swap_b32 v40, v42
v_permlane32_swap_b32 v41, v43
v_pk_add_f32 v[40:41], v[40:41], v[42:43]
v_mul_f32 v40, s50, v40
v_mul_f32 v41, s50, v41
v_fma_f32 v41, -v40, v40, v41
v_max_f32 v41, 0, v41
v_add_f32 v41, s51, v41
v_rsq_f32 v42, v41
s_nop 0
v_mul_f32 v43, v40, v42
v_sub_f32_e64 v43, 0, v43
v_fma_f32 v32, v32, v42, v43
v_fma_f32 v33, v33, v42, v43
v_fma_f32 v34, v34, v42, v43
v_fma_f32 v35, v35, v42, v43
v_fma_f32 v36, v36, v42, v43
v_fma_f32 v37, v37, v42, v43
v_fma_f32 v38, v38, v42, v43
v_fma_f32 v39, v39, v42, v43
v_cvt_pk_bf16_f32 v88, v32, v33
v_cvt_pk_bf16_f32 v89, v34, v35
v_cvt_pk_bf16_f32 v90, v36, v37
v_cvt_pk_bf16_f32 v91, v38, v39
s_add_u32 s58, s57, 137494528
buffer_store_dwordx4 v[88:91], v30, s[12:15], s58 offen sc1
s_waitcnt vmcnt(10)
v_lshlrev_b32 v32, 16, v92
v_and_b32 v33, 0xffff0000, v92
v_lshlrev_b32_e64 v34, 16, v93
v_and_b32 v35, 0xffff0000, v93
v_lshlrev_b32_e64 v36, 16, v94
v_and_b32 v37, 0xffff0000, v94
v_lshlrev_b32_e64 v38, 16, v95
v_and_b32 v39, 0xffff0000, v95
v_add_f32 v40, v32, v33
v_mul_f32 v41, v32, v32
v_fmac_f32 v41, v33, v33
v_add_f32 v40, v40, v34
v_fmac_f32 v41, v34, v34
v_add_f32 v40, v40, v35
v_fmac_f32 v41, v35, v35
v_add_f32 v40, v40, v36
v_fmac_f32 v41, v36, v36
v_add_f32 v40, v40, v37
v_fmac_f32 v41, v37, v37
v_add_f32 v40, v40, v38
v_fmac_f32 v41, v38, v38
v_add_f32 v40, v40, v39
v_fmac_f32 v41, v39, v39
s_nop 0
v_add_f32_dpp v40, v40, v40 row_ror:8 row_mask:0xf bank_mask:0xf
v_add_f32_dpp v41, v41, v41 row_ror:8 row_mask:0xf bank_mask:0xf
s_nop 0
v_add_f32_dpp v40, v40, v40 row_ror:4 row_mask:0xf bank_mask:0xf
v_add_f32_dpp v41, v41, v41 row_ror:4 row_mask:0xf bank_mask:0xf
s_nop 0
v_add_f32_dpp v40, v40, v40 row_ror:2 row_mask:0xf bank_mask:0xf
v_add_f32_dpp v41, v41, v41 row_ror:2 row_mask:0xf bank_mask:0xf
s_nop 0
v_add_f32_dpp v40, v40, v40 row_ror:1 row_mask:0xf bank_mask:0xf
v_add_f32_dpp v41, v41, v41 row_ror:1 row_mask:0xf bank_mask:0xf
v_mov_b32 v42, v40
v_mov_b32 v43, v41
s_nop 0
v_permlane16_swap_b32 v40, v42
v_permlane16_swap_b32 v41, v43
v_pk_add_f32 v[40:41], v[40:41], v[42:43]
v_mov_b32 v42, v40
v_mov_b32 v43, v41
s_nop 0
v_permlane32_swap_b32 v40, v42
v_permlane32_swap_b32 v41, v43
v_pk_add_f32 v[40:41], v[40:41], v[42:43]
v_mul_f32 v40, s50, v40
v_mul_f32 v41, s50, v41
v_fma_f32 v41, -v40, v40, v41
v_max_f32 v41, 0, v41
v_add_f32 v41, s51, v41
v_rsq_f32 v42, v41
s_nop 0
v_mul_f32 v43, v40, v42
v_sub_f32_e64 v43, 0, v43
v_fma_f32 v32, v32, v42, v43
v_fma_f32 v33, v33, v42, v43
v_fma_f32 v34, v34, v42, v43
v_fma_f32 v35, v35, v42, v43
v_fma_f32 v36, v36, v42, v43
v_fma_f32 v37, v37, v42, v43
v_fma_f32 v38, v38, v42, v43
v_fma_f32 v39, v39, v42, v43
v_cvt_pk_bf16_f32 v92, v32, v33
v_cvt_pk_bf16_f32 v93, v34, v35
v_cvt_pk_bf16_f32 v94, v36, v37
v_cvt_pk_bf16_f32 v95, v38, v39
s_add_u32 s58, s57, 137691136
buffer_store_dwordx4 v[92:95], v30, s[12:15], s58 offen sc1
s_waitcnt vmcnt(10)
v_lshlrev_b32 v32, 16, v96
v_and_b32 v33, 0xffff0000, v96
v_lshlrev_b32_e64 v34, 16, v97
v_and_b32 v35, 0xffff0000, v97
v_lshlrev_b32_e64 v36, 16, v98
v_and_b32 v37, 0xffff0000, v98
v_lshlrev_b32_e64 v38, 16, v99
v_and_b32 v39, 0xffff0000, v99
v_add_f32 v40, v32, v33
v_mul_f32 v41, v32, v32
v_fmac_f32 v41, v33, v33
v_add_f32 v40, v40, v34
v_fmac_f32 v41, v34, v34
v_add_f32 v40, v40, v35
v_fmac_f32 v41, v35, v35
v_add_f32 v40, v40, v36
v_fmac_f32 v41, v36, v36
v_add_f32 v40, v40, v37
v_fmac_f32 v41, v37, v37
v_add_f32 v40, v40, v38
v_fmac_f32 v41, v38, v38
v_add_f32 v40, v40, v39
v_fmac_f32 v41, v39, v39
s_nop 0
v_add_f32_dpp v40, v40, v40 row_ror:8 row_mask:0xf bank_mask:0xf
v_add_f32_dpp v41, v41, v41 row_ror:8 row_mask:0xf bank_mask:0xf
s_nop 0
v_add_f32_dpp v40, v40, v40 row_ror:4 row_mask:0xf bank_mask:0xf
v_add_f32_dpp v41, v41, v41 row_ror:4 row_mask:0xf bank_mask:0xf
s_nop 0
v_add_f32_dpp v40, v40, v40 row_ror:2 row_mask:0xf bank_mask:0xf
v_add_f32_dpp v41, v41, v41 row_ror:2 row_mask:0xf bank_mask:0xf
s_nop 0
v_add_f32_dpp v40, v40, v40 row_ror:1 row_mask:0xf bank_mask:0xf
v_add_f32_dpp v41, v41, v41 row_ror:1 row_mask:0xf bank_mask:0xf
v_mov_b32 v42, v40
v_mov_b32 v43, v41
s_nop 0
v_permlane16_swap_b32 v40, v42
v_permlane16_swap_b32 v41, v43
v_pk_add_f32 v[40:41], v[40:41], v[42:43]
v_mov_b32 v42, v40
v_mov_b32 v43, v41
s_nop 0
v_permlane32_swap_b32 v40, v42
v_permlane32_swap_b32 v41, v43
v_pk_add_f32 v[40:41], v[40:41], v[42:43]
v_mul_f32 v40, s50, v40
v_mul_f32 v41, s50, v41
v_fma_f32 v41, -v40, v40, v41
v_max_f32 v41, 0, v41
v_add_f32 v41, s51, v41
v_rsq_f32 v42, v41
s_nop 0
v_mul_f32 v43, v40, v42
v_sub_f32_e64 v43, 0, v43
v_fma_f32 v32, v32, v42, v43
v_fma_f32 v33, v33, v42, v43
v_fma_f32 v34, v34, v42, v43
v_fma_f32 v35, v35, v42, v43
v_fma_f32 v36, v36, v42, v43
v_fma_f32 v37, v37, v42, v43
v_fma_f32 v38, v38, v42, v43
v_fma_f32 v39, v39, v42, v43
v_cvt_pk_bf16_f32 v96, v32, v33
v_cvt_pk_bf16_f32 v97, v34, v35
v_cvt_pk_bf16_f32 v98, v36, v37
v_cvt_pk_bf16_f32 v99, v38, v39
s_add_u32 s58, s57, 137887744
buffer_store_dwordx4 v[96:99], v30, s[12:15], s58 offen sc1
s_waitcnt vmcnt(10)
v_lshlrev_b32 v32, 16, v100
v_and_b32 v33, 0xffff0000, v100
v_lshlrev_b32_e64 v34, 16, v101
v_and_b32 v35, 0xffff0000, v101
v_lshlrev_b32_e64 v36, 16, v102
v_and_b32 v37, 0xffff0000, v102
v_lshlrev_b32_e64 v38, 16, v103
v_and_b32 v39, 0xffff0000, v103
v_add_f32 v40, v32, v33
v_mul_f32 v41, v32, v32
v_fmac_f32 v41, v33, v33
v_add_f32 v40, v40, v34
v_fmac_f32 v41, v34, v34
v_add_f32 v40, v40, v35
v_fmac_f32 v41, v35, v35
v_add_f32 v40, v40, v36
v_fmac_f32 v41, v36, v36
v_add_f32 v40, v40, v37
v_fmac_f32 v41, v37, v37
v_add_f32 v40, v40, v38
v_fmac_f32 v41, v38, v38
v_add_f32 v40, v40, v39
v_fmac_f32 v41, v39, v39
s_nop 0
v_add_f32_dpp v40, v40, v40 row_ror:8 row_mask:0xf bank_mask:0xf
v_add_f32_dpp v41, v41, v41 row_ror:8 row_mask:0xf bank_mask:0xf
s_nop 0
v_add_f32_dpp v40, v40, v40 row_ror:4 row_mask:0xf bank_mask:0xf
v_add_f32_dpp v41, v41, v41 row_ror:4 row_mask:0xf bank_mask:0xf
s_nop 0
v_add_f32_dpp v40, v40, v40 row_ror:2 row_mask:0xf bank_mask:0xf
v_add_f32_dpp v41, v41, v41 row_ror:2 row_mask:0xf bank_mask:0xf
s_nop 0
v_add_f32_dpp v40, v40, v40 row_ror:1 row_mask:0xf bank_mask:0xf
v_add_f32_dpp v41, v41, v41 row_ror:1 row_mask:0xf bank_mask:0xf
v_mov_b32 v42, v40
v_mov_b32 v43, v41
s_nop 0
v_permlane16_swap_b32 v40, v42
v_permlane16_swap_b32 v41, v43
v_pk_add_f32 v[40:41], v[40:41], v[42:43]
v_mov_b32 v42, v40
v_mov_b32 v43, v41
s_nop 0
v_permlane32_swap_b32 v40, v42
v_permlane32_swap_b32 v41, v43
v_pk_add_f32 v[40:41], v[40:41], v[42:43]
v_mul_f32 v40, s50, v40
v_mul_f32 v41, s50, v41
v_fma_f32 v41, -v40, v40, v41
v_max_f32 v41, 0, v41
v_add_f32 v41, s51, v41
v_rsq_f32 v42, v41
s_nop 0
v_mul_f32 v43, v40, v42
v_sub_f32_e64 v43, 0, v43
v_fma_f32 v32, v32, v42, v43
v_fma_f32 v33, v33, v42, v43
v_fma_f32 v34, v34, v42, v43
v_fma_f32 v35, v35, v42, v43
v_fma_f32 v36, v36, v42, v43
v_fma_f32 v37, v37, v42, v43
v_fma_f32 v38, v38, v42, v43
v_fma_f32 v39, v39, v42, v43
v_cvt_pk_bf16_f32 v100, v32, v33
v_cvt_pk_bf16_f32 v101, v34, v35
v_cvt_pk_bf16_f32 v102, v36, v37
v_cvt_pk_bf16_f32 v103, v38, v39
s_add_u32 s58, s57, 138084352
buffer_store_dwordx4 v[100:103], v30, s[12:15], s58 offen sc1
s_waitcnt vmcnt(10)
v_lshlrev_b32 v32, 16, v104
v_and_b32 v33, 0xffff0000, v104
v_lshlrev_b32_e64 v34, 16, v105
v_and_b32 v35, 0xffff0000, v105
v_lshlrev_b32_e64 v36, 16, v106
v_and_b32 v37, 0xffff0000, v106
v_lshlrev_b32_e64 v38, 16, v107
v_and_b32 v39, 0xffff0000, v107
v_add_f32 v40, v32, v33
v_mul_f32 v41, v32, v32
v_fmac_f32 v41, v33, v33
v_add_f32 v40, v40, v34
v_fmac_f32 v41, v34, v34
v_add_f32 v40, v40, v35
v_fmac_f32 v41, v35, v35
v_add_f32 v40, v40, v36
v_fmac_f32 v41, v36, v36
v_add_f32 v40, v40, v37
v_fmac_f32 v41, v37, v37
v_add_f32 v40, v40, v38
v_fmac_f32 v41, v38, v38
v_add_f32 v40, v40, v39
v_fmac_f32 v41, v39, v39
s_nop 0
v_add_f32_dpp v40, v40, v40 row_ror:8 row_mask:0xf bank_mask:0xf
v_add_f32_dpp v41, v41, v41 row_ror:8 row_mask:0xf bank_mask:0xf
s_nop 0
v_add_f32_dpp v40, v40, v40 row_ror:4 row_mask:0xf bank_mask:0xf
v_add_f32_dpp v41, v41, v41 row_ror:4 row_mask:0xf bank_mask:0xf
s_nop 0
v_add_f32_dpp v40, v40, v40 row_ror:2 row_mask:0xf bank_mask:0xf
v_add_f32_dpp v41, v41, v41 row_ror:2 row_mask:0xf bank_mask:0xf
s_nop 0
v_add_f32_dpp v40, v40, v40 row_ror:1 row_mask:0xf bank_mask:0xf
v_add_f32_dpp v41, v41, v41 row_ror:1 row_mask:0xf bank_mask:0xf
v_mov_b32 v42, v40
v_mov_b32 v43, v41
s_nop 0
v_permlane16_swap_b32 v40, v42
v_permlane16_swap_b32 v41, v43
v_pk_add_f32 v[40:41], v[40:41], v[42:43]
v_mov_b32 v42, v40
v_mov_b32 v43, v41
s_nop 0
v_permlane32_swap_b32 v40, v42
v_permlane32_swap_b32 v41, v43
v_pk_add_f32 v[40:41], v[40:41], v[42:43]
v_mul_f32 v40, s50, v40
v_mul_f32 v41, s50, v41
v_fma_f32 v41, -v40, v40, v41
v_max_f32 v41, 0, v41
v_add_f32 v41, s51, v41
v_rsq_f32_e64 v42, v41
s_nop 0
v_mul_f32_e64 v43, v40, v42
v_sub_f32_e64 v43, 0, v43
v_fma_f32 v32, v32, v42, v43
v_fma_f32 v33, v33, v42, v43
v_fma_f32 v34, v34, v42, v43
v_fma_f32 v35, v35, v42, v43
v_fma_f32 v36, v36, v42, v43
v_fma_f32 v37, v37, v42, v43
v_fma_f32 v38, v38, v42, v43
v_fma_f32 v39, v39, v42, v43
v_cvt_pk_bf16_f32 v104, v32, v33
v_cvt_pk_bf16_f32 v105, v34, v35
v_cvt_pk_bf16_f32 v106, v36, v37
v_cvt_pk_bf16_f32 v107, v38, v39
s_add_u32 s58, s57, 138280960
s_cmp_lt_u32 s56, 128
s_cselect_b32 s58, s58, s14
buffer_store_dwordx4 v[104:107], v30, s[12:15], s58 offen sc1
s_cmp_eq_u32 s92, 1
s_cbranch_scc1 SR_108
v_readfirstlane_b32 s89, v127
SR_108:
s_cmp_eq_u32 s92, 1
s_cbranch_scc1 VK_111
s_mov_b32 s61, 0
VW_109:
s_add_u32 s61, s61, 1
s_cmp_gt_u32 s61, 2097152
s_cbranch_scc1 FAIL
s_sleep 16
s_load_dwordx2 s[62:63], s[0:1], 88
v_mbcnt_lo_u32_b32 v60, -1, 0
v_and_b32 v61, 3, v60
v_lshrrev_b32 v60, 2, v60
v_lshlrev_b32 v60, 3, v60
v_lshl_add_u32 v60, v61, 6, v60
s_mov_b64 exec, 0xff
s_waitcnt lgkmcnt(0)
global_load_dwordx2 v[60:61], v60, s[62:63] sc1
s_mov_b64 exec, -1
VE_110:
s_mov_b64 exec, 0xff
s_waitcnt vmcnt(0)
v_cmp_eq_u32 vcc, -1, v60
s_mov_b64 exec, vcc
v_cmp_eq_u32 vcc, 0x2000, v61
s_mov_b64 exec, -1
s_cmp_eq_u32 vcc_lo, 0xff
s_cbranch_scc1 VG_112
s_mov_b32 s64, 0
s_mov_b32 s65, 0
s_mov_b32 s66, 1
s_mov_b32 s67, 1
v_readlane_b32 s68, v61, 0
v_readlane_b32 s69, v60, 0
s_cmp_eq_u32 s68, 0x2000
s_cselect_b32 s67, s67, 0
s_cmp_eq_u32 s69, -1
s_cselect_b32 s67, s67, 0
s_lshr_b32 s68, s68, 8
s_add_u32 s64, s64, s68
s_cmp_gt_u32 s91, 0
s_cselect_b32 s69, s68, 0
s_add_u32 s65, s65, s69
s_cmp_eq_u32 s68, 32
s_cselect_b32 s66, s66, 0
v_readlane_b32 s68, v61, 1
v_readlane_b32 s69, v60, 1
s_cmp_eq_u32 s68, 0x2000
s_cselect_b32 s67, s67, 0
s_cmp_eq_u32 s69, -1
s_cselect_b32 s67, s67, 0
s_lshr_b32 s68, s68, 8
s_add_u32 s64, s64, s68
s_cmp_gt_u32 s91, 1
s_cselect_b32 s69, s68, 0
s_add_u32 s65, s65, s69
s_cmp_eq_u32 s68, 32
s_cselect_b32 s66, s66, 0
v_readlane_b32 s68, v61, 2
v_readlane_b32 s69, v60, 2
s_cmp_eq_u32 s68, 0x2000
s_cselect_b32 s67, s67, 0
s_cmp_eq_u32 s69, -1
s_cselect_b32 s67, s67, 0
s_lshr_b32 s68, s68, 8
s_add_u32 s64, s64, s68
s_cmp_gt_u32 s91, 2
s_cselect_b32 s69, s68, 0
s_add_u32 s65, s65, s69
s_cmp_eq_u32 s68, 32
s_cselect_b32 s66, s66, 0
v_readlane_b32 s68, v61, 3
v_readlane_b32 s69, v60, 3
s_cmp_eq_u32 s68, 0x2000
s_cselect_b32 s67, s67, 0
s_cmp_eq_u32 s69, -1
s_cselect_b32 s67, s67, 0
s_lshr_b32 s68, s68, 8
s_add_u32 s64, s64, s68
s_cmp_gt_u32 s91, 3
s_cselect_b32 s69, s68, 0
s_add_u32 s65, s65, s69
s_cmp_eq_u32 s68, 32
s_cselect_b32 s66, s66, 0
v_readlane_b32 s68, v61, 4
v_readlane_b32 s69, v60, 4
s_cmp_eq_u32 s68, 0x2000
s_cselect_b32 s67, s67, 0
s_cmp_eq_u32 s69, -1
s_cselect_b32 s67, s67, 0
s_lshr_b32 s68, s68, 8
s_add_u32 s64, s64, s68
s_cmp_gt_u32 s91, 4
s_cselect_b32 s69, s68, 0
s_add_u32 s65, s65, s69
s_cmp_eq_u32 s68, 32
s_cselect_b32 s66, s66, 0
v_readlane_b32 s68, v61, 5
v_readlane_b32 s69, v60, 5
s_cmp_eq_u32 s68, 0x2000
s_cselect_b32 s67, s67, 0
s_cmp_eq_u32 s69, -1
s_cselect_b32 s67, s67, 0
s_lshr_b32 s68, s68, 8
s_add_u32 s64, s64, s68
s_cmp_gt_u32 s91, 5
s_cselect_b32 s69, s68, 0
s_add_u32 s65, s65, s69
s_cmp_eq_u32 s68, 32
s_cselect_b32 s66, s66, 0
v_readlane_b32 s68, v61, 6
v_readlane_b32 s69, v60, 6
s_cmp_eq_u32 s68, 0x2000
s_cselect_b32 s67, s67, 0
s_cmp_eq_u32 s69, -1
s_cselect_b32 s67, s67, 0
s_lshr_b32 s68, s68, 8
s_add_u32 s64, s64, s68
s_cmp_gt_u32 s91, 6
s_cselect_b32 s69, s68, 0
s_add_u32 s65, s65, s69
s_cmp_eq_u32 s68, 32
s_cselect_b32 s66, s66, 0
v_readlane_b32 s68, v61, 7
v_readlane_b32 s69, v60, 7
s_cmp_eq_u32 s68, 0x2000
s_cselect_b32 s67, s67, 0
s_cmp_eq_u32 s69, -1
s_cselect_b32 s67, s67, 0
s_lshr_b32 s68, s68, 8
s_add_u32 s64, s64, s68
s_cmp_gt_u32 s91, 7
s_cselect_b32 s69, s68, 0
s_add_u32 s65, s65, s69
s_cmp_eq_u32 s68, 32
s_cselect_b32 s66, s66, 0
s_cmp_lt_u32 s64, 256
s_cbranch_scc1 VW_109
s_cmp_gt_u32 s64, 256
s_cbranch_scc1 FAIL
s_cmp_eq_u32 s67, 0
s_cbranch_scc1 REROLE
VG_112:
s_mov_b32 s18, 1
s_mov_b32 s92, 1
VK_111:
v_lshlrev_b32 v1, 4, v0
s_lshl_b32 s21, s21, 2
s_add_u32 s21, s21, s19
s_lshl_b32 s22, s21, 10
v_mov_b64 v[8:9], 0
v_mov_b64 v[10:11], 0
s_add_u32 s23, s22, 159383552
s_cmp_lt_u32 s21, 16
s_cselect_b32 s23, s23, s14
buffer_store_dwordx4 v[8:11], v1, s[12:15], s23 offen sc1
s_waitcnt vmcnt(0)
s_barrier
s_cmp_lg_u32 s19, 0
s_cbranch_scc1 SG_113
s_load_dwordx2 s[62:63], s[0:1], 88
v_mov_b32 v60, 144
v_mov_b32 v61, 1
s_mov_b64 exec, 1
s_waitcnt lgkmcnt(0)
global_atomic_add v60, v61, s[62:63]
s_mov_b64 exec, -1
SG_113:
v_mov_b64 v[4:5], -1
v_mov_b64 v[6:7], -1
s_lshl_b32 s23, s21, 13
s_add_u32 s23, s23, 153092096
s_cmp_lt_u32 s21, 136
s_cselect_b32 s23, s23, s14
buffer_store_dwordx4 v[4:7], v1, s[12:15], s23 offen offset:0 sc1
buffer_store_dwordx4 v[4:7], v1, s[12:15], s23 offen offset:1024 sc1
buffer_store_dwordx4 v[4:7], v1, s[12:15], s23 offen offset:2048 sc1
buffer_store_dwordx4 v[4:7], v1, s[12:15], s23 offen offset:3072 sc1
s_add_u32 s23, s23, 4096
buffer_store_dwordx4 v[4:7], v1, s[12:15], s23 offen offset:0 sc1
buffer_store_dwordx4 v[4:7], v1, s[12:15], s23 offen offset:1024 sc1
buffer_store_dwordx4 v[4:7], v1, s[12:15], s23 offen offset:2048 sc1
buffer_store_dwordx4 v[4:7], v1, s[12:15], s23 offen offset:3072 sc1
s_mul_i32 s24, s21, 21846
s_lshr_b32 s24, s24, 16
s_mul_i32 s25, s24, 3
s_sub_u32 s25, s21, s25
s_lshl_b32 s24, s24, 19
s_lshl_b32 s25, s25, 13
s_add_u32 s23, s24, s25
s_add_u32 s23, s23, 100663296
buffer_store_dwordx4 v[4:7], v1, s[12:15], s23 offen offset:0 sc1
buffer_store_dwordx4 v[4:7], v1, s[12:15], s23 offen offset:1024 sc1
buffer_store_dwordx4 v[4:7], v1, s[12:15], s23 offen offset:2048 sc1
buffer_store_dwordx4 v[4:7], v1, s[12:15], s23 offen offset:3072 sc1
s_add_u32 s23, s23, 4096
buffer_store_dwordx4 v[4:7], v1, s[12:15], s23 offen offset:0 sc1
buffer_store_dwordx4 v[4:7], v1, s[12:15], s23 offen offset:1024 sc1
buffer_store_dwordx4 v[4:7], v1, s[12:15], s23 offen offset:2048 sc1
buffer_store_dwordx4 v[4:7], v1, s[12:15], s23 offen offset:3072 sc1
s_add_u32 s23, s22, 142606336
buffer_store_dwordx4 v[4:7], v1, s[12:15], s23 offen offset:0 sc1
s_add_u32 s23, s22, 146800640
buffer_store_dwordx4 v[4:7], v1, s[12:15], s23 offen offset:0 sc1
s_add_u32 s23, s22, 138412032
buffer_store_dwordx4 v[4:7], v1, s[12:15], s23 offen offset:0 sc1
s_add_u32 s23, s22, 140509184
buffer_store_dwordx4 v[4:7], v1, s[12:15], s23 offen offset:0 sc1
s_waitcnt vmcnt(0)
s_barrier
s_cmp_lg_u32 s19, 0
s_cbranch_scc1 SG_114
s_load_dwordx2 s[62:63], s[0:1], 88
v_mov_b32 v60, 208
v_mov_b32 v61, 1
s_mov_b64 exec, 1
s_waitcnt lgkmcnt(0)
global_atomic_add v60, v61, s[62:63]
s_mov_b64 exec, -1
SG_114:
W0GO:
s_load_dwordx2 s[48:49], s[0:1], 40
s_load_dwordx4 s[52:55], s[0:1], 64
v_and_b32 v1, 15, v0
v_lshrrev_b32 v2, 4, v0
v_lshlrev_b32_e64 v3, 13, v2
v_lshl_add_u32 v3, v1, 3, v3
v_lshrrev_b32 v4, 3, v0
s_movk_i32 s3, 3072
v_mul_lo_u32 v4, v4, s3
v_and_b32_e64 v5, 7, v0
v_bfe_u32 v7, v0, 4, 1
v_lshlrev_b32 v7, 1, v7
v_xor_b32 v5, v5, v7
v_xor_b32_e64 v7, 4, v5
v_lshl_add_u32 v7, v7, 4, v4
v_lshl_add_u32 v4, v5, 4, v4
v_and_b32 v5, 3, v0
s_waitcnt lgkmcnt(0)
s_mov_b32 s50, 0x400000
s_mov_b32 s51, 0x20000
s_mov_b32 s56, s54
s_mov_b32 s57, s55
s_mov_b32 s58, 0x80000
s_mov_b32 s59, 0x20000
s_mov_b32 s54, 0x180000
s_mov_b32 s55, 0x20000
s_lshr_b32 s20, s16, 1
s_lshl_b32 s20, s20, 7
s_mul_i32 s21, s19, 393216
s_add_u32 s20, s20, s21
s_lshl_b32 s21, s19, 14
s_add_u32 m0, s21, 0
s_add_u32 s22, s20, 0
buffer_load_dwordx4 v4, s[52:55], s22 offen lds
s_add_u32 m0, s21, 1024
s_add_u32 s22, s20, 24576
buffer_load_dwordx4 v7, s[52:55], s22 offen lds
s_add_u32 m0, s21, 2048
s_add_u32 s22, s20, 49152
buffer_load_dwordx4 v4, s[52:55], s22 offen lds
s_add_u32 m0, s21, 3072
s_add_u32 s22, s20, 73728
buffer_load_dwordx4 v7, s[52:55], s22 offen lds
s_add_u32 m0, s21, 4096
s_add_u32 s22, s20, 98304
buffer_load_dwordx4 v4, s[52:55], s22 offen lds
s_add_u32 m0, s21, 5120
s_add_u32 s22, s20, 122880
buffer_load_dwordx4 v7, s[52:55], s22 offen lds
s_add_u32 m0, s21, 6144
s_add_u32 s22, s20, 147456
buffer_load_dwordx4 v4, s[52:55], s22 offen lds
s_add_u32 m0, s21, 7168
s_add_u32 s22, s20, 172032
buffer_load_dwordx4 v7, s[52:55], s22 offen lds
s_add_u32 m0, s21, 8192
s_add_u32 s22, s20, 196608
buffer_load_dwordx4 v4, s[52:55], s22 offen lds
s_add_u32 m0, s21, 9216
s_add_u32 s22, s20, 221184
buffer_load_dwordx4 v7, s[52:55], s22 offen lds
s_add_u32 m0, s21, 10240
s_add_u32 s22, s20, 245760
buffer_load_dwordx4 v4, s[52:55], s22 offen lds
s_add_u32 m0, s21, 11264
s_add_u32 s22, s20, 270336
buffer_load_dwordx4 v7, s[52:55], s22 offen lds
s_add_u32 m0, s21, 12288
s_add_u32 s22, s20, 294912
buffer_load_dwordx4 v4, s[52:55], s22 offen lds
s_add_u32 m0, s21, 13312
s_add_u32 s22, s20, 319488
buffer_load_dwordx4 v7, s[52:55], s22 offen lds
s_add_u32 m0, s21, 14336
s_add_u32 s22, s20, 344064
buffer_load_dwordx4 v4, s[52:55], s22 offen lds
s_add_u32 m0, s21, 15360
s_add_u32 s22, s20, 368640
buffer_load_dwordx4 v7, s[52:55], s22 offen lds
v_lshrrev_b32_e64 v6, 2, v1
v_lshl_add_u32 v6, v2, 3, v6
v_lshlrev_b32_e64 v6, 7, v6
v_lshl_add_u32 v6, v5, 3, v6
v_bfe_u32 v8, v1, 3, 1
v_and_b32 v9, 1, v2
v_lshl_add_u32 v8, v9, 1, v8
v_xor_b32 v8, s19, v8
v_lshl_add_u32 v6, v8, 5, v6
s_mov_b32 s26, 0x05040100
s_mov_b32 s27, 0x07060302
s_lshr_b32 s23, s16, 1
s_lshl_b32 s23, s23, 19
s_and_b32 s24, s16, 1
s_lshl_b32 s24, s24, 9
s_add_u32 s23, s23, s24
s_lshl_b32 s24, s19, 7
s_add_u32 s23, s23, s24
s_lshr_b32 s28, s16, 1
s_lshl_b32 s28, s28, 16
s_lshl_b32 s24, s19, 8
s_add_u32 s28, s28, s24
s_add_u32 s25, s23, 0
buffer_load_dwordx2 v[192:193], v3, s[48:51], s25 offen
s_add_u32 s25, s23, 2048
buffer_load_dwordx2 v[194:195], v3, s[48:51], s25 offen
s_add_u32 s25, s23, 4096
buffer_load_dwordx2 v[196:197], v3, s[48:51], s25 offen
s_add_u32 s25, s23, 6144
buffer_load_dwordx2 v[198:199], v3, s[48:51], s25 offen
s_add_u32 s25, s23, 1024
buffer_load_dwordx2 v[200:201], v3, s[48:51], s25 offen
s_add_u32 s25, s23, 3072
buffer_load_dwordx2 v[202:203], v3, s[48:51], s25 offen
s_add_u32 s25, s23, 5120
buffer_load_dwordx2 v[204:205], v3, s[48:51], s25 offen
s_add_u32 s25, s23, 7168
buffer_load_dwordx2 v[206:207], v3, s[48:51], s25 offen
s_add_u32 s25, s23, 32768
buffer_load_dwordx2 v[208:209], v3, s[48:51], s25 offen
s_add_u32 s25, s23, 34816
buffer_load_dwordx2 v[210:211], v3, s[48:51], s25 offen
s_add_u32 s25, s23, 36864
buffer_load_dwordx2 v[212:213], v3, s[48:51], s25 offen
s_add_u32 s25, s23, 38912
buffer_load_dwordx2 v[214:215], v3, s[48:51], s25 offen
s_add_u32 s25, s23, 33792
buffer_load_dwordx2 v[216:217], v3, s[48:51], s25 offen
s_add_u32 s25, s23, 35840
buffer_load_dwordx2 v[218:219], v3, s[48:51], s25 offen
s_add_u32 s25, s23, 37888
buffer_load_dwordx2 v[220:221], v3, s[48:51], s25 offen
s_add_u32 s25, s23, 39936
buffer_load_dwordx2 v[222:223], v3, s[48:51], s25 offen
s_add_u32 s25, s23, 65536
buffer_load_dwordx2 v[224:225], v3, s[48:51], s25 offen
s_add_u32 s25, s23, 67584
buffer_load_dwordx2 v[226:227], v3, s[48:51], s25 offen
s_add_u32 s25, s23, 69632
buffer_load_dwordx2 v[228:229], v3, s[48:51], s25 offen
s_add_u32 s25, s23, 71680
buffer_load_dwordx2 v[230:231], v3, s[48:51], s25 offen
s_add_u32 s25, s23, 66560
buffer_load_dwordx2 v[232:233], v3, s[48:51], s25 offen
s_add_u32 s25, s23, 68608
buffer_load_dwordx2 v[234:235], v3, s[48:51], s25 offen
s_add_u32 s25, s23, 70656
buffer_load_dwordx2 v[236:237], v3, s[48:51], s25 offen
s_add_u32 s25, s23, 72704
buffer_load_dwordx2 v[238:239], v3, s[48:51], s25 offen
s_add_u32 s25, s23, 98304
buffer_load_dwordx2 v[240:241], v3, s[48:51], s25 offen
s_add_u32 s25, s23, 100352
buffer_load_dwordx2 v[242:243], v3, s[48:51], s25 offen
s_add_u32 s25, s23, 102400
buffer_load_dwordx2 v[244:245], v3, s[48:51], s25 offen
s_add_u32 s25, s23, 104448
buffer_load_dwordx2 v[246:247], v3, s[48:51], s25 offen
s_add_u32 s25, s23, 99328
buffer_load_dwordx2 v[248:249], v3, s[48:51], s25 offen
s_add_u32 s25, s23, 101376
buffer_load_dwordx2 v[250:251], v3, s[48:51], s25 offen
s_add_u32 s25, s23, 103424
buffer_load_dwordx2 v[252:253], v3, s[48:51], s25 offen
s_add_u32 s25, s23, 105472
buffer_load_dwordx2 v[254:255], v3, s[48:51], s25 offen
s_waitcnt vmcnt(30)
v_perm_b32 v80, v194, v192, s26
s_waitcnt vmcnt(28)
v_perm_b32 v81, v198, v196, s26
s_waitcnt vmcnt(26)
v_perm_b32 v82, v202, v200, s26
s_waitcnt vmcnt(24)
v_perm_b32 v83, v206, v204, s26
v_perm_b32 v84, v194, v192, s27
v_perm_b32 v85, v198, v196, s27
v_perm_b32 v86, v202, v200, s27
v_perm_b32 v87, v206, v204, s27
v_perm_b32 v88, v195, v193, s26
v_perm_b32 v89, v199, v197, s26
v_perm_b32 v90, v203, v201, s26
v_perm_b32 v91, v207, v205, s26
v_perm_b32 v92, v195, v193, s27
v_perm_b32 v93, v199, v197, s27
v_perm_b32 v94, v203, v201, s27
v_perm_b32 v95, v207, v205, s27
v_accvgpr_write_b32 a0, v80
v_accvgpr_write_b32 a1, v81
v_accvgpr_write_b32 a2, v82
v_accvgpr_write_b32 a3, v83
v_accvgpr_write_b32 a4, v84
v_accvgpr_write_b32 a5, v85
v_accvgpr_write_b32 a6, v86
v_accvgpr_write_b32 a7, v87
v_accvgpr_write_b32 a8, v88
v_accvgpr_write_b32 a9, v89
v_accvgpr_write_b32 a10, v90
v_accvgpr_write_b32 a11, v91
v_accvgpr_write_b32 a12, v92
v_accvgpr_write_b32 a13, v93
v_accvgpr_write_b32 a14, v94
v_accvgpr_write_b32 a15, v95
s_barrier
ds_read_b64_tr_b16 v[128:129], v6 offset:0
ds_read_b64_tr_b16 v[130:131], v6 offset:512
ds_read_b64_tr_b16 v[132:133], v6 offset:4096
ds_read_b64_tr_b16 v[134:135], v6 offset:4608
ds_read_b64_tr_b16 v[136:137], v6 offset:8192
ds_read_b64_tr_b16 v[138:139], v6 offset:8704
ds_read_b64_tr_b16 v[140:141], v6 offset:12288
ds_read_b64_tr_b16 v[142:143], v6 offset:12800
ds_read_b64_tr_b16 v[144:145], v6 offset:16384
ds_read_b64_tr_b16 v[146:147], v6 offset:16896
ds_read_b64_tr_b16 v[148:149], v6 offset:20480
ds_read_b64_tr_b16 v[150:151], v6 offset:20992
ds_read_b64_tr_b16 v[152:153], v6 offset:24576
ds_read_b64_tr_b16 v[154:155], v6 offset:25088
ds_read_b64_tr_b16 v[156:157], v6 offset:28672
ds_read_b64_tr_b16 v[158:159], v6 offset:29184
ds_read_b64_tr_b16 v[160:161], v6 offset:32768
ds_read_b64_tr_b16 v[162:163], v6 offset:33280
ds_read_b64_tr_b16 v[164:165], v6 offset:36864
ds_read_b64_tr_b16 v[166:167], v6 offset:37376
ds_read_b64_tr_b16 v[168:169], v6 offset:40960
ds_read_b64_tr_b16 v[170:171], v6 offset:41472
ds_read_b64_tr_b16 v[172:173], v6 offset:45056
ds_read_b64_tr_b16 v[174:175], v6 offset:45568
ds_read_b64_tr_b16 v[176:177], v6 offset:49152
ds_read_b64_tr_b16 v[178:179], v6 offset:49664
ds_read_b64_tr_b16 v[180:181], v6 offset:53248
ds_read_b64_tr_b16 v[182:183], v6 offset:53760
ds_read_b64_tr_b16 v[184:185], v6 offset:57344
ds_read_b64_tr_b16 v[186:187], v6 offset:57856
ds_read_b64_tr_b16 v[188:189], v6 offset:61440
ds_read_b64_tr_b16 v[190:191], v6 offset:61952
s_waitcnt lgkmcnt(0)
s_barrier
s_add_u32 m0, s21, 0
s_add_u32 s22, s20, 1024
buffer_load_dwordx4 v4, s[52:55], s22 offen lds
s_add_u32 m0, s21, 1024
s_add_u32 s22, s20, 25600
buffer_load_dwordx4 v7, s[52:55], s22 offen lds
s_add_u32 m0, s21, 2048
s_add_u32 s22, s20, 50176
buffer_load_dwordx4 v4, s[52:55], s22 offen lds
s_add_u32 m0, s21, 3072
s_add_u32 s22, s20, 74752
buffer_load_dwordx4 v7, s[52:55], s22 offen lds
s_add_u32 m0, s21, 4096
s_add_u32 s22, s20, 99328
buffer_load_dwordx4 v4, s[52:55], s22 offen lds
s_add_u32 m0, s21, 5120
s_add_u32 s22, s20, 123904
buffer_load_dwordx4 v7, s[52:55], s22 offen lds
s_add_u32 m0, s21, 6144
s_add_u32 s22, s20, 148480
buffer_load_dwordx4 v4, s[52:55], s22 offen lds
s_add_u32 m0, s21, 7168
s_add_u32 s22, s20, 173056
buffer_load_dwordx4 v7, s[52:55], s22 offen lds
s_add_u32 m0, s21, 8192
s_add_u32 s22, s20, 197632
buffer_load_dwordx4 v4, s[52:55], s22 offen lds
s_add_u32 m0, s21, 9216
s_add_u32 s22, s20, 222208
buffer_load_dwordx4 v7, s[52:55], s22 offen lds
s_add_u32 m0, s21, 10240
s_add_u32 s22, s20, 246784
buffer_load_dwordx4 v4, s[52:55], s22 offen lds
s_add_u32 m0, s21, 11264
s_add_u32 s22, s20, 271360
buffer_load_dwordx4 v7, s[52:55], s22 offen lds
s_add_u32 m0, s21, 12288
s_add_u32 s22, s20, 295936
buffer_load_dwordx4 v4, s[52:55], s22 offen lds
s_add_u32 m0, s21, 13312
s_add_u32 s22, s20, 320512
buffer_load_dwordx4 v7, s[52:55], s22 offen lds
s_add_u32 m0, s21, 14336
s_add_u32 s22, s20, 345088
buffer_load_dwordx4 v4, s[52:55], s22 offen lds
s_add_u32 m0, s21, 15360
s_add_u32 s22, s20, 369664
buffer_load_dwordx4 v7, s[52:55], s22 offen lds
s_add_u32 s25, s23, 131072
buffer_load_dwordx2 v[192:193], v3, s[48:51], s25 offen
s_add_u32 s25, s23, 133120
buffer_load_dwordx2 v[194:195], v3, s[48:51], s25 offen
s_add_u32 s25, s23, 135168
buffer_load_dwordx2 v[196:197], v3, s[48:51], s25 offen
s_add_u32 s25, s23, 137216
buffer_load_dwordx2 v[198:199], v3, s[48:51], s25 offen
s_add_u32 s25, s23, 132096
buffer_load_dwordx2 v[200:201], v3, s[48:51], s25 offen
s_add_u32 s25, s23, 134144
buffer_load_dwordx2 v[202:203], v3, s[48:51], s25 offen
s_add_u32 s25, s23, 136192
buffer_load_dwordx2 v[204:205], v3, s[48:51], s25 offen
s_add_u32 s25, s23, 138240
buffer_load_dwordx2 v[206:207], v3, s[48:51], s25 offen
s_waitcnt vmcnt(46)
v_perm_b32 v80, v210, v208, s26
s_waitcnt vmcnt(44)
v_perm_b32 v81, v214, v212, s26
s_waitcnt vmcnt(42)
v_perm_b32 v82, v218, v216, s26
s_waitcnt vmcnt(40)
v_perm_b32 v83, v222, v220, s26
v_perm_b32 v84, v210, v208, s27
v_perm_b32 v85, v214, v212, s27
v_perm_b32 v86, v218, v216, s27
v_perm_b32 v87, v222, v220, s27
v_perm_b32 v88, v211, v209, s26
v_perm_b32 v89, v215, v213, s26
v_perm_b32 v90, v219, v217, s26
v_perm_b32 v91, v223, v221, s26
v_perm_b32 v92, v211, v209, s27
v_perm_b32 v93, v215, v213, s27
v_perm_b32 v94, v219, v217, s27
v_perm_b32 v95, v223, v221, s27
v_accvgpr_write_b32 a16, v80
v_accvgpr_write_b32 a17, v81
v_accvgpr_write_b32 a18, v82
v_accvgpr_write_b32 a19, v83
v_accvgpr_write_b32 a20, v84
v_accvgpr_write_b32 a21, v85
v_accvgpr_write_b32 a22, v86
v_accvgpr_write_b32 a23, v87
v_accvgpr_write_b32 a24, v88
v_accvgpr_write_b32 a25, v89
v_accvgpr_write_b32 a26, v90
v_accvgpr_write_b32 a27, v91
v_accvgpr_write_b32 a28, v92
v_accvgpr_write_b32 a29, v93
v_accvgpr_write_b32 a30, v94
v_accvgpr_write_b32 a31, v95
s_add_u32 s25, s23, 163840
buffer_load_dwordx2 v[208:209], v3, s[48:51], s25 offen
s_add_u32 s25, s23, 165888
buffer_load_dwordx2 v[210:211], v3, s[48:51], s25 offen
s_add_u32 s25, s23, 167936
buffer_load_dwordx2 v[212:213], v3, s[48:51], s25 offen
s_add_u32 s25, s23, 169984
buffer_load_dwordx2 v[214:215], v3, s[48:51], s25 offen
s_add_u32 s25, s23, 164864
buffer_load_dwordx2 v[216:217], v3, s[48:51], s25 offen
s_add_u32 s25, s23, 166912
buffer_load_dwordx2 v[218:219], v3, s[48:51], s25 offen
s_add_u32 s25, s23, 168960
buffer_load_dwordx2 v[220:221], v3, s[48:51], s25 offen
s_add_u32 s25, s23, 171008
buffer_load_dwordx2 v[222:223], v3, s[48:51], s25 offen
s_waitcnt vmcnt(46)
v_perm_b32 v80, v226, v224, s26
s_waitcnt vmcnt(44)
v_perm_b32 v81, v230, v228, s26
s_waitcnt vmcnt(42)
v_perm_b32 v82, v234, v232, s26
s_waitcnt vmcnt(40)
v_perm_b32 v83, v238, v236, s26
v_perm_b32 v84, v226, v224, s27
v_perm_b32 v85, v230, v228, s27
v_perm_b32 v86, v234, v232, s27
v_perm_b32 v87, v238, v236, s27
v_perm_b32 v88, v227, v225, s26
v_perm_b32 v89, v231, v229, s26
v_perm_b32 v90, v235, v233, s26
v_perm_b32 v91, v239, v237, s26
v_perm_b32 v92, v227, v225, s27
v_perm_b32 v93, v231, v229, s27
v_perm_b32 v94, v235, v233, s27
v_perm_b32 v95, v239, v237, s27
v_accvgpr_write_b32 a32, v80
v_accvgpr_write_b32 a33, v81
v_accvgpr_write_b32 a34, v82
v_accvgpr_write_b32 a35, v83
v_accvgpr_write_b32 a36, v84
v_accvgpr_write_b32 a37, v85
v_accvgpr_write_b32 a38, v86
v_accvgpr_write_b32 a39, v87
v_accvgpr_write_b32 a40, v88
v_accvgpr_write_b32 a41, v89
v_accvgpr_write_b32 a42, v90
v_accvgpr_write_b32 a43, v91
v_accvgpr_write_b32 a44, v92
v_accvgpr_write_b32 a45, v93
v_accvgpr_write_b32 a46, v94
v_accvgpr_write_b32 a47, v95
s_add_u32 s25, s23, 196608
buffer_load_dwordx2 v[224:225], v3, s[48:51], s25 offen
s_add_u32 s25, s23, 198656
buffer_load_dwordx2 v[226:227], v3, s[48:51], s25 offen
s_add_u32 s25, s23, 200704
buffer_load_dwordx2 v[228:229], v3, s[48:51], s25 offen
s_add_u32 s25, s23, 202752
buffer_load_dwordx2 v[230:231], v3, s[48:51], s25 offen
s_add_u32 s25, s23, 197632
buffer_load_dwordx2 v[232:233], v3, s[48:51], s25 offen
s_add_u32 s25, s23, 199680
buffer_load_dwordx2 v[234:235], v3, s[48:51], s25 offen
s_add_u32 s25, s23, 201728
buffer_load_dwordx2 v[236:237], v3, s[48:51], s25 offen
s_add_u32 s25, s23, 203776
buffer_load_dwordx2 v[238:239], v3, s[48:51], s25 offen
s_cmp_eq_u32 s92, 1
s_cbranch_scc1 SR_115
v_readfirstlane_b32 s89, v127
SR_115:
s_load_dwordx2 s[62:63], s[0:1], 88
v_mbcnt_lo_u32_b32 v16, -1, 0
v_and_b32 v17, 3, v16
v_lshrrev_b32 v16, 2, v16
v_lshlrev_b32 v16, 3, v16
v_lshl_add_u32 v16, v17, 6, v16
s_mov_b64 exec, 0xff
s_waitcnt lgkmcnt(0)
global_load_dwordx2 v[16:17], v16, s[62:63] sc1
s_mov_b64 exec, -1
s_waitcnt vmcnt(47)
v_perm_b32 v80, v242, v240, s26
s_waitcnt vmcnt(45)
v_perm_b32 v81, v246, v244, s26
s_waitcnt vmcnt(43)
v_perm_b32 v82, v250, v248, s26
s_waitcnt vmcnt(41)
v_perm_b32 v83, v254, v252, s26
v_perm_b32 v84, v242, v240, s27
v_perm_b32 v85, v246, v244, s27
v_perm_b32 v86, v250, v248, s27
v_perm_b32 v87, v254, v252, s27
v_perm_b32 v88, v243, v241, s26
v_perm_b32 v89, v247, v245, s26
v_perm_b32 v90, v251, v249, s26
v_perm_b32 v91, v255, v253, s26
v_perm_b32 v92, v243, v241, s27
v_perm_b32 v93, v247, v245, s27
v_perm_b32 v94, v251, v249, s27
v_perm_b32 v95, v255, v253, s27
v_accvgpr_write_b32 a48, v80
v_accvgpr_write_b32 a49, v81
v_accvgpr_write_b32 a50, v82
v_accvgpr_write_b32 a51, v83
v_accvgpr_write_b32 a52, v84
v_accvgpr_write_b32 a53, v85
v_accvgpr_write_b32 a54, v86
v_accvgpr_write_b32 a55, v87
v_accvgpr_write_b32 a56, v88
v_accvgpr_write_b32 a57, v89
v_accvgpr_write_b32 a58, v90
v_accvgpr_write_b32 a59, v91
v_accvgpr_write_b32 a60, v92
v_accvgpr_write_b32 a61, v93
v_accvgpr_write_b32 a62, v94
v_accvgpr_write_b32 a63, v95
s_add_u32 s25, s23, 229376
buffer_load_dwordx2 v[240:241], v3, s[48:51], s25 offen
s_add_u32 s25, s23, 231424
buffer_load_dwordx2 v[242:243], v3, s[48:51], s25 offen
s_add_u32 s25, s23, 233472
buffer_load_dwordx2 v[244:245], v3, s[48:51], s25 offen
s_add_u32 s25, s23, 235520
buffer_load_dwordx2 v[246:247], v3, s[48:51], s25 offen
s_add_u32 s25, s23, 230400
buffer_load_dwordx2 v[248:249], v3, s[48:51], s25 offen
s_add_u32 s25, s23, 232448
buffer_load_dwordx2 v[250:251], v3, s[48:51], s25 offen
s_add_u32 s25, s23, 234496
buffer_load_dwordx2 v[252:253], v3, s[48:51], s25 offen
s_add_u32 s25, s23, 236544
buffer_load_dwordx2 v[254:255], v3, s[48:51], s25 offen
s_waitcnt vmcnt(31)
v_perm_b32 v80, v194, v192, s26
s_waitcnt vmcnt(29)
v_perm_b32 v81, v198, v196, s26
s_waitcnt vmcnt(27)
v_perm_b32 v82, v202, v200, s26
s_waitcnt vmcnt(25)
v_perm_b32 v83, v206, v204, s26
v_perm_b32 v84, v194, v192, s27
v_perm_b32 v85, v198, v196, s27
v_perm_b32 v86, v202, v200, s27
v_perm_b32 v87, v206, v204, s27
v_perm_b32 v88, v195, v193, s26
v_perm_b32 v89, v199, v197, s26
v_perm_b32 v90, v203, v201, s26
v_perm_b32 v91, v207, v205, s26
v_perm_b32 v92, v195, v193, s27
v_perm_b32 v93, v199, v197, s27
v_perm_b32 v94, v203, v201, s27
v_perm_b32 v95, v207, v205, s27
v_accvgpr_write_b32 a64, v80
v_accvgpr_write_b32 a65, v81
v_accvgpr_write_b32 a66, v82
v_accvgpr_write_b32 a67, v83
v_accvgpr_write_b32 a68, v84
v_accvgpr_write_b32 a69, v85
v_accvgpr_write_b32 a70, v86
v_accvgpr_write_b32 a71, v87
v_accvgpr_write_b32 a72, v88
v_accvgpr_write_b32 a73, v89
v_accvgpr_write_b32 a74, v90
v_accvgpr_write_b32 a75, v91
v_accvgpr_write_b32 a76, v92
v_accvgpr_write_b32 a77, v93
v_accvgpr_write_b32 a78, v94
v_accvgpr_write_b32 a79, v95
s_add_u32 m0, s21, 98304
s_add_u32 s22, s20, 2048
buffer_load_dwordx4 v4, s[52:55], s22 offen lds
s_add_u32 m0, s21, 99328
s_add_u32 s22, s20, 26624
buffer_load_dwordx4 v7, s[52:55], s22 offen lds
s_add_u32 m0, s21, 100352
s_add_u32 s22, s20, 51200
buffer_load_dwordx4 v4, s[52:55], s22 offen lds
s_add_u32 m0, s21, 101376
s_add_u32 s22, s20, 75776
buffer_load_dwordx4 v7, s[52:55], s22 offen lds
s_add_u32 m0, s21, 102400
s_add_u32 s22, s20, 100352
buffer_load_dwordx4 v4, s[52:55], s22 offen lds
s_add_u32 m0, s21, 103424
s_add_u32 s22, s20, 124928
buffer_load_dwordx4 v7, s[52:55], s22 offen lds
s_add_u32 m0, s21, 104448
s_add_u32 s22, s20, 149504
buffer_load_dwordx4 v4, s[52:55], s22 offen lds
s_add_u32 m0, s21, 105472
s_add_u32 s22, s20, 174080
buffer_load_dwordx4 v7, s[52:55], s22 offen lds
s_add_u32 m0, s21, 106496
s_add_u32 s22, s20, 198656
buffer_load_dwordx4 v4, s[52:55], s22 offen lds
s_add_u32 m0, s21, 107520
s_add_u32 s22, s20, 223232
buffer_load_dwordx4 v7, s[52:55], s22 offen lds
s_add_u32 m0, s21, 108544
s_add_u32 s22, s20, 247808
buffer_load_dwordx4 v4, s[52:55], s22 offen lds
s_add_u32 m0, s21, 109568
s_add_u32 s22, s20, 272384
buffer_load_dwordx4 v7, s[52:55], s22 offen lds
s_add_u32 m0, s21, 110592
s_add_u32 s22, s20, 296960
buffer_load_dwordx4 v4, s[52:55], s22 offen lds
s_add_u32 m0, s21, 111616
s_add_u32 s22, s20, 321536
buffer_load_dwordx4 v7, s[52:55], s22 offen lds
s_add_u32 m0, s21, 112640
s_add_u32 s22, s20, 346112
buffer_load_dwordx4 v4, s[52:55], s22 offen lds
s_add_u32 m0, s21, 113664
s_add_u32 s22, s20, 370688
buffer_load_dwordx4 v7, s[52:55], s22 offen lds
s_add_u32 s25, s23, 262144
buffer_load_dwordx2 v[192:193], v3, s[48:51], s25 offen
s_add_u32 s25, s23, 264192
buffer_load_dwordx2 v[194:195], v3, s[48:51], s25 offen
s_add_u32 s25, s23, 266240
buffer_load_dwordx2 v[196:197], v3, s[48:51], s25 offen
s_add_u32 s25, s23, 268288
buffer_load_dwordx2 v[198:199], v3, s[48:51], s25 offen
s_add_u32 s25, s23, 263168
buffer_load_dwordx2 v[200:201], v3, s[48:51], s25 offen
s_add_u32 s25, s23, 265216
buffer_load_dwordx2 v[202:203], v3, s[48:51], s25 offen
s_add_u32 s25, s23, 267264
buffer_load_dwordx2 v[204:205], v3, s[48:51], s25 offen
s_add_u32 s25, s23, 269312
buffer_load_dwordx2 v[206:207], v3, s[48:51], s25 offen
s_waitcnt vmcnt(47)
v_perm_b32 v80, v210, v208, s26
s_waitcnt vmcnt(45)
v_perm_b32 v81, v214, v212, s26
s_waitcnt vmcnt(43)
v_perm_b32 v82, v218, v216, s26
s_waitcnt vmcnt(41)
v_perm_b32 v83, v222, v220, s26
v_perm_b32 v84, v210, v208, s27
v_perm_b32 v85, v214, v212, s27
v_perm_b32 v86, v218, v216, s27
v_perm_b32 v87, v222, v220, s27
v_perm_b32 v88, v211, v209, s26
v_perm_b32 v89, v215, v213, s26
v_perm_b32 v90, v219, v217, s26
v_perm_b32 v91, v223, v221, s26
v_perm_b32 v92, v211, v209, s27
v_perm_b32 v93, v215, v213, s27
v_perm_b32 v94, v219, v217, s27
v_perm_b32 v95, v223, v221, s27
v_accvgpr_write_b32 a80, v80
v_accvgpr_write_b32 a81, v81
v_accvgpr_write_b32 a82, v82
v_accvgpr_write_b32 a83, v83
v_accvgpr_write_b32 a84, v84
v_accvgpr_write_b32 a85, v85
v_accvgpr_write_b32 a86, v86
v_accvgpr_write_b32 a87, v87
v_accvgpr_write_b32 a88, v88
v_accvgpr_write_b32 a89, v89
v_accvgpr_write_b32 a90, v90
v_accvgpr_write_b32 a91, v91
v_accvgpr_write_b32 a92, v92
v_accvgpr_write_b32 a93, v93
v_accvgpr_write_b32 a94, v94
v_accvgpr_write_b32 a95, v95
s_add_u32 s25, s23, 294912
buffer_load_dwordx2 v[208:209], v3, s[48:51], s25 offen
s_add_u32 s25, s23, 296960
buffer_load_dwordx2 v[210:211], v3, s[48:51], s25 offen
s_add_u32 s25, s23, 299008
buffer_load_dwordx2 v[212:213], v3, s[48:51], s25 offen
s_add_u32 s25, s23, 301056
buffer_load_dwordx2 v[214:215], v3, s[48:51], s25 offen
s_add_u32 s25, s23, 295936
buffer_load_dwordx2 v[216:217], v3, s[48:51], s25 offen
s_add_u32 s25, s23, 297984
buffer_load_dwordx2 v[218:219], v3, s[48:51], s25 offen
s_add_u32 s25, s23, 300032
buffer_load_dwordx2 v[220:221], v3, s[48:51], s25 offen
s_add_u32 s25, s23, 302080
buffer_load_dwordx2 v[222:223], v3, s[48:51], s25 offen
s_cmp_eq_u32 s92, 1
s_cbranch_scc1 VK_118
s_mov_b32 s61, 0
s_branch VE_117
VW_116:
s_add_u32 s61, s61, 1
s_cmp_gt_u32 s61, 2097152
s_cbranch_scc1 FAIL
s_sleep 16
s_load_dwordx2 s[62:63], s[0:1], 88
v_mbcnt_lo_u32_b32 v16, -1, 0
v_and_b32 v17, 3, v16
v_lshrrev_b32_e64 v16, 2, v16
v_lshlrev_b32 v16, 3, v16
v_lshl_add_u32 v16, v17, 6, v16
s_mov_b64 exec, 0xff
s_waitcnt lgkmcnt(0)
global_load_dwordx2 v[16:17], v16, s[62:63] sc1
s_mov_b64 exec, -1
VE_117:
s_mov_b64 exec, 0xff
s_waitcnt vmcnt(0)
v_cmp_eq_u32 vcc, -1, v16
s_mov_b64 exec, vcc
v_cmp_eq_u32 vcc, 0x2000, v17
s_mov_b64 exec, -1
s_cmp_eq_u32 vcc_lo, 0xff
s_cbranch_scc1 VG_119
s_mov_b32 s64, 0
s_mov_b32 s65, 0
s_mov_b32 s66, 1
s_mov_b32 s67, 1
v_readlane_b32 s68, v17, 0
v_readlane_b32 s69, v16, 0
s_cmp_eq_u32 s68, 0x2000
s_cselect_b32 s67, s67, 0
s_cmp_eq_u32 s69, -1
s_cselect_b32 s67, s67, 0
s_lshr_b32 s68, s68, 8
s_add_u32 s64, s64, s68
s_cmp_gt_u32 s91, 0
s_cselect_b32 s69, s68, 0
s_add_u32 s65, s65, s69
s_cmp_eq_u32 s68, 32
s_cselect_b32 s66, s66, 0
v_readlane_b32 s68, v17, 1
v_readlane_b32 s69, v16, 1
s_cmp_eq_u32 s68, 0x2000
s_cselect_b32 s67, s67, 0
s_cmp_eq_u32 s69, -1
s_cselect_b32 s67, s67, 0
s_lshr_b32 s68, s68, 8
s_add_u32 s64, s64, s68
s_cmp_gt_u32 s91, 1
s_cselect_b32 s69, s68, 0
s_add_u32 s65, s65, s69
s_cmp_eq_u32 s68, 32
s_cselect_b32 s66, s66, 0
v_readlane_b32 s68, v17, 2
v_readlane_b32 s69, v16, 2
s_cmp_eq_u32 s68, 0x2000
s_cselect_b32 s67, s67, 0
s_cmp_eq_u32 s69, -1
s_cselect_b32 s67, s67, 0
s_lshr_b32 s68, s68, 8
s_add_u32 s64, s64, s68
s_cmp_gt_u32 s91, 2
s_cselect_b32 s69, s68, 0
s_add_u32 s65, s65, s69
s_cmp_eq_u32 s68, 32
s_cselect_b32 s66, s66, 0
v_readlane_b32 s68, v17, 3
v_readlane_b32 s69, v16, 3
s_cmp_eq_u32 s68, 0x2000
s_cselect_b32 s67, s67, 0
s_cmp_eq_u32 s69, -1
s_cselect_b32 s67, s67, 0
s_lshr_b32 s68, s68, 8
s_add_u32 s64, s64, s68
s_cmp_gt_u32 s91, 3
s_cselect_b32 s69, s68, 0
s_add_u32 s65, s65, s69
s_cmp_eq_u32 s68, 32
s_cselect_b32 s66, s66, 0
v_readlane_b32 s68, v17, 4
v_readlane_b32 s69, v16, 4
s_cmp_eq_u32 s68, 0x2000
s_cselect_b32 s67, s67, 0
s_cmp_eq_u32 s69, -1
s_cselect_b32 s67, s67, 0
s_lshr_b32 s68, s68, 8
s_add_u32 s64, s64, s68
s_cmp_gt_u32 s91, 4
s_cselect_b32 s69, s68, 0
s_add_u32 s65, s65, s69
s_cmp_eq_u32 s68, 32
s_cselect_b32 s66, s66, 0
v_readlane_b32 s68, v17, 5
v_readlane_b32 s69, v16, 5
s_cmp_eq_u32 s68, 0x2000
s_cselect_b32 s67, s67, 0
s_cmp_eq_u32 s69, -1
s_cselect_b32 s67, s67, 0
s_lshr_b32 s68, s68, 8
s_add_u32 s64, s64, s68
s_cmp_gt_u32 s91, 5
s_cselect_b32 s69, s68, 0
s_add_u32 s65, s65, s69
s_cmp_eq_u32 s68, 32
s_cselect_b32 s66, s66, 0
v_readlane_b32 s68, v17, 6
v_readlane_b32 s69, v16, 6
s_cmp_eq_u32 s68, 0x2000
s_cselect_b32 s67, s67, 0
s_cmp_eq_u32 s69, -1
s_cselect_b32 s67, s67, 0
s_lshr_b32 s68, s68, 8
s_add_u32 s64, s64, s68
s_cmp_gt_u32 s91, 6
s_cselect_b32 s69, s68, 0
s_add_u32 s65, s65, s69
s_cmp_eq_u32 s68, 32
s_cselect_b32 s66, s66, 0
v_readlane_b32 s68, v17, 7
v_readlane_b32 s69, v16, 7
s_cmp_eq_u32 s68, 0x2000
s_cselect_b32 s67, s67, 0
s_cmp_eq_u32 s69, -1
s_cselect_b32 s67, s67, 0
s_lshr_b32 s68, s68, 8
s_add_u32 s64, s64, s68
s_cmp_gt_u32 s91, 7
s_cselect_b32 s69, s68, 0
s_add_u32 s65, s65, s69
s_cmp_eq_u32 s68, 32
s_cselect_b32 s66, s66, 0
s_cmp_lt_u32 s64, 256
s_cbranch_scc1 VW_116
s_cmp_gt_u32 s64, 256
s_cbranch_scc1 FAIL
s_cmp_eq_u32 s67, 0
s_cbranch_scc1 REROLE
VG_119:
s_mov_b32 s18, 1
s_mov_b32 s92, 1
VK_118:
v_lshlrev_b32_e64 v62, 4, v0
v_mov_b64 v[64:65], -1
v_mov_b64_e64 v[66:67], -1
s_mul_i32 s64, s17, 851968
s_add_u32 s64, s64, 154206208
s_lshl_b32 s65, s16, 2
s_add_u32 s65, s65, s19
s_cmp_eq_u32 s18, 0
s_cbranch_scc1 IA_120
s_lshl_b32 s66, s65, 12
s_add_u32 s66, s66, s64
s_add_u32 s66, s66, 0
buffer_store_dwordx4 v[64:67], v62, s[12:15], s66 offen offset:0
buffer_store_dwordx4 v[64:67], v62, s[12:15], s66 offen offset:1024
buffer_store_dwordx4 v[64:67], v62, s[12:15], s66 offen offset:2048
buffer_store_dwordx4 v[64:67], v62, s[12:15], s66 offen offset:3072
s_lshl_b32 s66, s65, 12
s_add_u32 s66, s66, s64
s_add_u32 s66, s66, 262144
buffer_store_dwordx4 v[64:67], v62, s[12:15], s66 offen offset:0
buffer_store_dwordx4 v[64:67], v62, s[12:15], s66 offen offset:1024
buffer_store_dwordx4 v[64:67], v62, s[12:15], s66 offen offset:2048
buffer_store_dwordx4 v[64:67], v62, s[12:15], s66 offen offset:3072
s_lshl_b32 s66, s65, 12
s_add_u32 s66, s66, s64
s_add_u32 s66, s66, 524288
buffer_store_dwordx4 v[64:67], v62, s[12:15], s66 offen offset:0
buffer_store_dwordx4 v[64:67], v62, s[12:15], s66 offen offset:1024
buffer_store_dwordx4 v[64:67], v62, s[12:15], s66 offen offset:2048
buffer_store_dwordx4 v[64:67], v62, s[12:15], s66 offen offset:3072
s_lshl_b32 s66, s65, 10
s_add_u32 s66, s66, s64
s_add_u32 s66, s66, 786432
buffer_store_dwordx4 v[64:67], v62, s[12:15], s66 offen offset:0
s_branch IB_121
IA_120:
s_lshl_b32 s66, s65, 12
s_add_u32 s66, s66, s64
s_add_u32 s66, s66, 0
buffer_store_dwordx4 v[64:67], v62, s[12:15], s66 offen offset:0 sc1
buffer_store_dwordx4 v[64:67], v62, s[12:15], s66 offen offset:1024 sc1
buffer_store_dwordx4 v[64:67], v62, s[12:15], s66 offen offset:2048 sc1
buffer_store_dwordx4 v[64:67], v62, s[12:15], s66 offen offset:3072 sc1
s_lshl_b32 s66, s65, 12
s_add_u32 s66, s66, s64
s_add_u32 s66, s66, 262144
buffer_store_dwordx4 v[64:67], v62, s[12:15], s66 offen offset:0 sc1
buffer_store_dwordx4 v[64:67], v62, s[12:15], s66 offen offset:1024 sc1
buffer_store_dwordx4 v[64:67], v62, s[12:15], s66 offen offset:2048 sc1
buffer_store_dwordx4 v[64:67], v62, s[12:15], s66 offen offset:3072 sc1
s_lshl_b32 s66, s65, 12
s_add_u32 s66, s66, s64
s_add_u32 s66, s66, 524288
buffer_store_dwordx4 v[64:67], v62, s[12:15], s66 offen offset:0 sc1
buffer_store_dwordx4 v[64:67], v62, s[12:15], s66 offen offset:1024 sc1
buffer_store_dwordx4 v[64:67], v62, s[12:15], s66 offen offset:2048 sc1
buffer_store_dwordx4 v[64:67], v62, s[12:15], s66 offen offset:3072 sc1
s_lshl_b32 s66, s65, 10
s_add_u32 s66, s66, s64
s_add_u32 s66, s66, 786432
buffer_store_dwordx4 v[64:67], v62, s[12:15], s66 offen offset:0 sc1
IB_121:
s_waitcnt vmcnt(60)
v_perm_b32 v80, v226, v224, s26
s_waitcnt vmcnt(58)
v_perm_b32 v81, v230, v228, s26
s_waitcnt vmcnt(56)
v_perm_b32 v82, v234, v232, s26
s_waitcnt vmcnt(54)
v_perm_b32 v83, v238, v236, s26
v_perm_b32 v84, v226, v224, s27
v_perm_b32 v85, v230, v228, s27
v_perm_b32 v86, v234, v232, s27
v_perm_b32 v87, v238, v236, s27
v_perm_b32 v88, v227, v225, s26
v_perm_b32 v89, v231, v229, s26
v_perm_b32 v90, v235, v233, s26
v_perm_b32 v91, v239, v237, s26
v_perm_b32 v92, v227, v225, s27
v_perm_b32 v93, v231, v229, s27
v_perm_b32 v94, v235, v233, s27
v_perm_b32 v95, v239, v237, s27
v_accvgpr_write_b32 a96, v80
v_accvgpr_write_b32 a97, v81
v_accvgpr_write_b32 a98, v82
v_accvgpr_write_b32 a99, v83
v_accvgpr_write_b32 a100, v84
v_accvgpr_write_b32 a101, v85
v_accvgpr_write_b32 a102, v86
v_accvgpr_write_b32 a103, v87
v_accvgpr_write_b32 a104, v88
v_accvgpr_write_b32 a105, v89
v_accvgpr_write_b32 a106, v90
v_accvgpr_write_b32 a107, v91
v_accvgpr_write_b32 a108, v92
v_accvgpr_write_b32 a109, v93
v_accvgpr_write_b32 a110, v94
v_accvgpr_write_b32 a111, v95
s_add_u32 s25, s23, 327680
buffer_load_dwordx2 v[224:225], v3, s[48:51], s25 offen
s_add_u32 s25, s23, 329728
buffer_load_dwordx2 v[226:227], v3, s[48:51], s25 offen
s_add_u32 s25, s23, 331776
buffer_load_dwordx2 v[228:229], v3, s[48:51], s25 offen
s_add_u32 s25, s23, 333824
buffer_load_dwordx2 v[230:231], v3, s[48:51], s25 offen
s_add_u32 s25, s23, 328704
buffer_load_dwordx2 v[232:233], v3, s[48:51], s25 offen
s_add_u32 s25, s23, 330752
buffer_load_dwordx2 v[234:235], v3, s[48:51], s25 offen
s_add_u32 s25, s23, 332800
buffer_load_dwordx2 v[236:237], v3, s[48:51], s25 offen
s_add_u32 s25, s23, 334848
buffer_load_dwordx2 v[238:239], v3, s[48:51], s25 offen
s_waitcnt vmcnt(59)
v_perm_b32 v80, v242, v240, s26
s_waitcnt vmcnt(57)
v_perm_b32 v81, v246, v244, s26
s_waitcnt vmcnt(55)
v_perm_b32 v82, v250, v248, s26
s_waitcnt vmcnt(53)
v_perm_b32 v83, v254, v252, s26
v_perm_b32 v84, v242, v240, s27
v_perm_b32 v85, v246, v244, s27
v_perm_b32 v86, v250, v248, s27
v_perm_b32 v87, v254, v252, s27
v_perm_b32 v88, v243, v241, s26
v_perm_b32 v89, v247, v245, s26
v_perm_b32 v90, v251, v249, s26
v_perm_b32 v91, v255, v253, s26
v_perm_b32 v92, v243, v241, s27
v_perm_b32 v93, v247, v245, s27
v_perm_b32 v94, v251, v249, s27
v_perm_b32 v95, v255, v253, s27
v_accvgpr_write_b32 a112, v80
v_accvgpr_write_b32 a113, v81
v_accvgpr_write_b32 a114, v82
v_accvgpr_write_b32 a115, v83
v_accvgpr_write_b32 a116, v84
v_accvgpr_write_b32 a117, v85
v_accvgpr_write_b32 a118, v86
v_accvgpr_write_b32 a119, v87
v_accvgpr_write_b32 a120, v88
v_accvgpr_write_b32 a121, v89
v_accvgpr_write_b32 a122, v90
v_accvgpr_write_b32 a123, v91
v_accvgpr_write_b32 a124, v92
v_accvgpr_write_b32 a125, v93
v_accvgpr_write_b32 a126, v94
v_accvgpr_write_b32 a127, v95
s_add_u32 s25, s23, 360448
buffer_load_dwordx2 v[240:241], v3, s[48:51], s25 offen
s_add_u32 s25, s23, 362496
buffer_load_dwordx2 v[242:243], v3, s[48:51], s25 offen
s_add_u32 s25, s23, 364544
buffer_load_dwordx2 v[244:245], v3, s[48:51], s25 offen
s_add_u32 s25, s23, 366592
buffer_load_dwordx2 v[246:247], v3, s[48:51], s25 offen
s_add_u32 s25, s23, 361472
buffer_load_dwordx2 v[248:249], v3, s[48:51], s25 offen
s_add_u32 s25, s23, 363520
buffer_load_dwordx2 v[250:251], v3, s[48:51], s25 offen
s_add_u32 s25, s23, 365568
buffer_load_dwordx2 v[252:253], v3, s[48:51], s25 offen
s_add_u32 s25, s23, 367616
buffer_load_dwordx2 v[254:255], v3, s[48:51], s25 offen
s_waitcnt vmcnt(43)
v_perm_b32 v80, v194, v192, s26
s_waitcnt vmcnt(41)
v_perm_b32 v81, v198, v196, s26
s_waitcnt vmcnt(39)
v_perm_b32 v82, v202, v200, s26
s_waitcnt vmcnt(37)
v_perm_b32 v83, v206, v204, s26
v_perm_b32 v84, v194, v192, s27
v_perm_b32 v85, v198, v196, s27
v_perm_b32 v86, v202, v200, s27
v_perm_b32 v87, v206, v204, s27
v_perm_b32 v88, v195, v193, s26
v_perm_b32 v89, v199, v197, s26
v_perm_b32 v90, v203, v201, s26
v_perm_b32 v91, v207, v205, s26
v_perm_b32 v92, v195, v193, s27
v_perm_b32 v93, v199, v197, s27
v_perm_b32 v94, v203, v201, s27
v_perm_b32 v95, v207, v205, s27
v_accvgpr_write_b32 a128, v80
v_accvgpr_write_b32 a129, v81
v_accvgpr_write_b32 a130, v82
v_accvgpr_write_b32 a131, v83
v_accvgpr_write_b32 a132, v84
v_accvgpr_write_b32 a133, v85
v_accvgpr_write_b32 a134, v86
v_accvgpr_write_b32 a135, v87
v_accvgpr_write_b32 a136, v88
v_accvgpr_write_b32 a137, v89
v_accvgpr_write_b32 a138, v90
v_accvgpr_write_b32 a139, v91
v_accvgpr_write_b32 a140, v92
v_accvgpr_write_b32 a141, v93
v_accvgpr_write_b32 a142, v94
v_accvgpr_write_b32 a143, v95
s_add_u32 s25, s23, 393216
buffer_load_dwordx2 v[192:193], v3, s[48:51], s25 offen
s_add_u32 s25, s23, 395264
buffer_load_dwordx2 v[194:195], v3, s[48:51], s25 offen
s_add_u32 s25, s23, 397312
buffer_load_dwordx2 v[196:197], v3, s[48:51], s25 offen
s_add_u32 s25, s23, 399360
buffer_load_dwordx2 v[198:199], v3, s[48:51], s25 offen
s_add_u32 s25, s23, 394240
buffer_load_dwordx2 v[200:201], v3, s[48:51], s25 offen
s_add_u32 s25, s23, 396288
buffer_load_dwordx2 v[202:203], v3, s[48:51], s25 offen
s_add_u32 s25, s23, 398336
buffer_load_dwordx2 v[204:205], v3, s[48:51], s25 offen
s_add_u32 s25, s23, 400384
buffer_load_dwordx2 v[206:207], v3, s[48:51], s25 offen
s_waitcnt vmcnt(43)
v_perm_b32 v80, v210, v208, s26
s_waitcnt vmcnt(41)
v_perm_b32 v81, v214, v212, s26
s_waitcnt vmcnt(39)
v_perm_b32 v82, v218, v216, s26
s_waitcnt vmcnt(37)
v_perm_b32 v83, v222, v220, s26
v_perm_b32 v84, v210, v208, s27
v_perm_b32 v85, v214, v212, s27
v_perm_b32 v86, v218, v216, s27
v_perm_b32 v87, v222, v220, s27
v_perm_b32 v88, v211, v209, s26
v_perm_b32 v89, v215, v213, s26
v_perm_b32 v90, v219, v217, s26
v_perm_b32 v91, v223, v221, s26
v_perm_b32 v92, v211, v209, s27
v_perm_b32 v93, v215, v213, s27
v_perm_b32 v94, v219, v217, s27
v_perm_b32 v95, v223, v221, s27
v_accvgpr_write_b32 a144, v80
v_accvgpr_write_b32 a145, v81
v_accvgpr_write_b32 a146, v82
v_accvgpr_write_b32 a147, v83
v_accvgpr_write_b32 a148, v84
v_accvgpr_write_b32 a149, v85
v_accvgpr_write_b32 a150, v86
v_accvgpr_write_b32 a151, v87
v_accvgpr_write_b32 a152, v88
v_accvgpr_write_b32 a153, v89
v_accvgpr_write_b32 a154, v90
v_accvgpr_write_b32 a155, v91
v_accvgpr_write_b32 a156, v92
v_accvgpr_write_b32 a157, v93
v_accvgpr_write_b32 a158, v94
v_accvgpr_write_b32 a159, v95
s_add_u32 s25, s23, 425984
buffer_load_dwordx2 v[208:209], v3, s[48:51], s25 offen
s_add_u32 s25, s23, 428032
buffer_load_dwordx2 v[210:211], v3, s[48:51], s25 offen
s_add_u32 s25, s23, 430080
buffer_load_dwordx2 v[212:213], v3, s[48:51], s25 offen
s_add_u32 s25, s23, 432128
buffer_load_dwordx2 v[214:215], v3, s[48:51], s25 offen
s_add_u32 s25, s23, 427008
buffer_load_dwordx2 v[216:217], v3, s[48:51], s25 offen
s_add_u32 s25, s23, 429056
buffer_load_dwordx2 v[218:219], v3, s[48:51], s25 offen
s_add_u32 s25, s23, 431104
buffer_load_dwordx2 v[220:221], v3, s[48:51], s25 offen
s_add_u32 s25, s23, 433152
buffer_load_dwordx2 v[222:223], v3, s[48:51], s25 offen
s_waitcnt vmcnt(30)
v_perm_b32 v80, v226, v224, s26
s_waitcnt vmcnt(28)
v_perm_b32 v81, v230, v228, s26
s_waitcnt vmcnt(26)
v_perm_b32 v82, v234, v232, s26
s_waitcnt vmcnt(24)
v_perm_b32 v83, v238, v236, s26
v_perm_b32 v84, v226, v224, s27
v_perm_b32 v85, v230, v228, s27
v_perm_b32 v86, v234, v232, s27
v_perm_b32 v87, v238, v236, s27
v_perm_b32 v88, v227, v225, s26
v_perm_b32 v89, v231, v229, s26
v_perm_b32 v90, v235, v233, s26
v_perm_b32 v91, v239, v237, s26
v_perm_b32 v92, v227, v225, s27
v_perm_b32 v93, v231, v229, s27
v_perm_b32 v94, v235, v233, s27
v_perm_b32 v95, v239, v237, s27
v_accvgpr_write_b32 a160, v80
v_accvgpr_write_b32 a161, v81
v_accvgpr_write_b32 a162, v82
v_accvgpr_write_b32 a163, v83
v_accvgpr_write_b32 a164, v84
v_accvgpr_write_b32 a165, v85
v_accvgpr_write_b32 a166, v86
v_accvgpr_write_b32 a167, v87
v_accvgpr_write_b32 a168, v88
v_accvgpr_write_b32 a169, v89
v_accvgpr_write_b32 a170, v90
v_accvgpr_write_b32 a171, v91
v_accvgpr_write_b32 a172, v92
v_accvgpr_write_b32 a173, v93
v_accvgpr_write_b32 a174, v94
v_accvgpr_write_b32 a175, v95
s_add_u32 s25, s23, 458752
buffer_load_dwordx2 v[224:225], v3, s[48:51], s25 offen
s_add_u32 s25, s23, 460800
buffer_load_dwordx2 v[226:227], v3, s[48:51], s25 offen
s_add_u32 s25, s23, 462848
buffer_load_dwordx2 v[228:229], v3, s[48:51], s25 offen
s_add_u32 s25, s23, 464896
buffer_load_dwordx2 v[230:231], v3, s[48:51], s25 offen
s_add_u32 s25, s23, 459776
buffer_load_dwordx2 v[232:233], v3, s[48:51], s25 offen
s_add_u32 s25, s23, 461824
buffer_load_dwordx2 v[234:235], v3, s[48:51], s25 offen
s_add_u32 s25, s23, 463872
buffer_load_dwordx2 v[236:237], v3, s[48:51], s25 offen
s_add_u32 s25, s23, 465920
buffer_load_dwordx2 v[238:239], v3, s[48:51], s25 offen
s_barrier
s_cmp_lg_u32 s19, 0
s_cbranch_scc1 SG_122
s_load_dwordx2 s[62:63], s[0:1], 88
v_mov_b32 v60, 16
s_and_b32 s61, s17, 1
v_lshl_add_u32 v60, s61, 2, v60
v_mov_b32 v61, 1
s_mov_b64 exec, 1
s_waitcnt lgkmcnt(0)
global_atomic_add v60, v61, s[62:63]
s_mov_b64 exec, -1
SG_122:
s_waitcnt vmcnt(30)
v_perm_b32 v80, v242, v240, s26
s_waitcnt vmcnt(28)
v_perm_b32 v81, v246, v244, s26
s_waitcnt vmcnt(26)
v_perm_b32 v82, v250, v248, s26
s_waitcnt vmcnt(24)
v_perm_b32 v83, v254, v252, s26
v_perm_b32 v84, v242, v240, s27
v_perm_b32 v85, v246, v244, s27
v_perm_b32 v86, v250, v248, s27
v_perm_b32 v87, v254, v252, s27
v_perm_b32 v88, v243, v241, s26
v_perm_b32 v89, v247, v245, s26
v_perm_b32 v90, v251, v249, s26
v_perm_b32 v91, v255, v253, s26
v_perm_b32 v92, v243, v241, s27
v_perm_b32 v93, v247, v245, s27
v_perm_b32 v94, v251, v249, s27
v_perm_b32 v95, v255, v253, s27
v_accvgpr_write_b32 a176, v80
v_accvgpr_write_b32 a177, v81
v_accvgpr_write_b32 a178, v82
v_accvgpr_write_b32 a179, v83
v_accvgpr_write_b32 a180, v84
v_accvgpr_write_b32 a181, v85
v_accvgpr_write_b32 a182, v86
v_accvgpr_write_b32 a183, v87
v_accvgpr_write_b32 a184, v88
v_accvgpr_write_b32 a185, v89
v_accvgpr_write_b32 a186, v90
v_accvgpr_write_b32 a187, v91
v_accvgpr_write_b32 a188, v92
v_accvgpr_write_b32 a189, v93
v_accvgpr_write_b32 a190, v94
v_accvgpr_write_b32 a191, v95
s_add_u32 s25, s23, 491520
buffer_load_dwordx2 v[240:241], v3, s[48:51], s25 offen
s_add_u32 s25, s23, 493568
buffer_load_dwordx2 v[242:243], v3, s[48:51], s25 offen
s_add_u32 s25, s23, 495616
buffer_load_dwordx2 v[244:245], v3, s[48:51], s25 offen
s_add_u32 s25, s23, 497664
buffer_load_dwordx2 v[246:247], v3, s[48:51], s25 offen
s_add_u32 s25, s23, 492544
buffer_load_dwordx2 v[248:249], v3, s[48:51], s25 offen
s_add_u32 s25, s23, 494592
buffer_load_dwordx2 v[250:251], v3, s[48:51], s25 offen
s_add_u32 s25, s23, 496640
buffer_load_dwordx2 v[252:253], v3, s[48:51], s25 offen
s_add_u32 s25, s23, 498688
buffer_load_dwordx2 v[254:255], v3, s[48:51], s25 offen
s_waitcnt vmcnt(30)
v_perm_b32 v80, v194, v192, s26
s_waitcnt vmcnt(28)
v_perm_b32 v81, v198, v196, s26
s_waitcnt vmcnt(26)
v_perm_b32 v82, v202, v200, s26
s_waitcnt vmcnt(24)
v_perm_b32 v83, v206, v204, s26
v_perm_b32 v84, v194, v192, s27
v_perm_b32 v85, v198, v196, s27
v_perm_b32 v86, v202, v200, s27
v_perm_b32 v87, v206, v204, s27
v_perm_b32 v88, v195, v193, s26
v_perm_b32 v89, v199, v197, s26
v_perm_b32 v90, v203, v201, s26
v_perm_b32 v91, v207, v205, s26
v_perm_b32 v92, v195, v193, s27
v_perm_b32 v93, v199, v197, s27
v_perm_b32 v94, v203, v201, s27
v_perm_b32 v95, v207, v205, s27
v_accvgpr_write_b32 a192, v80
v_accvgpr_write_b32 a193, v81
v_accvgpr_write_b32 a194, v82
v_accvgpr_write_b32 a195, v83
v_accvgpr_write_b32 a196, v84
v_accvgpr_write_b32 a197, v85
v_accvgpr_write_b32 a198, v86
v_accvgpr_write_b32 a199, v87
v_accvgpr_write_b32 a200, v88
v_accvgpr_write_b32 a201, v89
v_accvgpr_write_b32 a202, v90
v_accvgpr_write_b32 a203, v91
v_accvgpr_write_b32 a204, v92
v_accvgpr_write_b32 a205, v93
v_accvgpr_write_b32 a206, v94
v_accvgpr_write_b32 a207, v95
s_add_u32 s25, s28, 0
buffer_load_dwordx2 v[192:193], v3, s[56:59], s25 offen
s_add_u32 s25, s28, 1024
buffer_load_dwordx2 v[194:195], v3, s[56:59], s25 offen
s_add_u32 s25, s28, 2048
buffer_load_dwordx2 v[196:197], v3, s[56:59], s25 offen
s_add_u32 s25, s28, 3072
buffer_load_dwordx2 v[198:199], v3, s[56:59], s25 offen
s_add_u32 s25, s28, 4096
buffer_load_dwordx2 v[200:201], v3, s[56:59], s25 offen
s_add_u32 s25, s28, 5120
buffer_load_dwordx2 v[202:203], v3, s[56:59], s25 offen
s_add_u32 s25, s28, 6144
buffer_load_dwordx2 v[204:205], v3, s[56:59], s25 offen
s_add_u32 s25, s28, 7168
buffer_load_dwordx2 v[206:207], v3, s[56:59], s25 offen
s_waitcnt vmcnt(30)
v_perm_b32 v80, v210, v208, s26
s_waitcnt vmcnt(28)
v_perm_b32 v81, v214, v212, s26
s_waitcnt vmcnt(26)
v_perm_b32 v82, v218, v216, s26
s_waitcnt vmcnt(24)
v_perm_b32 v83, v222, v220, s26
v_perm_b32 v84, v210, v208, s27
v_perm_b32 v85, v214, v212, s27
v_perm_b32 v86, v218, v216, s27
v_perm_b32 v87, v222, v220, s27
v_perm_b32 v88, v211, v209, s26
v_perm_b32 v89, v215, v213, s26
v_perm_b32 v90, v219, v217, s26
v_perm_b32 v91, v223, v221, s26
v_perm_b32 v92, v211, v209, s27
v_perm_b32 v93, v215, v213, s27
v_perm_b32 v94, v219, v217, s27
v_perm_b32 v95, v223, v221, s27
v_accvgpr_write_b32 a208, v80
v_accvgpr_write_b32 a209, v81
v_accvgpr_write_b32 a210, v82
v_accvgpr_write_b32 a211, v83
v_accvgpr_write_b32 a212, v84
v_accvgpr_write_b32 a213, v85
v_accvgpr_write_b32 a214, v86
v_accvgpr_write_b32 a215, v87
v_accvgpr_write_b32 a216, v88
v_accvgpr_write_b32 a217, v89
v_accvgpr_write_b32 a218, v90
v_accvgpr_write_b32 a219, v91
v_accvgpr_write_b32 a220, v92
v_accvgpr_write_b32 a221, v93
v_accvgpr_write_b32 a222, v94
v_accvgpr_write_b32 a223, v95
s_add_u32 s25, s28, 128
buffer_load_dwordx2 v[208:209], v3, s[56:59], s25 offen
s_add_u32 s25, s28, 1152
buffer_load_dwordx2 v[210:211], v3, s[56:59], s25 offen
s_add_u32 s25, s28, 2176
buffer_load_dwordx2 v[212:213], v3, s[56:59], s25 offen
s_add_u32 s25, s28, 3200
buffer_load_dwordx2 v[214:215], v3, s[56:59], s25 offen
s_add_u32 s25, s28, 4224
buffer_load_dwordx2 v[216:217], v3, s[56:59], s25 offen
s_add_u32 s25, s28, 5248
buffer_load_dwordx2 v[218:219], v3, s[56:59], s25 offen
s_add_u32 s25, s28, 6272
buffer_load_dwordx2 v[220:221], v3, s[56:59], s25 offen
s_add_u32 s25, s28, 7296
buffer_load_dwordx2 v[222:223], v3, s[56:59], s25 offen
s_waitcnt vmcnt(30)
v_perm_b32 v80, v226, v224, s26
s_waitcnt vmcnt(28)
v_perm_b32 v81, v230, v228, s26
s_waitcnt vmcnt(26)
v_perm_b32 v82, v234, v232, s26
s_waitcnt vmcnt(24)
v_perm_b32 v83, v238, v236, s26
v_perm_b32 v84, v226, v224, s27
v_perm_b32 v85, v230, v228, s27
v_perm_b32 v86, v234, v232, s27
v_perm_b32 v87, v238, v236, s27
v_perm_b32 v88, v227, v225, s26
v_perm_b32 v89, v231, v229, s26
v_perm_b32 v90, v235, v233, s26
v_perm_b32 v91, v239, v237, s26
v_perm_b32 v92, v227, v225, s27
v_perm_b32 v93, v231, v229, s27
v_perm_b32 v94, v235, v233, s27
v_perm_b32 v95, v239, v237, s27
v_accvgpr_write_b32 a224, v80
v_accvgpr_write_b32 a225, v81
v_accvgpr_write_b32 a226, v82
v_accvgpr_write_b32 a227, v83
v_accvgpr_write_b32 a228, v84
v_accvgpr_write_b32 a229, v85
v_accvgpr_write_b32 a230, v86
v_accvgpr_write_b32 a231, v87
v_accvgpr_write_b32 a232, v88
v_accvgpr_write_b32 a233, v89
v_accvgpr_write_b32 a234, v90
v_accvgpr_write_b32 a235, v91
v_accvgpr_write_b32 a236, v92
v_accvgpr_write_b32 a237, v93
v_accvgpr_write_b32 a238, v94
v_accvgpr_write_b32 a239, v95
s_add_u32 s25, s28, 32768
buffer_load_dwordx2 v[224:225], v3, s[56:59], s25 offen
s_add_u32 s25, s28, 33792
buffer_load_dwordx2 v[226:227], v3, s[56:59], s25 offen
s_add_u32 s25, s28, 34816
buffer_load_dwordx2 v[228:229], v3, s[56:59], s25 offen
s_add_u32 s25, s28, 35840
buffer_load_dwordx2 v[230:231], v3, s[56:59], s25 offen
s_add_u32 s25, s28, 36864
buffer_load_dwordx2 v[232:233], v3, s[56:59], s25 offen
s_add_u32 s25, s28, 37888
buffer_load_dwordx2 v[234:235], v3, s[56:59], s25 offen
s_add_u32 s25, s28, 38912
buffer_load_dwordx2 v[236:237], v3, s[56:59], s25 offen
s_add_u32 s25, s28, 39936
buffer_load_dwordx2 v[238:239], v3, s[56:59], s25 offen
s_waitcnt vmcnt(30)
v_perm_b32 v80, v242, v240, s26
s_waitcnt vmcnt(28)
v_perm_b32 v81, v246, v244, s26
s_waitcnt vmcnt(26)
v_perm_b32 v82, v250, v248, s26
s_waitcnt vmcnt(24)
v_perm_b32 v83, v254, v252, s26
v_perm_b32 v84, v242, v240, s27
v_perm_b32 v85, v246, v244, s27
v_perm_b32 v86, v250, v248, s27
v_perm_b32 v87, v254, v252, s27
v_perm_b32 v88, v243, v241, s26
v_perm_b32 v89, v247, v245, s26
v_perm_b32 v90, v251, v249, s26
v_perm_b32 v91, v255, v253, s26
v_perm_b32 v92, v243, v241, s27
v_perm_b32 v93, v247, v245, s27
v_perm_b32 v94, v251, v249, s27
v_perm_b32 v95, v255, v253, s27
v_accvgpr_write_b32 a240, v80
v_accvgpr_write_b32 a241, v81
v_accvgpr_write_b32 a242, v82
v_accvgpr_write_b32 a243, v83
v_accvgpr_write_b32 a244, v84
v_accvgpr_write_b32 a245, v85
v_accvgpr_write_b32 a246, v86
v_accvgpr_write_b32 a247, v87
v_accvgpr_write_b32 a248, v88
v_accvgpr_write_b32 a249, v89
v_accvgpr_write_b32 a250, v90
v_accvgpr_write_b32 a251, v91
v_accvgpr_write_b32 a252, v92
v_accvgpr_write_b32 a253, v93
v_accvgpr_write_b32 a254, v94
v_accvgpr_write_b32 a255, v95
s_add_u32 s25, s28, 32896
buffer_load_dwordx2 v[240:241], v3, s[56:59], s25 offen
s_add_u32 s25, s28, 33920
buffer_load_dwordx2 v[242:243], v3, s[56:59], s25 offen
s_add_u32 s25, s28, 34944
buffer_load_dwordx2 v[244:245], v3, s[56:59], s25 offen
s_add_u32 s25, s28, 35968
buffer_load_dwordx2 v[246:247], v3, s[56:59], s25 offen
s_add_u32 s25, s28, 36992
buffer_load_dwordx2 v[248:249], v3, s[56:59], s25 offen
s_add_u32 s25, s28, 38016
buffer_load_dwordx2 v[250:251], v3, s[56:59], s25 offen
s_add_u32 s25, s28, 39040
buffer_load_dwordx2 v[252:253], v3, s[56:59], s25 offen
s_add_u32 s25, s28, 40064
buffer_load_dwordx2 v[254:255], v3, s[56:59], s25 offen
s_waitcnt vmcnt(30)
v_perm_b32 v96, v194, v192, s26
s_waitcnt vmcnt(28)
v_perm_b32 v97, v198, v196, s26
s_waitcnt vmcnt(26)
v_perm_b32 v98, v202, v200, s26
s_waitcnt vmcnt(24)
v_perm_b32 v99, v206, v204, s26
v_perm_b32 v100, v194, v192, s27
v_perm_b32 v101, v198, v196, s27
v_perm_b32 v102, v202, v200, s27
v_perm_b32 v103, v206, v204, s27
v_perm_b32 v104, v195, v193, s26
v_perm_b32 v105, v199, v197, s26
v_perm_b32 v106, v203, v201, s26
v_perm_b32 v107, v207, v205, s26
v_perm_b32 v108, v195, v193, s27
v_perm_b32 v109, v199, v197, s27
v_perm_b32 v110, v203, v201, s27
v_perm_b32 v111, v207, v205, s27
s_waitcnt vmcnt(22)
v_perm_b32 v112, v210, v208, s26
s_waitcnt vmcnt(20)
v_perm_b32 v113, v214, v212, s26
s_waitcnt vmcnt(18)
v_perm_b32 v114, v218, v216, s26
s_waitcnt vmcnt(16)
v_perm_b32 v115, v222, v220, s26
v_perm_b32 v116, v210, v208, s27
v_perm_b32 v117, v214, v212, s27
v_perm_b32 v118, v218, v216, s27
v_perm_b32 v119, v222, v220, s27
v_perm_b32 v120, v211, v209, s26
v_perm_b32 v121, v215, v213, s26
v_perm_b32 v122, v219, v217, s26
v_perm_b32 v123, v223, v221, s26
v_perm_b32 v124, v211, v209, s27
v_perm_b32 v125, v215, v213, s27
v_perm_b32 v126, v219, v217, s27
v_perm_b32 v127, v223, v221, s27
s_waitcnt vmcnt(14)
v_perm_b32 v20, v226, v224, s26
s_waitcnt vmcnt(12)
v_perm_b32 v21, v230, v228, s26
s_waitcnt vmcnt(10)
v_perm_b32 v22, v234, v232, s26
s_waitcnt vmcnt(8)
v_perm_b32 v23, v238, v236, s26
v_perm_b32 v24, v226, v224, s27
v_perm_b32 v25, v230, v228, s27
v_perm_b32 v26, v234, v232, s27
v_perm_b32 v27, v238, v236, s27
v_perm_b32 v28, v227, v225, s26
v_perm_b32 v29, v231, v229, s26
v_perm_b32 v30, v235, v233, s26
v_perm_b32 v31, v239, v237, s26
v_perm_b32 v32, v227, v225, s27
v_perm_b32 v33, v231, v229, s27
v_perm_b32 v34, v235, v233, s27
v_perm_b32 v35, v239, v237, s27
s_waitcnt vmcnt(6)
v_perm_b32 v36, v242, v240, s26
s_waitcnt vmcnt(4)
v_perm_b32 v37, v246, v244, s26
s_waitcnt vmcnt(2)
v_perm_b32 v38, v250, v248, s26
s_waitcnt vmcnt(0)
v_perm_b32 v39, v254, v252, s26
v_perm_b32 v40, v242, v240, s27
v_perm_b32 v41, v246, v244, s27
v_perm_b32 v42, v250, v248, s27
v_perm_b32 v43, v254, v252, s27
v_perm_b32 v44, v243, v241, s26
v_perm_b32 v45, v247, v245, s26
v_perm_b32 v46, v251, v249, s26
v_perm_b32 v47, v255, v253, s26
v_perm_b32 v48, v243, v241, s27
v_perm_b32 v49, v247, v245, s27
v_perm_b32 v50, v251, v249, s27
v_perm_b32 v51, v255, v253, s27
s_waitcnt vmcnt(0)
s_barrier
ds_read_b64_tr_b16 v[192:193], v6 offset:0
ds_read_b64_tr_b16 v[194:195], v6 offset:512
ds_read_b64_tr_b16 v[196:197], v6 offset:4096
ds_read_b64_tr_b16 v[198:199], v6 offset:4608
ds_read_b64_tr_b16 v[200:201], v6 offset:8192
ds_read_b64_tr_b16 v[202:203], v6 offset:8704
ds_read_b64_tr_b16 v[204:205], v6 offset:12288
ds_read_b64_tr_b16 v[206:207], v6 offset:12800
ds_read_b64_tr_b16 v[208:209], v6 offset:16384
ds_read_b64_tr_b16 v[210:211], v6 offset:16896
ds_read_b64_tr_b16 v[212:213], v6 offset:20480
ds_read_b64_tr_b16 v[214:215], v6 offset:20992
ds_read_b64_tr_b16 v[216:217], v6 offset:24576
ds_read_b64_tr_b16 v[218:219], v6 offset:25088
ds_read_b64_tr_b16 v[220:221], v6 offset:28672
ds_read_b64_tr_b16 v[222:223], v6 offset:29184
ds_read_b64_tr_b16 v[224:225], v6 offset:32768
ds_read_b64_tr_b16 v[226:227], v6 offset:33280
ds_read_b64_tr_b16 v[228:229], v6 offset:36864
ds_read_b64_tr_b16 v[230:231], v6 offset:37376
ds_read_b64_tr_b16 v[232:233], v6 offset:40960
ds_read_b64_tr_b16 v[234:235], v6 offset:41472
ds_read_b64_tr_b16 v[236:237], v6 offset:45056
ds_read_b64_tr_b16 v[238:239], v6 offset:45568
ds_read_b64_tr_b16 v[240:241], v6 offset:49152
ds_read_b64_tr_b16 v[242:243], v6 offset:49664
ds_read_b64_tr_b16 v[244:245], v6 offset:53248
ds_read_b64_tr_b16 v[246:247], v6 offset:53760
ds_read_b64_tr_b16 v[248:249], v6 offset:57344
ds_read_b64_tr_b16 v[250:251], v6 offset:57856
ds_read_b64_tr_b16 v[252:253], v6 offset:61440
ds_read_b64_tr_b16 v[254:255], v6 offset:61952
s_waitcnt lgkmcnt(0)
s_barrier
s_lshl_b32 s21, s19, 13
s_add_u32 s21, s21, 32768
v_lshl_add_u32 v8, v0, 4, s21
ds_write_b128 v8, v[20:23] offset:0
ds_write_b128 v8, v[24:27] offset:1024
ds_write_b128 v8, v[28:31] offset:2048
ds_write_b128 v8, v[32:35] offset:3072
ds_write_b128 v8, v[36:39] offset:4096
ds_write_b128 v8, v[40:43] offset:5120
ds_write_b128 v8, v[44:47] offset:6144
ds_write_b128 v8, v[48:51] offset:7168
s_waitcnt lgkmcnt(0)
v_mov_b32 v4, v6
v_mov_b32 v40, v0
v_mov_b32 v41, v1
v_mov_b32 v42, v2
v_mov_b32_e64 v43, v4
v_add_u32 v2, 98304, v43
v_lshlrev_b32 v0, 4, v40
s_lshl_b32 s21, s19, 13
v_add_u32 v11, s21, v0
v_lshrrev_b32 v44, 3, v41
v_lshlrev_b32_e64 v44, 11, v44
v_lshl_add_u32 v44, v42, 8, v44
v_bfe_u32 v45, v41, 1, 2
v_lshl_add_u32 v44, v45, 6, v44
v_and_b32_e64 v45, 1, v41
v_lshl_add_u32 v1, v45, 4, v44
s_lshr_b32 s21, s16, 1
s_lshl_b32 s21, s21, 11
s_and_b32 s22, s16, 1
s_lshl_b32 s22, s22, 10
s_add_u32 s21, s21, s22
s_lshl_b32 s22, s19, 8
s_add_u32 s21, s21, s22
v_lshlrev_b32 v44, 16, v42
v_lshl_add_u32 v44, v41, 4, v44
v_add_u32 v3, s21, v44
s_lshr_b32 s21, s16, 1
s_lshl_b32 s21, s21, 11
s_and_b32 s22, s16, 1
s_lshl_b32 s22, s22, 14
s_add_u32 s21, s21, s22
s_lshl_b32 s22, s19, 9
s_add_u32 s21, s21, s22
v_add_u32 v4, s21, v44
v_lshrrev_b32 v44, 1, v42
v_lshl_add_u32 v44, v44, 4, v41
s_lshl_b32 s21, s19, 5
v_add_u32 v44, s21, v44
v_and_b32 v45, 1, v42
v_lshlrev_b32 v46, 11, v45
v_lshl_add_u32 v5, v44, 4, v46
v_lshl_add_u32 v6, v44, 3, v46
s_lshl_b32 s21, s19, 3
s_add_u32 s21, s21, 68608
v_lshlrev_b32 v46, 5, v45
v_add_u32_e64 v9, s21, v46
v_add_u32 v10, 68608, v46
v_mul_u32_u24 v45, 144, v41
v_lshl_add_u32 v46, v42, 3, v45
s_lshl_b32 s22, s19, 5
s_add_u32 s22, s22, 65536
v_add_u32 v7, s22, v46
v_lshl_add_u32 v45, v42, 4, v45
v_add_u32 v8, 65536, v45
v_add_u32 v45, 0, v42
v_xor_b32 v45, v45, v41
v_lshlrev_b32_e64 v45, 4, v45
v_lshl_add_u32 v12, v41, 10, v45
v_add_u32 v45, 4, v42
v_xor_b32 v45, v45, v41
v_lshlrev_b32 v45, 4, v45
v_lshl_add_u32 v13, v41, 10, v45
v_add_u32 v45, 8, v42
v_xor_b32 v45, v45, v41
v_lshlrev_b32 v45, 4, v45
v_lshl_add_u32 v14, v41, 10, v45
v_add_u32 v45, 12, v42
v_xor_b32 v45, v45, v41
v_lshlrev_b32_e64 v45, 4, v45
v_lshl_add_u32 v15, v41, 10, v45
s_lshl_b32 s21, s19, 2
s_add_u32 s22, s21, 0
v_xor_b32 v45, s22, v40
v_lshlrev_b32 v45, 4, v45
v_add_u32 v16, 0, v45
s_add_u32 s22, s21, 1
v_xor_b32 v45, s22, v40
v_lshlrev_b32 v45, 4, v45
v_add_u32 v17, 1024, v45
s_add_u32 s22, s21, 2
v_xor_b32 v45, s22, v40
v_lshlrev_b32_e64 v45, 4, v45
v_add_u32 v18, 2048, v45
s_add_u32 s22, s21, 3
v_xor_b32 v45, s22, v40
v_lshlrev_b32_e64 v45, 4, v45
v_add_u32 v19, 3072, v45
v_mov_b32 v45, 0xf149f2ca
s_mov_b32 s22, 0xffffffff
s_mov_b32 s23, 0xfff0ffff
v_cndmask_b32 v20, 0, v45, s[22:23]
s_mov_b32 s22, 0xffffffff
s_mov_b32 s23, 0xffe0fffe
v_cndmask_b32 v21, 0, v45, s[22:23]
s_mov_b32 s22, 0xffffffff
s_mov_b32 s23, 0xffc0fffc
v_cndmask_b32 v22, 0, v45, s[22:23]
s_mov_b32 s22, 0xffffffff
s_mov_b32 s23, 0xff80fff8
v_cndmask_b32 v23, 0, v45, s[22:23]
s_mov_b32 s22, 0xf00fff00
s_mov_b32 s23, 0xfff00ff
v_cndmask_b32 v24, 0, v45, s[22:23]
s_mov_b32 s22, 0xe01ffe01
s_mov_b32 s23, 0x1fff01ff
v_cndmask_b32 v25, 0, v45, s[22:23]
s_mov_b32 s22, 0xc03ffc03
s_mov_b32 s23, 0x3fff03ff
v_cndmask_b32 v26, 0, v45, s[22:23]
s_mov_b32 s22, 0x807ff807
s_mov_b32 s23, 0x7fff07ff
v_cndmask_b32 v27, 0, v45, s[22:23]
v_and_b32 v45, 1, v41
v_lshlrev_b32 v45, 4, v45
v_mov_b32 v46, 0x3f80
v_lshlrev_b32_e64 v45, v45, v46
s_mov_b32 s22, 0x30003
s_mov_b32 s23, 0x3000300
v_cndmask_b32 v28, 0, v45, s[22:23]
s_mov_b32 s22, 0xc000c
s_mov_b32 s23, 0xc000c00
v_cndmask_b32 v29, 0, v45, s[22:23]
s_mov_b32 s22, 0x300030
s_mov_b32 s23, 0x30003000
v_cndmask_b32 v30, 0, v45, s[22:23]
s_mov_b32 s22, 0xc000c0
s_mov_b32 s23, 0xc000c000
v_cndmask_b32 v31, 0, v45, s[22:23]
s_load_dwordx2 s[4:5], s[0:1], 0
s_load_dwordx2 s[8:9], s[0:1], 80
s_and_b32 s37, s17, 1
s_lshr_b32 s20, s17, 1
s_mov_b32 s45, 0
s_mul_i32 s25, s17, 851968
s_add_u32 s25, s25, 154206208
s_mov_b32 s26, s25
s_lshl_b32 s23, s16, 14
s_add_u32 s27, s26, s23
s_add_u32 s28, s25, 262144
s_add_u32 s29, s28, s23
s_mov_b32 s41, 0x3eb8aa3b
s_mov_b32 s42, 0x3eb8aa3b
s_mov_b32 s43, 0x3b000000
s_mov_b32 s44, 0x3727c5ac
s_lshl_b32 s39, s19, 13
s_add_u32 s40, s39, 4096
s_lshr_b32 s47, s16, 1
s_lshl_b32 s47, s47, 2
s_and_b32 s23, s16, 1
s_add_u32 s47, s47, s23
s_lshl_b32 s47, s47, 10
s_lshl_b32 s64, s23, 10
s_lshl_b32 s65, s19, 12
s_waitcnt lgkmcnt(0)
s_mov_b32 s6, 0x200000
s_mov_b32 s7, 0x20000
s_mov_b32 s10, 0x200000
s_mov_b32 s11, 0x20000
s_cmp_eq_u32 s37, 1
s_cselect_b32 s4, s12, s4
s_cselect_b32 s5, s13, s5
s_cselect_b32 s6, s14, s6
s_barrier
s_cmp_lg_u32 s19, 0
s_cbranch_scc1 RS_124
s_load_dwordx2 s[62:63], s[0:1], 88
v_mov_b32 v62, 48
s_and_b32 s61, s17, 1
s_lshl_b32 s61, s61, 2
s_add_u32 s61, s61, 16
v_mov_b32 v60, 208
v_writelane_b32 v60, s61, 1
s_mov_b32 s61, 0
s_mov_b64 exec, 3
s_waitcnt lgkmcnt(0)
s_branch RF_125
RW_123:
s_add_u32 s61, s61, 1
s_cmp_gt_u32 s61, 2097152
s_cbranch_scc1 FAIL
s_sleep 20
RF_125:
global_load_dword v61, v60, s[62:63] sc1
s_waitcnt vmcnt(0)
v_cmp_gt_u32_e64 vcc, v62, v61
s_cbranch_vccnz RW_123
s_mov_b64 exec, -1
RS_124:
s_barrier
s_cmp_eq_u32 s18, 0
s_cbranch_scc1 WBS
s_lshl_b32 s33, s37, 5
s_lshr_b32 s24, s16, 1
s_lshl_b32 s24, s24, 2
s_add_u32 s33, s33, s24
s_add_u32 s33, s33, s19
s_lshl_b32 s33, s33, 6
s_add_u32 s33, s33, s20
s_lshl_b32 s33, s33, 13
s_add_u32 s33, s33, 100663296
s_add_u32 s46, s33, 4096
WL_126:
s_mov_b32 m0, s39
s_nop 0
buffer_load_dwordx4 v0, s[12:15], s33 offen offset:0 sc1 lds
buffer_load_dwordx4 v0, s[12:15], s33 offen offset:1024 sc1 lds
buffer_load_dwordx4 v0, s[12:15], s33 offen offset:2048 sc1 lds
buffer_load_dwordx4 v0, s[12:15], s33 offen offset:3072 sc1 lds
s_mov_b32 m0, s40
s_nop 0
buffer_load_dwordx4 v0, s[12:15], s46 offen offset:0 sc1 lds
buffer_load_dwordx4 v0, s[12:15], s46 offen offset:1024 sc1 lds
buffer_load_dwordx4 v0, s[12:15], s46 offen offset:2048 sc1 lds
buffer_load_dwordx4 v0, s[12:15], s46 offen offset:3072 sc1 lds
s_and_b32 s21, s45, 1
s_bfe_u32 s48, s45, 0x10001
s_lshl_b32 s23, s21, 19
s_add_u32 s26, s25, s23
s_lshl_b32 s23, s16, 14
s_add_u32 s27, s26, s23
s_lshl_b32 s23, s37, 6
s_add_u32 s23, s23, s20
s_lshl_b32 s35, s23, 4
s_add_u32 s35, s35, s16
s_lshl_b32 s35, s35, 2
s_add_u32 s35, s35, s19
s_lshl_b32 s35, s35, 10
s_add_u32 s35, s35, 142606336
s_sub_u32 s36, s35, 65536
s_lshl_b32 s34, s20, 15
s_add_u32 s34, s34, s47
s_lshl_b32 s23, s21, 15
s_add_u32 s32, s25, s23
s_add_u32 s32, s32, 786432
s_add_u32 s30, s32, s47
s_xor_b32 s23, s23, 0x8000
s_add_u32 s31, s25, s23
s_add_u32 s31, s31, 786432
s_add_u32 s31, s31, s47
s_add_u32 s32, s32, s39
s_add_u32 s32, s32, s64
s_mov_b32 s22, 0
s_waitcnt vmcnt(0)
s_branch WOK_128
WO_127:
s_mov_b64 exec, -1
s_mov_b32 m0, s39
s_nop 0
buffer_load_dwordx4 v0, s[12:15], s33 offen offset:0 sc1 lds
buffer_load_dwordx4 v0, s[12:15], s33 offen offset:1024 sc1 lds
buffer_load_dwordx4 v0, s[12:15], s33 offen offset:2048 sc1 lds
buffer_load_dwordx4 v0, s[12:15], s33 offen offset:3072 sc1 lds
s_mov_b32 m0, s40
s_nop 0
buffer_load_dwordx4 v0, s[12:15], s46 offen offset:0 sc1 lds
buffer_load_dwordx4 v0, s[12:15], s46 offen offset:1024 sc1 lds
buffer_load_dwordx4 v0, s[12:15], s46 offen offset:2048 sc1 lds
buffer_load_dwordx4 v0, s[12:15], s46 offen offset:3072 sc1 lds
s_add_u32 s22, s22, 1
s_cmp_gt_u32 s22, 2097152
s_cbranch_scc1 FAIL
s_waitcnt vmcnt(0)
WOK_128:
ds_read_b128 v[48:51], v11 offset:0
ds_read_b128 v[52:55], v11 offset:1024
ds_read_b128 v[56:59], v11 offset:2048
ds_read_b128 v[60:63], v11 offset:3072
ds_read_b128 v[64:67], v11 offset:4096
ds_read_b128 v[68:71], v11 offset:5120
ds_read_b128 v[72:75], v11 offset:6144
ds_read_b128 v[76:79], v11 offset:7168
s_waitcnt lgkmcnt(6)
v_max_u32_e64 v36, v48, v52
s_waitcnt lgkmcnt(4)
v_max3_u32 v36, v36, v56, v60
s_waitcnt lgkmcnt(2)
v_max3_u32 v36, v36, v64, v68
s_waitcnt lgkmcnt(0)
v_max3_u32 v36, v36, v72, v76
v_cmp_eq_u32_e64 vcc, -1, v36
s_cbranch_vccz WK_129
s_mov_b64 exec, vcc
s_branch WO_127
WK_129:
s_barrier
ds_read_b128 v[80:83], v1 offset:32
ds_read_b128 v[84:87], v1 offset:1056
ds_read_b128 v[88:91], v1 offset:0
s_waitcnt lgkmcnt(2)
v_mfma_f32_16x16x32_bf16 v[48:51], v[80:83], a[0:3], 0
ds_read_b128 v[92:95], v1 offset:1024
v_mfma_f32_16x16x32_bf16 v[52:55], v[80:83], a[4:7], 0
s_mul_i32 s23, s37, 140509184
s_add_u32 s38, s23, s34
buffer_load_dwordx2 v[46:47], v6, s[4:7], s38 offen sc1
v_mfma_f32_16x16x32_bf16 v[56:59], v[80:83], a[8:11], 0
v_mfma_f32_16x16x32_bf16 v[60:63], v[80:83], a[12:15], 0
s_waitcnt lgkmcnt(2)
v_mfma_f32_16x16x32_bf16 v[48:51], v[84:87], a[16:19], v[48:51]
ds_read_b128 v[80:83], v1 offset:8224
v_mfma_f32_16x16x32_bf16 v[52:55], v[84:87], a[20:23], v[52:55]
v_mov_b64 v[36:37], -1
v_mov_b64_e64 v[38:39], -1
v_mfma_f32_16x16x32_bf16 v[56:59], v[84:87], a[24:27], v[56:59]
v_mfma_f32_16x16x32_bf16 v[60:63], v[84:87], a[28:31], v[60:63]
s_waitcnt lgkmcnt(2)
v_mfma_f32_16x16x32_bf16 v[48:51], v[88:91], a[32:35], v[48:51]
ds_read_b128 v[84:87], v1 offset:9248
v_mfma_f32_16x16x32_bf16 v[52:55], v[88:91], a[36:39], v[52:55]
s_add_u32 s23, s35, 196608
s_cmp_ge_u32 s20, 61
s_cselect_b32 s23, s14, s23
buffer_store_dwordx4 v[36:39], v0, s[12:15], s23 offen sc1
v_mfma_f32_16x16x32_bf16 v[56:59], v[88:91], a[40:43], v[56:59]
v_mfma_f32_16x16x32_bf16 v[60:63], v[88:91], a[44:47], v[60:63]
s_waitcnt lgkmcnt(2)
v_mfma_f32_16x16x32_bf16 v[48:51], v[92:95], a[48:51], v[48:51]
ds_read_b128 v[88:91], v1 offset:8192
v_mfma_f32_16x16x32_bf16 v[52:55], v[92:95], a[52:55], v[52:55]
s_cmp_ge_u32 s20, 61
s_cselect_b32 s24, 1, s37
v_mfma_f32_16x16x32_bf16 v[56:59], v[92:95], a[56:59], v[56:59]
v_mfma_f32_16x16x32_bf16 v[60:63], v[92:95], a[60:63], v[60:63]
s_waitcnt lgkmcnt(2)
v_mfma_f32_16x16x32_bf16 v[48:51], v[80:83], a[64:67], v[48:51]
ds_read_b128 v[92:95], v1 offset:9216
v_mfma_f32_16x16x32_bf16 v[52:55], v[80:83], a[68:71], v[52:55]
s_add_u32 s23, s34, 138510336
s_cmp_eq_u32 s24, 1
s_cselect_b32 s23, s14, s23
buffer_store_dwordx2 v[36:37], v6, s[12:15], s23 offen sc1
v_mfma_f32_16x16x32_bf16 v[56:59], v[80:83], a[72:75], v[56:59]
v_mfma_f32_16x16x32_bf16 v[60:63], v[80:83], a[76:79], v[60:63]
s_waitcnt lgkmcnt(2)
v_mfma_f32_16x16x32_bf16 v[48:51], v[84:87], a[80:83], v[48:51]
ds_read_b128 v[80:83], v1 offset:16416
v_mfma_f32_16x16x32_bf16 v[52:55], v[84:87], a[84:87], v[52:55]
v_mfma_f32_16x16x32_bf16 v[56:59], v[84:87], a[88:91], v[56:59]
v_mfma_f32_16x16x32_bf16 v[60:63], v[84:87], a[92:95], v[60:63]
s_waitcnt lgkmcnt(2)
v_mfma_f32_16x16x32_bf16 v[48:51], v[88:91], a[96:99], v[48:51]
ds_read_b128 v[84:87], v1 offset:17440
v_mfma_f32_16x16x32_bf16 v[52:55], v[88:91], a[100:103], v[52:55]
s_add_u32 s23, s34, 140607488
s_cmp_eq_u32 s24, 1
s_cselect_b32 s23, s14, s23
buffer_store_dwordx2 v[36:37], v6, s[12:15], s23 offen sc1
v_mfma_f32_16x16x32_bf16 v[56:59], v[88:91], a[104:107], v[56:59]
v_mfma_f32_16x16x32_bf16 v[60:63], v[88:91], a[108:111], v[60:63]
s_waitcnt lgkmcnt(2)
v_mfma_f32_16x16x32_bf16 v[48:51], v[92:95], a[112:115], v[48:51]
ds_read_b128 v[88:91], v1 offset:16384
v_mfma_f32_16x16x32_bf16 v[52:55], v[92:95], a[116:119], v[52:55]
v_mfma_f32_16x16x32_bf16 v[56:59], v[92:95], a[120:123], v[56:59]
v_mfma_f32_16x16x32_bf16 v[60:63], v[92:95], a[124:127], v[60:63]
s_waitcnt lgkmcnt(2)
v_mfma_f32_16x16x32_bf16 v[48:51], v[80:83], a[128:131], v[48:51]
ds_read_b128 v[92:95], v1 offset:17408
v_mfma_f32_16x16x32_bf16 v[52:55], v[80:83], a[132:135], v[52:55]
v_mfma_f32_16x16x32_bf16 v[56:59], v[80:83], a[136:139], v[56:59]
v_mfma_f32_16x16x32_bf16 v[60:63], v[80:83], a[140:143], v[60:63]
s_waitcnt lgkmcnt(2)
v_mfma_f32_16x16x32_bf16 v[48:51], v[84:87], a[144:147], v[48:51]
ds_read_b128 v[80:83], v1 offset:24608
v_mfma_f32_16x16x32_bf16 v[52:55], v[84:87], a[148:151], v[52:55]
v_mfma_f32_16x16x32_bf16 v[56:59], v[84:87], a[152:155], v[56:59]
v_mfma_f32_16x16x32_bf16 v[60:63], v[84:87], a[156:159], v[60:63]
s_waitcnt lgkmcnt(2)
v_mfma_f32_16x16x32_bf16 v[48:51], v[88:91], a[160:163], v[48:51]
ds_read_b128 v[84:87], v1 offset:25632
v_mfma_f32_16x16x32_bf16 v[52:55], v[88:91], a[164:167], v[52:55]
v_mfma_f32_16x16x32_bf16 v[56:59], v[88:91], a[168:171], v[56:59]
v_mfma_f32_16x16x32_bf16 v[60:63], v[88:91], a[172:175], v[60:63]
s_waitcnt lgkmcnt(2)
v_mfma_f32_16x16x32_bf16 v[48:51], v[92:95], a[176:179], v[48:51]
ds_read_b128 v[88:91], v1 offset:24576
v_mfma_f32_16x16x32_bf16 v[52:55], v[92:95], a[180:183], v[52:55]
v_mfma_f32_16x16x32_bf16 v[56:59], v[92:95], a[184:187], v[56:59]
v_mfma_f32_16x16x32_bf16 v[60:63], v[92:95], a[188:191], v[60:63]
s_waitcnt lgkmcnt(2)
v_mfma_f32_16x16x32_bf16 v[48:51], v[80:83], a[192:195], v[48:51]
ds_read_b128 v[92:95], v1 offset:25600
v_mfma_f32_16x16x32_bf16 v[52:55], v[80:83], a[196:199], v[52:55]
v_mfma_f32_16x16x32_bf16 v[56:59], v[80:83], a[200:203], v[56:59]
v_mfma_f32_16x16x32_bf16 v[60:63], v[80:83], a[204:207], v[60:63]
s_waitcnt lgkmcnt(2)
v_mfma_f32_16x16x32_bf16 v[48:51], v[84:87], a[208:211], v[48:51]
ds_read_b128 v[80:83], v1 offset:4128
v_mfma_f32_16x16x32_bf16 v[52:55], v[84:87], a[212:215], v[52:55]
v_mfma_f32_16x16x32_bf16 v[56:59], v[84:87], a[216:219], v[56:59]
v_mfma_f32_16x16x32_bf16 v[60:63], v[84:87], a[220:223], v[60:63]
s_waitcnt lgkmcnt(2)
v_mfma_f32_16x16x32_bf16 v[48:51], v[88:91], a[224:227], v[48:51]
ds_read_b128 v[84:87], v1 offset:5152
v_mfma_f32_16x16x32_bf16 v[52:55], v[88:91], a[228:231], v[52:55]
v_mfma_f32_16x16x32_bf16 v[56:59], v[88:91], a[232:235], v[56:59]
v_mfma_f32_16x16x32_bf16 v[60:63], v[88:91], a[236:239], v[60:63]
s_waitcnt lgkmcnt(2)
v_mfma_f32_16x16x32_bf16 v[48:51], v[92:95], a[240:243], v[48:51]
ds_read_b128 v[88:91], v1 offset:4096
v_mfma_f32_16x16x32_bf16 v[52:55], v[92:95], a[244:247], v[52:55]
v_mfma_f32_16x16x32_bf16 v[56:59], v[92:95], a[248:251], v[56:59]
v_mfma_f32_16x16x32_bf16 v[60:63], v[92:95], a[252:255], v[60:63]
s_waitcnt lgkmcnt(2)
v_mfma_f32_16x16x32_bf16 v[64:67], v[80:83], a[0:3], 0
ds_read_b128 v[92:95], v1 offset:5120
v_mfma_f32_16x16x32_bf16 v[68:71], v[80:83], a[4:7], 0
v_mfma_f32_16x16x32_bf16 v[72:75], v[80:83], a[8:11], 0
v_mfma_f32_16x16x32_bf16 v[76:79], v[80:83], a[12:15], 0
s_waitcnt lgkmcnt(2)
v_mfma_f32_16x16x32_bf16 v[64:67], v[84:87], a[16:19], v[64:67]
ds_read_b128 v[80:83], v1 offset:12320
v_mfma_f32_16x16x32_bf16 v[68:71], v[84:87], a[20:23], v[68:71]
v_mfma_f32_16x16x32_bf16 v[72:75], v[84:87], a[24:27], v[72:75]
s_add_u32 s23, s26, 0
v_mfma_f32_16x16x32_bf16 v[76:79], v[84:87], a[28:31], v[76:79]
v_cvt_pk_bf16_f32 v36, v48, v52
s_waitcnt lgkmcnt(2)
v_mfma_f32_16x16x32_bf16 v[64:67], v[88:91], a[32:35], v[64:67]
ds_read_b128 v[84:87], v1 offset:13344
v_mfma_f32_16x16x32_bf16 v[68:71], v[88:91], a[36:39], v[68:71]
v_mfma_f32_16x16x32_bf16 v[72:75], v[88:91], a[40:43], v[72:75]
v_cvt_pk_bf16_f32 v37, v56, v60
v_mfma_f32_16x16x32_bf16 v[76:79], v[88:91], a[44:47], v[76:79]
v_cvt_pk_bf16_f32 v38, v49, v53
s_waitcnt lgkmcnt(2)
v_mfma_f32_16x16x32_bf16 v[64:67], v[92:95], a[48:51], v[64:67]
ds_read_b128 v[88:91], v1 offset:12288
v_mfma_f32_16x16x32_bf16 v[68:71], v[92:95], a[52:55], v[68:71]
v_mfma_f32_16x16x32_bf16 v[72:75], v[92:95], a[56:59], v[72:75]
v_cvt_pk_bf16_f32 v39, v57, v61
v_mfma_f32_16x16x32_bf16 v[76:79], v[92:95], a[60:63], v[76:79]
v_and_or_b32 v36, v36, -2, s48
s_waitcnt lgkmcnt(2)
v_mfma_f32_16x16x32_bf16 v[64:67], v[80:83], a[64:67], v[64:67]
ds_read_b128 v[92:95], v1 offset:13312
v_mfma_f32_16x16x32_bf16 v[68:71], v[80:83], a[68:71], v[68:71]
v_mfma_f32_16x16x32_bf16 v[72:75], v[80:83], a[72:75], v[72:75]
buffer_store_dwordx4 v[36:39], v3, s[12:15], s23 offen offset:0
v_mfma_f32_16x16x32_bf16 v[76:79], v[80:83], a[76:79], v[76:79]
s_add_u32 s23, s26, 32768
s_waitcnt lgkmcnt(2)
v_mfma_f32_16x16x32_bf16 v[64:67], v[84:87], a[80:83], v[64:67]
ds_read_b128 v[80:83], v1 offset:20512
v_mfma_f32_16x16x32_bf16 v[68:71], v[84:87], a[84:87], v[68:71]
v_mfma_f32_16x16x32_bf16 v[72:75], v[84:87], a[88:91], v[72:75]
v_cvt_pk_bf16_f32 v40, v50, v54
v_mfma_f32_16x16x32_bf16 v[76:79], v[84:87], a[92:95], v[76:79]
v_cvt_pk_bf16_f32 v41, v58, v62
s_waitcnt lgkmcnt(2)
v_mfma_f32_16x16x32_bf16 v[64:67], v[88:91], a[96:99], v[64:67]
ds_read_b128 v[84:87], v1 offset:21536
v_mfma_f32_16x16x32_bf16 v[68:71], v[88:91], a[100:103], v[68:71]
v_mfma_f32_16x16x32_bf16 v[72:75], v[88:91], a[104:107], v[72:75]
v_cvt_pk_bf16_f32 v42, v51, v55
v_mfma_f32_16x16x32_bf16 v[76:79], v[88:91], a[108:111], v[76:79]
v_cvt_pk_bf16_f32 v43, v59, v63
s_waitcnt lgkmcnt(2)
v_mfma_f32_16x16x32_bf16 v[64:67], v[92:95], a[112:115], v[64:67]
ds_read_b128 v[88:91], v1 offset:20480
v_mfma_f32_16x16x32_bf16 v[68:71], v[92:95], a[116:119], v[68:71]
v_mfma_f32_16x16x32_bf16 v[72:75], v[92:95], a[120:123], v[72:75]
v_and_or_b32 v40, v40, -2, s48
v_mfma_f32_16x16x32_bf16 v[76:79], v[92:95], a[124:127], v[76:79]
buffer_store_dwordx4 v[40:43], v3, s[12:15], s23 offen offset:0
s_waitcnt lgkmcnt(2)
v_mfma_f32_16x16x32_bf16 v[64:67], v[80:83], a[128:131], v[64:67]
ds_read_b128 v[92:95], v1 offset:21504
v_mfma_f32_16x16x32_bf16 v[68:71], v[80:83], a[132:135], v[68:71]
v_mfma_f32_16x16x32_bf16 v[72:75], v[80:83], a[136:139], v[72:75]
v_mfma_f32_16x16x32_bf16 v[76:79], v[80:83], a[140:143], v[76:79]
s_waitcnt lgkmcnt(2)
v_mfma_f32_16x16x32_bf16 v[64:67], v[84:87], a[144:147], v[64:67]
ds_read_b128 v[80:83], v1 offset:28704
v_mfma_f32_16x16x32_bf16 v[68:71], v[84:87], a[148:151], v[68:71]
v_mfma_f32_16x16x32_bf16 v[72:75], v[84:87], a[152:155], v[72:75]
v_mfma_f32_16x16x32_bf16 v[76:79], v[84:87], a[156:159], v[76:79]
s_waitcnt lgkmcnt(2)
v_mfma_f32_16x16x32_bf16 v[64:67], v[88:91], a[160:163], v[64:67]
ds_read_b128 v[84:87], v1 offset:29728
v_mfma_f32_16x16x32_bf16 v[68:71], v[88:91], a[164:167], v[68:71]
v_mfma_f32_16x16x32_bf16 v[72:75], v[88:91], a[168:171], v[72:75]
v_mfma_f32_16x16x32_bf16 v[76:79], v[88:91], a[172:175], v[76:79]
s_waitcnt lgkmcnt(2)
v_mfma_f32_16x16x32_bf16 v[64:67], v[92:95], a[176:179], v[64:67]
ds_read_b128 v[88:91], v1 offset:28672
v_mfma_f32_16x16x32_bf16 v[68:71], v[92:95], a[180:183], v[68:71]
v_mfma_f32_16x16x32_bf16 v[72:75], v[92:95], a[184:187], v[72:75]
v_mfma_f32_16x16x32_bf16 v[76:79], v[92:95], a[188:191], v[76:79]
s_waitcnt lgkmcnt(2)
v_mfma_f32_16x16x32_bf16 v[64:67], v[80:83], a[192:195], v[64:67]
ds_read_b128 v[92:95], v1 offset:29696
v_mfma_f32_16x16x32_bf16 v[68:71], v[80:83], a[196:199], v[68:71]
v_mfma_f32_16x16x32_bf16 v[72:75], v[80:83], a[200:203], v[72:75]
v_mfma_f32_16x16x32_bf16 v[76:79], v[80:83], a[204:207], v[76:79]
s_waitcnt lgkmcnt(2)
v_mfma_f32_16x16x32_bf16 v[64:67], v[84:87], a[208:211], v[64:67]
v_mfma_f32_16x16x32_bf16 v[68:71], v[84:87], a[212:215], v[68:71]
v_mfma_f32_16x16x32_bf16 v[72:75], v[84:87], a[216:219], v[72:75]
v_mfma_f32_16x16x32_bf16 v[76:79], v[84:87], a[220:223], v[76:79]
s_waitcnt lgkmcnt(1)
v_mfma_f32_16x16x32_bf16 v[64:67], v[88:91], a[224:227], v[64:67]
v_mfma_f32_16x16x32_bf16 v[68:71], v[88:91], a[228:231], v[68:71]
v_mfma_f32_16x16x32_bf16 v[72:75], v[88:91], a[232:235], v[72:75]
v_mfma_f32_16x16x32_bf16 v[76:79], v[88:91], a[236:239], v[76:79]
s_waitcnt lgkmcnt(0)
v_mfma_f32_16x16x32_bf16 v[64:67], v[92:95], a[240:243], v[64:67]
v_mfma_f32_16x16x32_bf16 v[68:71], v[92:95], a[244:247], v[68:71]
v_mfma_f32_16x16x32_bf16 v[72:75], v[92:95], a[248:251], v[72:75]
v_mfma_f32_16x16x32_bf16 v[76:79], v[92:95], a[252:255], v[76:79]
s_add_u32 s23, s26, 16384
v_cvt_pk_bf16_f32 v36, v64, v68
s_nop 5
v_cvt_pk_bf16_f32 v37, v72, v76
v_cvt_pk_bf16_f32 v38, v65, v69
v_cvt_pk_bf16_f32 v39, v73, v77
v_and_or_b32 v36, v36, -2, s48
buffer_store_dwordx4 v[36:39], v3, s[12:15], s23 offen offset:0
s_add_u32 s23, s26, 49152
v_cvt_pk_bf16_f32 v40, v66, v70
v_cvt_pk_bf16_f32 v41, v74, v78
v_cvt_pk_bf16_f32 v42, v67, v71
v_cvt_pk_bf16_f32 v43, v75, v79
v_and_or_b32 v40, v40, -2, s48
buffer_store_dwordx4 v[40:43], v3, s[12:15], s23 offen offset:0
s_mov_b32 s22, 0
s_waitcnt vmcnt(0)
WR_130:
buffer_load_dwordx4 v[48:51], v5, s[12:15], s27 offen sc1
s_add_u32 s23, s27, 4096
buffer_load_dwordx4 v[52:55], v5, s[12:15], s23 offen sc1
s_add_u32 s23, s27, 8192
buffer_load_dwordx4 v[56:59], v5, s[12:15], s23 offen sc1
s_add_u32 s23, s27, 12288
buffer_load_dwordx4 v[60:63], v5, s[12:15], s23 offen sc1
s_mov_b64 exec, -1
s_add_u32 s22, s22, 1
s_cmp_gt_u32 s22, 2097152
s_cbranch_scc1 FAIL
s_waitcnt vmcnt(3)
v_mfma_f32_16x16x32_bf16 v[40:43], v[28:31], v[48:51], 0
v_xor_b32 v36, s48, v48
s_waitcnt vmcnt(2)
v_mfma_f32_16x16x32_bf16 v[40:43], v[28:31], v[52:55], v[40:43]
v_bitop3_b32 v36, v36, v52, s48 bitop3:0xf6
s_waitcnt vmcnt(1)
v_mfma_f32_16x16x32_bf16 v[40:43], v[28:31], v[56:59], v[40:43]
v_bitop3_b32 v36, v36, v56, s48 bitop3:0xf6
s_waitcnt vmcnt(0)
v_mfma_f32_16x16x32_bf16 v[40:43], v[28:31], v[60:63], v[40:43]
v_bitop3_b32 v36, v36, v60, s48 bitop3:0xf6
v_and_b32 v36, 1, v36
v_cmp_ne_u32_e64 vcc, 0, v36
s_cbranch_vccz WRE_131
s_mov_b64 exec, vcc
s_branch WR_130
WRE_131:
s_cmp_eq_u32 s37, 0
s_cbranch_scc1 WXK_133
WX_132:
s_waitcnt vmcnt(0)
v_cmp_eq_u32_e64 vcc, -1, v46
s_cbranch_vccz WXK_133
s_add_u32 s22, s22, 1
s_cmp_gt_u32 s22, 2097152
s_cbranch_scc1 FAIL
buffer_load_dwordx2 v[46:47], v6, s[4:7], s38 offen sc1
s_branch WX_132
WXK_133:
v_lshlrev_b32 v32, 16, v46
v_and_b32 v33, 0xffff0000, v46
v_lshlrev_b32_e64 v34, 16, v47
v_and_b32 v35, 0xffff0000, v47
v_pk_add_f32 v[32:33], v[32:33], v[40:41]
v_pk_add_f32 v[34:35], v[34:35], v[42:43]
v_add_f32 v48, v32, v33
v_mul_f32 v49, v32, v32
v_add_f32 v50, v34, v35
v_fmac_f32 v49, v33, v33
v_add_f32 v48, v48, v50
v_fmac_f32 v49, v34, v34
v_fmac_f32 v49, v35, v35
v_add_f32_dpp v48, v48, v48 row_ror:8 row_mask:0xf bank_mask:0xf
s_nop 0
v_add_f32_dpp v49, v49, v49 row_ror:8 row_mask:0xf bank_mask:0xf
v_add_f32_dpp v48, v48, v48 row_ror:4 row_mask:0xf bank_mask:0xf
s_nop 0
v_add_f32_dpp v49, v49, v49 row_ror:4 row_mask:0xf bank_mask:0xf
v_add_f32_dpp v48, v48, v48 row_ror:2 row_mask:0xf bank_mask:0xf
s_nop 0
v_add_f32_dpp v49, v49, v49 row_ror:2 row_mask:0xf bank_mask:0xf
v_add_f32_dpp v48, v48, v48 row_ror:1 row_mask:0xf bank_mask:0xf
s_nop 0
v_add_f32_dpp v49, v49, v49 row_ror:1 row_mask:0xf bank_mask:0xf
v_mov_b32 v50, v48
v_mov_b32 v51, v49
s_nop 0
v_permlane32_swap_b32_e64 v48, v50
v_permlane32_swap_b32_e64 v49, v51
v_pk_add_f32 v[48:49], v[48:49], v[50:51]
s_mov_b64 exec, 0x10001
ds_write_b64 v9, v[48:49]
s_mov_b64 exec, -1
v_mov_b64 v[44:45], -1
buffer_store_dwordx2 v[44:45], v6, s[12:15], s31 offen
s_waitcnt lgkmcnt(0)
s_barrier
ds_read_b128 v[50:53], v10
ds_read_b128 v[54:57], v10 offset:16
s_waitcnt lgkmcnt(1)
v_pk_add_f32 v[50:51], v[50:51], v[52:53]
s_waitcnt lgkmcnt(0)
v_pk_add_f32 v[54:55], v[54:55], v[56:57]
v_pk_add_f32 v[50:51], v[50:51], v[54:55]
v_mul_f32 v50, s43, v50
v_mul_f32 v51, s43, v51
v_fma_f32 v51, -v50, v50, v51
v_max_f32 v51, 0, v51
v_add_f32 v51, s44, v51
v_rsq_f32 v48, v51
s_nop 0
v_mul_f32 v49, v50, v48
v_sub_f32 v49, 0, v49
v_fma_f32 v50, v32, v48, v49
v_fma_f32 v51, v33, v48, v49
v_fma_f32 v52, v34, v48, v49
v_fma_f32 v53, v35, v48, v49
v_cvt_pk_bf16_f32 v46, v50, v51
v_cvt_pk_bf16_f32 v47, v52, v53
v_min_u32_e64 v46, -2, v46
buffer_store_dwordx2 v[46:47], v6, s[12:15], s30 offen
s_mov_b32 s22, 0
v_add_u32 v37, s65, v0
s_mov_b32 m0, s65
s_waitcnt vmcnt(0)
WN_134:
buffer_load_dwordx4 v16, s[12:15], s32 offen offset:0 sc1 lds
buffer_load_dwordx4 v17, s[12:15], s32 offen offset:1024 sc1 lds
buffer_load_dwordx4 v18, s[12:15], s32 offen offset:2048 sc1 lds
buffer_load_dwordx4 v19, s[12:15], s32 offen offset:3072 sc1 lds
s_mov_b64 exec, -1
s_add_u32 s22, s22, 1
s_cmp_gt_u32 s22, 2097152
s_cbranch_scc1 FAIL
s_waitcnt vmcnt(0)
ds_read_b128 v[48:51], v37 offset:0
ds_read_b128 v[52:55], v37 offset:1024
ds_read_b128 v[56:59], v37 offset:2048
ds_read_b128 v[60:63], v37 offset:3072
s_waitcnt lgkmcnt(3)
v_max_u32 v36, v48, v50
s_waitcnt lgkmcnt(2)
v_max3_u32 v36, v36, v52, v54
s_waitcnt lgkmcnt(1)
v_max3_u32 v36, v36, v56, v58
s_waitcnt lgkmcnt(0)
v_max3_u32 v36, v36, v60, v62
v_cmp_eq_u32 vcc, -1, v36
s_cbranch_vccz WK_135
s_mov_b64 exec, vcc
s_branch WN_134
WK_135:
s_barrier
v_mov_b64_e64 v[44:45], 0
v_mov_b64_e64 v[46:47], 0
s_cmp_eq_u32 s20, 0
s_cbranch_scc1 WNH_136
buffer_load_dwordx4 v[44:47], v0, s[12:15], s36 offen sc1
WNH_136:
ds_read_b128 v[64:67], v12 offset:0
ds_read_b64_tr_b16 v[80:81], v2 offset:0
ds_read_b64_tr_b16 v[82:83], v2 offset:512
ds_read_b128 v[68:71], v13 offset:0
ds_read_b64_tr_b16 v[84:85], v2 offset:4096
ds_read_b64_tr_b16 v[86:87], v2 offset:4608
ds_read_b128 v[72:75], v14 offset:0
ds_read_b64_tr_b16 v[88:89], v2 offset:8192
ds_read_b64_tr_b16 v[90:91], v2 offset:8704
s_waitcnt lgkmcnt(8)
v_mfma_f32_16x16x32_bf16 v[52:55], v[192:195], v[64:67], 0
ds_read_b128 v[76:79], v15 offset:0
s_waitcnt lgkmcnt(7)
v_mfma_f32_16x16x32_bf16 v[56:59], v[64:67], v[80:83], 0
ds_read_b64_tr_b16 v[92:93], v2 offset:12288
ds_read_b64_tr_b16 v[94:95], v2 offset:12800
v_mfma_f32_16x16x32_bf16 v[48:51], v[128:131], v[64:67], 0
s_waitcnt lgkmcnt(8)
v_mfma_f32_16x16x32_bf16 v[52:55], v[196:199], v[68:71], v[52:55]
ds_read_b128 v[64:67], v12 offset:256
s_waitcnt lgkmcnt(7)
v_mfma_f32_16x16x32_bf16 v[56:59], v[68:71], v[84:87], v[56:59]
ds_read_b64_tr_b16 v[80:81], v2 offset:16384
ds_read_b64_tr_b16 v[82:83], v2 offset:16896
v_mfma_f32_16x16x32_bf16 v[48:51], v[132:135], v[68:71], v[48:51]
s_waitcnt lgkmcnt(8)
v_mfma_f32_16x16x32_bf16 v[52:55], v[200:203], v[72:75], v[52:55]
ds_read_b128 v[68:71], v13 offset:256
s_waitcnt lgkmcnt(7)
v_mfma_f32_16x16x32_bf16 v[56:59], v[72:75], v[88:91], v[56:59]
ds_read_b64_tr_b16 v[84:85], v2 offset:20480
ds_read_b64_tr_b16 v[86:87], v2 offset:20992
v_mfma_f32_16x16x32_bf16 v[48:51], v[136:139], v[72:75], v[48:51]
s_waitcnt lgkmcnt(8)
v_mfma_f32_16x16x32_bf16 v[52:55], v[204:207], v[76:79], v[52:55]
ds_read_b128 v[72:75], v14 offset:256
s_waitcnt lgkmcnt(7)
v_mfma_f32_16x16x32_bf16 v[56:59], v[76:79], v[92:95], v[56:59]
ds_read_b64_tr_b16 v[88:89], v2 offset:24576
ds_read_b64_tr_b16 v[90:91], v2 offset:25088
v_mfma_f32_16x16x32_bf16 v[48:51], v[140:143], v[76:79], v[48:51]
s_waitcnt lgkmcnt(8)
v_mfma_f32_16x16x32_bf16 v[52:55], v[208:211], v[64:67], v[52:55]
ds_read_b128 v[76:79], v15 offset:256
s_waitcnt lgkmcnt(7)
v_mfma_f32_16x16x32_bf16 v[56:59], v[64:67], v[80:83], v[56:59]
ds_read_b64_tr_b16 v[92:93], v2 offset:28672
ds_read_b64_tr_b16 v[94:95], v2 offset:29184
v_mfma_f32_16x16x32_bf16 v[48:51], v[144:147], v[64:67], v[48:51]
s_waitcnt lgkmcnt(8)
v_mfma_f32_16x16x32_bf16 v[52:55], v[212:215], v[68:71], v[52:55]
ds_read_b128 v[64:67], v12 offset:512
s_waitcnt lgkmcnt(7)
v_mfma_f32_16x16x32_bf16 v[56:59], v[68:71], v[84:87], v[56:59]
ds_read_b64_tr_b16 v[80:81], v2 offset:32768
ds_read_b64_tr_b16 v[82:83], v2 offset:33280
v_mfma_f32_16x16x32_bf16 v[48:51], v[148:151], v[68:71], v[48:51]
s_waitcnt lgkmcnt(8)
v_mfma_f32_16x16x32_bf16 v[52:55], v[216:219], v[72:75], v[52:55]
ds_read_b128 v[68:71], v13 offset:512
s_waitcnt lgkmcnt(7)
v_mfma_f32_16x16x32_bf16 v[56:59], v[72:75], v[88:91], v[56:59]
ds_read_b64_tr_b16 v[84:85], v2 offset:36864
ds_read_b64_tr_b16 v[86:87], v2 offset:37376
v_mfma_f32_16x16x32_bf16 v[48:51], v[152:155], v[72:75], v[48:51]
s_waitcnt lgkmcnt(8)
v_mfma_f32_16x16x32_bf16 v[52:55], v[220:223], v[76:79], v[52:55]
ds_read_b128 v[72:75], v14 offset:512
s_waitcnt lgkmcnt(7)
v_mfma_f32_16x16x32_bf16 v[56:59], v[76:79], v[92:95], v[56:59]
ds_read_b64_tr_b16 v[88:89], v2 offset:40960
ds_read_b64_tr_b16 v[90:91], v2 offset:41472
v_mfma_f32_16x16x32_bf16 v[48:51], v[156:159], v[76:79], v[48:51]
s_waitcnt lgkmcnt(8)
v_mfma_f32_16x16x32_bf16 v[52:55], v[224:227], v[64:67], v[52:55]
ds_read_b128 v[76:79], v15 offset:512
s_waitcnt lgkmcnt(7)
v_mfma_f32_16x16x32_bf16 v[56:59], v[64:67], v[80:83], v[56:59]
ds_read_b64_tr_b16 v[92:93], v2 offset:45056
ds_read_b64_tr_b16 v[94:95], v2 offset:45568
v_mfma_f32_16x16x32_bf16 v[48:51], v[160:163], v[64:67], v[48:51]
s_waitcnt lgkmcnt(8)
v_mfma_f32_16x16x32_bf16 v[52:55], v[228:231], v[68:71], v[52:55]
ds_read_b128 v[64:67], v12 offset:768
s_waitcnt lgkmcnt(7)
v_mfma_f32_16x16x32_bf16 v[56:59], v[68:71], v[84:87], v[56:59]
ds_read_b64_tr_b16 v[80:81], v2 offset:49152
ds_read_b64_tr_b16 v[82:83], v2 offset:49664
v_mfma_f32_16x16x32_bf16 v[48:51], v[164:167], v[68:71], v[48:51]
s_waitcnt lgkmcnt(8)
v_mfma_f32_16x16x32_bf16 v[52:55], v[232:235], v[72:75], v[52:55]
ds_read_b128 v[68:71], v13 offset:768
s_waitcnt lgkmcnt(7)
v_mfma_f32_16x16x32_bf16 v[56:59], v[72:75], v[88:91], v[56:59]
ds_read_b64_tr_b16 v[84:85], v2 offset:53248
ds_read_b64_tr_b16 v[86:87], v2 offset:53760
v_mfma_f32_16x16x32_bf16 v[48:51], v[168:171], v[72:75], v[48:51]
s_waitcnt lgkmcnt(8)
v_mfma_f32_16x16x32_bf16 v[52:55], v[236:239], v[76:79], v[52:55]
ds_read_b128 v[72:75], v14 offset:768
s_waitcnt lgkmcnt(7)
v_mfma_f32_16x16x32_bf16 v[56:59], v[76:79], v[92:95], v[56:59]
ds_read_b64_tr_b16 v[88:89], v2 offset:57344
ds_read_b64_tr_b16 v[90:91], v2 offset:57856
v_mfma_f32_16x16x32_bf16 v[48:51], v[172:175], v[76:79], v[48:51]
s_waitcnt lgkmcnt(8)
v_mfma_f32_16x16x32_bf16 v[52:55], v[240:243], v[64:67], v[52:55]
ds_read_b128 v[76:79], v15 offset:768
s_waitcnt lgkmcnt(7)
v_mfma_f32_16x16x32_bf16 v[56:59], v[64:67], v[80:83], v[56:59]
ds_read_b64_tr_b16 v[92:93], v2 offset:61440
ds_read_b64_tr_b16 v[94:95], v2 offset:61952
v_mfma_f32_16x16x32_bf16 v[48:51], v[176:179], v[64:67], v[48:51]
s_waitcnt lgkmcnt(8)
v_mfma_f32_16x16x32_bf16 v[52:55], v[244:247], v[68:71], v[52:55]
s_waitcnt lgkmcnt(6)
v_mfma_f32_16x16x32_bf16 v[56:59], v[68:71], v[84:87], v[56:59]
v_mfma_f32_16x16x32_bf16 v[48:51], v[180:183], v[68:71], v[48:51]
s_waitcnt lgkmcnt(5)
v_mfma_f32_16x16x32_bf16 v[52:55], v[248:251], v[72:75], v[52:55]
s_waitcnt lgkmcnt(3)
v_mfma_f32_16x16x32_bf16 v[56:59], v[72:75], v[88:91], v[56:59]
v_mfma_f32_16x16x32_bf16 v[48:51], v[184:187], v[72:75], v[48:51]
s_waitcnt lgkmcnt(2)
v_mfma_f32_16x16x32_bf16 v[52:55], v[252:255], v[76:79], v[52:55]
s_waitcnt lgkmcnt(0)
v_mfma_f32_16x16x32_bf16 v[56:59], v[76:79], v[92:95], v[56:59]
v_mfma_f32_16x16x32_bf16 v[48:51], v[188:191], v[76:79], v[48:51]
v_cvt_pk_bf16_f32 v40, v52, v53
v_cvt_pk_bf16_f32 v41, v54, v55
s_nop 1
v_cvt_pk_bf16_f32 v42, v56, v57
v_cvt_pk_bf16_f32 v43, v58, v59
v_min_u32_e64 v40, -2, v40
s_nop 0
v_cvt_pk_bf16_f32 v38, v48, v49
v_cvt_pk_bf16_f32 v39, v50, v51
s_nop 1
v_mfma_f32_16x16x16_bf16 v[68:71], v[40:41], v[38:39], v[24:27]
s_cmp_eq_u32 s20, 0
s_cbranch_scc1 WHZ_139
s_mov_b32 s22, 0
WHR_138:
s_waitcnt vmcnt(0)
v_cmp_eq_u32 vcc, -1, v44
s_cbranch_vccz WHK_137
s_add_u32 s22, s22, 1
s_cmp_gt_u32 s22, 2097152
s_cbranch_scc1 FAIL
buffer_load_dwordx4 v[44:47], v0, s[12:15], s36 offen sc1
s_branch WHR_138
WHZ_139:
v_mov_b32 v64, 0xf149f2ca
v_mov_b32 v65, 0xf149f2ca
v_mov_b32 v66, 0xf149f2ca
v_mov_b32 v67, 0xf149f2ca
s_branch WHD_140
WHK_137:
v_mfma_f32_16x16x16_bf16 v[64:67], v[44:45], v[38:39], v[20:23]
WHD_140:
buffer_store_dwordx4 v[40:43], v0, s[12:15], s35 offen sc1
s_waitcnt vmcnt(1)
v_mov_b32_e64 v72, v46
v_mov_b32_e64 v73, v47
v_mov_b32_e64 v74, v42
v_mov_b32 v75, v43
v_max3_f32 v36, v68, v69, v70
s_nop 0
v_max3_f32 v36, v36, v71, v64
v_max3_f32 v36, v36, v65, v66
v_max_f32 v37, v36, v67
v_max_f32 v36, v36, v67
s_nop 1
v_permlane16_swap_b32 v36, v37
v_max_f32 v36, v36, v37
v_mov_b32 v37, v36
s_nop 1
v_permlane32_swap_b32 v36, v37
v_max_f32 v36, v36, v37
v_mul_f32 v36, s41, v36
v_fma_f32 v64, v64, s41, -v36
v_fma_f32 v65, v65, s41, -v36
v_fma_f32 v66, v66, s41, -v36
v_fma_f32 v67, v67, s41, -v36
v_fma_f32 v68, v68, s41, -v36
v_fma_f32 v69, v69, s41, -v36
v_fma_f32 v70, v70, s41, -v36
v_fma_f32 v71, v71, s41, -v36
v_exp_f32 v64, v64
v_exp_f32 v65, v65
v_exp_f32 v66, v66
v_exp_f32 v67, v67
v_exp_f32 v68, v68
v_exp_f32 v69, v69
v_exp_f32 v70, v70
v_exp_f32 v71, v71
v_pk_add_f32 v[36:37], v[64:65], v[66:67]
v_pk_add_f32 v[76:77], v[68:69], v[70:71]
v_pk_add_f32 v[36:37], v[36:37], v[76:77]
v_add_f32 v76, v36, v37
v_add_f32 v36, v36, v37
s_nop 1
v_permlane16_swap_b32 v36, v76
v_add_f32 v37, v36, v76
v_add_f32_e64 v36, v36, v76
s_nop 1
v_permlane32_swap_b32_e64 v36, v37
v_add_f32_e64 v36, v36, v37
v_rcp_f32 v36, v36
s_nop 0
v_pk_mul_f32 v[64:65], v[64:65], v[36:37] op_sel_hi:[1,0]
v_pk_mul_f32 v[66:67], v[66:67], v[36:37] op_sel_hi:[1,0]
v_pk_mul_f32 v[68:69], v[68:69], v[36:37] op_sel_hi:[1,0]
v_pk_mul_f32 v[70:71], v[70:71], v[36:37] op_sel_hi:[1,0]
v_cvt_pk_bf16_f32 v76, v64, v65
v_cvt_pk_bf16_f32 v77, v66, v67
v_cvt_pk_bf16_f32 v78, v68, v69
v_cvt_pk_bf16_f32 v79, v70, v71
s_nop 1
v_mfma_f32_16x16x32_bf16 v[48:51], v[72:75], v[76:79], 0
s_nop 7
v_cvt_pk_bf16_f32 v38, v48, v49
v_cvt_pk_bf16_f32 v39, v50, v51
ds_write_b64 v7, v[38:39]
s_waitcnt lgkmcnt(0)
s_barrier
ds_read_b128 v[40:43], v8 offset:0
ds_read_b128 v[44:47], v8 offset:64
v_add_u32 v36, 32768, v11
ds_read_b128 v[80:83], v36 offset:0
ds_read_b128 v[84:87], v36 offset:1024
ds_read_b128 v[88:91], v36 offset:2048
ds_read_b128 v[92:95], v36 offset:3072
s_waitcnt lgkmcnt(5)
v_mfma_f32_16x16x32_bf16 v[48:51], v[40:43], v[96:99], 0
v_mfma_f32_16x16x32_bf16 v[52:55], v[40:43], v[100:103], 0
v_mfma_f32_16x16x32_bf16 v[56:59], v[40:43], v[104:107], 0
v_mfma_f32_16x16x32_bf16 v[60:63], v[40:43], v[108:111], 0
v_mfma_f32_16x16x32_bf16 v[64:67], v[40:43], v[112:115], 0
v_mfma_f32_16x16x32_bf16 v[68:71], v[40:43], v[116:119], 0
v_mfma_f32_16x16x32_bf16 v[72:75], v[40:43], v[120:123], 0
v_mfma_f32_16x16x32_bf16 v[76:79], v[40:43], v[124:127], 0
s_waitcnt lgkmcnt(3)
v_mfma_f32_16x16x32_bf16 v[48:51], v[44:47], v[80:83], v[48:51]
ds_read_b128 v[80:83], v36 offset:4096
s_waitcnt lgkmcnt(3)
v_mfma_f32_16x16x32_bf16 v[52:55], v[44:47], v[84:87], v[52:55]
ds_read_b128 v[84:87], v36 offset:5120
s_waitcnt lgkmcnt(3)
v_mfma_f32_16x16x32_bf16 v[56:59], v[44:47], v[88:91], v[56:59]
ds_read_b128 v[88:91], v36 offset:6144
s_waitcnt lgkmcnt(3)
v_mfma_f32_16x16x32_bf16 v[60:63], v[44:47], v[92:95], v[60:63]
ds_read_b128 v[92:95], v36 offset:7168
s_waitcnt lgkmcnt(3)
v_mfma_f32_16x16x32_bf16 v[64:67], v[44:47], v[80:83], v[64:67]
s_waitcnt lgkmcnt(2)
v_mfma_f32_16x16x32_bf16 v[68:71], v[44:47], v[84:87], v[68:71]
s_waitcnt lgkmcnt(1)
v_mfma_f32_16x16x32_bf16 v[72:75], v[44:47], v[88:91], v[72:75]
s_waitcnt lgkmcnt(0)
v_mfma_f32_16x16x32_bf16 v[76:79], v[44:47], v[92:95], v[76:79]
s_add_u32 s23, s28, 0
v_cvt_pk_bf16_f32 v80, v48, v52
v_cvt_pk_bf16_f32 v81, v56, v60
v_cvt_pk_bf16_f32 v82, v49, v53
v_cvt_pk_bf16_f32 v83, v57, v61
v_and_or_b32 v80, v80, -2, s21
buffer_store_dwordx4 v[80:83], v4, s[12:15], s23 offen offset:0
s_add_u32 s23, s28, 32768
v_cvt_pk_bf16_f32 v84, v50, v54
v_cvt_pk_bf16_f32 v85, v58, v62
v_cvt_pk_bf16_f32 v86, v51, v55
v_cvt_pk_bf16_f32 v87, v59, v63
v_and_or_b32 v84, v84, -2, s21
buffer_store_dwordx4 v[84:87], v4, s[12:15], s23 offen offset:0
s_add_u32 s23, s28, 0
v_cvt_pk_bf16_f32 v88, v64, v68
v_cvt_pk_bf16_f32 v89, v72, v76
v_cvt_pk_bf16_f32 v90, v65, v69
v_cvt_pk_bf16_f32 v91, v73, v77
v_and_or_b32 v88, v88, -2, s21
buffer_store_dwordx4 v[88:91], v4, s[12:15], s23 offen offset:256
s_add_u32 s23, s28, 32768
v_cvt_pk_bf16_f32 v92, v66, v70
v_cvt_pk_bf16_f32 v93, v74, v78
v_cvt_pk_bf16_f32 v94, v67, v71
v_cvt_pk_bf16_f32 v95, v75, v79
v_and_or_b32 v92, v92, -2, s21
buffer_store_dwordx4 v[92:95], v4, s[12:15], s23 offen offset:256
s_mov_b32 s22, 0
s_waitcnt vmcnt(0)
WR_141:
buffer_load_dwordx4 v[48:51], v5, s[12:15], s29 offen sc1
s_add_u32 s23, s29, 4096
buffer_load_dwordx4 v[52:55], v5, s[12:15], s23 offen sc1
s_add_u32 s23, s29, 8192
buffer_load_dwordx4 v[56:59], v5, s[12:15], s23 offen sc1
s_add_u32 s23, s29, 12288
buffer_load_dwordx4 v[60:63], v5, s[12:15], s23 offen sc1
s_mov_b64 exec, -1
s_add_u32 s22, s22, 1
s_cmp_gt_u32 s22, 2097152
s_cbranch_scc1 FAIL
s_waitcnt vmcnt(3)
v_mfma_f32_16x16x32_bf16 v[40:43], v[28:31], v[48:51], 0
v_xor_b32 v36, s21, v48
s_waitcnt vmcnt(2)
v_mfma_f32_16x16x32_bf16 v[40:43], v[28:31], v[52:55], v[40:43]
v_bitop3_b32 v36, v36, v52, s21 bitop3:0xf6
s_waitcnt vmcnt(1)
v_mfma_f32_16x16x32_bf16 v[40:43], v[28:31], v[56:59], v[40:43]
v_bitop3_b32 v36, v36, v56, s21 bitop3:0xf6
s_waitcnt vmcnt(0)
v_mfma_f32_16x16x32_bf16 v[40:43], v[28:31], v[60:63], v[40:43]
v_bitop3_b32 v36, v36, v60, s21 bitop3:0xf6
v_and_b32 v36, 1, v36
v_cmp_ne_u32_e64 vcc, 0, v36
s_cbranch_vccz WRE_142
s_mov_b64 exec, vcc
s_branch WR_141
WRE_142:
s_nop 3
v_pk_add_f32 v[32:33], v[32:33], v[40:41]
v_pk_add_f32 v[34:35], v[34:35], v[42:43]
s_cmp_eq_u32 s37, 1
s_cbranch_scc1 WF_143
v_add_f32 v48, v32, v33
v_mul_f32 v49, v32, v32
v_add_f32 v50, v34, v35
v_fmac_f32 v49, v33, v33
v_add_f32 v48, v48, v50
v_fmac_f32 v49, v34, v34
v_fmac_f32 v49, v35, v35
v_add_f32_dpp v48, v48, v48 row_ror:8 row_mask:0xf bank_mask:0xf
s_nop 0
v_add_f32_dpp v49, v49, v49 row_ror:8 row_mask:0xf bank_mask:0xf
v_add_f32_dpp v48, v48, v48 row_ror:4 row_mask:0xf bank_mask:0xf
s_nop 0
v_add_f32_dpp v49, v49, v49 row_ror:4 row_mask:0xf bank_mask:0xf
v_add_f32_dpp v48, v48, v48 row_ror:2 row_mask:0xf bank_mask:0xf
s_nop 0
v_add_f32_dpp v49, v49, v49 row_ror:2 row_mask:0xf bank_mask:0xf
v_add_f32_dpp v48, v48, v48 row_ror:1 row_mask:0xf bank_mask:0xf
s_nop 0
v_add_f32_dpp v49, v49, v49 row_ror:1 row_mask:0xf bank_mask:0xf
v_mov_b32 v50, v48
v_mov_b32 v51, v49
s_nop 0
v_permlane32_swap_b32_e64 v48, v50
v_permlane32_swap_b32 v49, v51
v_pk_add_f32 v[48:49], v[48:49], v[50:51]
s_mov_b64 exec, 0x10001
ds_write_b64 v9, v[48:49]
s_mov_b64 exec, -1
v_cvt_pk_bf16_f32 v44, v32, v33
v_cvt_pk_bf16_f32 v45, v34, v35
v_min_u32_e64 v44, -2, v44
s_add_u32 s23, s34, 140509184
buffer_store_dwordx2 v[44:45], v6, s[12:15], s23 offen sc1
s_waitcnt lgkmcnt(0)
s_barrier
ds_read_b128 v[50:53], v10
ds_read_b128 v[54:57], v10 offset:16
s_waitcnt lgkmcnt(1)
v_pk_add_f32 v[50:51], v[50:51], v[52:53]
s_waitcnt lgkmcnt(0)
v_pk_add_f32 v[54:55], v[54:55], v[56:57]
v_pk_add_f32 v[50:51], v[50:51], v[54:55]
v_mul_f32 v50, s43, v50
v_mul_f32 v51, s43, v51
v_fma_f32 v51, -v50, v50, v51
v_max_f32 v51, 0, v51
v_add_f32 v51, s44, v51
v_rsq_f32 v48, v51
s_nop 0
v_mul_f32 v49, v50, v48
v_sub_f32 v49, 0, v49
v_fma_f32 v50, v32, v48, v49
v_fma_f32 v51, v33, v48, v49
v_fma_f32 v52, v34, v48, v49
v_fma_f32 v53, v35, v48, v49
v_cvt_pk_bf16_f32 v46, v50, v51
v_cvt_pk_bf16_f32 v47, v52, v53
v_min_u32_e64 v46, -2, v46
s_add_u32 s23, s34, 138412032
buffer_store_dwordx2 v[46:47], v6, s[12:15], s23 offen sc1
s_branch WE_144
WF_143:
v_cvt_pk_bf16_f32 v46, v32, v33
v_cvt_pk_bf16_f32 v47, v34, v35
buffer_store_dwordx2 v[46:47], v6, s[8:11], s34 offen
WE_144:
s_add_u32 s33, s33, 24576
s_add_u32 s46, s46, 24576
s_add_u32 s45, s45, 1
s_add_u32 s20, s20, 3
s_cmp_lt_u32 s20, 64
s_cbranch_scc1 WL_126
s_branch FIN
WBS:
s_lshl_b32 s33, s37, 5
s_lshr_b32 s24, s16, 1
s_lshl_b32 s24, s24, 2
s_add_u32 s33, s33, s24
s_add_u32 s33, s33, s19
s_lshl_b32 s33, s33, 6
s_add_u32 s33, s33, s20
s_lshl_b32 s33, s33, 13
s_add_u32 s33, s33, 100663296
s_add_u32 s46, s33, 4096
WL_145:
s_mov_b32 m0, s39
s_nop 0
buffer_load_dwordx4 v0, s[12:15], s33 offen offset:0 sc1 lds
buffer_load_dwordx4 v0, s[12:15], s33 offen offset:1024 sc1 lds
buffer_load_dwordx4 v0, s[12:15], s33 offen offset:2048 sc1 lds
buffer_load_dwordx4 v0, s[12:15], s33 offen offset:3072 sc1 lds
s_mov_b32 m0, s40
s_nop 0
buffer_load_dwordx4 v0, s[12:15], s46 offen offset:0 sc1 lds
buffer_load_dwordx4 v0, s[12:15], s46 offen offset:1024 sc1 lds
buffer_load_dwordx4 v0, s[12:15], s46 offen offset:2048 sc1 lds
buffer_load_dwordx4 v0, s[12:15], s46 offen offset:3072 sc1 lds
s_and_b32 s21, s45, 1
s_bfe_u32 s48, s45, 0x10001
s_lshl_b32 s23, s21, 19
s_add_u32 s26, s25, s23
s_lshl_b32 s23, s16, 14
s_add_u32 s27, s26, s23
s_lshl_b32 s23, s37, 6
s_add_u32 s23, s23, s20
s_lshl_b32 s35, s23, 4
s_add_u32 s35, s35, s16
s_lshl_b32 s35, s35, 2
s_add_u32 s35, s35, s19
s_lshl_b32 s35, s35, 10
s_add_u32 s35, s35, 142606336
s_sub_u32 s36, s35, 65536
s_lshl_b32 s34, s20, 15
s_add_u32 s34, s34, s47
s_lshl_b32 s23, s21, 15
s_add_u32 s32, s25, s23
s_add_u32 s32, s32, 786432
s_add_u32 s30, s32, s47
s_xor_b32 s23, s23, 0x8000
s_add_u32 s31, s25, s23
s_add_u32 s31, s31, 786432
s_add_u32 s31, s31, s47
s_add_u32 s32, s32, s39
s_add_u32 s32, s32, s64
s_mov_b32 s22, 0
s_waitcnt vmcnt(0)
s_branch WOK_147
WO_146:
s_mov_b64 exec, -1
s_mov_b32 m0, s39
s_nop 0
buffer_load_dwordx4 v0, s[12:15], s33 offen offset:0 sc1 lds
buffer_load_dwordx4 v0, s[12:15], s33 offen offset:1024 sc1 lds
buffer_load_dwordx4 v0, s[12:15], s33 offen offset:2048 sc1 lds
buffer_load_dwordx4 v0, s[12:15], s33 offen offset:3072 sc1 lds
s_mov_b32 m0, s40
s_nop 0
buffer_load_dwordx4 v0, s[12:15], s46 offen offset:0 sc1 lds
buffer_load_dwordx4 v0, s[12:15], s46 offen offset:1024 sc1 lds
buffer_load_dwordx4 v0, s[12:15], s46 offen offset:2048 sc1 lds
buffer_load_dwordx4 v0, s[12:15], s46 offen offset:3072 sc1 lds
s_add_u32 s22, s22, 1
s_cmp_gt_u32 s22, 2097152
s_cbranch_scc1 FAIL
s_waitcnt vmcnt(0)
WOK_147:
ds_read_b128 v[48:51], v11 offset:0
ds_read_b128 v[52:55], v11 offset:1024
ds_read_b128 v[56:59], v11 offset:2048
ds_read_b128 v[60:63], v11 offset:3072
ds_read_b128 v[64:67], v11 offset:4096
ds_read_b128 v[68:71], v11 offset:5120
ds_read_b128 v[72:75], v11 offset:6144
ds_read_b128 v[76:79], v11 offset:7168
s_waitcnt lgkmcnt(6)
v_max_u32_e64 v36, v48, v52
s_waitcnt lgkmcnt(4)
v_max3_u32 v36, v36, v56, v60
s_waitcnt lgkmcnt(2)
v_max3_u32 v36, v36, v64, v68
s_waitcnt lgkmcnt(0)
v_max3_u32 v36, v36, v72, v76
v_cmp_eq_u32_e64 vcc, -1, v36
s_cbranch_vccz WK_148
s_mov_b64 exec, vcc
s_branch WO_146
WK_148:
s_barrier
ds_read_b128 v[80:83], v1 offset:32
ds_read_b128 v[84:87], v1 offset:1056
ds_read_b128 v[88:91], v1 offset:0
s_waitcnt lgkmcnt(2)
v_mfma_f32_16x16x32_bf16 v[48:51], v[80:83], a[0:3], 0
ds_read_b128 v[92:95], v1 offset:1024
v_mfma_f32_16x16x32_bf16 v[52:55], v[80:83], a[4:7], 0
s_mul_i32 s23, s37, 140509184
s_add_u32 s38, s23, s34
buffer_load_dwordx2 v[46:47], v6, s[4:7], s38 offen sc1
v_mfma_f32_16x16x32_bf16 v[56:59], v[80:83], a[8:11], 0
v_mfma_f32_16x16x32_bf16 v[60:63], v[80:83], a[12:15], 0
s_waitcnt lgkmcnt(2)
v_mfma_f32_16x16x32_bf16 v[48:51], v[84:87], a[16:19], v[48:51]
ds_read_b128 v[80:83], v1 offset:8224
v_mfma_f32_16x16x32_bf16 v[52:55], v[84:87], a[20:23], v[52:55]
v_mov_b64 v[36:37], -1
v_mov_b64_e64 v[38:39], -1
v_mfma_f32_16x16x32_bf16 v[56:59], v[84:87], a[24:27], v[56:59]
v_mfma_f32_16x16x32_bf16 v[60:63], v[84:87], a[28:31], v[60:63]
s_waitcnt lgkmcnt(2)
v_mfma_f32_16x16x32_bf16 v[48:51], v[88:91], a[32:35], v[48:51]
ds_read_b128 v[84:87], v1 offset:9248
v_mfma_f32_16x16x32_bf16 v[52:55], v[88:91], a[36:39], v[52:55]
s_add_u32 s23, s35, 196608
s_cmp_ge_u32 s20, 61
s_cselect_b32 s23, s14, s23
buffer_store_dwordx4 v[36:39], v0, s[12:15], s23 offen sc1
v_mfma_f32_16x16x32_bf16 v[56:59], v[88:91], a[40:43], v[56:59]
v_mfma_f32_16x16x32_bf16 v[60:63], v[88:91], a[44:47], v[60:63]
s_waitcnt lgkmcnt(2)
v_mfma_f32_16x16x32_bf16 v[48:51], v[92:95], a[48:51], v[48:51]
ds_read_b128 v[88:91], v1 offset:8192
v_mfma_f32_16x16x32_bf16 v[52:55], v[92:95], a[52:55], v[52:55]
s_cmp_ge_u32 s20, 61
s_cselect_b32 s24, 1, s37
v_mfma_f32_16x16x32_bf16 v[56:59], v[92:95], a[56:59], v[56:59]
v_mfma_f32_16x16x32_bf16 v[60:63], v[92:95], a[60:63], v[60:63]
s_waitcnt lgkmcnt(2)
v_mfma_f32_16x16x32_bf16 v[48:51], v[80:83], a[64:67], v[48:51]
ds_read_b128 v[92:95], v1 offset:9216
v_mfma_f32_16x16x32_bf16 v[52:55], v[80:83], a[68:71], v[52:55]
s_add_u32 s23, s34, 138510336
s_cmp_eq_u32 s24, 1
s_cselect_b32 s23, s14, s23
buffer_store_dwordx2 v[36:37], v6, s[12:15], s23 offen sc1
v_mfma_f32_16x16x32_bf16 v[56:59], v[80:83], a[72:75], v[56:59]
v_mfma_f32_16x16x32_bf16 v[60:63], v[80:83], a[76:79], v[60:63]
s_waitcnt lgkmcnt(2)
v_mfma_f32_16x16x32_bf16 v[48:51], v[84:87], a[80:83], v[48:51]
ds_read_b128 v[80:83], v1 offset:16416
v_mfma_f32_16x16x32_bf16 v[52:55], v[84:87], a[84:87], v[52:55]
v_mfma_f32_16x16x32_bf16 v[56:59], v[84:87], a[88:91], v[56:59]
v_mfma_f32_16x16x32_bf16 v[60:63], v[84:87], a[92:95], v[60:63]
s_waitcnt lgkmcnt(2)
v_mfma_f32_16x16x32_bf16 v[48:51], v[88:91], a[96:99], v[48:51]
ds_read_b128 v[84:87], v1 offset:17440
v_mfma_f32_16x16x32_bf16 v[52:55], v[88:91], a[100:103], v[52:55]
s_add_u32 s23, s34, 140607488
s_cmp_eq_u32 s24, 1
s_cselect_b32 s23, s14, s23
buffer_store_dwordx2 v[36:37], v6, s[12:15], s23 offen sc1
v_mfma_f32_16x16x32_bf16 v[56:59], v[88:91], a[104:107], v[56:59]
v_mfma_f32_16x16x32_bf16 v[60:63], v[88:91], a[108:111], v[60:63]
s_waitcnt lgkmcnt(2)
v_mfma_f32_16x16x32_bf16 v[48:51], v[92:95], a[112:115], v[48:51]
ds_read_b128 v[88:91], v1 offset:16384
v_mfma_f32_16x16x32_bf16 v[52:55], v[92:95], a[116:119], v[52:55]
v_mfma_f32_16x16x32_bf16 v[56:59], v[92:95], a[120:123], v[56:59]
v_mfma_f32_16x16x32_bf16 v[60:63], v[92:95], a[124:127], v[60:63]
s_waitcnt lgkmcnt(2)
v_mfma_f32_16x16x32_bf16 v[48:51], v[80:83], a[128:131], v[48:51]
ds_read_b128 v[92:95], v1 offset:17408
v_mfma_f32_16x16x32_bf16 v[52:55], v[80:83], a[132:135], v[52:55]
v_mfma_f32_16x16x32_bf16 v[56:59], v[80:83], a[136:139], v[56:59]
v_mfma_f32_16x16x32_bf16 v[60:63], v[80:83], a[140:143], v[60:63]
s_waitcnt lgkmcnt(2)
v_mfma_f32_16x16x32_bf16 v[48:51], v[84:87], a[144:147], v[48:51]
ds_read_b128 v[80:83], v1 offset:24608
v_mfma_f32_16x16x32_bf16 v[52:55], v[84:87], a[148:151], v[52:55]
v_mfma_f32_16x16x32_bf16 v[56:59], v[84:87], a[152:155], v[56:59]
v_mfma_f32_16x16x32_bf16 v[60:63], v[84:87], a[156:159], v[60:63]
s_waitcnt lgkmcnt(2)
v_mfma_f32_16x16x32_bf16 v[48:51], v[88:91], a[160:163], v[48:51]
ds_read_b128 v[84:87], v1 offset:25632
v_mfma_f32_16x16x32_bf16 v[52:55], v[88:91], a[164:167], v[52:55]
v_mfma_f32_16x16x32_bf16 v[56:59], v[88:91], a[168:171], v[56:59]
v_mfma_f32_16x16x32_bf16 v[60:63], v[88:91], a[172:175], v[60:63]
s_waitcnt lgkmcnt(2)
v_mfma_f32_16x16x32_bf16 v[48:51], v[92:95], a[176:179], v[48:51]
ds_read_b128 v[88:91], v1 offset:24576
v_mfma_f32_16x16x32_bf16 v[52:55], v[92:95], a[180:183], v[52:55]
v_mfma_f32_16x16x32_bf16 v[56:59], v[92:95], a[184:187], v[56:59]
v_mfma_f32_16x16x32_bf16 v[60:63], v[92:95], a[188:191], v[60:63]
s_waitcnt lgkmcnt(2)
v_mfma_f32_16x16x32_bf16 v[48:51], v[80:83], a[192:195], v[48:51]
ds_read_b128 v[92:95], v1 offset:25600
v_mfma_f32_16x16x32_bf16 v[52:55], v[80:83], a[196:199], v[52:55]
v_mfma_f32_16x16x32_bf16 v[56:59], v[80:83], a[200:203], v[56:59]
v_mfma_f32_16x16x32_bf16 v[60:63], v[80:83], a[204:207], v[60:63]
s_waitcnt lgkmcnt(2)
v_mfma_f32_16x16x32_bf16 v[48:51], v[84:87], a[208:211], v[48:51]
ds_read_b128 v[80:83], v1 offset:4128
v_mfma_f32_16x16x32_bf16 v[52:55], v[84:87], a[212:215], v[52:55]
v_mfma_f32_16x16x32_bf16 v[56:59], v[84:87], a[216:219], v[56:59]
v_mfma_f32_16x16x32_bf16 v[60:63], v[84:87], a[220:223], v[60:63]
s_waitcnt lgkmcnt(2)
v_mfma_f32_16x16x32_bf16 v[48:51], v[88:91], a[224:227], v[48:51]
ds_read_b128 v[84:87], v1 offset:5152
v_mfma_f32_16x16x32_bf16 v[52:55], v[88:91], a[228:231], v[52:55]
v_mfma_f32_16x16x32_bf16 v[56:59], v[88:91], a[232:235], v[56:59]
v_mfma_f32_16x16x32_bf16 v[60:63], v[88:91], a[236:239], v[60:63]
s_waitcnt lgkmcnt(2)
v_mfma_f32_16x16x32_bf16 v[48:51], v[92:95], a[240:243], v[48:51]
ds_read_b128 v[88:91], v1 offset:4096
v_mfma_f32_16x16x32_bf16 v[52:55], v[92:95], a[244:247], v[52:55]
v_mfma_f32_16x16x32_bf16 v[56:59], v[92:95], a[248:251], v[56:59]
v_mfma_f32_16x16x32_bf16 v[60:63], v[92:95], a[252:255], v[60:63]
s_waitcnt lgkmcnt(2)
v_mfma_f32_16x16x32_bf16 v[64:67], v[80:83], a[0:3], 0
ds_read_b128 v[92:95], v1 offset:5120
v_mfma_f32_16x16x32_bf16 v[68:71], v[80:83], a[4:7], 0
v_mfma_f32_16x16x32_bf16 v[72:75], v[80:83], a[8:11], 0
v_mfma_f32_16x16x32_bf16 v[76:79], v[80:83], a[12:15], 0
s_waitcnt lgkmcnt(2)
v_mfma_f32_16x16x32_bf16 v[64:67], v[84:87], a[16:19], v[64:67]
ds_read_b128 v[80:83], v1 offset:12320
v_mfma_f32_16x16x32_bf16 v[68:71], v[84:87], a[20:23], v[68:71]
v_mfma_f32_16x16x32_bf16 v[72:75], v[84:87], a[24:27], v[72:75]
s_add_u32 s23, s26, 0
v_mfma_f32_16x16x32_bf16 v[76:79], v[84:87], a[28:31], v[76:79]
v_cvt_pk_bf16_f32 v36, v48, v52
s_waitcnt lgkmcnt(2)
v_mfma_f32_16x16x32_bf16 v[64:67], v[88:91], a[32:35], v[64:67]
ds_read_b128 v[84:87], v1 offset:13344
v_mfma_f32_16x16x32_bf16 v[68:71], v[88:91], a[36:39], v[68:71]
v_mfma_f32_16x16x32_bf16 v[72:75], v[88:91], a[40:43], v[72:75]
v_cvt_pk_bf16_f32 v37, v56, v60
v_mfma_f32_16x16x32_bf16 v[76:79], v[88:91], a[44:47], v[76:79]
v_cvt_pk_bf16_f32 v38, v49, v53
s_waitcnt lgkmcnt(2)
v_mfma_f32_16x16x32_bf16 v[64:67], v[92:95], a[48:51], v[64:67]
ds_read_b128 v[88:91], v1 offset:12288
v_mfma_f32_16x16x32_bf16 v[68:71], v[92:95], a[52:55], v[68:71]
v_mfma_f32_16x16x32_bf16 v[72:75], v[92:95], a[56:59], v[72:75]
v_cvt_pk_bf16_f32 v39, v57, v61
v_mfma_f32_16x16x32_bf16 v[76:79], v[92:95], a[60:63], v[76:79]
v_and_or_b32 v36, v36, -2, s48
s_waitcnt lgkmcnt(2)
v_mfma_f32_16x16x32_bf16 v[64:67], v[80:83], a[64:67], v[64:67]
ds_read_b128 v[92:95], v1 offset:13312
v_mfma_f32_16x16x32_bf16 v[68:71], v[80:83], a[68:71], v[68:71]
v_mfma_f32_16x16x32_bf16 v[72:75], v[80:83], a[72:75], v[72:75]
buffer_store_dwordx4 v[36:39], v3, s[12:15], s23 offen offset:0 sc1
v_mfma_f32_16x16x32_bf16 v[76:79], v[80:83], a[76:79], v[76:79]
s_add_u32 s23, s26, 32768
s_waitcnt lgkmcnt(2)
v_mfma_f32_16x16x32_bf16 v[64:67], v[84:87], a[80:83], v[64:67]
ds_read_b128 v[80:83], v1 offset:20512
v_mfma_f32_16x16x32_bf16 v[68:71], v[84:87], a[84:87], v[68:71]
v_mfma_f32_16x16x32_bf16 v[72:75], v[84:87], a[88:91], v[72:75]
v_cvt_pk_bf16_f32 v40, v50, v54
v_mfma_f32_16x16x32_bf16 v[76:79], v[84:87], a[92:95], v[76:79]
v_cvt_pk_bf16_f32 v41, v58, v62
s_waitcnt lgkmcnt(2)
v_mfma_f32_16x16x32_bf16 v[64:67], v[88:91], a[96:99], v[64:67]
ds_read_b128 v[84:87], v1 offset:21536
v_mfma_f32_16x16x32_bf16 v[68:71], v[88:91], a[100:103], v[68:71]
v_mfma_f32_16x16x32_bf16 v[72:75], v[88:91], a[104:107], v[72:75]
v_cvt_pk_bf16_f32 v42, v51, v55
v_mfma_f32_16x16x32_bf16 v[76:79], v[88:91], a[108:111], v[76:79]
v_cvt_pk_bf16_f32 v43, v59, v63
s_waitcnt lgkmcnt(2)
v_mfma_f32_16x16x32_bf16 v[64:67], v[92:95], a[112:115], v[64:67]
ds_read_b128 v[88:91], v1 offset:20480
v_mfma_f32_16x16x32_bf16 v[68:71], v[92:95], a[116:119], v[68:71]
v_mfma_f32_16x16x32_bf16 v[72:75], v[92:95], a[120:123], v[72:75]
v_and_or_b32 v40, v40, -2, s48
v_mfma_f32_16x16x32_bf16 v[76:79], v[92:95], a[124:127], v[76:79]
buffer_store_dwordx4 v[40:43], v3, s[12:15], s23 offen offset:0 sc1
s_waitcnt lgkmcnt(2)
v_mfma_f32_16x16x32_bf16 v[64:67], v[80:83], a[128:131], v[64:67]
ds_read_b128 v[92:95], v1 offset:21504
v_mfma_f32_16x16x32_bf16 v[68:71], v[80:83], a[132:135], v[68:71]
v_mfma_f32_16x16x32_bf16 v[72:75], v[80:83], a[136:139], v[72:75]
v_mfma_f32_16x16x32_bf16 v[76:79], v[80:83], a[140:143], v[76:79]
s_waitcnt lgkmcnt(2)
v_mfma_f32_16x16x32_bf16 v[64:67], v[84:87], a[144:147], v[64:67]
ds_read_b128 v[80:83], v1 offset:28704
v_mfma_f32_16x16x32_bf16 v[68:71], v[84:87], a[148:151], v[68:71]
v_mfma_f32_16x16x32_bf16 v[72:75], v[84:87], a[152:155], v[72:75]
v_mfma_f32_16x16x32_bf16 v[76:79], v[84:87], a[156:159], v[76:79]
s_waitcnt lgkmcnt(2)
v_mfma_f32_16x16x32_bf16 v[64:67], v[88:91], a[160:163], v[64:67]
ds_read_b128 v[84:87], v1 offset:29728
v_mfma_f32_16x16x32_bf16 v[68:71], v[88:91], a[164:167], v[68:71]
v_mfma_f32_16x16x32_bf16 v[72:75], v[88:91], a[168:171], v[72:75]
v_mfma_f32_16x16x32_bf16 v[76:79], v[88:91], a[172:175], v[76:79]
s_waitcnt lgkmcnt(2)
v_mfma_f32_16x16x32_bf16 v[64:67], v[92:95], a[176:179], v[64:67]
ds_read_b128 v[88:91], v1 offset:28672
v_mfma_f32_16x16x32_bf16 v[68:71], v[92:95], a[180:183], v[68:71]
v_mfma_f32_16x16x32_bf16 v[72:75], v[92:95], a[184:187], v[72:75]
v_mfma_f32_16x16x32_bf16 v[76:79], v[92:95], a[188:191], v[76:79]
s_waitcnt lgkmcnt(2)
v_mfma_f32_16x16x32_bf16 v[64:67], v[80:83], a[192:195], v[64:67]
ds_read_b128 v[92:95], v1 offset:29696
v_mfma_f32_16x16x32_bf16 v[68:71], v[80:83], a[196:199], v[68:71]
v_mfma_f32_16x16x32_bf16 v[72:75], v[80:83], a[200:203], v[72:75]
v_mfma_f32_16x16x32_bf16 v[76:79], v[80:83], a[204:207], v[76:79]
s_waitcnt lgkmcnt(2)
v_mfma_f32_16x16x32_bf16 v[64:67], v[84:87], a[208:211], v[64:67]
v_mfma_f32_16x16x32_bf16 v[68:71], v[84:87], a[212:215], v[68:71]
v_mfma_f32_16x16x32_bf16 v[72:75], v[84:87], a[216:219], v[72:75]
v_mfma_f32_16x16x32_bf16 v[76:79], v[84:87], a[220:223], v[76:79]
s_waitcnt lgkmcnt(1)
v_mfma_f32_16x16x32_bf16 v[64:67], v[88:91], a[224:227], v[64:67]
v_mfma_f32_16x16x32_bf16 v[68:71], v[88:91], a[228:231], v[68:71]
v_mfma_f32_16x16x32_bf16 v[72:75], v[88:91], a[232:235], v[72:75]
v_mfma_f32_16x16x32_bf16 v[76:79], v[88:91], a[236:239], v[76:79]
s_waitcnt lgkmcnt(0)
v_mfma_f32_16x16x32_bf16 v[64:67], v[92:95], a[240:243], v[64:67]
v_mfma_f32_16x16x32_bf16 v[68:71], v[92:95], a[244:247], v[68:71]
v_mfma_f32_16x16x32_bf16 v[72:75], v[92:95], a[248:251], v[72:75]
v_mfma_f32_16x16x32_bf16 v[76:79], v[92:95], a[252:255], v[76:79]
s_add_u32 s23, s26, 16384
v_cvt_pk_bf16_f32 v36, v64, v68
s_nop 5
v_cvt_pk_bf16_f32 v37, v72, v76
v_cvt_pk_bf16_f32 v38, v65, v69
v_cvt_pk_bf16_f32 v39, v73, v77
v_and_or_b32 v36, v36, -2, s48
buffer_store_dwordx4 v[36:39], v3, s[12:15], s23 offen offset:0 sc1
s_add_u32 s23, s26, 49152
v_cvt_pk_bf16_f32 v40, v66, v70
v_cvt_pk_bf16_f32 v41, v74, v78
v_cvt_pk_bf16_f32 v42, v67, v71
v_cvt_pk_bf16_f32 v43, v75, v79
v_and_or_b32 v40, v40, -2, s48
buffer_store_dwordx4 v[40:43], v3, s[12:15], s23 offen offset:0 sc1
s_mov_b32 s22, 0
s_waitcnt vmcnt(0)
WR_149:
buffer_load_dwordx4 v[48:51], v5, s[12:15], s27 offen sc1
s_add_u32 s23, s27, 4096
buffer_load_dwordx4 v[52:55], v5, s[12:15], s23 offen sc1
s_add_u32 s23, s27, 8192
buffer_load_dwordx4 v[56:59], v5, s[12:15], s23 offen sc1
s_add_u32 s23, s27, 12288
buffer_load_dwordx4 v[60:63], v5, s[12:15], s23 offen sc1
s_mov_b64 exec, -1
s_add_u32 s22, s22, 1
s_cmp_gt_u32 s22, 2097152
s_cbranch_scc1 FAIL
s_waitcnt vmcnt(3)
v_mfma_f32_16x16x32_bf16 v[40:43], v[28:31], v[48:51], 0
v_xor_b32 v36, s48, v48
s_waitcnt vmcnt(2)
v_mfma_f32_16x16x32_bf16 v[40:43], v[28:31], v[52:55], v[40:43]
v_bitop3_b32 v36, v36, v52, s48 bitop3:0xf6
s_waitcnt vmcnt(1)
v_mfma_f32_16x16x32_bf16 v[40:43], v[28:31], v[56:59], v[40:43]
v_bitop3_b32 v36, v36, v56, s48 bitop3:0xf6
s_waitcnt vmcnt(0)
v_mfma_f32_16x16x32_bf16 v[40:43], v[28:31], v[60:63], v[40:43]
v_bitop3_b32 v36, v36, v60, s48 bitop3:0xf6
v_and_b32 v36, 1, v36
v_cmp_ne_u32_e64 vcc, 0, v36
s_cbranch_vccz WRE_150
s_mov_b64 exec, vcc
s_branch WR_149
WRE_150:
s_cmp_eq_u32 s37, 0
s_cbranch_scc1 WXK_152
WX_151:
s_waitcnt vmcnt(0)
v_cmp_eq_u32_e64 vcc, -1, v46
s_cbranch_vccz WXK_152
s_add_u32 s22, s22, 1
s_cmp_gt_u32 s22, 2097152
s_cbranch_scc1 FAIL
buffer_load_dwordx2 v[46:47], v6, s[4:7], s38 offen sc1
s_branch WX_151
WXK_152:
v_lshlrev_b32 v32, 16, v46
v_and_b32 v33, 0xffff0000, v46
v_lshlrev_b32_e64 v34, 16, v47
v_and_b32 v35, 0xffff0000, v47
v_pk_add_f32 v[32:33], v[32:33], v[40:41]
v_pk_add_f32 v[34:35], v[34:35], v[42:43]
v_add_f32 v48, v32, v33
v_mul_f32 v49, v32, v32
v_add_f32 v50, v34, v35
v_fmac_f32 v49, v33, v33
v_add_f32 v48, v48, v50
v_fmac_f32 v49, v34, v34
v_fmac_f32 v49, v35, v35
v_add_f32_dpp v48, v48, v48 row_ror:8 row_mask:0xf bank_mask:0xf
s_nop 0
v_add_f32_dpp v49, v49, v49 row_ror:8 row_mask:0xf bank_mask:0xf
v_add_f32_dpp v48, v48, v48 row_ror:4 row_mask:0xf bank_mask:0xf
s_nop 0
v_add_f32_dpp v49, v49, v49 row_ror:4 row_mask:0xf bank_mask:0xf
v_add_f32_dpp v48, v48, v48 row_ror:2 row_mask:0xf bank_mask:0xf
s_nop 0
v_add_f32_dpp v49, v49, v49 row_ror:2 row_mask:0xf bank_mask:0xf
v_add_f32_dpp v48, v48, v48 row_ror:1 row_mask:0xf bank_mask:0xf
s_nop 0
v_add_f32_dpp v49, v49, v49 row_ror:1 row_mask:0xf bank_mask:0xf
v_mov_b32 v50, v48
v_mov_b32 v51, v49
s_nop 0
v_permlane32_swap_b32_e64 v48, v50
v_permlane32_swap_b32_e64 v49, v51
v_pk_add_f32 v[48:49], v[48:49], v[50:51]
s_mov_b64 exec, 0x10001
ds_write_b64 v9, v[48:49]
s_mov_b64 exec, -1
v_mov_b64 v[44:45], -1
buffer_store_dwordx2 v[44:45], v6, s[12:15], s31 offen sc1
s_waitcnt lgkmcnt(0)
s_barrier
ds_read_b128 v[50:53], v10
ds_read_b128 v[54:57], v10 offset:16
s_waitcnt lgkmcnt(1)
v_pk_add_f32 v[50:51], v[50:51], v[52:53]
s_waitcnt lgkmcnt(0)
v_pk_add_f32 v[54:55], v[54:55], v[56:57]
v_pk_add_f32 v[50:51], v[50:51], v[54:55]
v_mul_f32 v50, s43, v50
v_mul_f32 v51, s43, v51
v_fma_f32 v51, -v50, v50, v51
v_max_f32 v51, 0, v51
v_add_f32 v51, s44, v51
v_rsq_f32 v48, v51
s_nop 0
v_mul_f32 v49, v50, v48
v_sub_f32 v49, 0, v49
v_fma_f32 v50, v32, v48, v49
v_fma_f32 v51, v33, v48, v49
v_fma_f32 v52, v34, v48, v49
v_fma_f32 v53, v35, v48, v49
v_cvt_pk_bf16_f32 v46, v50, v51
v_cvt_pk_bf16_f32 v47, v52, v53
v_min_u32_e64 v46, -2, v46
buffer_store_dwordx2 v[46:47], v6, s[12:15], s30 offen sc1
s_mov_b32 s22, 0
v_add_u32 v37, s65, v0
s_mov_b32 m0, s65
s_waitcnt vmcnt(0)
WN_153:
buffer_load_dwordx4 v16, s[12:15], s32 offen offset:0 sc1 lds
buffer_load_dwordx4 v17, s[12:15], s32 offen offset:1024 sc1 lds
buffer_load_dwordx4 v18, s[12:15], s32 offen offset:2048 sc1 lds
buffer_load_dwordx4 v19, s[12:15], s32 offen offset:3072 sc1 lds
s_mov_b64 exec, -1
s_add_u32 s22, s22, 1
s_cmp_gt_u32 s22, 2097152
s_cbranch_scc1 FAIL
s_waitcnt vmcnt(0)
ds_read_b128 v[48:51], v37 offset:0
ds_read_b128 v[52:55], v37 offset:1024
ds_read_b128 v[56:59], v37 offset:2048
ds_read_b128 v[60:63], v37 offset:3072
s_waitcnt lgkmcnt(3)
v_max_u32 v36, v48, v50
s_waitcnt lgkmcnt(2)
v_max3_u32 v36, v36, v52, v54
s_waitcnt lgkmcnt(1)
v_max3_u32 v36, v36, v56, v58
s_waitcnt lgkmcnt(0)
v_max3_u32 v36, v36, v60, v62
v_cmp_eq_u32 vcc, -1, v36
s_cbranch_vccz WK_154
s_mov_b64 exec, vcc
s_branch WN_153
WK_154:
s_barrier
v_mov_b64_e64 v[44:45], 0
v_mov_b64_e64 v[46:47], 0
s_cmp_eq_u32 s20, 0
s_cbranch_scc1 WNH_155
buffer_load_dwordx4 v[44:47], v0, s[12:15], s36 offen sc1
WNH_155:
ds_read_b128 v[64:67], v12 offset:0
ds_read_b64_tr_b16 v[80:81], v2 offset:0
ds_read_b64_tr_b16 v[82:83], v2 offset:512
ds_read_b128 v[68:71], v13 offset:0
ds_read_b64_tr_b16 v[84:85], v2 offset:4096
ds_read_b64_tr_b16 v[86:87], v2 offset:4608
ds_read_b128 v[72:75], v14 offset:0
ds_read_b64_tr_b16 v[88:89], v2 offset:8192
ds_read_b64_tr_b16 v[90:91], v2 offset:8704
s_waitcnt lgkmcnt(8)
v_mfma_f32_16x16x32_bf16 v[52:55], v[192:195], v[64:67], 0
ds_read_b128 v[76:79], v15 offset:0
s_waitcnt lgkmcnt(7)
v_mfma_f32_16x16x32_bf16 v[56:59], v[64:67], v[80:83], 0
ds_read_b64_tr_b16 v[92:93], v2 offset:12288
ds_read_b64_tr_b16 v[94:95], v2 offset:12800
v_mfma_f32_16x16x32_bf16 v[48:51], v[128:131], v[64:67], 0
s_waitcnt lgkmcnt(8)
v_mfma_f32_16x16x32_bf16 v[52:55], v[196:199], v[68:71], v[52:55]
ds_read_b128 v[64:67], v12 offset:256
s_waitcnt lgkmcnt(7)
v_mfma_f32_16x16x32_bf16 v[56:59], v[68:71], v[84:87], v[56:59]
ds_read_b64_tr_b16 v[80:81], v2 offset:16384
ds_read_b64_tr_b16 v[82:83], v2 offset:16896
v_mfma_f32_16x16x32_bf16 v[48:51], v[132:135], v[68:71], v[48:51]
s_waitcnt lgkmcnt(8)
v_mfma_f32_16x16x32_bf16 v[52:55], v[200:203], v[72:75], v[52:55]
ds_read_b128 v[68:71], v13 offset:256
s_waitcnt lgkmcnt(7)
v_mfma_f32_16x16x32_bf16 v[56:59], v[72:75], v[88:91], v[56:59]
ds_read_b64_tr_b16 v[84:85], v2 offset:20480
ds_read_b64_tr_b16 v[86:87], v2 offset:20992
v_mfma_f32_16x16x32_bf16 v[48:51], v[136:139], v[72:75], v[48:51]
s_waitcnt lgkmcnt(8)
v_mfma_f32_16x16x32_bf16 v[52:55], v[204:207], v[76:79], v[52:55]
ds_read_b128 v[72:75], v14 offset:256
s_waitcnt lgkmcnt(7)
v_mfma_f32_16x16x32_bf16 v[56:59], v[76:79], v[92:95], v[56:59]
ds_read_b64_tr_b16 v[88:89], v2 offset:24576
ds_read_b64_tr_b16 v[90:91], v2 offset:25088
v_mfma_f32_16x16x32_bf16 v[48:51], v[140:143], v[76:79], v[48:51]
s_waitcnt lgkmcnt(8)
v_mfma_f32_16x16x32_bf16 v[52:55], v[208:211], v[64:67], v[52:55]
ds_read_b128 v[76:79], v15 offset:256
s_waitcnt lgkmcnt(7)
v_mfma_f32_16x16x32_bf16 v[56:59], v[64:67], v[80:83], v[56:59]
ds_read_b64_tr_b16 v[92:93], v2 offset:28672
ds_read_b64_tr_b16 v[94:95], v2 offset:29184
v_mfma_f32_16x16x32_bf16 v[48:51], v[144:147], v[64:67], v[48:51]
s_waitcnt lgkmcnt(8)
v_mfma_f32_16x16x32_bf16 v[52:55], v[212:215], v[68:71], v[52:55]
ds_read_b128 v[64:67], v12 offset:512
s_waitcnt lgkmcnt(7)
v_mfma_f32_16x16x32_bf16 v[56:59], v[68:71], v[84:87], v[56:59]
ds_read_b64_tr_b16 v[80:81], v2 offset:32768
ds_read_b64_tr_b16 v[82:83], v2 offset:33280
v_mfma_f32_16x16x32_bf16 v[48:51], v[148:151], v[68:71], v[48:51]
s_waitcnt lgkmcnt(8)
v_mfma_f32_16x16x32_bf16 v[52:55], v[216:219], v[72:75], v[52:55]
ds_read_b128 v[68:71], v13 offset:512
s_waitcnt lgkmcnt(7)
v_mfma_f32_16x16x32_bf16 v[56:59], v[72:75], v[88:91], v[56:59]
ds_read_b64_tr_b16 v[84:85], v2 offset:36864
ds_read_b64_tr_b16 v[86:87], v2 offset:37376
v_mfma_f32_16x16x32_bf16 v[48:51], v[152:155], v[72:75], v[48:51]
s_waitcnt lgkmcnt(8)
v_mfma_f32_16x16x32_bf16 v[52:55], v[220:223], v[76:79], v[52:55]
ds_read_b128 v[72:75], v14 offset:512
s_waitcnt lgkmcnt(7)
v_mfma_f32_16x16x32_bf16 v[56:59], v[76:79], v[92:95], v[56:59]
ds_read_b64_tr_b16 v[88:89], v2 offset:40960
ds_read_b64_tr_b16 v[90:91], v2 offset:41472
v_mfma_f32_16x16x32_bf16 v[48:51], v[156:159], v[76:79], v[48:51]
s_waitcnt lgkmcnt(8)
v_mfma_f32_16x16x32_bf16 v[52:55], v[224:227], v[64:67], v[52:55]
ds_read_b128 v[76:79], v15 offset:512
s_waitcnt lgkmcnt(7)
v_mfma_f32_16x16x32_bf16 v[56:59], v[64:67], v[80:83], v[56:59]
ds_read_b64_tr_b16 v[92:93], v2 offset:45056
ds_read_b64_tr_b16 v[94:95], v2 offset:45568
v_mfma_f32_16x16x32_bf16 v[48:51], v[160:163], v[64:67], v[48:51]
s_waitcnt lgkmcnt(8)
v_mfma_f32_16x16x32_bf16 v[52:55], v[228:231], v[68:71], v[52:55]
ds_read_b128 v[64:67], v12 offset:768
s_waitcnt lgkmcnt(7)
v_mfma_f32_16x16x32_bf16 v[56:59], v[68:71], v[84:87], v[56:59]
ds_read_b64_tr_b16 v[80:81], v2 offset:49152
ds_read_b64_tr_b16 v[82:83], v2 offset:49664
v_mfma_f32_16x16x32_bf16 v[48:51], v[164:167], v[68:71], v[48:51]
s_waitcnt lgkmcnt(8)
v_mfma_f32_16x16x32_bf16 v[52:55], v[232:235], v[72:75], v[52:55]
ds_read_b128 v[68:71], v13 offset:768
s_waitcnt lgkmcnt(7)
v_mfma_f32_16x16x32_bf16 v[56:59], v[72:75], v[88:91], v[56:59]
ds_read_b64_tr_b16 v[84:85], v2 offset:53248
ds_read_b64_tr_b16 v[86:87], v2 offset:53760
v_mfma_f32_16x16x32_bf16 v[48:51], v[168:171], v[72:75], v[48:51]
s_waitcnt lgkmcnt(8)
v_mfma_f32_16x16x32_bf16 v[52:55], v[236:239], v[76:79], v[52:55]
ds_read_b128 v[72:75], v14 offset:768
s_waitcnt lgkmcnt(7)
v_mfma_f32_16x16x32_bf16 v[56:59], v[76:79], v[92:95], v[56:59]
ds_read_b64_tr_b16 v[88:89], v2 offset:57344
ds_read_b64_tr_b16 v[90:91], v2 offset:57856
v_mfma_f32_16x16x32_bf16 v[48:51], v[172:175], v[76:79], v[48:51]
s_waitcnt lgkmcnt(8)
v_mfma_f32_16x16x32_bf16 v[52:55], v[240:243], v[64:67], v[52:55]
ds_read_b128 v[76:79], v15 offset:768
s_waitcnt lgkmcnt(7)
v_mfma_f32_16x16x32_bf16 v[56:59], v[64:67], v[80:83], v[56:59]
ds_read_b64_tr_b16 v[92:93], v2 offset:61440
ds_read_b64_tr_b16 v[94:95], v2 offset:61952
v_mfma_f32_16x16x32_bf16 v[48:51], v[176:179], v[64:67], v[48:51]
s_waitcnt lgkmcnt(8)
v_mfma_f32_16x16x32_bf16 v[52:55], v[244:247], v[68:71], v[52:55]
s_waitcnt lgkmcnt(6)
v_mfma_f32_16x16x32_bf16 v[56:59], v[68:71], v[84:87], v[56:59]
v_mfma_f32_16x16x32_bf16 v[48:51], v[180:183], v[68:71], v[48:51]
s_waitcnt lgkmcnt(5)
v_mfma_f32_16x16x32_bf16 v[52:55], v[248:251], v[72:75], v[52:55]
s_waitcnt lgkmcnt(3)
v_mfma_f32_16x16x32_bf16 v[56:59], v[72:75], v[88:91], v[56:59]
v_mfma_f32_16x16x32_bf16 v[48:51], v[184:187], v[72:75], v[48:51]
s_waitcnt lgkmcnt(2)
v_mfma_f32_16x16x32_bf16 v[52:55], v[252:255], v[76:79], v[52:55]
s_waitcnt lgkmcnt(0)
v_mfma_f32_16x16x32_bf16 v[56:59], v[76:79], v[92:95], v[56:59]
v_mfma_f32_16x16x32_bf16 v[48:51], v[188:191], v[76:79], v[48:51]
v_cvt_pk_bf16_f32 v40, v52, v53
v_cvt_pk_bf16_f32 v41, v54, v55
s_nop 1
v_cvt_pk_bf16_f32 v42, v56, v57
v_cvt_pk_bf16_f32 v43, v58, v59
v_min_u32_e64 v40, -2, v40
s_nop 0
v_cvt_pk_bf16_f32 v38, v48, v49
v_cvt_pk_bf16_f32 v39, v50, v51
s_nop 1
v_mfma_f32_16x16x16_bf16 v[68:71], v[40:41], v[38:39], v[24:27]
s_cmp_eq_u32 s20, 0
s_cbranch_scc1 WHZ_158
s_mov_b32 s22, 0
WHR_157:
s_waitcnt vmcnt(0)
v_cmp_eq_u32 vcc, -1, v44
s_cbranch_vccz WHK_156
s_add_u32 s22, s22, 1
s_cmp_gt_u32 s22, 2097152
s_cbranch_scc1 FAIL
buffer_load_dwordx4 v[44:47], v0, s[12:15], s36 offen sc1
s_branch WHR_157
WHZ_158:
v_mov_b32 v64, 0xf149f2ca
v_mov_b32 v65, 0xf149f2ca
v_mov_b32 v66, 0xf149f2ca
v_mov_b32 v67, 0xf149f2ca
s_branch WHD_159
WHK_156:
v_mfma_f32_16x16x16_bf16 v[64:67], v[44:45], v[38:39], v[20:23]
WHD_159:
buffer_store_dwordx4 v[40:43], v0, s[12:15], s35 offen sc1
s_waitcnt vmcnt(1)
v_mov_b32_e64 v72, v46
v_mov_b32_e64 v73, v47
v_mov_b32_e64 v74, v42
v_mov_b32 v75, v43
v_max3_f32 v36, v68, v69, v70
s_nop 0
v_max3_f32 v36, v36, v71, v64
v_max3_f32 v36, v36, v65, v66
v_max_f32 v37, v36, v67
v_max_f32 v36, v36, v67
s_nop 1
v_permlane16_swap_b32 v36, v37
v_max_f32 v36, v36, v37
v_mov_b32 v37, v36
s_nop 1
v_permlane32_swap_b32 v36, v37
v_max_f32 v36, v36, v37
v_mul_f32 v36, s41, v36
v_fma_f32 v64, v64, s41, -v36
v_fma_f32 v65, v65, s41, -v36
v_fma_f32 v66, v66, s41, -v36
v_fma_f32 v67, v67, s41, -v36
v_fma_f32 v68, v68, s41, -v36
v_fma_f32 v69, v69, s41, -v36
v_fma_f32 v70, v70, s41, -v36
v_fma_f32 v71, v71, s41, -v36
v_exp_f32 v64, v64
v_exp_f32 v65, v65
v_exp_f32 v66, v66
v_exp_f32 v67, v67
v_exp_f32 v68, v68
v_exp_f32 v69, v69
v_exp_f32 v70, v70
v_exp_f32 v71, v71
v_pk_add_f32 v[36:37], v[64:65], v[66:67]
v_pk_add_f32 v[76:77], v[68:69], v[70:71]
v_pk_add_f32 v[36:37], v[36:37], v[76:77]
v_add_f32 v76, v36, v37
v_add_f32 v36, v36, v37
s_nop 1
v_permlane16_swap_b32 v36, v76
v_add_f32 v37, v36, v76
v_add_f32_e64 v36, v36, v76
s_nop 1
v_permlane32_swap_b32_e64 v36, v37
v_add_f32_e64 v36, v36, v37
v_rcp_f32 v36, v36
s_nop 0
v_pk_mul_f32 v[64:65], v[64:65], v[36:37] op_sel_hi:[1,0]
v_pk_mul_f32 v[66:67], v[66:67], v[36:37] op_sel_hi:[1,0]
v_pk_mul_f32 v[68:69], v[68:69], v[36:37] op_sel_hi:[1,0]
v_pk_mul_f32 v[70:71], v[70:71], v[36:37] op_sel_hi:[1,0]
v_cvt_pk_bf16_f32 v76, v64, v65
v_cvt_pk_bf16_f32 v77, v66, v67
v_cvt_pk_bf16_f32 v78, v68, v69
v_cvt_pk_bf16_f32 v79, v70, v71
s_nop 1
v_mfma_f32_16x16x32_bf16 v[48:51], v[72:75], v[76:79], 0
s_nop 7
v_cvt_pk_bf16_f32 v38, v48, v49
v_cvt_pk_bf16_f32 v39, v50, v51
ds_write_b64 v7, v[38:39]
s_waitcnt lgkmcnt(0)
s_barrier
ds_read_b128 v[40:43], v8 offset:0
ds_read_b128 v[44:47], v8 offset:64
v_add_u32 v36, 32768, v11
ds_read_b128 v[80:83], v36 offset:0
ds_read_b128 v[84:87], v36 offset:1024
ds_read_b128 v[88:91], v36 offset:2048
ds_read_b128 v[92:95], v36 offset:3072
s_waitcnt lgkmcnt(5)
v_mfma_f32_16x16x32_bf16 v[48:51], v[40:43], v[96:99], 0
v_mfma_f32_16x16x32_bf16 v[52:55], v[40:43], v[100:103], 0
v_mfma_f32_16x16x32_bf16 v[56:59], v[40:43], v[104:107], 0
v_mfma_f32_16x16x32_bf16 v[60:63], v[40:43], v[108:111], 0
v_mfma_f32_16x16x32_bf16 v[64:67], v[40:43], v[112:115], 0
v_mfma_f32_16x16x32_bf16 v[68:71], v[40:43], v[116:119], 0
v_mfma_f32_16x16x32_bf16 v[72:75], v[40:43], v[120:123], 0
v_mfma_f32_16x16x32_bf16 v[76:79], v[40:43], v[124:127], 0
s_waitcnt lgkmcnt(3)
v_mfma_f32_16x16x32_bf16 v[48:51], v[44:47], v[80:83], v[48:51]
ds_read_b128 v[80:83], v36 offset:4096
s_waitcnt lgkmcnt(3)
v_mfma_f32_16x16x32_bf16 v[52:55], v[44:47], v[84:87], v[52:55]
ds_read_b128 v[84:87], v36 offset:5120
s_waitcnt lgkmcnt(3)
v_mfma_f32_16x16x32_bf16 v[56:59], v[44:47], v[88:91], v[56:59]
ds_read_b128 v[88:91], v36 offset:6144
s_waitcnt lgkmcnt(3)
v_mfma_f32_16x16x32_bf16 v[60:63], v[44:47], v[92:95], v[60:63]
ds_read_b128 v[92:95], v36 offset:7168
s_waitcnt lgkmcnt(3)
v_mfma_f32_16x16x32_bf16 v[64:67], v[44:47], v[80:83], v[64:67]
s_waitcnt lgkmcnt(2)
v_mfma_f32_16x16x32_bf16 v[68:71], v[44:47], v[84:87], v[68:71]
s_waitcnt lgkmcnt(1)
v_mfma_f32_16x16x32_bf16 v[72:75], v[44:47], v[88:91], v[72:75]
s_waitcnt lgkmcnt(0)
v_mfma_f32_16x16x32_bf16 v[76:79], v[44:47], v[92:95], v[76:79]
s_add_u32 s23, s28, 0
v_cvt_pk_bf16_f32 v80, v48, v52
v_cvt_pk_bf16_f32 v81, v56, v60
v_cvt_pk_bf16_f32 v82, v49, v53
v_cvt_pk_bf16_f32 v83, v57, v61
v_and_or_b32 v80, v80, -2, s21
buffer_store_dwordx4 v[80:83], v4, s[12:15], s23 offen offset:0 sc1
s_add_u32 s23, s28, 32768
v_cvt_pk_bf16_f32 v84, v50, v54
v_cvt_pk_bf16_f32 v85, v58, v62
v_cvt_pk_bf16_f32 v86, v51, v55
v_cvt_pk_bf16_f32 v87, v59, v63
v_and_or_b32 v84, v84, -2, s21
buffer_store_dwordx4 v[84:87], v4, s[12:15], s23 offen offset:0 sc1
s_add_u32 s23, s28, 0
v_cvt_pk_bf16_f32 v88, v64, v68
v_cvt_pk_bf16_f32 v89, v72, v76
v_cvt_pk_bf16_f32 v90, v65, v69
v_cvt_pk_bf16_f32 v91, v73, v77
v_and_or_b32 v88, v88, -2, s21
buffer_store_dwordx4 v[88:91], v4, s[12:15], s23 offen offset:256 sc1
s_add_u32 s23, s28, 32768
v_cvt_pk_bf16_f32 v92, v66, v70
v_cvt_pk_bf16_f32 v93, v74, v78
v_cvt_pk_bf16_f32 v94, v67, v71
v_cvt_pk_bf16_f32 v95, v75, v79
v_and_or_b32 v92, v92, -2, s21
buffer_store_dwordx4 v[92:95], v4, s[12:15], s23 offen offset:256 sc1
s_mov_b32 s22, 0
s_waitcnt vmcnt(0)
WR_160:
buffer_load_dwordx4 v[48:51], v5, s[12:15], s29 offen sc1
s_add_u32 s23, s29, 4096
buffer_load_dwordx4 v[52:55], v5, s[12:15], s23 offen sc1
s_add_u32 s23, s29, 8192
buffer_load_dwordx4 v[56:59], v5, s[12:15], s23 offen sc1
s_add_u32 s23, s29, 12288
buffer_load_dwordx4 v[60:63], v5, s[12:15], s23 offen sc1
s_mov_b64 exec, -1
s_add_u32 s22, s22, 1
s_cmp_gt_u32 s22, 2097152
s_cbranch_scc1 FAIL
s_waitcnt vmcnt(3)
v_mfma_f32_16x16x32_bf16 v[40:43], v[28:31], v[48:51], 0
v_xor_b32 v36, s21, v48
s_waitcnt vmcnt(2)
v_mfma_f32_16x16x32_bf16 v[40:43], v[28:31], v[52:55], v[40:43]
v_bitop3_b32 v36, v36, v52, s21 bitop3:0xf6
s_waitcnt vmcnt(1)
v_mfma_f32_16x16x32_bf16 v[40:43], v[28:31], v[56:59], v[40:43]
v_bitop3_b32 v36, v36, v56, s21 bitop3:0xf6
s_waitcnt vmcnt(0)
v_mfma_f32_16x16x32_bf16 v[40:43], v[28:31], v[60:63], v[40:43]
v_bitop3_b32 v36, v36, v60, s21 bitop3:0xf6
v_and_b32 v36, 1, v36
v_cmp_ne_u32_e64 vcc, 0, v36
s_cbranch_vccz WRE_161
s_mov_b64 exec, vcc
s_branch WR_160
WRE_161:
s_nop 3
v_pk_add_f32 v[32:33], v[32:33], v[40:41]
v_pk_add_f32 v[34:35], v[34:35], v[42:43]
s_cmp_eq_u32 s37, 1
s_cbranch_scc1 WF_162
v_add_f32 v48, v32, v33
v_mul_f32 v49, v32, v32
v_add_f32 v50, v34, v35
v_fmac_f32 v49, v33, v33
v_add_f32 v48, v48, v50
v_fmac_f32 v49, v34, v34
v_fmac_f32 v49, v35, v35
v_add_f32_dpp v48, v48, v48 row_ror:8 row_mask:0xf bank_mask:0xf
s_nop 0
v_add_f32_dpp v49, v49, v49 row_ror:8 row_mask:0xf bank_mask:0xf
v_add_f32_dpp v48, v48, v48 row_ror:4 row_mask:0xf bank_mask:0xf
s_nop 0
v_add_f32_dpp v49, v49, v49 row_ror:4 row_mask:0xf bank_mask:0xf
v_add_f32_dpp v48, v48, v48 row_ror:2 row_mask:0xf bank_mask:0xf
s_nop 0
v_add_f32_dpp v49, v49, v49 row_ror:2 row_mask:0xf bank_mask:0xf
v_add_f32_dpp v48, v48, v48 row_ror:1 row_mask:0xf bank_mask:0xf
s_nop 0
v_add_f32_dpp v49, v49, v49 row_ror:1 row_mask:0xf bank_mask:0xf
v_mov_b32 v50, v48
v_mov_b32 v51, v49
s_nop 0
v_permlane32_swap_b32_e64 v48, v50
v_permlane32_swap_b32 v49, v51
v_pk_add_f32 v[48:49], v[48:49], v[50:51]
s_mov_b64 exec, 0x10001
ds_write_b64 v9, v[48:49]
s_mov_b64 exec, -1
v_cvt_pk_bf16_f32 v44, v32, v33
v_cvt_pk_bf16_f32 v45, v34, v35
v_min_u32_e64 v44, -2, v44
s_add_u32 s23, s34, 140509184
buffer_store_dwordx2 v[44:45], v6, s[12:15], s23 offen sc1
s_waitcnt lgkmcnt(0)
s_barrier
ds_read_b128 v[50:53], v10
ds_read_b128 v[54:57], v10 offset:16
s_waitcnt lgkmcnt(1)
v_pk_add_f32 v[50:51], v[50:51], v[52:53]
s_waitcnt lgkmcnt(0)
v_pk_add_f32 v[54:55], v[54:55], v[56:57]
v_pk_add_f32 v[50:51], v[50:51], v[54:55]
v_mul_f32 v50, s43, v50
v_mul_f32 v51, s43, v51
v_fma_f32 v51, -v50, v50, v51
v_max_f32 v51, 0, v51
v_add_f32 v51, s44, v51
v_rsq_f32 v48, v51
s_nop 0
v_mul_f32 v49, v50, v48
v_sub_f32 v49, 0, v49
v_fma_f32 v50, v32, v48, v49
v_fma_f32 v51, v33, v48, v49
v_fma_f32 v52, v34, v48, v49
v_fma_f32 v53, v35, v48, v49
v_cvt_pk_bf16_f32 v46, v50, v51
v_cvt_pk_bf16_f32 v47, v52, v53
v_min_u32_e64 v46, -2, v46
s_add_u32 s23, s34, 138412032
buffer_store_dwordx2 v[46:47], v6, s[12:15], s23 offen sc1
s_branch WE_163
WF_162:
v_cvt_pk_bf16_f32 v46, v32, v33
v_cvt_pk_bf16_f32 v47, v34, v35
buffer_store_dwordx2 v[46:47], v6, s[8:11], s34 offen
WE_163:
s_add_u32 s33, s33, 24576
s_add_u32 s46, s46, 24576
s_add_u32 s45, s45, 1
s_add_u32 s20, s20, 3
s_cmp_lt_u32 s20, 64
s_cbranch_scc1 WL_145
s_branch FIN
ROLE_P:
s_sub_u32 s21, s21, 160
s_and_b32 s16, s21, 31
s_lshr_b32 s17, s21, 5
s_load_dwordx4 s[40:43], s[0:1], 16
s_load_dwordx2 s[44:45], s[0:1], 32
v_lshrrev_b32_e64 v1, 4, v0
v_and_b32_e64 v2, 15, v0
v_lshlrev_b32 v3, 13, v1
v_lshl_add_u32 v3, v2, 4, v3
s_waitcnt lgkmcnt(0)
s_cmp_eq_u32 s17, 0
s_cselect_b32 s4, s42, s44
s_cselect_b32 s5, s43, s45
s_cmp_eq_u32 s17, 2
s_cselect_b32 s4, s40, s4
s_cselect_b32 s5, s41, s5
s_mov_b32 s6, 0x400000
s_mov_b32 s7, 0x20000
s_lshl_b32 s20, s16, 8
s_lshl_b32 s21, s19, 15
s_add_u32 s20, s20, s21
s_lshl_b32 s21, s19, 10
s_add_u32 m0, s21, 0
s_add_u32 s22, s20, 0
buffer_load_dwordx4 v3, s[4:7], s22 offen lds
s_add_u32 m0, s21, 4096
s_add_u32 s22, s20, 131072
buffer_load_dwordx4 v3, s[4:7], s22 offen lds
s_add_u32 m0, s21, 8192
s_add_u32 s22, s20, 262144
buffer_load_dwordx4 v3, s[4:7], s22 offen lds
s_add_u32 m0, s21, 12288
s_add_u32 s22, s20, 393216
buffer_load_dwordx4 v3, s[4:7], s22 offen lds
s_add_u32 m0, s21, 16384
s_add_u32 s22, s20, 524288
buffer_load_dwordx4 v3, s[4:7], s22 offen lds
s_add_u32 m0, s21, 20480
s_add_u32 s22, s20, 655360
buffer_load_dwordx4 v3, s[4:7], s22 offen lds
s_add_u32 m0, s21, 24576
s_add_u32 s22, s20, 786432
buffer_load_dwordx4 v3, s[4:7], s22 offen lds
s_add_u32 m0, s21, 28672
s_add_u32 s22, s20, 917504
buffer_load_dwordx4 v3, s[4:7], s22 offen lds
s_add_u32 m0, s21, 32768
s_add_u32 s22, s20, 1048576
buffer_load_dwordx4 v3, s[4:7], s22 offen lds
s_add_u32 m0, s21, 36864
s_add_u32 s22, s20, 1179648
buffer_load_dwordx4 v3, s[4:7], s22 offen lds
s_add_u32 m0, s21, 40960
s_add_u32 s22, s20, 1310720
buffer_load_dwordx4 v3, s[4:7], s22 offen lds
s_add_u32 m0, s21, 45056
s_add_u32 s22, s20, 1441792
buffer_load_dwordx4 v3, s[4:7], s22 offen lds
s_add_u32 m0, s21, 49152
s_add_u32 s22, s20, 1572864
buffer_load_dwordx4 v3, s[4:7], s22 offen lds
s_add_u32 m0, s21, 53248
s_add_u32 s22, s20, 1703936
buffer_load_dwordx4 v3, s[4:7], s22 offen lds
s_add_u32 m0, s21, 57344
s_add_u32 s22, s20, 1835008
buffer_load_dwordx4 v3, s[4:7], s22 offen lds
s_add_u32 m0, s21, 61440
s_add_u32 s22, s20, 1966080
buffer_load_dwordx4 v3, s[4:7], s22 offen lds
s_add_u32 m0, s21, 65536
s_add_u32 s22, s20, 2097152
buffer_load_dwordx4 v3, s[4:7], s22 offen lds
s_add_u32 m0, s21, 69632
s_add_u32 s22, s20, 2228224
buffer_load_dwordx4 v3, s[4:7], s22 offen lds
s_add_u32 m0, s21, 73728
s_add_u32 s22, s20, 2359296
buffer_load_dwordx4 v3, s[4:7], s22 offen lds
s_add_u32 m0, s21, 77824
s_add_u32 s22, s20, 2490368
buffer_load_dwordx4 v3, s[4:7], s22 offen lds
s_add_u32 m0, s21, 81920
s_add_u32 s22, s20, 2621440
buffer_load_dwordx4 v3, s[4:7], s22 offen lds
s_add_u32 m0, s21, 86016
s_add_u32 s22, s20, 2752512
buffer_load_dwordx4 v3, s[4:7], s22 offen lds
s_add_u32 m0, s21, 90112
s_add_u32 s22, s20, 2883584
buffer_load_dwordx4 v3, s[4:7], s22 offen lds
s_add_u32 m0, s21, 94208
s_add_u32 s22, s20, 3014656
buffer_load_dwordx4 v3, s[4:7], s22 offen lds
s_add_u32 m0, s21, 98304
s_add_u32 s22, s20, 3145728
buffer_load_dwordx4 v3, s[4:7], s22 offen lds
s_add_u32 m0, s21, 102400
s_add_u32 s22, s20, 3276800
buffer_load_dwordx4 v3, s[4:7], s22 offen lds
s_add_u32 m0, s21, 106496
s_add_u32 s22, s20, 3407872
buffer_load_dwordx4 v3, s[4:7], s22 offen lds
s_add_u32 m0, s21, 110592
s_add_u32 s22, s20, 3538944
buffer_load_dwordx4 v3, s[4:7], s22 offen lds
s_add_u32 m0, s21, 114688
s_add_u32 s22, s20, 3670016
buffer_load_dwordx4 v3, s[4:7], s22 offen lds
s_add_u32 m0, s21, 118784
s_add_u32 s22, s20, 3801088
buffer_load_dwordx4 v3, s[4:7], s22 offen lds
s_add_u32 m0, s21, 122880
s_add_u32 s22, s20, 3932160
buffer_load_dwordx4 v3, s[4:7], s22 offen lds
s_add_u32 m0, s21, 126976
s_add_u32 s22, s20, 4063232
buffer_load_dwordx4 v3, s[4:7], s22 offen lds
v_lshrrev_b32 v4, 2, v2
v_lshrrev_b32 v5, 1, v1
v_lshl_add_u32 v4, v5, 3, v4
v_lshlrev_b32 v4, 8, v4
v_and_b32 v5, 1, v1
v_and_b32 v6, 3, v2
v_lshrrev_b32 v7, 1, v6
v_and_b32 v8, 1, v6
v_lshl_add_u32 v7, v8, 1, v7
s_cmp_eq_u32 s17, 1
s_cselect_b64 vcc, -1, 0
v_cndmask_b32 v6, v7, v6, vcc
v_lshl_add_u32 v4, v6, 3, v4
s_lshl_b32 s21, s19, 6
s_and_b32 s22, s19, 1
s_lshl_b32 s22, s22, 6
s_lshr_b32 s23, s19, 1
s_lshl_b32 s23, s23, 5
s_add_u32 s22, s22, s23
s_cmp_eq_u32 s17, 2
s_cselect_b32 s21, s22, s21
s_cselect_b32 s22, 7, 5
v_lshlrev_b32 v5, s22, v5
v_add3_u32 v4, v4, v5, s21
v_add_u32 v5, 0x10000, v4
s_waitcnt vmcnt(0)
s_barrier
ds_read_b64_tr_b16 a[0:1], v4 offset:0
ds_read_b64_tr_b16 a[2:3], v4 offset:1024
ds_read_b64_tr_b16 a[4:5], v4 offset:4096
ds_read_b64_tr_b16 a[6:7], v4 offset:5120
ds_read_b64_tr_b16 a[8:9], v4 offset:8192
ds_read_b64_tr_b16 a[10:11], v4 offset:9216
ds_read_b64_tr_b16 a[12:13], v4 offset:12288
ds_read_b64_tr_b16 a[14:15], v4 offset:13312
ds_read_b64_tr_b16 a[16:17], v4 offset:16384
ds_read_b64_tr_b16 a[18:19], v4 offset:17408
ds_read_b64_tr_b16 a[20:21], v4 offset:20480
ds_read_b64_tr_b16 a[22:23], v4 offset:21504
ds_read_b64_tr_b16 a[24:25], v4 offset:24576
ds_read_b64_tr_b16 a[26:27], v4 offset:25600
ds_read_b64_tr_b16 a[28:29], v4 offset:28672
ds_read_b64_tr_b16 a[30:31], v4 offset:29696
ds_read_b64_tr_b16 a[32:33], v4 offset:32768
ds_read_b64_tr_b16 a[34:35], v4 offset:33792
ds_read_b64_tr_b16 a[36:37], v4 offset:36864
ds_read_b64_tr_b16 a[38:39], v4 offset:37888
ds_read_b64_tr_b16 a[40:41], v4 offset:40960
ds_read_b64_tr_b16 a[42:43], v4 offset:41984
ds_read_b64_tr_b16 a[44:45], v4 offset:45056
ds_read_b64_tr_b16 a[46:47], v4 offset:46080
ds_read_b64_tr_b16 a[48:49], v4 offset:49152
ds_read_b64_tr_b16 a[50:51], v4 offset:50176
ds_read_b64_tr_b16 a[52:53], v4 offset:53248
ds_read_b64_tr_b16 a[54:55], v4 offset:54272
ds_read_b64_tr_b16 a[56:57], v4 offset:57344
ds_read_b64_tr_b16 a[58:59], v4 offset:58368
ds_read_b64_tr_b16 a[60:61], v4 offset:61440
ds_read_b64_tr_b16 a[62:63], v4 offset:62464
ds_read_b64_tr_b16 a[64:65], v5 offset:0
ds_read_b64_tr_b16 a[66:67], v5 offset:1024
ds_read_b64_tr_b16 a[68:69], v5 offset:4096
ds_read_b64_tr_b16 a[70:71], v5 offset:5120
ds_read_b64_tr_b16 a[72:73], v5 offset:8192
ds_read_b64_tr_b16 a[74:75], v5 offset:9216
ds_read_b64_tr_b16 a[76:77], v5 offset:12288
ds_read_b64_tr_b16 a[78:79], v5 offset:13312
ds_read_b64_tr_b16 a[80:81], v5 offset:16384
ds_read_b64_tr_b16 a[82:83], v5 offset:17408
ds_read_b64_tr_b16 a[84:85], v5 offset:20480
ds_read_b64_tr_b16 a[86:87], v5 offset:21504
ds_read_b64_tr_b16 a[88:89], v5 offset:24576
ds_read_b64_tr_b16 a[90:91], v5 offset:25600
ds_read_b64_tr_b16 a[92:93], v5 offset:28672
ds_read_b64_tr_b16 a[94:95], v5 offset:29696
ds_read_b64_tr_b16 a[96:97], v5 offset:32768
ds_read_b64_tr_b16 a[98:99], v5 offset:33792
ds_read_b64_tr_b16 a[100:101], v5 offset:36864
ds_read_b64_tr_b16 a[102:103], v5 offset:37888
ds_read_b64_tr_b16 a[104:105], v5 offset:40960
ds_read_b64_tr_b16 a[106:107], v5 offset:41984
ds_read_b64_tr_b16 a[108:109], v5 offset:45056
ds_read_b64_tr_b16 a[110:111], v5 offset:46080
ds_read_b64_tr_b16 a[112:113], v5 offset:49152
ds_read_b64_tr_b16 a[114:115], v5 offset:50176
ds_read_b64_tr_b16 a[116:117], v5 offset:53248
ds_read_b64_tr_b16 a[118:119], v5 offset:54272
ds_read_b64_tr_b16 a[120:121], v5 offset:57344
ds_read_b64_tr_b16 a[122:123], v5 offset:58368
ds_read_b64_tr_b16 a[124:125], v5 offset:61440
ds_read_b64_tr_b16 a[126:127], v5 offset:62464
s_waitcnt lgkmcnt(0)
s_barrier
v_mov_b32 v7, v0
v_lshlrev_b32 v0, 4, v7
s_lshl_b32 s21, s19, 13
v_add_u32 v54, s21, v0
s_and_b32 s21, s19, 1
s_lshl_b32 s21, s21, 3
s_add_u32 s22, s21, 0
v_xor_b32 v8, s22, v7
v_lshlrev_b32 v8, 4, v8
s_add_u32 s22, s21, 1
v_xor_b32 v9, s22, v7
v_lshlrev_b32 v9, 4, v9
s_add_u32 s22, s21, 2
v_xor_b32 v10, s22, v7
v_lshlrev_b32 v10, 4, v10
s_add_u32 s22, s21, 3
v_xor_b32 v11, s22, v7
v_lshlrev_b32 v11, 4, v11
s_add_u32 s22, s21, 4
v_xor_b32 v12, s22, v7
v_lshlrev_b32 v12, 4, v12
s_add_u32 s22, s21, 5
v_xor_b32 v13, s22, v7
v_lshlrev_b32 v13, 4, v13
s_add_u32 s22, s21, 6
v_xor_b32 v14, s22, v7
v_lshlrev_b32 v14, 4, v14
s_add_u32 s22, s21, 7
v_xor_b32 v15, s22, v7
v_lshlrev_b32 v15, 4, v15
v_and_b32 v5, 31, v7
v_lshrrev_b32 v6, 5, v7
v_mov_b32_e64 v55, v5
v_bfe_u32 v3, v5, 3, 1
v_and_b32 v4, 7, v5
v_lshlrev_b32 v4, 1, v4
v_lshl_add_u32 v3, v3, 4, v4
v_lshrrev_b32 v4, 4, v5
v_add_u32 v3, v3, v4
s_cmp_eq_u32 s17, 2
s_cselect_b64 vcc, -1, 0
v_cndmask_b32 v55, v5, v3, vcc
v_and_b32 v3, 15, v55
v_add_u32 v4, 0, v6
v_xor_b32 v4, v4, v3
v_lshlrev_b32_e64 v4, 4, v4
v_lshl_add_u32 v16, v55, 10, v4
v_mov_b32 v128, v16
v_add_u32 v4, 2, v6
v_xor_b32 v4, v4, v3
v_lshlrev_b32 v4, 4, v4
v_lshl_add_u32 v17, v55, 10, v4
v_mov_b32 v129, v17
v_add_u32 v4, 4, v6
v_xor_b32 v4, v4, v3
v_lshlrev_b32 v4, 4, v4
v_lshl_add_u32 v18, v55, 10, v4
v_mov_b32 v130, v18
v_add_u32 v4, 6, v6
v_xor_b32 v4, v4, v3
v_lshlrev_b32 v4, 4, v4
v_lshl_add_u32 v19, v55, 10, v4
v_mov_b32 v131, v19
v_add_u32 v4, 8, v6
v_xor_b32 v4, v4, v3
v_lshlrev_b32 v4, 4, v4
v_lshl_add_u32 v20, v55, 10, v4
v_mov_b32 v132, v20
v_add_u32 v4, 10, v6
v_xor_b32 v4, v4, v3
v_lshlrev_b32 v4, 4, v4
v_lshl_add_u32 v21, v55, 10, v4
v_mov_b32 v133, v21
v_add_u32 v4, 12, v6
v_xor_b32 v4, v4, v3
v_lshlrev_b32 v4, 4, v4
v_lshl_add_u32 v22, v55, 10, v4
v_mov_b32 v134, v22
v_add_u32 v4, 14, v6
v_xor_b32 v4, v4, v3
v_lshlrev_b32 v4, 4, v4
v_lshl_add_u32 v23, v55, 10, v4
v_mov_b32 v135, v23
v_mov_b64 v[48:49], -1
v_mov_b64_e64 v[50:51], -1
v_cmp_eq_u32 vcc, 0, v0
v_mov_b32 v136, 0x7fffffff
s_nop 0
v_cndmask_b32 v136, v136, v0, vcc
v_mov_b32 v53, 98304
s_lshl_b32 s21, s19, 2
v_add_u32 v52, s21, v53
s_cmp_eq_u32 s92, 1
s_cbranch_scc1 SR_164
v_readfirstlane_b32 s89, v127
SR_164:
s_cmp_eq_u32 s92, 1
s_cbranch_scc1 VK_167
s_mov_b32 s61, 0
VW_165:
s_add_u32 s61, s61, 1
s_cmp_gt_u32 s61, 2097152
s_cbranch_scc1 FAIL
s_sleep 16
s_load_dwordx2 s[62:63], s[0:1], 88
v_mbcnt_lo_u32_b32 v60, -1, 0
v_and_b32_e64 v61, 3, v60
v_lshrrev_b32_e64 v60, 2, v60
v_lshlrev_b32_e64 v60, 3, v60
v_lshl_add_u32 v60, v61, 6, v60
s_mov_b64 exec, 0xff
s_waitcnt lgkmcnt(0)
global_load_dwordx2 v[60:61], v60, s[62:63] sc1
s_mov_b64 exec, -1
VE_166:
s_mov_b64 exec, 0xff
s_waitcnt vmcnt(0)
v_cmp_eq_u32_e64 vcc, -1, v60
s_mov_b64 exec, vcc
v_cmp_eq_u32 vcc, 0x2000, v61
s_mov_b64 exec, -1
s_cmp_eq_u32 vcc_lo, 0xff
s_cbranch_scc1 VG_168
s_mov_b32 s64, 0
s_mov_b32 s65, 0
s_mov_b32 s66, 1
s_mov_b32 s67, 1
v_readlane_b32 s68, v61, 0
v_readlane_b32 s69, v60, 0
s_cmp_eq_u32 s68, 0x2000
s_cselect_b32 s67, s67, 0
s_cmp_eq_u32 s69, -1
s_cselect_b32 s67, s67, 0
s_lshr_b32 s68, s68, 8
s_add_u32 s64, s64, s68
s_cmp_gt_u32 s91, 0
s_cselect_b32 s69, s68, 0
s_add_u32 s65, s65, s69
s_cmp_eq_u32 s68, 32
s_cselect_b32 s66, s66, 0
v_readlane_b32 s68, v61, 1
v_readlane_b32 s69, v60, 1
s_cmp_eq_u32 s68, 0x2000
s_cselect_b32 s67, s67, 0
s_cmp_eq_u32 s69, -1
s_cselect_b32 s67, s67, 0
s_lshr_b32 s68, s68, 8
s_add_u32 s64, s64, s68
s_cmp_gt_u32 s91, 1
s_cselect_b32 s69, s68, 0
s_add_u32 s65, s65, s69
s_cmp_eq_u32 s68, 32
s_cselect_b32 s66, s66, 0
v_readlane_b32 s68, v61, 2
v_readlane_b32 s69, v60, 2
s_cmp_eq_u32 s68, 0x2000
s_cselect_b32 s67, s67, 0
s_cmp_eq_u32 s69, -1
s_cselect_b32 s67, s67, 0
s_lshr_b32 s68, s68, 8
s_add_u32 s64, s64, s68
s_cmp_gt_u32 s91, 2
s_cselect_b32 s69, s68, 0
s_add_u32 s65, s65, s69
s_cmp_eq_u32 s68, 32
s_cselect_b32 s66, s66, 0
v_readlane_b32 s68, v61, 3
v_readlane_b32 s69, v60, 3
s_cmp_eq_u32 s68, 0x2000
s_cselect_b32 s67, s67, 0
s_cmp_eq_u32 s69, -1
s_cselect_b32 s67, s67, 0
s_lshr_b32 s68, s68, 8
s_add_u32 s64, s64, s68
s_cmp_gt_u32 s91, 3
s_cselect_b32 s69, s68, 0
s_add_u32 s65, s65, s69
s_cmp_eq_u32 s68, 32
s_cselect_b32 s66, s66, 0
v_readlane_b32 s68, v61, 4
v_readlane_b32 s69, v60, 4
s_cmp_eq_u32 s68, 0x2000
s_cselect_b32 s67, s67, 0
s_cmp_eq_u32 s69, -1
s_cselect_b32 s67, s67, 0
s_lshr_b32 s68, s68, 8
s_add_u32 s64, s64, s68
s_cmp_gt_u32 s91, 4
s_cselect_b32 s69, s68, 0
s_add_u32 s65, s65, s69
s_cmp_eq_u32 s68, 32
s_cselect_b32 s66, s66, 0
v_readlane_b32 s68, v61, 5
v_readlane_b32 s69, v60, 5
s_cmp_eq_u32 s68, 0x2000
s_cselect_b32 s67, s67, 0
s_cmp_eq_u32 s69, -1
s_cselect_b32 s67, s67, 0
s_lshr_b32 s68, s68, 8
s_add_u32 s64, s64, s68
s_cmp_gt_u32 s91, 5
s_cselect_b32 s69, s68, 0
s_add_u32 s65, s65, s69
s_cmp_eq_u32 s68, 32
s_cselect_b32 s66, s66, 0
v_readlane_b32 s68, v61, 6
v_readlane_b32 s69, v60, 6
s_cmp_eq_u32 s68, 0x2000
s_cselect_b32 s67, s67, 0
s_cmp_eq_u32 s69, -1
s_cselect_b32 s67, s67, 0
s_lshr_b32 s68, s68, 8
s_add_u32 s64, s64, s68
s_cmp_gt_u32 s91, 6
s_cselect_b32 s69, s68, 0
s_add_u32 s65, s65, s69
s_cmp_eq_u32 s68, 32
s_cselect_b32 s66, s66, 0
v_readlane_b32 s68, v61, 7
v_readlane_b32 s69, v60, 7
s_cmp_eq_u32 s68, 0x2000
s_cselect_b32 s67, s67, 0
s_cmp_eq_u32 s69, -1
s_cselect_b32 s67, s67, 0
s_lshr_b32 s68, s68, 8
s_add_u32 s64, s64, s68
s_cmp_gt_u32 s91, 7
s_cselect_b32 s69, s68, 0
s_add_u32 s65, s65, s69
s_cmp_eq_u32 s68, 32
s_cselect_b32 s66, s66, 0
s_cmp_lt_u32 s64, 256
s_cbranch_scc1 VW_165
s_cmp_gt_u32 s64, 256
s_cbranch_scc1 FAIL
s_cmp_eq_u32 s67, 0
s_cbranch_scc1 REROLE
VG_168:
s_mov_b32 s18, 1
s_mov_b32 s92, 1
VK_167:
s_cmp_lg_u32 s19, 0
s_cbranch_scc1 RS_170
s_load_dwordx2 s[62:63], s[0:1], 88
v_mov_b32 v60, 144
s_mov_b32 s61, 0
s_mov_b64 exec, 1
s_waitcnt lgkmcnt(0)
RW_169:
s_add_u32 s61, s61, 1
s_cmp_gt_u32 s61, 2097152
s_cbranch_scc1 FAIL
s_sleep 8
global_load_dword v61, v60, s[62:63] sc1
s_waitcnt vmcnt(0)
v_cmp_gt_u32_e64 vcc, 48, v61
s_cbranch_vccnz RW_169
s_mov_b64 exec, -1
RS_170:
s_barrier
s_cmp_eq_u32 s17, 1
s_cbranch_scc1 PM1
s_cmp_eq_u32 s17, 2
s_cbranch_scc1 PM2
PM0:
v_bfe_u32 v3, v5, 3, 1
v_lshlrev_b32_e64 v3, 12, v3
v_lshl_add_u32 v3, v6, 8, v3
v_lshrrev_b32_e64 v4, 4, v5
v_lshl_add_u32 v3, v4, 7, v3
v_and_b32_e64 v4, 7, v5
v_lshl_add_u32 v3, v4, 4, v3
s_lshl_b32 s34, s19, 10
v_add_u32_e64 v2, s34, v3
s_lshl_b32 s30, s16, 8
s_lshl_b32 s34, s19, 4
s_add_u32 s30, s30, s34
s_add_u32 s30, s30, 159383552
s_mov_b32 s31, 268435456
s_mov_b32 s54, 268435456
s_mov_b32 s48, 268435456
s_mov_b32 s49, 268435456
s_mov_b32 s32, 0
s_mov_b32 s55, 0
s_mov_b32 s56, 0
s_mov_b32 s33, 0
s_lshl_b32 s47, s19, 13
s_mov_b32 s58, 0xfefefeff
s_mov_b32 s59, 0xfefefefe
s_mov_b32 s22, 0
s_mov_b32 s23, 0
s_mov_b32 s24, 0
s_mov_b32 s25, 1
s_mov_b32 s20, 2
s_mov_b32 s21, 0
s_mov_b32 s42, 0
s_mov_b32 s43, 32768
s_mov_b32 s44, 65536
s_mov_b32 s36, 0
s_lshl_b32 s28, s22, 6
s_add_u32 s28, s28, s23
s_lshl_b32 s28, s28, 15
s_add_u32 s28, s28, s47
s_add_u32 s28, s28, 136314880
s_add_u32 s29, s28, 4096
s_add_u32 s45, s42, s47
s_add_u32 s46, s45, 4096
s_mov_b32 m0, s45
s_nop 0
buffer_load_dwordx4 v8, s[12:15], s28 offen offset:0 sc1 lds
buffer_load_dwordx4 v9, s[12:15], s28 offen offset:1024 sc1 lds
buffer_load_dwordx4 v10, s[12:15], s28 offen offset:2048 sc1 lds
buffer_load_dwordx4 v11, s[12:15], s28 offen offset:3072 sc1 lds
s_mov_b32 m0, s46
s_nop 0
buffer_load_dwordx4 v12, s[12:15], s29 offen offset:0 sc1 lds
buffer_load_dwordx4 v13, s[12:15], s29 offen offset:1024 sc1 lds
buffer_load_dwordx4 v14, s[12:15], s29 offen offset:2048 sc1 lds
buffer_load_dwordx4 v15, s[12:15], s29 offen offset:3072 sc1 lds
s_lshl_b32 s28, s24, 6
s_add_u32 s28, s28, s25
s_lshl_b32 s28, s28, 15
s_add_u32 s28, s28, s47
s_add_u32 s28, s28, 136314880
s_add_u32 s29, s28, 4096
s_add_u32 s45, s43, s47
s_add_u32 s46, s45, 4096
s_mov_b32 m0, s45
s_nop 0
buffer_load_dwordx4 v8, s[12:15], s28 offen offset:0 sc1 lds
buffer_load_dwordx4 v9, s[12:15], s28 offen offset:1024 sc1 lds
buffer_load_dwordx4 v10, s[12:15], s28 offen offset:2048 sc1 lds
buffer_load_dwordx4 v11, s[12:15], s28 offen offset:3072 sc1 lds
s_mov_b32 m0, s46
s_nop 0
buffer_load_dwordx4 v12, s[12:15], s29 offen offset:0 sc1 lds
buffer_load_dwordx4 v13, s[12:15], s29 offen offset:1024 sc1 lds
buffer_load_dwordx4 v14, s[12:15], s29 offen offset:2048 sc1 lds
buffer_load_dwordx4 v15, s[12:15], s29 offen offset:3072 sc1 lds
s_waitcnt vmcnt(0)
s_barrier
ds_read_b128 v[64:67], v16 offset:0
ds_read_b128 v[68:71], v17 offset:0
ds_read_b128 v[72:75], v18 offset:0
ds_read_b128 v[76:79], v19 offset:0
PL_171:
s_cmp_eq_u32 s24, 1
s_cbranch_scc1 PB_176
s_waitcnt lgkmcnt(3)
v_mfma_f32_32x32x16_bf16 v[24:39], a[0:3], v[64:67], 0
ds_read_b128 v[80:83], v20 offset:0
s_bitcmp1_b64 s[58:59], s21
s_cselect_b32 s34, s24, 0
s_cmp_lt_u32 s20, 18
s_cselect_b32 s34, 1, s34
s_cmp_lt_u32 s20, 64
s_cselect_b32 s34, s34, 0
s_waitcnt lgkmcnt(3)
v_mfma_f32_32x32x16_bf16 v[24:39], a[4:7], v[68:71], v[24:39]
ds_read_b128 v[84:87], v21 offset:0
s_cmp_ge_u32 s21, 64
s_cselect_b32 s37, 1, 0
s_min_u32 s35, s21, 63
buffer_store_dwordx4 v[40:43], v2, s[12:15], s48 offen offset:0 sc1
s_waitcnt lgkmcnt(3)
v_mfma_f32_32x32x16_bf16 v[24:39], a[8:11], v[72:75], v[24:39]
ds_read_b128 v[88:91], v22 offset:0
s_cmp_eq_u32 s34, 1
s_cselect_b32 s27, s20, s35
s_cselect_b32 s37, 0, s37
s_cselect_b32 s26, 0, 1
s_waitcnt lgkmcnt(3)
v_mfma_f32_32x32x16_bf16 v[24:39], a[12:15], v[76:79], v[24:39]
ds_read_b128 v[92:95], v23 offset:0
s_add_u32 s20, s20, s34
s_add_u32 s21, s21, s26
buffer_store_dwordx4 v[44:47], v2, s[12:15], s48 offen offset:512 sc1
s_waitcnt lgkmcnt(3)
v_mfma_f32_32x32x16_bf16 v[24:39], a[16:19], v[80:83], v[24:39]
ds_read_b128 v[64:67], v16 offset:256
s_lshl_b32 s28, s26, 6
s_add_u32 s28, s28, s27
s_lshl_b32 s28, s28, 15
s_add_u32 s28, s28, s47
s_waitcnt lgkmcnt(3)
v_mfma_f32_32x32x16_bf16 v[24:39], a[20:23], v[84:87], v[24:39]
ds_read_b128 v[68:71], v17 offset:256
s_add_u32 s28, s28, 136314880
s_add_u32 s29, s28, 4096
s_add_u32 s45, s44, s47
s_add_u32 s46, s45, 4096
buffer_store_dwordx4 v[48:51], v0, s[12:15], s49 offen sc1
s_waitcnt lgkmcnt(3)
v_mfma_f32_32x32x16_bf16 v[24:39], a[24:27], v[88:91], v[24:39]
ds_read_b128 v[72:75], v18 offset:256
s_waitcnt lgkmcnt(3)
v_mfma_f32_32x32x16_bf16 v[24:39], a[28:31], v[92:95], v[24:39]
ds_read_b128 v[76:79], v19 offset:256
s_waitcnt vmcnt(13)
v_mov_b32 v3, s55
buffer_store_dword v3, v136, s[12:15], s54 offen sc1
s_waitcnt lgkmcnt(3)
v_mfma_f32_32x32x16_bf16 v[24:39], a[32:35], v[64:67], v[24:39]
ds_read_b128 v[80:83], v20 offset:256
s_waitcnt lgkmcnt(3)
v_mfma_f32_32x32x16_bf16 v[24:39], a[36:39], v[68:71], v[24:39]
ds_read_b128 v[84:87], v21 offset:256
s_waitcnt lgkmcnt(3)
v_mfma_f32_32x32x16_bf16 v[24:39], a[40:43], v[72:75], v[24:39]
ds_read_b128 v[88:91], v22 offset:256
s_waitcnt lgkmcnt(3)
v_mfma_f32_32x32x16_bf16 v[24:39], a[44:47], v[76:79], v[24:39]
ds_read_b128 v[92:95], v23 offset:256
s_waitcnt lgkmcnt(3)
v_mfma_f32_32x32x16_bf16 v[24:39], a[48:51], v[80:83], v[24:39]
ds_read_b128 v[64:67], v16 offset:512
s_waitcnt lgkmcnt(3)
v_mfma_f32_32x32x16_bf16 v[24:39], a[52:55], v[84:87], v[24:39]
ds_read_b128 v[68:71], v17 offset:512
s_waitcnt lgkmcnt(3)
v_mfma_f32_32x32x16_bf16 v[24:39], a[56:59], v[88:91], v[24:39]
ds_read_b128 v[72:75], v18 offset:512
s_mov_b32 m0, s45
s_nop 0
buffer_load_dwordx4 v8, s[12:15], s28 offen offset:0 sc1 lds
s_waitcnt lgkmcnt(3)
v_mfma_f32_32x32x16_bf16 v[24:39], a[60:63], v[92:95], v[24:39]
ds_read_b128 v[76:79], v19 offset:512
s_lshl_b32 s34, s22, 5
s_add_u32 s34, s34, s16
s_lshl_b32 s34, s34, 6
s_add_u32 s34, s34, s23
s_waitcnt lgkmcnt(3)
v_mfma_f32_32x32x16_bf16 v[24:39], a[64:67], v[64:67], v[24:39]
ds_read_b128 v[80:83], v20 offset:512
buffer_load_dwordx4 v9, s[12:15], s28 offen offset:1024 sc1 lds
s_waitcnt lgkmcnt(3)
v_mfma_f32_32x32x16_bf16 v[24:39], a[68:71], v[68:71], v[24:39]
ds_read_b128 v[84:87], v21 offset:512
s_mul_i32 s38, s34, 24576
s_lshl_b32 s39, s34, 13
s_lshl_b32 s35, s19, 10
s_add_u32 s39, s39, s35
s_waitcnt lgkmcnt(3)
v_mfma_f32_32x32x16_bf16 v[24:39], a[72:75], v[72:75], v[24:39]
ds_read_b128 v[88:91], v22 offset:512
buffer_load_dwordx4 v10, s[12:15], s28 offen offset:2048 sc1 lds
s_waitcnt lgkmcnt(3)
v_mfma_f32_32x32x16_bf16 v[24:39], a[76:79], v[76:79], v[24:39]
ds_read_b128 v[92:95], v23 offset:512
s_add_u32 s39, s39, 100687872
s_cmp_ge_u32 s23, 61
s_cselect_b32 s39, s14, s39
s_waitcnt lgkmcnt(3)
v_mfma_f32_32x32x16_bf16 v[24:39], a[80:83], v[80:83], v[24:39]
ds_read_b128 v[64:67], v16 offset:768
buffer_load_dwordx4 v11, s[12:15], s28 offen offset:3072 sc1 lds
s_waitcnt lgkmcnt(3)
v_mfma_f32_32x32x16_bf16 v[24:39], a[84:87], v[84:87], v[24:39]
ds_read_b128 v[68:71], v17 offset:768
s_lshl_b32 s40, s22, 13
s_add_u32 s40, s40, s30
s_add_u32 s41, s23, 1
s_waitcnt lgkmcnt(3)
v_mfma_f32_32x32x16_bf16 v[24:39], a[88:91], v[88:91], v[24:39]
ds_read_b128 v[72:75], v18 offset:768
s_mov_b32 m0, s46
s_nop 0
buffer_load_dwordx4 v12, s[12:15], s29 offen offset:0 sc1 lds
s_waitcnt lgkmcnt(3)
v_mfma_f32_32x32x16_bf16 v[24:39], a[92:95], v[92:95], v[24:39]
ds_read_b128 v[76:79], v19 offset:768
s_mov_b32 s57, s43
s_mov_b32 s60, s36
s_cmp_lt_u32 s23, 2
s_cselect_b32 s61, 1, s22
s_waitcnt lgkmcnt(3)
v_mfma_f32_32x32x16_bf16 v[24:39], a[96:99], v[64:67], v[24:39]
ds_read_b128 v[80:83], v20 offset:768
buffer_load_dwordx4 v13, s[12:15], s29 offen offset:1024 sc1 lds
v_add_u32 v16, s57, v128
s_waitcnt lgkmcnt(3)
v_mfma_f32_32x32x16_bf16 v[24:39], a[100:103], v[68:71], v[24:39]
ds_read_b128 v[84:87], v21 offset:768
s_mov_b32 s22, s24
s_mov_b32 s23, s25
s_mov_b32 s24, s26
s_mov_b32 s25, s27
v_add_u32 v17, s57, v129
s_waitcnt lgkmcnt(3)
v_mfma_f32_32x32x16_bf16 v[24:39], a[104:107], v[72:75], v[24:39]
ds_read_b128 v[88:91], v22 offset:768
buffer_load_dwordx4 v14, s[12:15], s29 offen offset:2048 sc1 lds
v_add_u32 v18, s57, v130
s_waitcnt lgkmcnt(3)
v_mfma_f32_32x32x16_bf16 v[24:39], a[108:111], v[76:79], v[24:39]
ds_read_b128 v[92:95], v23 offset:768
s_mov_b32 s34, s42
s_mov_b32 s42, s43
s_mov_b32 s43, s44
s_mov_b32 s44, s34
s_mov_b32 s36, s37
v_add_u32_e64 v19, s57, v131
s_waitcnt lgkmcnt(3)
v_mfma_f32_32x32x16_bf16 v[24:39], a[112:115], v[80:83], v[24:39]
buffer_load_dwordx4 v15, s[12:15], s29 offen offset:3072 sc1 lds
v_add_u32 v20, s57, v132
s_cmp_eq_u32 s56, 1
s_cselect_b32 s54, s14, s31
s_cselect_b32 s31, s31, s14
s_mov_b32 s55, s32
s_waitcnt lgkmcnt(2)
v_mfma_f32_32x32x16_bf16 v[24:39], a[116:119], v[84:87], v[24:39]
v_add_u32_e64 v21, s57, v133
s_waitcnt vmcnt(13) lgkmcnt(0)
s_barrier
ds_read_b128 v[64:67], v16 offset:0
v_mfma_f32_32x32x16_bf16 v[24:39], a[120:123], v[88:91], v[24:39]
v_add_u32_e64 v22, s57, v134
ds_read_b128 v[68:71], v17 offset:0
ds_read_b128 v[72:75], v18 offset:0
s_cbranch_scc0 PF_177
s_waitcnt vmcnt(9)
PF_177:
v_mov_b32_e64 v3, s32
buffer_store_dword v3, v136, s[12:15], s31 offen sc1
v_mfma_f32_32x32x16_bf16 v[24:39], a[124:127], v[92:95], v[24:39]
v_add_u32_e64 v23, s57, v135
ds_read_b128 v[76:79], v19 offset:0
s_mov_b32 s48, s38
s_mov_b32 s49, s39
s_mov_b32 s31, s40
s_mov_b32 s32, s41
s_mov_b32 s56, s61
s_nop 4
v_cvt_pk_bf16_f32 v40, v24, v25
v_cvt_pk_bf16_f32 v41, v26, v27
v_cvt_pk_bf16_f32 v42, v28, v29
v_cvt_pk_bf16_f32 v43, v30, v31
v_cvt_pk_bf16_f32 v44, v32, v33
v_cvt_pk_bf16_f32 v45, v34, v35
v_cvt_pk_bf16_f32 v46, v36, v37
v_cvt_pk_bf16_f32 v47, v38, v39
s_branch PL_171
PB_176:
s_waitcnt lgkmcnt(3)
v_mfma_f32_32x32x16_bf16 v[24:39], a[0:3], v[64:67], 0
ds_read_b128 v[80:83], v20 offset:0
s_bitcmp1_b64 s[58:59], s21
s_cselect_b32 s34, s24, 0
s_cmp_lt_u32 s20, 18
s_cselect_b32 s34, 1, s34
s_cmp_lt_u32 s20, 64
s_cselect_b32 s34, s34, 0
s_waitcnt lgkmcnt(3)
v_mfma_f32_32x32x16_bf16 v[24:39], a[4:7], v[68:71], v[24:39]
ds_read_b128 v[84:87], v21 offset:0
s_cmp_ge_u32 s21, 64
s_cselect_b32 s37, 1, 0
s_min_u32 s35, s21, 63
buffer_store_dwordx4 v[40:43], v2, s[12:15], s48 offen offset:0 sc1
s_waitcnt lgkmcnt(3)
v_mfma_f32_32x32x16_bf16 v[24:39], a[8:11], v[72:75], v[24:39]
ds_read_b128 v[88:91], v22 offset:0
s_cmp_eq_u32 s34, 1
s_cselect_b32 s27, s20, s35
s_cselect_b32 s37, 0, s37
s_cselect_b32 s26, 0, 1
s_waitcnt lgkmcnt(3)
v_mfma_f32_32x32x16_bf16 v[24:39], a[12:15], v[76:79], v[24:39]
ds_read_b128 v[92:95], v23 offset:0
s_add_u32 s20, s20, s34
s_add_u32 s21, s21, s26
buffer_store_dwordx4 v[44:47], v2, s[12:15], s48 offen offset:512 sc1
s_waitcnt lgkmcnt(3)
v_mfma_f32_32x32x16_bf16 v[24:39], a[16:19], v[80:83], v[24:39]
ds_read_b128 v[64:67], v16 offset:256
s_lshl_b32 s28, s26, 6
s_add_u32 s28, s28, s27
s_lshl_b32 s28, s28, 15
s_add_u32 s28, s28, s47
s_waitcnt lgkmcnt(3)
v_mfma_f32_32x32x16_bf16 v[24:39], a[20:23], v[84:87], v[24:39]
ds_read_b128 v[68:71], v17 offset:256
s_add_u32 s28, s28, 136314880
s_add_u32 s29, s28, 4096
s_add_u32 s45, s44, s47
s_add_u32 s46, s45, 4096
buffer_store_dwordx4 v[48:51], v0, s[12:15], s49 offen sc1
s_waitcnt lgkmcnt(3)
v_mfma_f32_32x32x16_bf16 v[24:39], a[24:27], v[88:91], v[24:39]
ds_read_b128 v[72:75], v18 offset:256
v_add_u32 v1, s43, v54
s_waitcnt lgkmcnt(3)
v_mfma_f32_32x32x16_bf16 v[24:39], a[28:31], v[92:95], v[24:39]
ds_read_b128 v[76:79], v19 offset:256
s_waitcnt vmcnt(13)
v_mov_b32 v3, s55
buffer_store_dword v3, v136, s[12:15], s54 offen sc1
s_waitcnt lgkmcnt(3)
v_mfma_f32_32x32x16_bf16 v[24:39], a[32:35], v[64:67], v[24:39]
ds_read_b128 v[80:83], v20 offset:256
s_waitcnt lgkmcnt(3)
v_mfma_f32_32x32x16_bf16 v[24:39], a[36:39], v[68:71], v[24:39]
ds_read_b128 v[84:87], v21 offset:256
s_waitcnt vmcnt(5)
ds_read_b128 v[96:99], v1 offset:0
ds_read_b128 v[100:103], v1 offset:1024
ds_read_b128 v[104:107], v1 offset:2048
ds_read_b128 v[108:111], v1 offset:3072
s_waitcnt lgkmcnt(7)
v_mfma_f32_32x32x16_bf16 v[24:39], a[40:43], v[72:75], v[24:39]
ds_read_b128 v[88:91], v22 offset:256
ds_read_b128 v[112:115], v1 offset:4096
ds_read_b128 v[116:119], v1 offset:5120
ds_read_b128 v[120:123], v1 offset:6144
ds_read_b128 v[124:127], v1 offset:7168
s_waitcnt lgkmcnt(11)
v_mfma_f32_32x32x16_bf16 v[24:39], a[44:47], v[76:79], v[24:39]
ds_read_b128 v[92:95], v23 offset:256
s_waitcnt lgkmcnt(11)
v_mfma_f32_32x32x16_bf16 v[24:39], a[48:51], v[80:83], v[24:39]
ds_read_b128 v[64:67], v16 offset:512
s_waitcnt lgkmcnt(10)
v_max_u32 v4, v96, v98
s_waitcnt lgkmcnt(9)
v_max3_u32 v4, v4, v100, v102
s_waitcnt lgkmcnt(8)
v_max3_u32 v4, v4, v104, v106
s_waitcnt lgkmcnt(7)
v_max3_u32 v4, v4, v108, v110
s_waitcnt lgkmcnt(5)
v_max3_u32 v4, v4, v112, v114
v_mfma_f32_32x32x16_bf16 v[24:39], a[52:55], v[84:87], v[24:39]
ds_read_b128 v[68:71], v17 offset:512
s_waitcnt lgkmcnt(5)
v_max3_u32 v4, v4, v116, v118
s_waitcnt lgkmcnt(4)
v_max3_u32 v4, v4, v120, v122
s_waitcnt lgkmcnt(3)
v_max3_u32 v4, v4, v124, v126
v_cmp_eq_u32 vcc, -1, v4
v_mfma_f32_32x32x16_bf16 v[24:39], a[56:59], v[88:91], v[24:39]
ds_read_b128 v[72:75], v18 offset:512
s_cmp_lg_u64 vcc, 0
s_cselect_b32 s34, 1, 0
v_mov_b32_e64 v3, s34
ds_write_b32 v52, v3
s_mov_b32 m0, s45
s_nop 0
buffer_load_dwordx4 v8, s[12:15], s28 offen offset:0 sc1 lds
s_waitcnt lgkmcnt(4)
v_mfma_f32_32x32x16_bf16 v[24:39], a[60:63], v[92:95], v[24:39]
ds_read_b128 v[76:79], v19 offset:512
s_lshl_b32 s34, s22, 5
s_add_u32 s34, s34, s16
s_lshl_b32 s34, s34, 6
s_add_u32 s34, s34, s23
s_waitcnt lgkmcnt(4)
v_mfma_f32_32x32x16_bf16 v[24:39], a[64:67], v[64:67], v[24:39]
ds_read_b128 v[80:83], v20 offset:512
buffer_load_dwordx4 v9, s[12:15], s28 offen offset:1024 sc1 lds
s_waitcnt lgkmcnt(4)
v_mfma_f32_32x32x16_bf16 v[24:39], a[68:71], v[68:71], v[24:39]
ds_read_b128 v[84:87], v21 offset:512
s_mul_i32 s38, s34, 24576
s_lshl_b32 s39, s34, 13
s_lshl_b32 s35, s19, 10
s_add_u32 s39, s39, s35
s_waitcnt lgkmcnt(4)
v_mfma_f32_32x32x16_bf16 v[24:39], a[72:75], v[72:75], v[24:39]
ds_read_b128 v[88:91], v22 offset:512
buffer_load_dwordx4 v10, s[12:15], s28 offen offset:2048 sc1 lds
s_waitcnt lgkmcnt(3)
v_mfma_f32_32x32x16_bf16 v[24:39], a[76:79], v[76:79], v[24:39]
ds_read_b128 v[92:95], v23 offset:512
s_add_u32 s39, s39, 100687872
s_cmp_ge_u32 s23, 61
s_cselect_b32 s39, s14, s39
s_waitcnt lgkmcnt(3)
v_mfma_f32_32x32x16_bf16 v[24:39], a[80:83], v[80:83], v[24:39]
ds_read_b128 v[64:67], v16 offset:768
buffer_load_dwordx4 v11, s[12:15], s28 offen offset:3072 sc1 lds
s_waitcnt lgkmcnt(3)
v_mfma_f32_32x32x16_bf16 v[24:39], a[84:87], v[84:87], v[24:39]
ds_read_b128 v[68:71], v17 offset:768
s_lshl_b32 s40, s22, 13
s_add_u32 s40, s40, s30
s_add_u32 s41, s23, 1
s_waitcnt lgkmcnt(3)
v_mfma_f32_32x32x16_bf16 v[24:39], a[88:91], v[88:91], v[24:39]
ds_read_b128 v[72:75], v18 offset:768
s_mov_b32 m0, s46
s_nop 0
buffer_load_dwordx4 v12, s[12:15], s29 offen offset:0 sc1 lds
s_waitcnt lgkmcnt(3)
v_mfma_f32_32x32x16_bf16 v[24:39], a[92:95], v[92:95], v[24:39]
ds_read_b128 v[76:79], v19 offset:768
s_mov_b32 s57, s43
s_mov_b32 s60, s36
s_cmp_lt_u32 s23, 2
s_cselect_b32 s61, 1, s22
s_waitcnt lgkmcnt(3)
v_mfma_f32_32x32x16_bf16 v[24:39], a[96:99], v[64:67], v[24:39]
ds_read_b128 v[80:83], v20 offset:768
buffer_load_dwordx4 v13, s[12:15], s29 offen offset:1024 sc1 lds
v_add_u32 v16, s57, v128
s_waitcnt lgkmcnt(3)
v_mfma_f32_32x32x16_bf16 v[24:39], a[100:103], v[68:71], v[24:39]
ds_read_b128 v[84:87], v21 offset:768
s_mov_b32 s22, s24
s_mov_b32 s23, s25
s_mov_b32 s24, s26
s_mov_b32 s25, s27
v_add_u32 v17, s57, v129
s_waitcnt lgkmcnt(3)
v_mfma_f32_32x32x16_bf16 v[24:39], a[104:107], v[72:75], v[24:39]
ds_read_b128 v[88:91], v22 offset:768
buffer_load_dwordx4 v14, s[12:15], s29 offen offset:2048 sc1 lds
v_add_u32 v18, s57, v130
s_waitcnt lgkmcnt(3)
v_mfma_f32_32x32x16_bf16 v[24:39], a[108:111], v[76:79], v[24:39]
ds_read_b128 v[92:95], v23 offset:768
s_mov_b32 s34, s42
s_mov_b32 s42, s43
s_mov_b32 s43, s44
s_mov_b32 s44, s34
s_mov_b32 s36, s37
v_add_u32_e64 v19, s57, v131
s_waitcnt lgkmcnt(3)
v_mfma_f32_32x32x16_bf16 v[24:39], a[112:115], v[80:83], v[24:39]
buffer_load_dwordx4 v15, s[12:15], s29 offen offset:3072 sc1 lds
v_add_u32 v20, s57, v132
s_cmp_eq_u32 s56, 1
s_cselect_b32 s54, s14, s31
s_cselect_b32 s31, s31, s14
s_mov_b32 s55, s32
s_waitcnt lgkmcnt(2)
v_mfma_f32_32x32x16_bf16 v[24:39], a[116:119], v[84:87], v[24:39]
v_add_u32_e64 v21, s57, v133
s_waitcnt vmcnt(13) lgkmcnt(0)
s_barrier
ds_read_b128 v[96:99], v53
ds_read_b128 v[64:67], v16 offset:0
v_mfma_f32_32x32x16_bf16 v[24:39], a[120:123], v[88:91], v[24:39]
v_add_u32_e64 v22, s57, v134
ds_read_b128 v[68:71], v17 offset:0
ds_read_b128 v[72:75], v18 offset:0
s_cbranch_scc0 PF_178
s_waitcnt vmcnt(9)
PF_178:
v_mov_b32_e64 v3, s32
buffer_store_dword v3, v136, s[12:15], s31 offen sc1
v_mfma_f32_32x32x16_bf16 v[24:39], a[124:127], v[92:95], v[24:39]
v_add_u32 v23, s57, v135
ds_read_b128 v[76:79], v19 offset:0
s_waitcnt lgkmcnt(4)
v_or3_b32 v4, v96, v97, v98
v_or3_b32 v4, v4, v99, s60
v_cmp_ne_u32 vcc, 0, v4
v_xor_b32 v52, 16, v52
v_xor_b32_e64 v53, 16, v53
s_mov_b32 s48, s38
s_mov_b32 s49, s39
s_mov_b32 s31, s40
s_mov_b32 s32, s41
s_mov_b32 s56, s61
s_cbranch_vccnz PS_172
v_cvt_pk_bf16_f32 v40, v24, v25
v_cvt_pk_bf16_f32 v41, v26, v27
v_cvt_pk_bf16_f32 v42, v28, v29
v_cvt_pk_bf16_f32 v43, v30, v31
v_cvt_pk_bf16_f32 v44, v32, v33
v_cvt_pk_bf16_f32 v45, v34, v35
v_cvt_pk_bf16_f32 v46, v36, v37
v_cvt_pk_bf16_f32 v47, v38, v39
s_branch PL_171
PS_172:
s_lshl_b32 s28, s22, 6
s_add_u32 s28, s28, s23
s_lshl_b32 s28, s28, 15
s_add_u32 s28, s28, s47
s_add_u32 s28, s28, 136314880
s_add_u32 s29, s28, 4096
s_add_u32 s45, s42, s47
s_add_u32 s46, s45, 4096
s_mov_b32 m0, s45
s_nop 0
buffer_load_dwordx4 v8, s[12:15], s28 offen offset:0 sc1 lds
buffer_load_dwordx4 v9, s[12:15], s28 offen offset:1024 sc1 lds
buffer_load_dwordx4 v10, s[12:15], s28 offen offset:2048 sc1 lds
buffer_load_dwordx4 v11, s[12:15], s28 offen offset:3072 sc1 lds
s_mov_b32 m0, s46
s_nop 0
buffer_load_dwordx4 v12, s[12:15], s29 offen offset:0 sc1 lds
buffer_load_dwordx4 v13, s[12:15], s29 offen offset:1024 sc1 lds
buffer_load_dwordx4 v14, s[12:15], s29 offen offset:2048 sc1 lds
buffer_load_dwordx4 v15, s[12:15], s29 offen offset:3072 sc1 lds
v_cvt_pk_bf16_f32 v40, v24, v25
v_cvt_pk_bf16_f32 v41, v26, v27
v_cvt_pk_bf16_f32 v42, v28, v29
v_cvt_pk_bf16_f32 v43, v30, v31
buffer_store_dwordx4 v[40:43], v2, s[12:15], s48 offen offset:0 sc1
v_cvt_pk_bf16_f32 v44, v32, v33
v_cvt_pk_bf16_f32 v45, v34, v35
v_cvt_pk_bf16_f32 v46, v36, v37
v_cvt_pk_bf16_f32 v47, v38, v39
buffer_store_dwordx4 v[44:47], v2, s[12:15], s48 offen offset:512 sc1
buffer_store_dwordx4 v[48:51], v0, s[12:15], s49 offen sc1
s_mov_b32 s48, 268435456
s_mov_b32 s49, 268435456
s_mov_b32 s33, 0
s_waitcnt vmcnt(3)
s_cmp_eq_u32 s60, 1
s_cbranch_scc1 PFIN_175
PCHK_173:
ds_read_b128 v[96:99], v1 offset:0
ds_read_b128 v[100:103], v1 offset:1024
ds_read_b128 v[104:107], v1 offset:2048
ds_read_b128 v[108:111], v1 offset:3072
ds_read_b128 v[112:115], v1 offset:4096
ds_read_b128 v[116:119], v1 offset:5120
ds_read_b128 v[120:123], v1 offset:6144
ds_read_b128 v[124:127], v1 offset:7168
s_waitcnt lgkmcnt(7)
v_max_u32 v4, v96, v98
s_waitcnt lgkmcnt(6)
v_max3_u32 v4, v4, v100, v102
s_waitcnt lgkmcnt(5)
v_max3_u32 v4, v4, v104, v106
s_waitcnt lgkmcnt(4)
v_max3_u32 v4, v4, v108, v110
s_waitcnt lgkmcnt(3)
v_max3_u32 v4, v4, v112, v114
s_waitcnt lgkmcnt(2)
v_max3_u32 v4, v4, v116, v118
s_waitcnt lgkmcnt(1)
v_max3_u32 v4, v4, v120, v122
s_waitcnt lgkmcnt(0)
v_max3_u32 v4, v4, v124, v126
v_cmp_eq_u32 vcc, -1, v4
s_cbranch_vccz PGO_174
s_add_u32 s33, s33, 1
s_cmp_gt_u32 s33, 2097152
s_cbranch_scc1 FAIL
s_cmp_eq_u32 s31, s14
s_cbranch_scc1 PRE_179
s_waitcnt vmcnt(0)
v_mov_b32 v3, s55
buffer_store_dword v3, v136, s[12:15], s54 offen sc1
v_mov_b32 v3, s32
buffer_store_dword v3, v136, s[12:15], s31 offen sc1
s_mov_b32 s54, 268435456
s_mov_b32 s31, 268435456
PRE_179:
s_mov_b32 m0, s45
s_nop 0
buffer_load_dwordx4 v8, s[12:15], s28 offen offset:0 sc1 lds
buffer_load_dwordx4 v9, s[12:15], s28 offen offset:1024 sc1 lds
buffer_load_dwordx4 v10, s[12:15], s28 offen offset:2048 sc1 lds
buffer_load_dwordx4 v11, s[12:15], s28 offen offset:3072 sc1 lds
s_mov_b32 m0, s46
s_nop 0
buffer_load_dwordx4 v12, s[12:15], s29 offen offset:0 sc1 lds
buffer_load_dwordx4 v13, s[12:15], s29 offen offset:1024 sc1 lds
buffer_load_dwordx4 v14, s[12:15], s29 offen offset:2048 sc1 lds
buffer_load_dwordx4 v15, s[12:15], s29 offen offset:3072 sc1 lds
s_waitcnt vmcnt(0)
s_branch PCHK_173
PGO_174:
s_barrier
ds_read_b128 v[64:67], v16 offset:0
ds_read_b128 v[68:71], v17 offset:0
ds_read_b128 v[72:75], v18 offset:0
ds_read_b128 v[76:79], v19 offset:0
s_branch PL_171
PFIN_175:
s_waitcnt vmcnt(0)
v_mov_b32 v3, s55
buffer_store_dword v3, v136, s[12:15], s54 offen sc1
v_mov_b32_e64 v3, s32
buffer_store_dword v3, v136, s[12:15], s31 offen sc1
s_branch FIN
PM1:
v_and_b32 v3, 1, v5
v_lshlrev_b32_e64 v3, 10, v3
v_lshl_add_u32 v3, v6, 8, v3
v_lshrrev_b32 v4, 1, v5
v_lshl_add_u32 v3, v4, 4, v3
s_lshl_b32 s34, s19, 11
s_add_u32 s34, s34, 8192
v_add_u32 v2, s34, v3
s_lshl_b32 s30, s16, 8
s_lshl_b32 s34, s19, 4
s_add_u32 s30, s30, s34
s_add_u32 s30, s30, 159383616
s_mov_b32 s31, 268435456
s_mov_b32 s54, 268435456
s_mov_b32 s48, 268435456
s_mov_b32 s49, 268435456
s_mov_b32 s32, 0
s_mov_b32 s55, 0
s_mov_b32 s56, 0
s_mov_b32 s33, 0
s_lshl_b32 s47, s19, 13
s_mov_b32 s58, 0xfefefeff
s_mov_b32 s59, 0xfefefefe
s_mov_b32 s22, 0
s_mov_b32 s23, 0
s_mov_b32 s24, 0
s_mov_b32 s25, 1
s_mov_b32 s20, 2
s_mov_b32 s21, 0
s_mov_b32 s42, 0
s_mov_b32 s43, 32768
s_mov_b32 s44, 65536
s_mov_b32 s36, 0
s_lshl_b32 s28, s22, 6
s_add_u32 s28, s28, s23
s_lshl_b32 s28, s28, 15
s_add_u32 s28, s28, s47
s_add_u32 s28, s28, 136314880
s_add_u32 s29, s28, 4096
s_add_u32 s45, s42, s47
s_add_u32 s46, s45, 4096
s_mov_b32 m0, s45
s_nop 0
buffer_load_dwordx4 v8, s[12:15], s28 offen offset:0 sc1 lds
buffer_load_dwordx4 v9, s[12:15], s28 offen offset:1024 sc1 lds
buffer_load_dwordx4 v10, s[12:15], s28 offen offset:2048 sc1 lds
buffer_load_dwordx4 v11, s[12:15], s28 offen offset:3072 sc1 lds
s_mov_b32 m0, s46
s_nop 0
buffer_load_dwordx4 v12, s[12:15], s29 offen offset:0 sc1 lds
buffer_load_dwordx4 v13, s[12:15], s29 offen offset:1024 sc1 lds
buffer_load_dwordx4 v14, s[12:15], s29 offen offset:2048 sc1 lds
buffer_load_dwordx4 v15, s[12:15], s29 offen offset:3072 sc1 lds
s_lshl_b32 s28, s24, 6
s_add_u32 s28, s28, s25
s_lshl_b32 s28, s28, 15
s_add_u32 s28, s28, s47
s_add_u32 s28, s28, 136314880
s_add_u32 s29, s28, 4096
s_add_u32 s45, s43, s47
s_add_u32 s46, s45, 4096
s_mov_b32 m0, s45
s_nop 0
buffer_load_dwordx4 v8, s[12:15], s28 offen offset:0 sc1 lds
buffer_load_dwordx4 v9, s[12:15], s28 offen offset:1024 sc1 lds
buffer_load_dwordx4 v10, s[12:15], s28 offen offset:2048 sc1 lds
buffer_load_dwordx4 v11, s[12:15], s28 offen offset:3072 sc1 lds
s_mov_b32 m0, s46
s_nop 0
buffer_load_dwordx4 v12, s[12:15], s29 offen offset:0 sc1 lds
buffer_load_dwordx4 v13, s[12:15], s29 offen offset:1024 sc1 lds
buffer_load_dwordx4 v14, s[12:15], s29 offen offset:2048 sc1 lds
buffer_load_dwordx4 v15, s[12:15], s29 offen offset:3072 sc1 lds
s_waitcnt vmcnt(0)
s_barrier
ds_read_b128 v[64:67], v16 offset:0
ds_read_b128 v[68:71], v17 offset:0
ds_read_b128 v[72:75], v18 offset:0
ds_read_b128 v[76:79], v19 offset:0
PL_180:
s_cmp_eq_u32 s24, 1
s_cbranch_scc1 PB_185
s_waitcnt lgkmcnt(3)
v_mfma_f32_32x32x16_bf16 v[24:39], v[64:67], a[0:3], 0
ds_read_b128 v[80:83], v20 offset:0
s_bitcmp1_b64 s[58:59], s21
s_cselect_b32 s34, s24, 0
s_cmp_lt_u32 s20, 18
s_cselect_b32 s34, 1, s34
s_cmp_lt_u32 s20, 64
s_cselect_b32 s34, s34, 0
s_waitcnt lgkmcnt(3)
v_mfma_f32_32x32x16_bf16 v[24:39], v[68:71], a[4:7], v[24:39]
ds_read_b128 v[84:87], v21 offset:0
s_cmp_ge_u32 s21, 64
s_cselect_b32 s37, 1, 0
s_min_u32 s35, s21, 63
buffer_store_dwordx4 v[40:43], v2, s[12:15], s48 offen offset:0 sc1
s_waitcnt lgkmcnt(3)
v_mfma_f32_32x32x16_bf16 v[24:39], v[72:75], a[8:11], v[24:39]
ds_read_b128 v[88:91], v22 offset:0
s_cmp_eq_u32 s34, 1
s_cselect_b32 s27, s20, s35
s_cselect_b32 s37, 0, s37
s_cselect_b32 s26, 0, 1
s_waitcnt lgkmcnt(3)
v_mfma_f32_32x32x16_bf16 v[24:39], v[76:79], a[12:15], v[24:39]
ds_read_b128 v[92:95], v23 offset:0
s_add_u32 s20, s20, s34
s_add_u32 s21, s21, s26
buffer_store_dwordx4 v[44:47], v2, s[12:15], s48 offen offset:512 sc1
s_waitcnt lgkmcnt(3)
v_mfma_f32_32x32x16_bf16 v[24:39], v[80:83], a[16:19], v[24:39]
ds_read_b128 v[64:67], v16 offset:256
s_lshl_b32 s28, s26, 6
s_add_u32 s28, s28, s27
s_lshl_b32 s28, s28, 15
s_add_u32 s28, s28, s47
s_waitcnt lgkmcnt(3)
v_mfma_f32_32x32x16_bf16 v[24:39], v[84:87], a[20:23], v[24:39]
ds_read_b128 v[68:71], v17 offset:256
s_add_u32 s28, s28, 136314880
s_add_u32 s29, s28, 4096
s_add_u32 s45, s44, s47
s_add_u32 s46, s45, 4096
buffer_store_dwordx4 v[48:51], v0, s[12:15], s49 offen sc1
s_waitcnt lgkmcnt(3)
v_mfma_f32_32x32x16_bf16 v[24:39], v[88:91], a[24:27], v[24:39]
ds_read_b128 v[72:75], v18 offset:256
s_waitcnt lgkmcnt(3)
v_mfma_f32_32x32x16_bf16 v[24:39], v[92:95], a[28:31], v[24:39]
ds_read_b128 v[76:79], v19 offset:256
s_waitcnt vmcnt(13)
v_mov_b32 v3, s55
buffer_store_dword v3, v136, s[12:15], s54 offen sc1
s_waitcnt lgkmcnt(3)
v_mfma_f32_32x32x16_bf16 v[24:39], v[64:67], a[32:35], v[24:39]
ds_read_b128 v[80:83], v20 offset:256
s_waitcnt lgkmcnt(3)
v_mfma_f32_32x32x16_bf16 v[24:39], v[68:71], a[36:39], v[24:39]
ds_read_b128 v[84:87], v21 offset:256
s_waitcnt lgkmcnt(3)
v_mfma_f32_32x32x16_bf16 v[24:39], v[72:75], a[40:43], v[24:39]
ds_read_b128 v[88:91], v22 offset:256
s_waitcnt lgkmcnt(3)
v_mfma_f32_32x32x16_bf16 v[24:39], v[76:79], a[44:47], v[24:39]
ds_read_b128 v[92:95], v23 offset:256
s_waitcnt lgkmcnt(3)
v_mfma_f32_32x32x16_bf16 v[24:39], v[80:83], a[48:51], v[24:39]
ds_read_b128 v[64:67], v16 offset:512
s_waitcnt lgkmcnt(3)
v_mfma_f32_32x32x16_bf16 v[24:39], v[84:87], a[52:55], v[24:39]
ds_read_b128 v[68:71], v17 offset:512
s_waitcnt lgkmcnt(3)
v_mfma_f32_32x32x16_bf16 v[24:39], v[88:91], a[56:59], v[24:39]
ds_read_b128 v[72:75], v18 offset:512
s_mov_b32 m0, s45
s_nop 0
buffer_load_dwordx4 v8, s[12:15], s28 offen offset:0 sc1 lds
s_waitcnt lgkmcnt(3)
v_mfma_f32_32x32x16_bf16 v[24:39], v[92:95], a[60:63], v[24:39]
ds_read_b128 v[76:79], v19 offset:512
s_lshl_b32 s34, s22, 5
s_add_u32 s34, s34, s16
s_lshl_b32 s34, s34, 6
s_add_u32 s34, s34, s23
s_waitcnt lgkmcnt(3)
v_mfma_f32_32x32x16_bf16 v[24:39], v[64:67], a[64:67], v[24:39]
ds_read_b128 v[80:83], v20 offset:512
buffer_load_dwordx4 v9, s[12:15], s28 offen offset:1024 sc1 lds
s_waitcnt lgkmcnt(3)
v_mfma_f32_32x32x16_bf16 v[24:39], v[68:71], a[68:71], v[24:39]
ds_read_b128 v[84:87], v21 offset:512
s_mul_i32 s38, s34, 24576
s_lshl_b32 s39, s34, 13
s_lshl_b32 s35, s19, 10
s_add_u32 s39, s39, s35
s_waitcnt lgkmcnt(3)
v_mfma_f32_32x32x16_bf16 v[24:39], v[72:75], a[72:75], v[24:39]
ds_read_b128 v[88:91], v22 offset:512
buffer_load_dwordx4 v10, s[12:15], s28 offen offset:2048 sc1 lds
s_waitcnt lgkmcnt(3)
v_mfma_f32_32x32x16_bf16 v[24:39], v[76:79], a[76:79], v[24:39]
ds_read_b128 v[92:95], v23 offset:512
s_add_u32 s39, s39, 100691968
s_cmp_ge_u32 s23, 61
s_cselect_b32 s39, s14, s39
s_waitcnt lgkmcnt(3)
v_mfma_f32_32x32x16_bf16 v[24:39], v[80:83], a[80:83], v[24:39]
ds_read_b128 v[64:67], v16 offset:768
buffer_load_dwordx4 v11, s[12:15], s28 offen offset:3072 sc1 lds
s_waitcnt lgkmcnt(3)
v_mfma_f32_32x32x16_bf16 v[24:39], v[84:87], a[84:87], v[24:39]
ds_read_b128 v[68:71], v17 offset:768
s_lshl_b32 s40, s22, 13
s_add_u32 s40, s40, s30
s_add_u32 s41, s23, 1
s_waitcnt lgkmcnt(3)
v_mfma_f32_32x32x16_bf16 v[24:39], v[88:91], a[88:91], v[24:39]
ds_read_b128 v[72:75], v18 offset:768
s_mov_b32 m0, s46
s_nop 0
buffer_load_dwordx4 v12, s[12:15], s29 offen offset:0 sc1 lds
s_waitcnt lgkmcnt(3)
v_mfma_f32_32x32x16_bf16 v[24:39], v[92:95], a[92:95], v[24:39]
ds_read_b128 v[76:79], v19 offset:768
s_mov_b32 s57, s43
s_mov_b32 s60, s36
s_cmp_lt_u32 s23, 2
s_cselect_b32 s61, 1, s22
s_waitcnt lgkmcnt(3)
v_mfma_f32_32x32x16_bf16 v[24:39], v[64:67], a[96:99], v[24:39]
ds_read_b128 v[80:83], v20 offset:768
buffer_load_dwordx4 v13, s[12:15], s29 offen offset:1024 sc1 lds
v_add_u32 v16, s57, v128
s_waitcnt lgkmcnt(3)
v_mfma_f32_32x32x16_bf16 v[24:39], v[68:71], a[100:103], v[24:39]
ds_read_b128 v[84:87], v21 offset:768
s_mov_b32 s22, s24
s_mov_b32 s23, s25
s_mov_b32 s24, s26
s_mov_b32 s25, s27
v_add_u32 v17, s57, v129
s_waitcnt lgkmcnt(3)
v_mfma_f32_32x32x16_bf16 v[24:39], v[72:75], a[104:107], v[24:39]
ds_read_b128 v[88:91], v22 offset:768
buffer_load_dwordx4 v14, s[12:15], s29 offen offset:2048 sc1 lds
v_add_u32 v18, s57, v130
s_waitcnt lgkmcnt(3)
v_mfma_f32_32x32x16_bf16 v[24:39], v[76:79], a[108:111], v[24:39]
ds_read_b128 v[92:95], v23 offset:768
s_mov_b32 s34, s42
s_mov_b32 s42, s43
s_mov_b32 s43, s44
s_mov_b32 s44, s34
s_mov_b32 s36, s37
v_add_u32_e64 v19, s57, v131
s_waitcnt lgkmcnt(3)
v_mfma_f32_32x32x16_bf16 v[24:39], v[80:83], a[112:115], v[24:39]
buffer_load_dwordx4 v15, s[12:15], s29 offen offset:3072 sc1 lds
v_add_u32 v20, s57, v132
s_cmp_eq_u32 s56, 1
s_cselect_b32 s54, s14, s31
s_cselect_b32 s31, s31, s14
s_mov_b32 s55, s32
s_waitcnt lgkmcnt(2)
v_mfma_f32_32x32x16_bf16 v[24:39], v[84:87], a[116:119], v[24:39]
v_add_u32_e64 v21, s57, v133
s_waitcnt vmcnt(13) lgkmcnt(0)
s_barrier
ds_read_b128 v[64:67], v16 offset:0
v_mfma_f32_32x32x16_bf16 v[24:39], v[88:91], a[120:123], v[24:39]
v_add_u32_e64 v22, s57, v134
ds_read_b128 v[68:71], v17 offset:0
ds_read_b128 v[72:75], v18 offset:0
s_cbranch_scc0 PF_186
s_waitcnt vmcnt(9)
PF_186:
v_mov_b32_e64 v3, s32
buffer_store_dword v3, v136, s[12:15], s31 offen sc1
v_mfma_f32_32x32x16_bf16 v[24:39], v[92:95], a[124:127], v[24:39]
v_add_u32_e64 v23, s57, v135
ds_read_b128 v[76:79], v19 offset:0
s_mov_b32 s48, s38
s_mov_b32 s49, s39
s_mov_b32 s31, s40
s_mov_b32 s32, s41
s_mov_b32 s56, s61
s_nop 4
v_cvt_pk_bf16_f32 v40, v24, v25
v_cvt_pk_bf16_f32 v41, v26, v27
v_cvt_pk_bf16_f32 v42, v28, v29
v_cvt_pk_bf16_f32 v43, v30, v31
v_cvt_pk_bf16_f32 v44, v32, v33
v_cvt_pk_bf16_f32 v45, v34, v35
v_cvt_pk_bf16_f32 v46, v36, v37
v_cvt_pk_bf16_f32 v47, v38, v39
s_branch PL_180
PB_185:
s_waitcnt lgkmcnt(3)
v_mfma_f32_32x32x16_bf16 v[24:39], v[64:67], a[0:3], 0
ds_read_b128 v[80:83], v20 offset:0
s_bitcmp1_b64 s[58:59], s21
s_cselect_b32 s34, s24, 0
s_cmp_lt_u32 s20, 18
s_cselect_b32 s34, 1, s34
s_cmp_lt_u32 s20, 64
s_cselect_b32 s34, s34, 0
s_waitcnt lgkmcnt(3)
v_mfma_f32_32x32x16_bf16 v[24:39], v[68:71], a[4:7], v[24:39]
ds_read_b128 v[84:87], v21 offset:0
s_cmp_ge_u32 s21, 64
s_cselect_b32 s37, 1, 0
s_min_u32 s35, s21, 63
buffer_store_dwordx4 v[40:43], v2, s[12:15], s48 offen offset:0 sc1
s_waitcnt lgkmcnt(3)
v_mfma_f32_32x32x16_bf16 v[24:39], v[72:75], a[8:11], v[24:39]
ds_read_b128 v[88:91], v22 offset:0
s_cmp_eq_u32 s34, 1
s_cselect_b32 s27, s20, s35
s_cselect_b32 s37, 0, s37
s_cselect_b32 s26, 0, 1
s_waitcnt lgkmcnt(3)
v_mfma_f32_32x32x16_bf16 v[24:39], v[76:79], a[12:15], v[24:39]
ds_read_b128 v[92:95], v23 offset:0
s_add_u32 s20, s20, s34
s_add_u32 s21, s21, s26
buffer_store_dwordx4 v[44:47], v2, s[12:15], s48 offen offset:512 sc1
s_waitcnt lgkmcnt(3)
v_mfma_f32_32x32x16_bf16 v[24:39], v[80:83], a[16:19], v[24:39]
ds_read_b128 v[64:67], v16 offset:256
s_lshl_b32 s28, s26, 6
s_add_u32 s28, s28, s27
s_lshl_b32 s28, s28, 15
s_add_u32 s28, s28, s47
s_waitcnt lgkmcnt(3)
v_mfma_f32_32x32x16_bf16 v[24:39], v[84:87], a[20:23], v[24:39]
ds_read_b128 v[68:71], v17 offset:256
s_add_u32 s28, s28, 136314880
s_add_u32 s29, s28, 4096
s_add_u32 s45, s44, s47
s_add_u32 s46, s45, 4096
buffer_store_dwordx4 v[48:51], v0, s[12:15], s49 offen sc1
s_waitcnt lgkmcnt(3)
v_mfma_f32_32x32x16_bf16 v[24:39], v[88:91], a[24:27], v[24:39]
ds_read_b128 v[72:75], v18 offset:256
v_add_u32 v1, s43, v54
s_waitcnt lgkmcnt(3)
v_mfma_f32_32x32x16_bf16 v[24:39], v[92:95], a[28:31], v[24:39]
ds_read_b128 v[76:79], v19 offset:256
s_waitcnt vmcnt(13)
v_mov_b32 v3, s55
buffer_store_dword v3, v136, s[12:15], s54 offen sc1
s_waitcnt lgkmcnt(3)
v_mfma_f32_32x32x16_bf16 v[24:39], v[64:67], a[32:35], v[24:39]
ds_read_b128 v[80:83], v20 offset:256
s_waitcnt lgkmcnt(3)
v_mfma_f32_32x32x16_bf16 v[24:39], v[68:71], a[36:39], v[24:39]
ds_read_b128 v[84:87], v21 offset:256
s_waitcnt vmcnt(5)
ds_read_b128 v[96:99], v1 offset:0
ds_read_b128 v[100:103], v1 offset:1024
ds_read_b128 v[104:107], v1 offset:2048
ds_read_b128 v[108:111], v1 offset:3072
s_waitcnt lgkmcnt(7)
v_mfma_f32_32x32x16_bf16 v[24:39], v[72:75], a[40:43], v[24:39]
ds_read_b128 v[88:91], v22 offset:256
ds_read_b128 v[112:115], v1 offset:4096
ds_read_b128 v[116:119], v1 offset:5120
ds_read_b128 v[120:123], v1 offset:6144
ds_read_b128 v[124:127], v1 offset:7168
s_waitcnt lgkmcnt(11)
v_mfma_f32_32x32x16_bf16 v[24:39], v[76:79], a[44:47], v[24:39]
ds_read_b128 v[92:95], v23 offset:256
s_waitcnt lgkmcnt(11)
v_mfma_f32_32x32x16_bf16 v[24:39], v[80:83], a[48:51], v[24:39]
ds_read_b128 v[64:67], v16 offset:512
s_waitcnt lgkmcnt(10)
v_max_u32 v4, v96, v98
s_waitcnt lgkmcnt(9)
v_max3_u32 v4, v4, v100, v102
s_waitcnt lgkmcnt(8)
v_max3_u32 v4, v4, v104, v106
s_waitcnt lgkmcnt(7)
v_max3_u32 v4, v4, v108, v110
s_waitcnt lgkmcnt(5)
v_max3_u32 v4, v4, v112, v114
v_mfma_f32_32x32x16_bf16 v[24:39], v[84:87], a[52:55], v[24:39]
ds_read_b128 v[68:71], v17 offset:512
s_waitcnt lgkmcnt(5)
v_max3_u32 v4, v4, v116, v118
s_waitcnt lgkmcnt(4)
v_max3_u32 v4, v4, v120, v122
s_waitcnt lgkmcnt(3)
v_max3_u32 v4, v4, v124, v126
v_cmp_eq_u32 vcc, -1, v4
v_mfma_f32_32x32x16_bf16 v[24:39], v[88:91], a[56:59], v[24:39]
ds_read_b128 v[72:75], v18 offset:512
s_cmp_lg_u64 vcc, 0
s_cselect_b32 s34, 1, 0
v_mov_b32_e64 v3, s34
ds_write_b32 v52, v3
s_mov_b32 m0, s45
s_nop 0
buffer_load_dwordx4 v8, s[12:15], s28 offen offset:0 sc1 lds
s_waitcnt lgkmcnt(4)
v_mfma_f32_32x32x16_bf16 v[24:39], v[92:95], a[60:63], v[24:39]
ds_read_b128 v[76:79], v19 offset:512
s_lshl_b32 s34, s22, 5
s_add_u32 s34, s34, s16
s_lshl_b32 s34, s34, 6
s_add_u32 s34, s34, s23
s_waitcnt lgkmcnt(4)
v_mfma_f32_32x32x16_bf16 v[24:39], v[64:67], a[64:67], v[24:39]
ds_read_b128 v[80:83], v20 offset:512
buffer_load_dwordx4 v9, s[12:15], s28 offen offset:1024 sc1 lds
s_waitcnt lgkmcnt(4)
v_mfma_f32_32x32x16_bf16 v[24:39], v[68:71], a[68:71], v[24:39]
ds_read_b128 v[84:87], v21 offset:512
s_mul_i32 s38, s34, 24576
s_lshl_b32 s39, s34, 13
s_lshl_b32 s35, s19, 10
s_add_u32 s39, s39, s35
s_waitcnt lgkmcnt(4)
v_mfma_f32_32x32x16_bf16 v[24:39], v[72:75], a[72:75], v[24:39]
ds_read_b128 v[88:91], v22 offset:512
buffer_load_dwordx4 v10, s[12:15], s28 offen offset:2048 sc1 lds
s_waitcnt lgkmcnt(3)
v_mfma_f32_32x32x16_bf16 v[24:39], v[76:79], a[76:79], v[24:39]
ds_read_b128 v[92:95], v23 offset:512
s_add_u32 s39, s39, 100691968
s_cmp_ge_u32 s23, 61
s_cselect_b32 s39, s14, s39
s_waitcnt lgkmcnt(3)
v_mfma_f32_32x32x16_bf16 v[24:39], v[80:83], a[80:83], v[24:39]
ds_read_b128 v[64:67], v16 offset:768
buffer_load_dwordx4 v11, s[12:15], s28 offen offset:3072 sc1 lds
s_waitcnt lgkmcnt(3)
v_mfma_f32_32x32x16_bf16 v[24:39], v[84:87], a[84:87], v[24:39]
ds_read_b128 v[68:71], v17 offset:768
s_lshl_b32 s40, s22, 13
s_add_u32 s40, s40, s30
s_add_u32 s41, s23, 1
s_waitcnt lgkmcnt(3)
v_mfma_f32_32x32x16_bf16 v[24:39], v[88:91], a[88:91], v[24:39]
ds_read_b128 v[72:75], v18 offset:768
s_mov_b32 m0, s46
s_nop 0
buffer_load_dwordx4 v12, s[12:15], s29 offen offset:0 sc1 lds
s_waitcnt lgkmcnt(3)
v_mfma_f32_32x32x16_bf16 v[24:39], v[92:95], a[92:95], v[24:39]
ds_read_b128 v[76:79], v19 offset:768
s_mov_b32 s57, s43
s_mov_b32 s60, s36
s_cmp_lt_u32 s23, 2
s_cselect_b32 s61, 1, s22
s_waitcnt lgkmcnt(3)
v_mfma_f32_32x32x16_bf16 v[24:39], v[64:67], a[96:99], v[24:39]
ds_read_b128 v[80:83], v20 offset:768
buffer_load_dwordx4 v13, s[12:15], s29 offen offset:1024 sc1 lds
v_add_u32 v16, s57, v128
s_waitcnt lgkmcnt(3)
v_mfma_f32_32x32x16_bf16 v[24:39], v[68:71], a[100:103], v[24:39]
ds_read_b128 v[84:87], v21 offset:768
s_mov_b32 s22, s24
s_mov_b32 s23, s25
s_mov_b32 s24, s26
s_mov_b32 s25, s27
v_add_u32 v17, s57, v129
s_waitcnt lgkmcnt(3)
v_mfma_f32_32x32x16_bf16 v[24:39], v[72:75], a[104:107], v[24:39]
ds_read_b128 v[88:91], v22 offset:768
buffer_load_dwordx4 v14, s[12:15], s29 offen offset:2048 sc1 lds
v_add_u32 v18, s57, v130
s_waitcnt lgkmcnt(3)
v_mfma_f32_32x32x16_bf16 v[24:39], v[76:79], a[108:111], v[24:39]
ds_read_b128 v[92:95], v23 offset:768
s_mov_b32 s34, s42
s_mov_b32 s42, s43
s_mov_b32 s43, s44
s_mov_b32 s44, s34
s_mov_b32 s36, s37
v_add_u32_e64 v19, s57, v131
s_waitcnt lgkmcnt(3)
v_mfma_f32_32x32x16_bf16 v[24:39], v[80:83], a[112:115], v[24:39]
buffer_load_dwordx4 v15, s[12:15], s29 offen offset:3072 sc1 lds
v_add_u32 v20, s57, v132
s_cmp_eq_u32 s56, 1
s_cselect_b32 s54, s14, s31
s_cselect_b32 s31, s31, s14
s_mov_b32 s55, s32
s_waitcnt lgkmcnt(2)
v_mfma_f32_32x32x16_bf16 v[24:39], v[84:87], a[116:119], v[24:39]
v_add_u32_e64 v21, s57, v133
s_waitcnt vmcnt(13) lgkmcnt(0)
s_barrier
ds_read_b128 v[96:99], v53
ds_read_b128 v[64:67], v16 offset:0
v_mfma_f32_32x32x16_bf16 v[24:39], v[88:91], a[120:123], v[24:39]
v_add_u32_e64 v22, s57, v134
ds_read_b128 v[68:71], v17 offset:0
ds_read_b128 v[72:75], v18 offset:0
s_cbranch_scc0 PF_187
s_waitcnt vmcnt(9)
PF_187:
v_mov_b32_e64 v3, s32
buffer_store_dword v3, v136, s[12:15], s31 offen sc1
v_mfma_f32_32x32x16_bf16 v[24:39], v[92:95], a[124:127], v[24:39]
v_add_u32 v23, s57, v135
ds_read_b128 v[76:79], v19 offset:0
s_waitcnt lgkmcnt(4)
v_or3_b32 v4, v96, v97, v98
v_or3_b32 v4, v4, v99, s60
v_cmp_ne_u32 vcc, 0, v4
v_xor_b32 v52, 16, v52
v_xor_b32_e64 v53, 16, v53
s_mov_b32 s48, s38
s_mov_b32 s49, s39
s_mov_b32 s31, s40
s_mov_b32 s32, s41
s_mov_b32 s56, s61
s_cbranch_vccnz PS_181
v_cvt_pk_bf16_f32 v40, v24, v25
v_cvt_pk_bf16_f32 v41, v26, v27
v_cvt_pk_bf16_f32 v42, v28, v29
v_cvt_pk_bf16_f32 v43, v30, v31
v_cvt_pk_bf16_f32 v44, v32, v33
v_cvt_pk_bf16_f32 v45, v34, v35
v_cvt_pk_bf16_f32 v46, v36, v37
v_cvt_pk_bf16_f32 v47, v38, v39
s_branch PL_180
PS_181:
s_lshl_b32 s28, s22, 6
s_add_u32 s28, s28, s23
s_lshl_b32 s28, s28, 15
s_add_u32 s28, s28, s47
s_add_u32 s28, s28, 136314880
s_add_u32 s29, s28, 4096
s_add_u32 s45, s42, s47
s_add_u32 s46, s45, 4096
s_mov_b32 m0, s45
s_nop 0
buffer_load_dwordx4 v8, s[12:15], s28 offen offset:0 sc1 lds
buffer_load_dwordx4 v9, s[12:15], s28 offen offset:1024 sc1 lds
buffer_load_dwordx4 v10, s[12:15], s28 offen offset:2048 sc1 lds
buffer_load_dwordx4 v11, s[12:15], s28 offen offset:3072 sc1 lds
s_mov_b32 m0, s46
s_nop 0
buffer_load_dwordx4 v12, s[12:15], s29 offen offset:0 sc1 lds
buffer_load_dwordx4 v13, s[12:15], s29 offen offset:1024 sc1 lds
buffer_load_dwordx4 v14, s[12:15], s29 offen offset:2048 sc1 lds
buffer_load_dwordx4 v15, s[12:15], s29 offen offset:3072 sc1 lds
v_cvt_pk_bf16_f32 v40, v24, v25
v_cvt_pk_bf16_f32 v41, v26, v27
v_cvt_pk_bf16_f32 v42, v28, v29
v_cvt_pk_bf16_f32 v43, v30, v31
buffer_store_dwordx4 v[40:43], v2, s[12:15], s48 offen offset:0 sc1
v_cvt_pk_bf16_f32 v44, v32, v33
v_cvt_pk_bf16_f32 v45, v34, v35
v_cvt_pk_bf16_f32 v46, v36, v37
v_cvt_pk_bf16_f32 v47, v38, v39
buffer_store_dwordx4 v[44:47], v2, s[12:15], s48 offen offset:512 sc1
buffer_store_dwordx4 v[48:51], v0, s[12:15], s49 offen sc1
s_mov_b32 s48, 268435456
s_mov_b32 s49, 268435456
s_mov_b32 s33, 0
s_waitcnt vmcnt(3)
s_cmp_eq_u32 s60, 1
s_cbranch_scc1 PFIN_184
PCHK_182:
ds_read_b128 v[96:99], v1 offset:0
ds_read_b128 v[100:103], v1 offset:1024
ds_read_b128 v[104:107], v1 offset:2048
ds_read_b128 v[108:111], v1 offset:3072
ds_read_b128 v[112:115], v1 offset:4096
ds_read_b128 v[116:119], v1 offset:5120
ds_read_b128 v[120:123], v1 offset:6144
ds_read_b128 v[124:127], v1 offset:7168
s_waitcnt lgkmcnt(7)
v_max_u32 v4, v96, v98
s_waitcnt lgkmcnt(6)
v_max3_u32 v4, v4, v100, v102
s_waitcnt lgkmcnt(5)
v_max3_u32 v4, v4, v104, v106
s_waitcnt lgkmcnt(4)
v_max3_u32 v4, v4, v108, v110
s_waitcnt lgkmcnt(3)
v_max3_u32 v4, v4, v112, v114
s_waitcnt lgkmcnt(2)
v_max3_u32 v4, v4, v116, v118
s_waitcnt lgkmcnt(1)
v_max3_u32 v4, v4, v120, v122
s_waitcnt lgkmcnt(0)
v_max3_u32 v4, v4, v124, v126
v_cmp_eq_u32 vcc, -1, v4
s_cbranch_vccz PGO_183
s_add_u32 s33, s33, 1
s_cmp_gt_u32 s33, 2097152
s_cbranch_scc1 FAIL
s_cmp_eq_u32 s31, s14
s_cbranch_scc1 PRE_188
s_waitcnt vmcnt(0)
v_mov_b32 v3, s55
buffer_store_dword v3, v136, s[12:15], s54 offen sc1
v_mov_b32 v3, s32
buffer_store_dword v3, v136, s[12:15], s31 offen sc1
s_mov_b32 s54, 268435456
s_mov_b32 s31, 268435456
PRE_188:
s_mov_b32 m0, s45
s_nop 0
buffer_load_dwordx4 v8, s[12:15], s28 offen offset:0 sc1 lds
buffer_load_dwordx4 v9, s[12:15], s28 offen offset:1024 sc1 lds
buffer_load_dwordx4 v10, s[12:15], s28 offen offset:2048 sc1 lds
buffer_load_dwordx4 v11, s[12:15], s28 offen offset:3072 sc1 lds
s_mov_b32 m0, s46
s_nop 0
buffer_load_dwordx4 v12, s[12:15], s29 offen offset:0 sc1 lds
buffer_load_dwordx4 v13, s[12:15], s29 offen offset:1024 sc1 lds
buffer_load_dwordx4 v14, s[12:15], s29 offen offset:2048 sc1 lds
buffer_load_dwordx4 v15, s[12:15], s29 offen offset:3072 sc1 lds
s_waitcnt vmcnt(0)
s_branch PCHK_182
PGO_183:
s_barrier
ds_read_b128 v[64:67], v16 offset:0
ds_read_b128 v[68:71], v17 offset:0
ds_read_b128 v[72:75], v18 offset:0
ds_read_b128 v[76:79], v19 offset:0
s_branch PL_180
PFIN_184:
s_waitcnt vmcnt(0)
v_mov_b32 v3, s55
buffer_store_dword v3, v136, s[12:15], s54 offen sc1
v_mov_b32_e64 v3, s32
buffer_store_dword v3, v136, s[12:15], s31 offen sc1
s_branch FIN
PM2:
v_lshrrev_b32 v3, 3, v5
v_lshlrev_b32_e64 v3, 11, v3
v_lshl_add_u32 v3, v6, 8, v3
v_bfe_u32 v4, v5, 2, 1
v_lshl_add_u32 v3, v4, 7, v3
v_and_b32 v4, 3, v5
v_lshl_add_u32 v3, v4, 4, v3
s_and_b32 s34, s19, 1
s_lshl_b32 s34, s34, 10
s_lshr_b32 s35, s19, 1
s_lshl_b32 s35, s35, 9
s_add_u32 s34, s34, s35
s_add_u32 s34, s34, 16384
s_mov_b32 s50, 0x33333333
s_mov_b32 s51, 0x33333333
v_add_u32 v2, s34, v3
s_lshl_b32 s30, s16, 8
s_lshl_b32 s34, s19, 4
s_add_u32 s30, s30, s34
s_add_u32 s30, s30, 159383680
s_mov_b32 s31, 268435456
s_mov_b32 s54, 268435456
s_mov_b32 s48, 268435456
s_mov_b32 s49, 268435456
s_mov_b32 s32, 0
s_mov_b32 s55, 0
s_mov_b32 s56, 0
s_mov_b32 s33, 0
s_lshl_b32 s47, s19, 13
s_mov_b32 s58, 0xfefefeff
s_mov_b32 s59, 0xfefefefe
s_mov_b32 s22, 0
s_mov_b32 s23, 0
s_mov_b32 s24, 0
s_mov_b32 s25, 1
s_mov_b32 s20, 2
s_mov_b32 s21, 0
s_mov_b32 s42, 0
s_mov_b32 s43, 32768
s_mov_b32 s44, 65536
s_mov_b32 s36, 0
s_lshl_b32 s28, s22, 6
s_add_u32 s28, s28, s23
s_lshl_b32 s28, s28, 15
s_add_u32 s28, s28, s47
s_add_u32 s28, s28, 136314880
s_add_u32 s29, s28, 4096
s_add_u32 s45, s42, s47
s_add_u32 s46, s45, 4096
s_mov_b32 m0, s45
s_nop 0
buffer_load_dwordx4 v8, s[12:15], s28 offen offset:0 sc1 lds
buffer_load_dwordx4 v9, s[12:15], s28 offen offset:1024 sc1 lds
buffer_load_dwordx4 v10, s[12:15], s28 offen offset:2048 sc1 lds
buffer_load_dwordx4 v11, s[12:15], s28 offen offset:3072 sc1 lds
s_mov_b32 m0, s46
s_nop 0
buffer_load_dwordx4 v12, s[12:15], s29 offen offset:0 sc1 lds
buffer_load_dwordx4 v13, s[12:15], s29 offen offset:1024 sc1 lds
buffer_load_dwordx4 v14, s[12:15], s29 offen offset:2048 sc1 lds
buffer_load_dwordx4 v15, s[12:15], s29 offen offset:3072 sc1 lds
s_lshl_b32 s28, s24, 6
s_add_u32 s28, s28, s25
s_lshl_b32 s28, s28, 15
s_add_u32 s28, s28, s47
s_add_u32 s28, s28, 136314880
s_add_u32 s29, s28, 4096
s_add_u32 s45, s43, s47
s_add_u32 s46, s45, 4096
s_mov_b32 m0, s45
s_nop 0
buffer_load_dwordx4 v8, s[12:15], s28 offen offset:0 sc1 lds
buffer_load_dwordx4 v9, s[12:15], s28 offen offset:1024 sc1 lds
buffer_load_dwordx4 v10, s[12:15], s28 offen offset:2048 sc1 lds
buffer_load_dwordx4 v11, s[12:15], s28 offen offset:3072 sc1 lds
s_mov_b32 m0, s46
s_nop 0
buffer_load_dwordx4 v12, s[12:15], s29 offen offset:0 sc1 lds
buffer_load_dwordx4 v13, s[12:15], s29 offen offset:1024 sc1 lds
buffer_load_dwordx4 v14, s[12:15], s29 offen offset:2048 sc1 lds
buffer_load_dwordx4 v15, s[12:15], s29 offen offset:3072 sc1 lds
s_waitcnt vmcnt(0)
s_barrier
ds_read_b128 v[64:67], v16 offset:0
ds_read_b128 v[68:71], v17 offset:0
ds_read_b128 v[72:75], v18 offset:0
ds_read_b128 v[76:79], v19 offset:0
PL_189:
s_cmp_eq_u32 s24, 1
s_cbranch_scc1 PB_194
s_waitcnt lgkmcnt(3)
v_mfma_f32_32x32x16_bf16 v[24:39], a[0:3], v[64:67], 0
ds_read_b128 v[80:83], v20 offset:0
s_bitcmp1_b64 s[58:59], s21
s_cselect_b32 s34, s24, 0
s_cmp_lt_u32 s20, 18
s_cselect_b32 s34, 1, s34
s_cmp_lt_u32 s20, 64
s_cselect_b32 s34, s34, 0
s_waitcnt lgkmcnt(3)
v_mfma_f32_32x32x16_bf16 v[24:39], a[4:7], v[68:71], v[24:39]
ds_read_b128 v[84:87], v21 offset:0
s_cmp_ge_u32 s21, 64
s_cselect_b32 s37, 1, 0
s_min_u32 s35, s21, 63
buffer_store_dwordx4 v[40:43], v2, s[12:15], s48 offen offset:0 sc1
s_waitcnt lgkmcnt(3)
v_mfma_f32_32x32x16_bf16 v[24:39], a[8:11], v[72:75], v[24:39]
ds_read_b128 v[88:91], v22 offset:0
s_cmp_eq_u32 s34, 1
s_cselect_b32 s27, s20, s35
s_cselect_b32 s37, 0, s37
s_cselect_b32 s26, 0, 1
s_waitcnt lgkmcnt(3)
v_mfma_f32_32x32x16_bf16 v[24:39], a[12:15], v[76:79], v[24:39]
ds_read_b128 v[92:95], v23 offset:0
s_add_u32 s20, s20, s34
s_add_u32 s21, s21, s26
buffer_store_dwordx4 v[44:47], v2, s[12:15], s48 offen offset:64 sc1
s_waitcnt lgkmcnt(3)
v_mfma_f32_32x32x16_bf16 v[24:39], a[16:19], v[80:83], v[24:39]
ds_read_b128 v[64:67], v16 offset:256
s_lshl_b32 s28, s26, 6
s_add_u32 s28, s28, s27
s_lshl_b32 s28, s28, 15
s_add_u32 s28, s28, s47
s_waitcnt lgkmcnt(3)
v_mfma_f32_32x32x16_bf16 v[24:39], a[20:23], v[84:87], v[24:39]
ds_read_b128 v[68:71], v17 offset:256
s_add_u32 s28, s28, 136314880
s_add_u32 s29, s28, 4096
s_add_u32 s45, s44, s47
s_add_u32 s46, s45, 4096
s_waitcnt lgkmcnt(3)
v_mfma_f32_32x32x16_bf16 v[24:39], a[24:27], v[88:91], v[24:39]
ds_read_b128 v[72:75], v18 offset:256
s_waitcnt lgkmcnt(3)
v_mfma_f32_32x32x16_bf16 v[24:39], a[28:31], v[92:95], v[24:39]
ds_read_b128 v[76:79], v19 offset:256
s_waitcnt vmcnt(12)
v_mov_b32 v3, s55
buffer_store_dword v3, v136, s[12:15], s54 offen sc1
s_waitcnt lgkmcnt(3)
v_mfma_f32_32x32x16_bf16 v[24:39], a[32:35], v[64:67], v[24:39]
ds_read_b128 v[80:83], v20 offset:256
s_waitcnt lgkmcnt(3)
v_mfma_f32_32x32x16_bf16 v[24:39], a[36:39], v[68:71], v[24:39]
ds_read_b128 v[84:87], v21 offset:256
s_waitcnt lgkmcnt(3)
v_mfma_f32_32x32x16_bf16 v[24:39], a[40:43], v[72:75], v[24:39]
ds_read_b128 v[88:91], v22 offset:256
s_waitcnt lgkmcnt(3)
v_mfma_f32_32x32x16_bf16 v[24:39], a[44:47], v[76:79], v[24:39]
ds_read_b128 v[92:95], v23 offset:256
s_waitcnt lgkmcnt(3)
v_mfma_f32_32x32x16_bf16 v[24:39], a[48:51], v[80:83], v[24:39]
ds_read_b128 v[64:67], v16 offset:512
s_waitcnt lgkmcnt(3)
v_mfma_f32_32x32x16_bf16 v[24:39], a[52:55], v[84:87], v[24:39]
ds_read_b128 v[68:71], v17 offset:512
s_waitcnt lgkmcnt(3)
v_mfma_f32_32x32x16_bf16 v[24:39], a[56:59], v[88:91], v[24:39]
ds_read_b128 v[72:75], v18 offset:512
s_mov_b32 m0, s45
s_nop 0
buffer_load_dwordx4 v8, s[12:15], s28 offen offset:0 sc1 lds
s_waitcnt lgkmcnt(3)
v_mfma_f32_32x32x16_bf16 v[24:39], a[60:63], v[92:95], v[24:39]
ds_read_b128 v[76:79], v19 offset:512
s_lshl_b32 s34, s22, 5
s_add_u32 s34, s34, s16
s_lshl_b32 s34, s34, 6
s_add_u32 s34, s34, s23
s_waitcnt lgkmcnt(3)
v_mfma_f32_32x32x16_bf16 v[24:39], a[64:67], v[64:67], v[24:39]
ds_read_b128 v[80:83], v20 offset:512
buffer_load_dwordx4 v9, s[12:15], s28 offen offset:1024 sc1 lds
s_waitcnt lgkmcnt(3)
v_mfma_f32_32x32x16_bf16 v[24:39], a[68:71], v[68:71], v[24:39]
ds_read_b128 v[84:87], v21 offset:512
s_mul_i32 s38, s34, 24576
s_lshl_b32 s39, s34, 13
s_lshl_b32 s35, s19, 10
s_add_u32 s39, s39, s35
s_waitcnt lgkmcnt(3)
v_mfma_f32_32x32x16_bf16 v[24:39], a[72:75], v[72:75], v[24:39]
ds_read_b128 v[88:91], v22 offset:512
buffer_load_dwordx4 v10, s[12:15], s28 offen offset:2048 sc1 lds
s_waitcnt lgkmcnt(3)
v_mfma_f32_32x32x16_bf16 v[24:39], a[76:79], v[76:79], v[24:39]
ds_read_b128 v[92:95], v23 offset:512
s_add_u32 s39, s39, 100696064
s_cmp_ge_u32 s23, 61
s_cselect_b32 s39, s14, s39
s_waitcnt lgkmcnt(3)
v_mfma_f32_32x32x16_bf16 v[24:39], a[80:83], v[80:83], v[24:39]
ds_read_b128 v[64:67], v16 offset:768
buffer_load_dwordx4 v11, s[12:15], s28 offen offset:3072 sc1 lds
s_waitcnt lgkmcnt(3)
v_mfma_f32_32x32x16_bf16 v[24:39], a[84:87], v[84:87], v[24:39]
ds_read_b128 v[68:71], v17 offset:768
s_lshl_b32 s40, s22, 13
s_add_u32 s40, s40, s30
s_add_u32 s41, s23, 1
s_waitcnt lgkmcnt(3)
v_mfma_f32_32x32x16_bf16 v[24:39], a[88:91], v[88:91], v[24:39]
ds_read_b128 v[72:75], v18 offset:768
s_mov_b32 m0, s46
s_nop 0
buffer_load_dwordx4 v12, s[12:15], s29 offen offset:0 sc1 lds
s_waitcnt lgkmcnt(3)
v_mfma_f32_32x32x16_bf16 v[24:39], a[92:95], v[92:95], v[24:39]
ds_read_b128 v[76:79], v19 offset:768
s_mov_b32 s57, s43
s_mov_b32 s60, s36
s_cmp_lt_u32 s23, 2
s_cselect_b32 s61, 1, s22
s_waitcnt lgkmcnt(3)
v_mfma_f32_32x32x16_bf16 v[24:39], a[96:99], v[64:67], v[24:39]
ds_read_b128 v[80:83], v20 offset:768
buffer_load_dwordx4 v13, s[12:15], s29 offen offset:1024 sc1 lds
v_add_u32 v16, s57, v128
s_waitcnt lgkmcnt(3)
v_mfma_f32_32x32x16_bf16 v[24:39], a[100:103], v[68:71], v[24:39]
ds_read_b128 v[84:87], v21 offset:768
s_mov_b32 s22, s24
s_mov_b32 s23, s25
s_mov_b32 s24, s26
s_mov_b32 s25, s27
v_add_u32 v17, s57, v129
s_waitcnt lgkmcnt(3)
v_mfma_f32_32x32x16_bf16 v[24:39], a[104:107], v[72:75], v[24:39]
ds_read_b128 v[88:91], v22 offset:768
buffer_load_dwordx4 v14, s[12:15], s29 offen offset:2048 sc1 lds
v_add_u32_e64 v18, s57, v130
s_waitcnt lgkmcnt(3)
v_mfma_f32_32x32x16_bf16 v[24:39], a[108:111], v[76:79], v[24:39]
ds_read_b128 v[92:95], v23 offset:768
s_mov_b32 s34, s42
s_mov_b32 s42, s43
s_mov_b32 s43, s44
s_mov_b32 s44, s34
s_mov_b32 s36, s37
v_add_u32 v19, s57, v131
s_waitcnt lgkmcnt(3)
v_mfma_f32_32x32x16_bf16 v[24:39], a[112:115], v[80:83], v[24:39]
buffer_load_dwordx4 v15, s[12:15], s29 offen offset:3072 sc1 lds
v_add_u32 v20, s57, v132
s_cmp_eq_u32 s56, 1
s_cselect_b32 s54, s14, s31
s_cselect_b32 s31, s31, s14
s_mov_b32 s55, s32
s_waitcnt lgkmcnt(2)
v_mfma_f32_32x32x16_bf16 v[24:39], a[116:119], v[84:87], v[24:39]
v_add_u32 v21, s57, v133
s_waitcnt vmcnt(12) lgkmcnt(0)
s_barrier
ds_read_b128 v[64:67], v16 offset:0
v_mfma_f32_32x32x16_bf16 v[24:39], a[120:123], v[88:91], v[24:39]
v_add_u32 v22, s57, v134
ds_read_b128 v[68:71], v17 offset:0
ds_read_b128 v[72:75], v18 offset:0
s_cbranch_scc0 PF_195
s_waitcnt vmcnt(9)
PF_195:
v_mov_b32_e64 v3, s32
buffer_store_dword v3, v136, s[12:15], s31 offen sc1
v_mfma_f32_32x32x16_bf16 v[24:39], a[124:127], v[92:95], v[24:39]
v_add_u32_e64 v23, s57, v135
ds_read_b128 v[76:79], v19 offset:0
s_mov_b32 s48, s38
s_mov_b32 s49, s39
s_mov_b32 s31, s40
s_mov_b32 s32, s41
s_mov_b32 s56, s61
s_nop 4
v_cvt_pk_bf16_f32 v96, v24, v25
v_cvt_pk_bf16_f32 v97, v26, v27
v_cvt_pk_bf16_f32 v98, v28, v29
v_cvt_pk_bf16_f32 v99, v30, v31
v_cvt_pk_bf16_f32 v100, v32, v33
v_cvt_pk_bf16_f32 v101, v34, v35
v_cvt_pk_bf16_f32 v102, v36, v37
v_cvt_pk_bf16_f32 v103, v38, v39
s_mov_b64 vcc, s[50:51]
v_cndmask_b32_dpp v40, v96, v100, vcc quad_perm:[0,1,0,1] row_mask:0xf bank_mask:0xf
v_cndmask_b32_dpp v41, v97, v101, vcc quad_perm:[0,1,0,1] row_mask:0xf bank_mask:0xf
v_cndmask_b32_dpp v42, v98, v102, vcc quad_perm:[0,1,0,1] row_mask:0xf bank_mask:0xf
v_cndmask_b32_dpp v43, v99, v103, vcc quad_perm:[0,1,0,1] row_mask:0xf bank_mask:0xf
s_not_b64 vcc, vcc
v_cndmask_b32_dpp v44, v100, v96, vcc quad_perm:[2,3,2,3] row_mask:0xf bank_mask:0xf
v_cndmask_b32_dpp v45, v101, v97, vcc quad_perm:[2,3,2,3] row_mask:0xf bank_mask:0xf
v_cndmask_b32_dpp v46, v102, v98, vcc quad_perm:[2,3,2,3] row_mask:0xf bank_mask:0xf
v_cndmask_b32_dpp v47, v103, v99, vcc quad_perm:[2,3,2,3] row_mask:0xf bank_mask:0xf
s_branch PL_189
PB_194:
s_waitcnt lgkmcnt(3)
v_mfma_f32_32x32x16_bf16 v[24:39], a[0:3], v[64:67], 0
ds_read_b128 v[80:83], v20 offset:0
s_bitcmp1_b64 s[58:59], s21
s_cselect_b32 s34, s24, 0
s_cmp_lt_u32 s20, 18
s_cselect_b32 s34, 1, s34
s_cmp_lt_u32 s20, 64
s_cselect_b32 s34, s34, 0
s_waitcnt lgkmcnt(3)
v_mfma_f32_32x32x16_bf16 v[24:39], a[4:7], v[68:71], v[24:39]
ds_read_b128 v[84:87], v21 offset:0
s_cmp_ge_u32 s21, 64
s_cselect_b32 s37, 1, 0
s_min_u32 s35, s21, 63
buffer_store_dwordx4 v[40:43], v2, s[12:15], s48 offen offset:0 sc1
s_waitcnt lgkmcnt(3)
v_mfma_f32_32x32x16_bf16 v[24:39], a[8:11], v[72:75], v[24:39]
ds_read_b128 v[88:91], v22 offset:0
s_cmp_eq_u32 s34, 1
s_cselect_b32 s27, s20, s35
s_cselect_b32 s37, 0, s37
s_cselect_b32 s26, 0, 1
s_waitcnt lgkmcnt(3)
v_mfma_f32_32x32x16_bf16 v[24:39], a[12:15], v[76:79], v[24:39]
ds_read_b128 v[92:95], v23 offset:0
s_add_u32 s20, s20, s34
s_add_u32 s21, s21, s26
buffer_store_dwordx4 v[44:47], v2, s[12:15], s48 offen offset:64 sc1
s_waitcnt lgkmcnt(3)
v_mfma_f32_32x32x16_bf16 v[24:39], a[16:19], v[80:83], v[24:39]
ds_read_b128 v[64:67], v16 offset:256
s_lshl_b32 s28, s26, 6
s_add_u32 s28, s28, s27
s_lshl_b32 s28, s28, 15
s_add_u32 s28, s28, s47
s_waitcnt lgkmcnt(3)
v_mfma_f32_32x32x16_bf16 v[24:39], a[20:23], v[84:87], v[24:39]
ds_read_b128 v[68:71], v17 offset:256
s_add_u32 s28, s28, 136314880
s_add_u32 s29, s28, 4096
s_add_u32 s45, s44, s47
s_add_u32 s46, s45, 4096
s_waitcnt lgkmcnt(3)
v_mfma_f32_32x32x16_bf16 v[24:39], a[24:27], v[88:91], v[24:39]
ds_read_b128 v[72:75], v18 offset:256
v_add_u32 v1, s43, v54
s_waitcnt lgkmcnt(3)
v_mfma_f32_32x32x16_bf16 v[24:39], a[28:31], v[92:95], v[24:39]
ds_read_b128 v[76:79], v19 offset:256
s_waitcnt vmcnt(12)
v_mov_b32 v3, s55
buffer_store_dword v3, v136, s[12:15], s54 offen sc1
s_waitcnt lgkmcnt(3)
v_mfma_f32_32x32x16_bf16 v[24:39], a[32:35], v[64:67], v[24:39]
ds_read_b128 v[80:83], v20 offset:256
s_waitcnt lgkmcnt(3)
v_mfma_f32_32x32x16_bf16 v[24:39], a[36:39], v[68:71], v[24:39]
ds_read_b128 v[84:87], v21 offset:256
s_waitcnt vmcnt(4)
ds_read_b128 v[96:99], v1 offset:0
ds_read_b128 v[100:103], v1 offset:1024
ds_read_b128 v[104:107], v1 offset:2048
ds_read_b128 v[108:111], v1 offset:3072
s_waitcnt lgkmcnt(7)
v_mfma_f32_32x32x16_bf16 v[24:39], a[40:43], v[72:75], v[24:39]
ds_read_b128 v[88:91], v22 offset:256
ds_read_b128 v[112:115], v1 offset:4096
ds_read_b128 v[116:119], v1 offset:5120
ds_read_b128 v[120:123], v1 offset:6144
ds_read_b128 v[124:127], v1 offset:7168
s_waitcnt lgkmcnt(11)
v_mfma_f32_32x32x16_bf16 v[24:39], a[44:47], v[76:79], v[24:39]
ds_read_b128 v[92:95], v23 offset:256
s_waitcnt lgkmcnt(11)
v_mfma_f32_32x32x16_bf16 v[24:39], a[48:51], v[80:83], v[24:39]
ds_read_b128 v[64:67], v16 offset:512
s_waitcnt lgkmcnt(10)
v_max_u32 v4, v96, v98
s_waitcnt lgkmcnt(9)
v_max3_u32 v4, v4, v100, v102
s_waitcnt lgkmcnt(8)
v_max3_u32 v4, v4, v104, v106
s_waitcnt lgkmcnt(7)
v_max3_u32 v4, v4, v108, v110
s_waitcnt lgkmcnt(5)
v_max3_u32 v4, v4, v112, v114
v_mfma_f32_32x32x16_bf16 v[24:39], a[52:55], v[84:87], v[24:39]
ds_read_b128 v[68:71], v17 offset:512
s_waitcnt lgkmcnt(5)
v_max3_u32 v4, v4, v116, v118
s_waitcnt lgkmcnt(4)
v_max3_u32 v4, v4, v120, v122
s_waitcnt lgkmcnt(3)
v_max3_u32 v4, v4, v124, v126
v_cmp_eq_u32 vcc, -1, v4
v_mfma_f32_32x32x16_bf16 v[24:39], a[56:59], v[88:91], v[24:39]
ds_read_b128 v[72:75], v18 offset:512
s_cmp_lg_u64 vcc, 0
s_cselect_b32 s34, 1, 0
v_mov_b32_e64 v3, s34
ds_write_b32 v52, v3
s_mov_b32 m0, s45
s_nop 0
buffer_load_dwordx4 v8, s[12:15], s28 offen offset:0 sc1 lds
s_waitcnt lgkmcnt(4)
v_mfma_f32_32x32x16_bf16 v[24:39], a[60:63], v[92:95], v[24:39]
ds_read_b128 v[76:79], v19 offset:512
s_lshl_b32 s34, s22, 5
s_add_u32 s34, s34, s16
s_lshl_b32 s34, s34, 6
s_add_u32 s34, s34, s23
s_waitcnt lgkmcnt(4)
v_mfma_f32_32x32x16_bf16 v[24:39], a[64:67], v[64:67], v[24:39]
ds_read_b128 v[80:83], v20 offset:512
buffer_load_dwordx4 v9, s[12:15], s28 offen offset:1024 sc1 lds
s_waitcnt lgkmcnt(4)
v_mfma_f32_32x32x16_bf16 v[24:39], a[68:71], v[68:71], v[24:39]
ds_read_b128 v[84:87], v21 offset:512
s_mul_i32 s38, s34, 24576
s_lshl_b32 s39, s34, 13
s_lshl_b32 s35, s19, 10
s_add_u32 s39, s39, s35
s_waitcnt lgkmcnt(4)
v_mfma_f32_32x32x16_bf16 v[24:39], a[72:75], v[72:75], v[24:39]
ds_read_b128 v[88:91], v22 offset:512
buffer_load_dwordx4 v10, s[12:15], s28 offen offset:2048 sc1 lds
s_waitcnt lgkmcnt(3)
v_mfma_f32_32x32x16_bf16 v[24:39], a[76:79], v[76:79], v[24:39]
ds_read_b128 v[92:95], v23 offset:512
s_add_u32 s39, s39, 100696064
s_cmp_ge_u32 s23, 61
s_cselect_b32 s39, s14, s39
s_waitcnt lgkmcnt(3)
v_mfma_f32_32x32x16_bf16 v[24:39], a[80:83], v[80:83], v[24:39]
ds_read_b128 v[64:67], v16 offset:768
buffer_load_dwordx4 v11, s[12:15], s28 offen offset:3072 sc1 lds
s_waitcnt lgkmcnt(3)
v_mfma_f32_32x32x16_bf16 v[24:39], a[84:87], v[84:87], v[24:39]
ds_read_b128 v[68:71], v17 offset:768
s_lshl_b32 s40, s22, 13
s_add_u32 s40, s40, s30
s_add_u32 s41, s23, 1
s_waitcnt lgkmcnt(3)
v_mfma_f32_32x32x16_bf16 v[24:39], a[88:91], v[88:91], v[24:39]
ds_read_b128 v[72:75], v18 offset:768
s_mov_b32 m0, s46
s_nop 0
buffer_load_dwordx4 v12, s[12:15], s29 offen offset:0 sc1 lds
s_waitcnt lgkmcnt(3)
v_mfma_f32_32x32x16_bf16 v[24:39], a[92:95], v[92:95], v[24:39]
ds_read_b128 v[76:79], v19 offset:768
s_mov_b32 s57, s43
s_mov_b32 s60, s36
s_cmp_lt_u32 s23, 2
s_cselect_b32 s61, 1, s22
s_waitcnt lgkmcnt(3)
v_mfma_f32_32x32x16_bf16 v[24:39], a[96:99], v[64:67], v[24:39]
ds_read_b128 v[80:83], v20 offset:768
buffer_load_dwordx4 v13, s[12:15], s29 offen offset:1024 sc1 lds
v_add_u32 v16, s57, v128
s_waitcnt lgkmcnt(3)
v_mfma_f32_32x32x16_bf16 v[24:39], a[100:103], v[68:71], v[24:39]
ds_read_b128 v[84:87], v21 offset:768
s_mov_b32 s22, s24
s_mov_b32 s23, s25
s_mov_b32 s24, s26
s_mov_b32 s25, s27
v_add_u32 v17, s57, v129
s_waitcnt lgkmcnt(3)
v_mfma_f32_32x32x16_bf16 v[24:39], a[104:107], v[72:75], v[24:39]
ds_read_b128 v[88:91], v22 offset:768
buffer_load_dwordx4 v14, s[12:15], s29 offen offset:2048 sc1 lds
v_add_u32 v18, s57, v130
s_waitcnt lgkmcnt(3)
v_mfma_f32_32x32x16_bf16 v[24:39], a[108:111], v[76:79], v[24:39]
ds_read_b128 v[92:95], v23 offset:768
s_mov_b32 s34, s42
s_mov_b32 s42, s43
s_mov_b32 s43, s44
s_mov_b32 s44, s34
s_mov_b32 s36, s37
v_add_u32_e64 v19, s57, v131
s_waitcnt lgkmcnt(3)
v_mfma_f32_32x32x16_bf16 v[24:39], a[112:115], v[80:83], v[24:39]
buffer_load_dwordx4 v15, s[12:15], s29 offen offset:3072 sc1 lds
v_add_u32 v20, s57, v132
s_cmp_eq_u32 s56, 1
s_cselect_b32 s54, s14, s31
s_cselect_b32 s31, s31, s14
s_mov_b32 s55, s32
s_waitcnt lgkmcnt(2)
v_mfma_f32_32x32x16_bf16 v[24:39], a[116:119], v[84:87], v[24:39]
v_add_u32_e64 v21, s57, v133
s_waitcnt vmcnt(12) lgkmcnt(0)
s_barrier
ds_read_b128 v[96:99], v53
ds_read_b128 v[64:67], v16 offset:0
v_mfma_f32_32x32x16_bf16 v[24:39], a[120:123], v[88:91], v[24:39]
v_add_u32_e64 v22, s57, v134
ds_read_b128 v[68:71], v17 offset:0
ds_read_b128 v[72:75], v18 offset:0
s_cbranch_scc0 PF_196
s_waitcnt vmcnt(9)
PF_196:
v_mov_b32_e64 v3, s32
buffer_store_dword v3, v136, s[12:15], s31 offen sc1
v_mfma_f32_32x32x16_bf16 v[24:39], a[124:127], v[92:95], v[24:39]
v_add_u32 v23, s57, v135
ds_read_b128 v[76:79], v19 offset:0
s_waitcnt lgkmcnt(4)
v_or3_b32 v4, v96, v97, v98
v_or3_b32 v4, v4, v99, s60
v_cmp_ne_u32 vcc, 0, v4
v_xor_b32 v52, 16, v52
v_xor_b32_e64 v53, 16, v53
s_mov_b32 s48, s38
s_mov_b32 s49, s39
s_mov_b32 s31, s40
s_mov_b32 s32, s41
s_mov_b32 s56, s61
s_cbranch_vccnz PS_190
v_cvt_pk_bf16_f32 v96, v24, v25
v_cvt_pk_bf16_f32 v97, v26, v27
v_cvt_pk_bf16_f32 v98, v28, v29
v_cvt_pk_bf16_f32 v99, v30, v31
v_cvt_pk_bf16_f32 v100, v32, v33
v_cvt_pk_bf16_f32 v101, v34, v35
v_cvt_pk_bf16_f32 v102, v36, v37
v_cvt_pk_bf16_f32 v103, v38, v39
s_mov_b64 vcc, s[50:51]
v_cndmask_b32_dpp v40, v96, v100, vcc quad_perm:[0,1,0,1] row_mask:0xf bank_mask:0xf
v_cndmask_b32_dpp v41, v97, v101, vcc quad_perm:[0,1,0,1] row_mask:0xf bank_mask:0xf
v_cndmask_b32_dpp v42, v98, v102, vcc quad_perm:[0,1,0,1] row_mask:0xf bank_mask:0xf
v_cndmask_b32_dpp v43, v99, v103, vcc quad_perm:[0,1,0,1] row_mask:0xf bank_mask:0xf
s_not_b64 vcc, vcc
v_cndmask_b32_dpp v44, v100, v96, vcc quad_perm:[2,3,2,3] row_mask:0xf bank_mask:0xf
v_cndmask_b32_dpp v45, v101, v97, vcc quad_perm:[2,3,2,3] row_mask:0xf bank_mask:0xf
v_cndmask_b32_dpp v46, v102, v98, vcc quad_perm:[2,3,2,3] row_mask:0xf bank_mask:0xf
v_cndmask_b32_dpp v47, v103, v99, vcc quad_perm:[2,3,2,3] row_mask:0xf bank_mask:0xf
s_branch PL_189
PS_190:
s_lshl_b32 s28, s22, 6
s_add_u32 s28, s28, s23
s_lshl_b32 s28, s28, 15
s_add_u32 s28, s28, s47
s_add_u32 s28, s28, 136314880
s_add_u32 s29, s28, 4096
s_add_u32 s45, s42, s47
s_add_u32 s46, s45, 4096
s_mov_b32 m0, s45
s_nop 0
buffer_load_dwordx4 v8, s[12:15], s28 offen offset:0 sc1 lds
buffer_load_dwordx4 v9, s[12:15], s28 offen offset:1024 sc1 lds
buffer_load_dwordx4 v10, s[12:15], s28 offen offset:2048 sc1 lds
buffer_load_dwordx4 v11, s[12:15], s28 offen offset:3072 sc1 lds
s_mov_b32 m0, s46
s_nop 0
buffer_load_dwordx4 v12, s[12:15], s29 offen offset:0 sc1 lds
buffer_load_dwordx4 v13, s[12:15], s29 offen offset:1024 sc1 lds
buffer_load_dwordx4 v14, s[12:15], s29 offen offset:2048 sc1 lds
buffer_load_dwordx4 v15, s[12:15], s29 offen offset:3072 sc1 lds
v_cvt_pk_bf16_f32 v96, v24, v25
v_cvt_pk_bf16_f32 v97, v26, v27
v_cvt_pk_bf16_f32 v98, v28, v29
v_cvt_pk_bf16_f32 v99, v30, v31
v_cvt_pk_bf16_f32 v100, v32, v33
v_cvt_pk_bf16_f32 v101, v34, v35
v_cvt_pk_bf16_f32 v102, v36, v37
v_cvt_pk_bf16_f32 v103, v38, v39
s_mov_b64 vcc, s[50:51]
v_cndmask_b32_dpp v40, v96, v100, vcc quad_perm:[0,1,0,1] row_mask:0xf bank_mask:0xf
v_cndmask_b32_dpp v41, v97, v101, vcc quad_perm:[0,1,0,1] row_mask:0xf bank_mask:0xf
v_cndmask_b32_dpp v42, v98, v102, vcc quad_perm:[0,1,0,1] row_mask:0xf bank_mask:0xf
v_cndmask_b32_dpp v43, v99, v103, vcc quad_perm:[0,1,0,1] row_mask:0xf bank_mask:0xf
buffer_store_dwordx4 v[40:43], v2, s[12:15], s48 offen offset:0 sc1
s_not_b64 vcc, vcc
v_cndmask_b32_dpp v44, v100, v96, vcc quad_perm:[2,3,2,3] row_mask:0xf bank_mask:0xf
v_cndmask_b32_dpp v45, v101, v97, vcc quad_perm:[2,3,2,3] row_mask:0xf bank_mask:0xf
v_cndmask_b32_dpp v46, v102, v98, vcc quad_perm:[2,3,2,3] row_mask:0xf bank_mask:0xf
v_cndmask_b32_dpp v47, v103, v99, vcc quad_perm:[2,3,2,3] row_mask:0xf bank_mask:0xf
buffer_store_dwordx4 v[44:47], v2, s[12:15], s48 offen offset:64 sc1
s_mov_b32 s48, 268435456
s_mov_b32 s49, 268435456
s_mov_b32 s33, 0
s_waitcnt vmcnt(2)
s_cmp_eq_u32 s60, 1
s_cbranch_scc1 PFIN_193
PCHK_191:
ds_read_b128 v[96:99], v1 offset:0
ds_read_b128 v[100:103], v1 offset:1024
ds_read_b128 v[104:107], v1 offset:2048
ds_read_b128 v[108:111], v1 offset:3072
ds_read_b128 v[112:115], v1 offset:4096
ds_read_b128 v[116:119], v1 offset:5120
ds_read_b128 v[120:123], v1 offset:6144
ds_read_b128 v[124:127], v1 offset:7168
s_waitcnt lgkmcnt(7)
v_max_u32_e64 v4, v96, v98
s_waitcnt lgkmcnt(6)
v_max3_u32 v4, v4, v100, v102
s_waitcnt lgkmcnt(5)
v_max3_u32 v4, v4, v104, v106
s_waitcnt lgkmcnt(4)
v_max3_u32 v4, v4, v108, v110
s_waitcnt lgkmcnt(3)
v_max3_u32 v4, v4, v112, v114
s_waitcnt lgkmcnt(2)
v_max3_u32 v4, v4, v116, v118
s_waitcnt lgkmcnt(1)
v_max3_u32 v4, v4, v120, v122
s_waitcnt lgkmcnt(0)
v_max3_u32 v4, v4, v124, v126
v_cmp_eq_u32_e64 vcc, -1, v4
s_cbranch_vccz PGO_192
s_add_u32 s33, s33, 1
s_cmp_gt_u32 s33, 2097152
s_cbranch_scc1 FAIL
s_cmp_eq_u32 s31, s14
s_cbranch_scc1 PRE_197
s_waitcnt vmcnt(0)
v_mov_b32_e64 v3, s55
buffer_store_dword v3, v136, s[12:15], s54 offen sc1
v_mov_b32_e64 v3, s32
buffer_store_dword v3, v136, s[12:15], s31 offen sc1
s_mov_b32 s54, 268435456
s_mov_b32 s31, 268435456
PRE_197:
s_mov_b32 m0, s45
s_nop 0
buffer_load_dwordx4 v8, s[12:15], s28 offen offset:0 sc1 lds
buffer_load_dwordx4 v9, s[12:15], s28 offen offset:1024 sc1 lds
buffer_load_dwordx4 v10, s[12:15], s28 offen offset:2048 sc1 lds
buffer_load_dwordx4 v11, s[12:15], s28 offen offset:3072 sc1 lds
s_mov_b32 m0, s46
s_nop 0
buffer_load_dwordx4 v12, s[12:15], s29 offen offset:0 sc1 lds
buffer_load_dwordx4 v13, s[12:15], s29 offen offset:1024 sc1 lds
buffer_load_dwordx4 v14, s[12:15], s29 offen offset:2048 sc1 lds
buffer_load_dwordx4 v15, s[12:15], s29 offen offset:3072 sc1 lds
s_waitcnt vmcnt(0)
s_branch PCHK_191
PGO_192:
s_barrier
ds_read_b128 v[64:67], v16 offset:0
ds_read_b128 v[68:71], v17 offset:0
ds_read_b128 v[72:75], v18 offset:0
ds_read_b128 v[76:79], v19 offset:0
s_branch PL_189
PFIN_193:
s_waitcnt vmcnt(0)
v_mov_b32 v3, s55
buffer_store_dword v3, v136, s[12:15], s54 offen sc1
v_mov_b32_e64 v3, s32
buffer_store_dword v3, v136, s[12:15], s31 offen sc1
s_branch FIN
FAIL:
s_load_dwordx2 s[8:9], s[0:1], 88
s_mov_b64 exec, 1
v_mov_b32 v2, 80
v_mov_b32 v3, 1
s_waitcnt lgkmcnt(0)
global_atomic_add v2, v3, s[8:9]
s_waitcnt vmcnt(0)
s_endpgm
FIN:
DONE:
CODE_END:
s_endpgm
.section .rodata,"a"
.p2align 6
.amdhsa_kernel interleave_layers__memory_aug_recurrent_mem_tr__sliding_local_dilated__prompt_kernel
  .amdhsa_next_free_vgpr 512
  .amdhsa_next_free_sgpr 102
  .amdhsa_accum_offset 256
  .amdhsa_group_segment_fixed_size 0
  .amdhsa_kernarg_size 104
  .amdhsa_user_sgpr_count 2
  .amdhsa_user_sgpr_kernarg_segment_ptr 1
  .amdhsa_system_sgpr_workgroup_id_x 1
  .amdhsa_float_denorm_mode_32 3
.end_amdhsa_kernel
```
